```python
import torch

def _softmax(x, axis=-1):
    return torch.softmax(x, dim=axis)

def _gelu(x):
    return torch.nn.functional.gelu(x, approximate='tanh')

def _silu(x):
    return torch.nn.functional.silu(x)

def _sigmoid(x):
    return torch.sigmoid(x)

def _layernorm(x, axis=-1, eps=1e-05):
    m = x.mean(dim=axis, keepdim=True)
    v = x.var(dim=axis, keepdim=True, unbiased=False)
    return (x - m) / torch.sqrt(v + eps)

def _scatter_add(tgt, idx, src, axis=0):
    return tgt.clone().index_add_(axis, idx, src)

def _segment_sum(src, seg, n):
    out = torch.zeros((n,) + src.shape[1:], dtype=src.dtype)
    return out.index_add_(0, seg, src)

def _pad(x, pw):
    flat = tuple((v for pair in reversed(pw) for v in pair))
    return torch.nn.functional.pad(x, flat)
kernel_name = 'parallel_sum__memory_aug_recurrent_mem_tr__glu_gated_glu__prompt'

def setup_inputs():

    _w = lambda a: (lambda t: t.to(torch.bfloat16) if t.is_floating_point() else t)(torch.as_tensor(a))

    def _A_setup():
        B, S, Dm = (1, 2048, 512)
        H, Dh = (32, 128)
        M, seg = (8, 32)
        seg = min(seg, S)
        S = S // seg * seg
        return {'x': _w((lambda *s: torch.randn(*s, dtype=torch.bfloat16) * 0.05)(B, S, Dm)), 'mem0': _w((lambda *s: torch.randn(*s, dtype=torch.bfloat16) * 1.6)(B, M, Dm)), 'Wq': _w((lambda *s: torch.randn(*s, dtype=torch.bfloat16) * 0.8)(Dm, H, Dh) * Dm ** (-0.5)), 'Wk': _w((lambda *s: torch.randn(*s, dtype=torch.bfloat16) * 0.8)(Dm, H, Dh) * Dm ** (-0.5)), 'Wv': _w((lambda *s: torch.randn(*s, dtype=torch.bfloat16) * 1.6)(Dm, H, Dh) * Dm ** (-0.5)), 'Wo': _w((lambda *s: torch.randn(*s, dtype=torch.bfloat16) * 1.6)(H, Dh, Dm) * (H * Dh) ** (-0.5)), 'seg_len': seg}
    _A_in = _A_setup()

    def _B_setup():
        B, S, D, F = (1, 2048, 512, 1792)
        return {'x': _w((lambda *s: torch.randn(*s, dtype=torch.bfloat16) * 0.05)(B, S, D)), 'w_gate': _w((lambda *s: torch.randn(*s, dtype=torch.bfloat16) * 0.05)(D, F)), 'w_up': _w((lambda *s: torch.randn(*s, dtype=torch.bfloat16) * 0.05)(D, F)), 'w_down': _w((lambda *s: torch.randn(*s, dtype=torch.bfloat16) * 0.05)(F, D))}
    _B_in = _B_setup()
    return {'A_x': _A_in['x'], 'A_mem0': _A_in['mem0'], 'A_Wq': _A_in['Wq'], 'A_Wk': _A_in['Wk'], 'A_Wv': _A_in['Wv'], 'A_Wo': _A_in['Wo'], 'A_seg_len': _A_in['seg_len'], 'B_x': _B_in['x'], 'B_w_gate': _B_in['w_gate'], 'B_w_up': _B_in['w_up'], 'B_w_down': _B_in['w_down']}

def reference(A_x, A_mem0, A_Wq, A_Wk, A_Wv, A_Wo, A_seg_len, B_x, B_w_gate, B_w_up, B_w_down):

    def _A_ref(x, mem0, Wq, Wk, Wv, Wo, seg_len):
        B, S, Dm = x.shape
        H, Dh = (Wq.shape[1], Wq.shape[2])
        M = mem0.shape[1]
        scale = Dh ** (-0.5)
        n_seg = S // seg_len
        L = M + seg_len
        idx = torch.arange(L)
        mask = (idx[:, None] < M) | (idx[:, None] >= idx[None, :])
        mem = mem0
        outs = []
        for s in range(n_seg):
            xs = x[:, s * seg_len:(s + 1) * seg_len, :].clone()
            h = torch.concatenate([mem, xs], axis=1)
            q = torch.einsum('btd,dhe->bhte', h, Wq)
            k = torch.einsum('btd,dhe->bhte', h, Wk)
            v = torch.einsum('btd,dhe->bhte', h, Wv)
            scores = torch.einsum('bhqe,bhke->bhqk', q, k) * scale
            scores = torch.where(mask[None, None], scores, -1000000000.0)
            p = _softmax(scores, axis=-1)
            o = torch.einsum('bhqk,bhke->bhqe', p, v)
            o = torch.einsum('bhte,hed->btd', o, Wo)
            mem = o[:, :M, :].clone()
            outs.append(o[:, M:, :])
        return torch.concatenate(outs, axis=1)

    def _B_ref(x, w_gate, w_up, w_down):
        g = torch.einsum('bsd,df->bsf', x, w_gate)
        u = torch.einsum('bsd,df->bsf', x, w_up)
        h = _sigmoid(g) * u
        return torch.einsum('bsf,fd->bsd', h, w_down)
    x = A_x
    xn = _layernorm(x, axis=-1)
    return x + _A_ref(xn, A_mem0, A_Wq, A_Wk, A_Wv, A_Wo, A_seg_len) + _B_ref(xn, B_w_gate, B_w_up, B_w_down)
```

```asm
; @launch kernel=prep_kernel grid=(3112,1,1) block=(256,1,1) lds=8704
; @launch kernel=chain_kernel grid=(256,1,1) block=(256,1,1) lds=163840
.amdgcn_target "amdgcn-amd-amdhsa--gfx950"
.text
.globl prep_kernel
.p2align 8
.type prep_kernel,@function
prep_kernel:
    s_cmp_ge_u32 s2, 3112
    s_cbranch_scc1 L_prep_done
    s_load_dwordx2 s[4:5], s[0:1], 104
    s_cmp_ge_u32 s2, 2984
    s_cbranch_scc1 L_prep_ln
    s_cmp_ge_u32 s2, 2720
    s_cbranch_scc1 L_prep_zero
    s_mov_b32 s6, s2
    s_cmp_lt_u32 s6, 1536
    s_cbranch_scc1 L_prep_qkv
    s_cmp_lt_u32 s6, 2048
    s_cbranch_scc1 L_prep_wo
    s_cmp_lt_u32 s6, 2272
    s_cbranch_scc1 L_prep_wg
    s_cmp_lt_u32 s6, 2496
    s_cbranch_scc1 L_prep_wu
    s_load_dwordx2 s[20:21], s[0:1], 80
    s_sub_u32 s7, s6, 2496
    s_lshr_b32 s16, s7, 2
    s_and_b32 s17, s7, 3
    s_lshl_b32 s19, s16, 15
    s_lshl_b32 s23, s17, 13
    s_add_u32 s19, s19, s23
    s_add_u32 s19, s19, 0x1400000
    s_lshl_b32 s16, s16, 5
    s_lshl_b32 s17, s17, 7
    s_mov_b32 s18, 1024
    s_mov_b32 s27, 1024
    s_mov_b32 s22, 1835008
    s_branch L_prep_go
L_prep_qkv:
    s_lshr_b32 s7, s6, 9
    s_lshl_b32 s7, s7, 3
    s_add_u32 s7, s7, 16
    s_load_dwordx2 s[20:21], s[0:1], s7
    s_and_b32 s16, s6, 15
    s_lshr_b32 s7, s6, 4
    s_lshl_b32 s19, s7, 17
    s_lshl_b32 s23, s16, 10
    s_add_u32 s19, s19, s23
    s_lshl_b32 s16, s16, 5
    s_and_b32 s17, s7, 31
    s_lshl_b32 s17, s17, 7
    s_mov_b32 s18, 8192
    s_mov_b32 s27, 16384
    s_mov_b32 s22, 4194304
    s_branch L_prep_go
L_prep_wo:
    s_load_dwordx2 s[20:21], s[0:1], 40
    s_sub_u32 s7, s6, 1536
    s_lshr_b32 s16, s7, 2
    s_and_b32 s17, s7, 3
    s_lshr_b32 s23, s16, 2
    s_lshl_b32 s19, s23, 17
    s_lshl_b32 s23, s17, 15
    s_add_u32 s19, s19, s23
    s_and_b32 s23, s16, 3
    s_lshl_b32 s23, s23, 10
    s_add_u32 s19, s19, s23
    s_add_u32 s19, s19, 0xc00000
    s_lshl_b32 s16, s16, 5
    s_lshl_b32 s17, s17, 7
    s_mov_b32 s18, 1024
    s_mov_b32 s27, 4096
    s_mov_b32 s22, 4194304
    s_branch L_prep_go
L_prep_wg:
    s_load_dwordx2 s[20:21], s[0:1], 64
    s_sub_u32 s7, s6, 2048
    s_mov_b32 s24, 0x1000000
    s_branch L_prep_gu
L_prep_wu:
    s_load_dwordx2 s[20:21], s[0:1], 72
    s_sub_u32 s7, s6, 2272
    s_mov_b32 s24, 0x1200000
L_prep_gu:
    s_and_b32 s16, s7, 15
    s_lshr_b32 s17, s7, 4
    s_lshl_b32 s19, s17, 17
    s_lshl_b32 s23, s16, 10
    s_add_u32 s19, s19, s23
    s_add_u32 s19, s19, s24
    s_lshl_b32 s16, s16, 5
    s_lshl_b32 s17, s17, 7
    s_mov_b32 s18, 3584
    s_mov_b32 s27, 16384
    s_mov_b32 s22, 1835008
L_prep_go:
    s_waitcnt lgkmcnt(0)
    s_mov_b32 s8, s20
    s_and_b32 s9, s21, 0xffff
    s_mov_b32 s10, s22
    s_mov_b32 s11, 0x00020000
    s_mov_b32 s12, s4
    s_and_b32 s13, s5, 0xffff
    s_mov_b32 s14, 0x10000000
    s_mov_b32 s15, 0x00020000
    v_lshrrev_b32 v1, 3, v0
    v_and_b32 v2, 7, v0
    v_mul_lo_u32 v3, v1, s18
    v_lshl_add_u32 v3, v2, 5, v3
    s_mul_i32 s25, s16, s18
    s_lshl_b32 s26, s17, 1
    s_add_u32 s25, s25, s26
    buffer_load_dwordx4 v[8:11], v3, s[8:11], s25 offen
    buffer_load_dwordx4 v[12:15], v3, s[8:11], s25 offen offset:16
    v_mul_u32_u24 v4, 272, v1
    v_lshl_add_u32 v4, v2, 5, v4
    v_and_b32 v5, 63, v0
    v_lshrrev_b32 v6, 4, v5
    v_bfe_u32 v7, v5, 2, 2
    v_lshl_add_u32 v6, v6, 2, v7
    v_mul_u32_u24 v6, 272, v6
    v_and_b32 v7, 3, v5
    v_lshl_add_u32 v6, v7, 3, v6
    v_lshrrev_b32 v7, 6, v0
    v_lshl_add_u32 v6, v7, 6, v6
    v_readfirstlane_b32 s3, v7
    v_lshlrev_b32 v5, 4, v5
    s_waitcnt vmcnt(0)
    ds_write_b128 v4, v[8:11]
    ds_write_b128 v4, v[12:15] offset:16
    s_waitcnt lgkmcnt(0)
    s_barrier
    ds_read_b64_tr_b16 v[16:17], v6 offset:0
    ds_read_b64_tr_b16 v[18:19], v6 offset:4352
    ds_read_b64_tr_b16 v[20:21], v6 offset:32
    ds_read_b64_tr_b16 v[22:23], v6 offset:4384
    s_lshl_b32 s3, s3, 1
    s_mul_i32 s3, s3, s27
    s_add_u32 s19, s19, s3
    s_add_u32 s20, s19, s27
    s_waitcnt lgkmcnt(2)
    buffer_store_dwordx4 v[16:19], v5, s[12:15], s19 offen
    s_waitcnt lgkmcnt(0)
    buffer_store_dwordx4 v[20:23], v5, s[12:15], s20 offen
    s_branch L_prep_done
L_prep_zero:
    s_waitcnt lgkmcnt(0)
    s_mov_b32 s12, s4
    s_and_b32 s13, s5, 0xffff
    s_mov_b32 s14, 0x10000000
    s_mov_b32 s15, 0x00020000
    s_sub_u32 s6, s2, 2720
    s_lshl_b32 s6, s6, 12
    s_add_u32 s6, s6, 0x7800000
    v_lshlrev_b32 v4, 4, v0
    v_mov_b32 v8, -1
    v_mov_b32 v9, -1
    v_mov_b32 v10, -1
    v_mov_b32 v11, -1
    buffer_store_dwordx4 v[8:11], v4, s[12:15], s6 offen
    s_branch L_prep_done
L_prep_ln:
    s_load_dwordx2 s[20:21], s[0:1], 0
    v_lshrrev_b32 v1, 6, v0
    s_nop 1
    v_readfirstlane_b32 s18, v1
    v_and_b32 v1, 63, v0
    v_lshlrev_b32 v2, 4, v1
    s_sub_u32 s6, s2, 2984
    s_lshl_b32 s6, s6, 2
    s_add_u32 s6, s6, s18
    s_waitcnt lgkmcnt(0)
    s_mov_b32 s8, s20
    s_and_b32 s9, s21, 0xffff
    s_mov_b32 s10, 0x200000
    s_mov_b32 s11, 0x00020000
    s_mov_b32 s12, s4
    s_and_b32 s13, s5, 0xffff
    s_mov_b32 s14, 0x10000000
    s_mov_b32 s15, 0x00020000
    s_lshl_b32 s19, s6, 12
    buffer_load_dwordx4 v[32:35], v2, s[8:11], s19 offen offset:0
    buffer_load_dwordx4 v[36:39], v2, s[8:11], s19 offen offset:1024
    buffer_load_dwordx4 v[40:43], v2, s[8:11], s19 offen offset:2048
    buffer_load_dwordx4 v[44:47], v2, s[8:11], s19 offen offset:3072
    v_lshrrev_b32 v21, 2, v1
    v_lshlrev_b32 v21, 10, v21
    v_and_b32 v22, 1, v1
    v_lshlrev_b32 v22, 9, v22
    v_add_u32 v21, v21, v22
    v_bfe_u32 v22, v1, 1, 1
    v_lshl_add_u32 v21, v22, 3, v21
    s_lshr_b32 s19, s6, 2
    s_lshl_b32 s19, s19, 14
    s_and_b32 s20, s6, 3
    s_lshl_b32 s20, s20, 6
    s_add_u32 s19, s19, s20
    s_add_u32 s19, s19, 0x7e00000
    s_mov_b32 s21, 0x3b000000
    s_mov_b32 s22, 0x3727c5ac
    s_waitcnt vmcnt(0)
    v_lshlrev_b32 v48, 16, v32
    v_and_b32 v49, 0xffff0000, v32
    v_lshlrev_b32 v50, 16, v33
    v_and_b32 v51, 0xffff0000, v33
    v_lshlrev_b32 v52, 16, v34
    v_and_b32 v53, 0xffff0000, v34
    v_lshlrev_b32 v54, 16, v35
    v_and_b32 v55, 0xffff0000, v35
    v_lshlrev_b32 v64, 16, v36
    v_and_b32 v65, 0xffff0000, v36
    v_lshlrev_b32 v66, 16, v37
    v_and_b32 v67, 0xffff0000, v37
    v_lshlrev_b32 v68, 16, v38
    v_and_b32 v69, 0xffff0000, v38
    v_lshlrev_b32 v70, 16, v39
    v_and_b32 v71, 0xffff0000, v39
    v_lshlrev_b32 v80, 16, v40
    v_and_b32 v81, 0xffff0000, v40
    v_lshlrev_b32 v82, 16, v41
    v_and_b32 v83, 0xffff0000, v41
    v_lshlrev_b32 v84, 16, v42
    v_and_b32 v85, 0xffff0000, v42
    v_lshlrev_b32 v86, 16, v43
    v_and_b32 v87, 0xffff0000, v43
    v_lshlrev_b32 v96, 16, v44
    v_and_b32 v97, 0xffff0000, v44
    v_lshlrev_b32 v98, 16, v45
    v_and_b32 v99, 0xffff0000, v45
    v_lshlrev_b32 v100, 16, v46
    v_and_b32 v101, 0xffff0000, v46
    v_lshlrev_b32 v102, 16, v47
    v_and_b32 v103, 0xffff0000, v47
    v_add_f32 v56, v48, v49
    v_add_f32 v72, v64, v65
    v_add_f32 v88, v80, v81
    v_add_f32 v104, v96, v97
    v_add_f32 v56, v56, v50
    v_add_f32 v72, v72, v66
    v_add_f32 v88, v88, v82
    v_add_f32 v104, v104, v98
    v_add_f32 v56, v56, v51
    v_add_f32 v72, v72, v67
    v_add_f32 v88, v88, v83
    v_add_f32 v104, v104, v99
    v_add_f32 v56, v56, v52
    v_add_f32 v72, v72, v68
    v_add_f32 v88, v88, v84
    v_add_f32 v104, v104, v100
    v_add_f32 v56, v56, v53
    v_add_f32 v72, v72, v69
    v_add_f32 v88, v88, v85
    v_add_f32 v104, v104, v101
    v_add_f32 v56, v56, v54
    v_add_f32 v72, v72, v70
    v_add_f32 v88, v88, v86
    v_add_f32 v104, v104, v102
    v_add_f32 v56, v56, v55
    v_add_f32 v72, v72, v71
    v_add_f32 v88, v88, v87
    v_add_f32 v104, v104, v103
    v_add_f32_dpp v56, v56, v56 quad_perm:[1,0,3,2] row_mask:0xf bank_mask:0xf
    v_add_f32_dpp v72, v72, v72 quad_perm:[1,0,3,2] row_mask:0xf bank_mask:0xf
    v_add_f32_dpp v88, v88, v88 quad_perm:[1,0,3,2] row_mask:0xf bank_mask:0xf
    v_add_f32_dpp v104, v104, v104 quad_perm:[1,0,3,2] row_mask:0xf bank_mask:0xf
    v_add_f32_dpp v56, v56, v56 quad_perm:[2,3,0,1] row_mask:0xf bank_mask:0xf
    v_add_f32_dpp v72, v72, v72 quad_perm:[2,3,0,1] row_mask:0xf bank_mask:0xf
    v_add_f32_dpp v88, v88, v88 quad_perm:[2,3,0,1] row_mask:0xf bank_mask:0xf
    v_add_f32_dpp v104, v104, v104 quad_perm:[2,3,0,1] row_mask:0xf bank_mask:0xf
    v_add_f32_dpp v56, v56, v56 row_half_mirror row_mask:0xf bank_mask:0xf
    v_add_f32_dpp v72, v72, v72 row_half_mirror row_mask:0xf bank_mask:0xf
    v_add_f32_dpp v88, v88, v88 row_half_mirror row_mask:0xf bank_mask:0xf
    v_add_f32_dpp v104, v104, v104 row_half_mirror row_mask:0xf bank_mask:0xf
    v_add_f32_dpp v56, v56, v56 row_mirror row_mask:0xf bank_mask:0xf
    v_add_f32_dpp v72, v72, v72 row_mirror row_mask:0xf bank_mask:0xf
    v_add_f32_dpp v88, v88, v88 row_mirror row_mask:0xf bank_mask:0xf
    v_add_f32_dpp v104, v104, v104 row_mirror row_mask:0xf bank_mask:0xf
    v_mov_b32 v59, v56
    v_mov_b32 v75, v72
    v_mov_b32 v91, v88
    v_mov_b32 v107, v104
    v_permlane16_swap_b32 v56, v59
    v_permlane16_swap_b32 v72, v75
    v_permlane16_swap_b32 v88, v91
    v_permlane16_swap_b32 v104, v107
    v_add_f32 v56, v56, v59
    v_add_f32 v72, v72, v75
    v_add_f32 v88, v88, v91
    v_add_f32 v104, v104, v107
    v_mov_b32 v59, v56
    v_mov_b32 v75, v72
    v_mov_b32 v91, v88
    v_mov_b32 v107, v104
    v_permlane32_swap_b32 v56, v59
    v_permlane32_swap_b32 v72, v75
    v_permlane32_swap_b32 v88, v91
    v_permlane32_swap_b32 v104, v107
    v_add_f32 v56, v56, v59
    v_add_f32 v72, v72, v75
    v_add_f32 v88, v88, v91
    v_add_f32 v104, v104, v107
    v_mul_f32 v57, s21, v56
    v_mul_f32 v73, s21, v72
    v_mul_f32 v89, s21, v88
    v_mul_f32 v105, s21, v104
    v_sub_f32 v59, v48, v57
    v_sub_f32 v75, v64, v73
    v_sub_f32 v91, v80, v89
    v_sub_f32 v107, v96, v105
    v_mul_f32 v58, v59, v59
    v_mul_f32 v74, v75, v75
    v_mul_f32 v90, v91, v91
    v_mul_f32 v106, v107, v107
    v_sub_f32 v59, v49, v57
    v_sub_f32 v75, v65, v73
    v_sub_f32 v91, v81, v89
    v_sub_f32 v107, v97, v105
    v_fmac_f32 v58, v59, v59
    v_fmac_f32 v74, v75, v75
    v_fmac_f32 v90, v91, v91
    v_fmac_f32 v106, v107, v107
    v_sub_f32 v59, v50, v57
    v_sub_f32 v75, v66, v73
    v_sub_f32 v91, v82, v89
    v_sub_f32 v107, v98, v105
    v_fmac_f32 v58, v59, v59
    v_fmac_f32 v74, v75, v75
    v_fmac_f32 v90, v91, v91
    v_fmac_f32 v106, v107, v107
    v_sub_f32 v59, v51, v57
    v_sub_f32 v75, v67, v73
    v_sub_f32 v91, v83, v89
    v_sub_f32 v107, v99, v105
    v_fmac_f32 v58, v59, v59
    v_fmac_f32 v74, v75, v75
    v_fmac_f32 v90, v91, v91
    v_fmac_f32 v106, v107, v107
    v_sub_f32 v59, v52, v57
    v_sub_f32 v75, v68, v73
    v_sub_f32 v91, v84, v89
    v_sub_f32 v107, v100, v105
    v_fmac_f32 v58, v59, v59
    v_fmac_f32 v74, v75, v75
    v_fmac_f32 v90, v91, v91
    v_fmac_f32 v106, v107, v107
    v_sub_f32 v59, v53, v57
    v_sub_f32 v75, v69, v73
    v_sub_f32 v91, v85, v89
    v_sub_f32 v107, v101, v105
    v_fmac_f32 v58, v59, v59
    v_fmac_f32 v74, v75, v75
    v_fmac_f32 v90, v91, v91
    v_fmac_f32 v106, v107, v107
    v_sub_f32 v59, v54, v57
    v_sub_f32 v75, v70, v73
    v_sub_f32 v91, v86, v89
    v_sub_f32 v107, v102, v105
    v_fmac_f32 v58, v59, v59
    v_fmac_f32 v74, v75, v75
    v_fmac_f32 v90, v91, v91
    v_fmac_f32 v106, v107, v107
    v_sub_f32 v59, v55, v57
    v_sub_f32 v75, v71, v73
    v_sub_f32 v91, v87, v89
    v_sub_f32 v107, v103, v105
    v_fmac_f32 v58, v59, v59
    v_fmac_f32 v74, v75, v75
    v_fmac_f32 v90, v91, v91
    v_fmac_f32 v106, v107, v107
    v_add_f32_dpp v58, v58, v58 quad_perm:[1,0,3,2] row_mask:0xf bank_mask:0xf
    v_add_f32_dpp v74, v74, v74 quad_perm:[1,0,3,2] row_mask:0xf bank_mask:0xf
    v_add_f32_dpp v90, v90, v90 quad_perm:[1,0,3,2] row_mask:0xf bank_mask:0xf
    v_add_f32_dpp v106, v106, v106 quad_perm:[1,0,3,2] row_mask:0xf bank_mask:0xf
    v_add_f32_dpp v58, v58, v58 quad_perm:[2,3,0,1] row_mask:0xf bank_mask:0xf
    v_add_f32_dpp v74, v74, v74 quad_perm:[2,3,0,1] row_mask:0xf bank_mask:0xf
    v_add_f32_dpp v90, v90, v90 quad_perm:[2,3,0,1] row_mask:0xf bank_mask:0xf
    v_add_f32_dpp v106, v106, v106 quad_perm:[2,3,0,1] row_mask:0xf bank_mask:0xf
    v_add_f32_dpp v58, v58, v58 row_half_mirror row_mask:0xf bank_mask:0xf
    v_add_f32_dpp v74, v74, v74 row_half_mirror row_mask:0xf bank_mask:0xf
    v_add_f32_dpp v90, v90, v90 row_half_mirror row_mask:0xf bank_mask:0xf
    v_add_f32_dpp v106, v106, v106 row_half_mirror row_mask:0xf bank_mask:0xf
    v_add_f32_dpp v58, v58, v58 row_mirror row_mask:0xf bank_mask:0xf
    v_add_f32_dpp v74, v74, v74 row_mirror row_mask:0xf bank_mask:0xf
    v_add_f32_dpp v90, v90, v90 row_mirror row_mask:0xf bank_mask:0xf
    v_add_f32_dpp v106, v106, v106 row_mirror row_mask:0xf bank_mask:0xf
    v_mov_b32 v59, v58
    v_mov_b32 v75, v74
    v_mov_b32 v91, v90
    v_mov_b32 v107, v106
    v_permlane16_swap_b32 v58, v59
    v_permlane16_swap_b32 v74, v75
    v_permlane16_swap_b32 v90, v91
    v_permlane16_swap_b32 v106, v107
    v_add_f32 v58, v58, v59
    v_add_f32 v74, v74, v75
    v_add_f32 v90, v90, v91
    v_add_f32 v106, v106, v107
    v_mov_b32 v59, v58
    v_mov_b32 v75, v74
    v_mov_b32 v91, v90
    v_mov_b32 v107, v106
    v_permlane32_swap_b32 v58, v59
    v_permlane32_swap_b32 v74, v75
    v_permlane32_swap_b32 v90, v91
    v_permlane32_swap_b32 v106, v107
    v_add_f32 v58, v58, v59
    v_add_f32 v74, v74, v75
    v_add_f32 v90, v90, v91
    v_add_f32 v106, v106, v107
    v_mul_f32 v58, s21, v58
    v_mul_f32 v74, s21, v74
    v_mul_f32 v90, s21, v90
    v_mul_f32 v106, s21, v106
    v_cvt_pk_bf16_f32 v56, v57, v58
    v_cvt_pk_bf16_f32 v72, v73, v74
    v_cvt_pk_bf16_f32 v88, v89, v90
    v_cvt_pk_bf16_f32 v104, v105, v106
    v_and_b32 v58, 0xffff0000, v56
    v_and_b32 v74, 0xffff0000, v72
    v_and_b32 v90, 0xffff0000, v88
    v_and_b32 v106, 0xffff0000, v104
    v_lshlrev_b32 v57, 16, v56
    v_lshlrev_b32 v73, 16, v72
    v_lshlrev_b32 v89, 16, v88
    v_lshlrev_b32 v105, 16, v104
    v_add_f32 v58, s22, v58
    v_add_f32 v74, s22, v74
    v_add_f32 v90, s22, v90
    v_add_f32 v106, s22, v106
    v_cvt_pk_bf16_f32 v58, v58, v58
    v_cvt_pk_bf16_f32 v74, v74, v74
    v_cvt_pk_bf16_f32 v90, v90, v90
    v_cvt_pk_bf16_f32 v106, v106, v106
    v_lshlrev_b32 v58, 16, v58
    v_lshlrev_b32 v74, 16, v74
    v_lshlrev_b32 v90, 16, v90
    v_lshlrev_b32 v106, 16, v106
    v_sqrt_f32 v58, v58
    v_sqrt_f32 v74, v74
    v_sqrt_f32 v90, v90
    v_sqrt_f32 v106, v106
    v_cvt_pk_bf16_f32 v58, v58, v58
    v_cvt_pk_bf16_f32 v74, v74, v74
    v_cvt_pk_bf16_f32 v90, v90, v90
    v_cvt_pk_bf16_f32 v106, v106, v106
    v_lshlrev_b32 v58, 16, v58
    v_lshlrev_b32 v74, 16, v74
    v_lshlrev_b32 v90, 16, v90
    v_lshlrev_b32 v106, 16, v106
    v_rcp_f32 v58, v58
    v_rcp_f32 v74, v74
    v_rcp_f32 v90, v90
    v_rcp_f32 v106, v106
    v_sub_f32 v48, v48, v57
    v_sub_f32 v49, v49, v57
    v_sub_f32 v50, v50, v57
    v_sub_f32 v51, v51, v57
    v_sub_f32 v52, v52, v57
    v_sub_f32 v53, v53, v57
    v_sub_f32 v54, v54, v57
    v_sub_f32 v55, v55, v57
    v_sub_f32 v64, v64, v73
    v_sub_f32 v65, v65, v73
    v_sub_f32 v66, v66, v73
    v_sub_f32 v67, v67, v73
    v_sub_f32 v68, v68, v73
    v_sub_f32 v69, v69, v73
    v_sub_f32 v70, v70, v73
    v_sub_f32 v71, v71, v73
    v_sub_f32 v80, v80, v89
    v_sub_f32 v81, v81, v89
    v_sub_f32 v82, v82, v89
    v_sub_f32 v83, v83, v89
    v_sub_f32 v84, v84, v89
    v_sub_f32 v85, v85, v89
    v_sub_f32 v86, v86, v89
    v_sub_f32 v87, v87, v89
    v_sub_f32 v96, v96, v105
    v_sub_f32 v97, v97, v105
    v_sub_f32 v98, v98, v105
    v_sub_f32 v99, v99, v105
    v_sub_f32 v100, v100, v105
    v_sub_f32 v101, v101, v105
    v_sub_f32 v102, v102, v105
    v_sub_f32 v103, v103, v105
    v_cvt_pk_bf16_f32 v60, v48, v49
    v_cvt_pk_bf16_f32 v61, v50, v51
    v_cvt_pk_bf16_f32 v62, v52, v53
    v_cvt_pk_bf16_f32 v63, v54, v55
    v_cvt_pk_bf16_f32 v76, v64, v65
    v_cvt_pk_bf16_f32 v77, v66, v67
    v_cvt_pk_bf16_f32 v78, v68, v69
    v_cvt_pk_bf16_f32 v79, v70, v71
    v_cvt_pk_bf16_f32 v92, v80, v81
    v_cvt_pk_bf16_f32 v93, v82, v83
    v_cvt_pk_bf16_f32 v94, v84, v85
    v_cvt_pk_bf16_f32 v95, v86, v87
    v_cvt_pk_bf16_f32 v108, v96, v97
    v_cvt_pk_bf16_f32 v109, v98, v99
    v_cvt_pk_bf16_f32 v110, v100, v101
    v_cvt_pk_bf16_f32 v111, v102, v103
    v_lshlrev_b32 v48, 16, v60
    v_and_b32 v49, 0xffff0000, v60
    v_lshlrev_b32 v50, 16, v61
    v_and_b32 v51, 0xffff0000, v61
    v_lshlrev_b32 v52, 16, v62
    v_and_b32 v53, 0xffff0000, v62
    v_lshlrev_b32 v54, 16, v63
    v_and_b32 v55, 0xffff0000, v63
    v_lshlrev_b32 v64, 16, v76
    v_and_b32 v65, 0xffff0000, v76
    v_lshlrev_b32 v66, 16, v77
    v_and_b32 v67, 0xffff0000, v77
    v_lshlrev_b32 v68, 16, v78
    v_and_b32 v69, 0xffff0000, v78
    v_lshlrev_b32 v70, 16, v79
    v_and_b32 v71, 0xffff0000, v79
    v_lshlrev_b32 v80, 16, v92
    v_and_b32 v81, 0xffff0000, v92
    v_lshlrev_b32 v82, 16, v93
    v_and_b32 v83, 0xffff0000, v93
    v_lshlrev_b32 v84, 16, v94
    v_and_b32 v85, 0xffff0000, v94
    v_lshlrev_b32 v86, 16, v95
    v_and_b32 v87, 0xffff0000, v95
    v_lshlrev_b32 v96, 16, v108
    v_and_b32 v97, 0xffff0000, v108
    v_lshlrev_b32 v98, 16, v109
    v_and_b32 v99, 0xffff0000, v109
    v_lshlrev_b32 v100, 16, v110
    v_and_b32 v101, 0xffff0000, v110
    v_lshlrev_b32 v102, 16, v111
    v_and_b32 v103, 0xffff0000, v111
    v_mul_f32 v48, v48, v58
    v_mul_f32 v49, v49, v58
    v_mul_f32 v50, v50, v58
    v_mul_f32 v51, v51, v58
    v_mul_f32 v52, v52, v58
    v_mul_f32 v53, v53, v58
    v_mul_f32 v54, v54, v58
    v_mul_f32 v55, v55, v58
    v_mul_f32 v64, v64, v74
    v_mul_f32 v65, v65, v74
    v_mul_f32 v66, v66, v74
    v_mul_f32 v67, v67, v74
    v_mul_f32 v68, v68, v74
    v_mul_f32 v69, v69, v74
    v_mul_f32 v70, v70, v74
    v_mul_f32 v71, v71, v74
    v_mul_f32 v80, v80, v90
    v_mul_f32 v81, v81, v90
    v_mul_f32 v82, v82, v90
    v_mul_f32 v83, v83, v90
    v_mul_f32 v84, v84, v90
    v_mul_f32 v85, v85, v90
    v_mul_f32 v86, v86, v90
    v_mul_f32 v87, v87, v90
    v_mul_f32 v96, v96, v106
    v_mul_f32 v97, v97, v106
    v_mul_f32 v98, v98, v106
    v_mul_f32 v99, v99, v106
    v_mul_f32 v100, v100, v106
    v_mul_f32 v101, v101, v106
    v_mul_f32 v102, v102, v106
    v_mul_f32 v103, v103, v106
    v_cvt_pk_bf16_f32 v60, v48, v49
    v_cvt_pk_bf16_f32 v61, v50, v51
    v_cvt_pk_bf16_f32 v62, v52, v53
    v_cvt_pk_bf16_f32 v63, v54, v55
    v_cvt_pk_bf16_f32 v76, v64, v65
    v_cvt_pk_bf16_f32 v77, v66, v67
    v_cvt_pk_bf16_f32 v78, v68, v69
    v_cvt_pk_bf16_f32 v79, v70, v71
    v_cvt_pk_bf16_f32 v92, v80, v81
    v_cvt_pk_bf16_f32 v93, v82, v83
    v_cvt_pk_bf16_f32 v94, v84, v85
    v_cvt_pk_bf16_f32 v95, v86, v87
    v_cvt_pk_bf16_f32 v108, v96, v97
    v_cvt_pk_bf16_f32 v109, v98, v99
    v_cvt_pk_bf16_f32 v110, v100, v101
    v_cvt_pk_bf16_f32 v111, v102, v103
    buffer_store_dwordx2 v[60:61], v21, s[12:15], s19 offen offset:0
    buffer_store_dwordx2 v[62:63], v21, s[12:15], s19 offen offset:256
    buffer_store_dwordx2 v[76:77], v21, s[12:15], s19 offen offset:16
    buffer_store_dwordx2 v[78:79], v21, s[12:15], s19 offen offset:272
    buffer_store_dwordx2 v[92:93], v21, s[12:15], s19 offen offset:32
    buffer_store_dwordx2 v[94:95], v21, s[12:15], s19 offen offset:288
    buffer_store_dwordx2 v[108:109], v21, s[12:15], s19 offen offset:48
    buffer_store_dwordx2 v[110:111], v21, s[12:15], s19 offen offset:304
L_prep_done:
    s_endpgm
.globl chain_kernel
.p2align 8
.type chain_kernel,@function
chain_kernel:
    s_cmp_ge_u32 s2, 256
    s_cbranch_scc1 L_ch_done
    s_and_b32 s3, s2, 7
    s_cmp_lg_u32 s3, 0
    s_cbranch_scc1 L_g1_entry
    s_load_dwordx2 s[4:5], s[0:1], 8
    s_load_dwordx2 s[6:7], s[0:1], 104
    v_lshrrev_b32 v1, 6, v0
    s_nop 1
    v_readfirstlane_b32 s18, v1
    s_lshr_b32 s16, s2, 3
    v_and_b32 v1, 63, v0
    v_lshlrev_b32 v2, 4, v1
    s_waitcnt lgkmcnt(0)
    s_mov_b32 s8, s4
    s_and_b32 s9, s5, 0xffff
    s_mov_b32 s10, 0x2000
    s_mov_b32 s11, 0x00020000
    s_mov_b32 s12, s6
    s_and_b32 s13, s7, 0xffff
    s_mov_b32 s14, 0x10000000
    s_mov_b32 s15, 0x00020000
    s_getreg_b32 s52, hwreg(HW_REG_XCC_ID)
    s_and_b32 s52, s52, 0xff
    v_mov_b32 v4, s52
    v_mov_b32 v5, 0
    s_lshl_b32 s20, s16, 2
    s_add_u32 s20, s20, 0x7906000
    buffer_store_dword v4, v5, s[12:15], s20 offen sc0 sc1
    s_lshl_b32 s19, s16, 17
    s_lshl_b32 s20, s18, 15
    s_add_u32 s19, s19, s20
    s_add_u32 s19, s19, 0xc00000
    v_add_u32 v3, s20, v2
    buffer_load_dwordx4 v[32:35], v2, s[12:15], s19 offen offset:0
    buffer_load_dwordx4 v[36:39], v2, s[12:15], s19 offen offset:1024
    buffer_load_dwordx4 v[40:43], v2, s[12:15], s19 offen offset:2048
    buffer_load_dwordx4 v[44:47], v2, s[12:15], s19 offen offset:3072
    s_add_u32 s19, s19, 4096
    buffer_load_dwordx4 v[48:51], v2, s[12:15], s19 offen offset:0
    buffer_load_dwordx4 v[52:55], v2, s[12:15], s19 offen offset:1024
    buffer_load_dwordx4 v[56:59], v2, s[12:15], s19 offen offset:2048
    buffer_load_dwordx4 v[60:63], v2, s[12:15], s19 offen offset:3072
    s_add_u32 s19, s19, 4096
    buffer_load_dwordx4 v[64:67], v2, s[12:15], s19 offen offset:0
    buffer_load_dwordx4 v[68:71], v2, s[12:15], s19 offen offset:1024
    buffer_load_dwordx4 v[72:75], v2, s[12:15], s19 offen offset:2048
    buffer_load_dwordx4 v[76:79], v2, s[12:15], s19 offen offset:3072
    s_add_u32 s19, s19, 4096
    buffer_load_dwordx4 v[80:83], v2, s[12:15], s19 offen offset:0
    buffer_load_dwordx4 v[84:87], v2, s[12:15], s19 offen offset:1024
    buffer_load_dwordx4 v[88:91], v2, s[12:15], s19 offen offset:2048
    buffer_load_dwordx4 v[92:95], v2, s[12:15], s19 offen offset:3072
    s_add_u32 s19, s19, 4096
    buffer_load_dwordx4 v[128:131], v2, s[12:15], s19 offen offset:0
    buffer_load_dwordx4 v[132:135], v2, s[12:15], s19 offen offset:1024
    buffer_load_dwordx4 v[136:139], v2, s[12:15], s19 offen offset:2048
    buffer_load_dwordx4 v[140:143], v2, s[12:15], s19 offen offset:3072
    s_add_u32 s19, s19, 4096
    buffer_load_dwordx4 v[144:147], v2, s[12:15], s19 offen offset:0
    buffer_load_dwordx4 v[148:151], v2, s[12:15], s19 offen offset:1024
    buffer_load_dwordx4 v[152:155], v2, s[12:15], s19 offen offset:2048
    buffer_load_dwordx4 v[156:159], v2, s[12:15], s19 offen offset:3072
    s_add_u32 s19, s19, 4096
    buffer_load_dwordx4 v[160:163], v2, s[12:15], s19 offen offset:0
    buffer_load_dwordx4 v[164:167], v2, s[12:15], s19 offen offset:1024
    buffer_load_dwordx4 v[168:171], v2, s[12:15], s19 offen offset:2048
    buffer_load_dwordx4 v[172:175], v2, s[12:15], s19 offen offset:3072
    s_add_u32 s19, s19, 4096
    buffer_load_dwordx4 v[176:179], v2, s[12:15], s19 offen offset:0
    buffer_load_dwordx4 v[180:183], v2, s[12:15], s19 offen offset:1024
    buffer_load_dwordx4 v[184:187], v2, s[12:15], s19 offen offset:2048
    buffer_load_dwordx4 v[188:191], v2, s[12:15], s19 offen offset:3072
    s_waitcnt vmcnt(31)
    ds_write_b128 v3, v[32:35] offset:0
    s_waitcnt vmcnt(30)
    ds_write_b128 v3, v[36:39] offset:1024
    s_waitcnt vmcnt(29)
    ds_write_b128 v3, v[40:43] offset:2048
    s_waitcnt vmcnt(28)
    ds_write_b128 v3, v[44:47] offset:3072
    s_waitcnt vmcnt(27)
    ds_write_b128 v3, v[48:51] offset:4096
    s_waitcnt vmcnt(26)
    ds_write_b128 v3, v[52:55] offset:5120
    s_waitcnt vmcnt(25)
    ds_write_b128 v3, v[56:59] offset:6144
    s_waitcnt vmcnt(24)
    ds_write_b128 v3, v[60:63] offset:7168
    s_waitcnt vmcnt(23)
    ds_write_b128 v3, v[64:67] offset:8192
    s_waitcnt vmcnt(22)
    ds_write_b128 v3, v[68:71] offset:9216
    s_waitcnt vmcnt(21)
    ds_write_b128 v3, v[72:75] offset:10240
    s_waitcnt vmcnt(20)
    ds_write_b128 v3, v[76:79] offset:11264
    s_waitcnt vmcnt(19)
    ds_write_b128 v3, v[80:83] offset:12288
    s_waitcnt vmcnt(18)
    ds_write_b128 v3, v[84:87] offset:13312
    s_waitcnt vmcnt(17)
    ds_write_b128 v3, v[88:91] offset:14336
    s_waitcnt vmcnt(16)
    ds_write_b128 v3, v[92:95] offset:15360
    s_waitcnt vmcnt(15)
    ds_write_b128 v3, v[128:131] offset:16384
    s_waitcnt vmcnt(14)
    ds_write_b128 v3, v[132:135] offset:17408
    s_waitcnt vmcnt(13)
    ds_write_b128 v3, v[136:139] offset:18432
    s_waitcnt vmcnt(12)
    ds_write_b128 v3, v[140:143] offset:19456
    s_waitcnt vmcnt(11)
    ds_write_b128 v3, v[144:147] offset:20480
    s_waitcnt vmcnt(10)
    ds_write_b128 v3, v[148:151] offset:21504
    s_waitcnt vmcnt(9)
    ds_write_b128 v3, v[152:155] offset:22528
    s_waitcnt vmcnt(8)
    ds_write_b128 v3, v[156:159] offset:23552
    s_waitcnt vmcnt(7)
    ds_write_b128 v3, v[160:163] offset:24576
    s_waitcnt vmcnt(6)
    ds_write_b128 v3, v[164:167] offset:25600
    s_waitcnt vmcnt(5)
    ds_write_b128 v3, v[168:171] offset:26624
    s_waitcnt vmcnt(4)
    ds_write_b128 v3, v[172:175] offset:27648
    s_waitcnt vmcnt(3)
    ds_write_b128 v3, v[176:179] offset:28672
    s_waitcnt vmcnt(2)
    ds_write_b128 v3, v[180:183] offset:29696
    s_waitcnt vmcnt(1)
    ds_write_b128 v3, v[184:187] offset:30720
    s_waitcnt vmcnt(0)
    ds_write_b128 v3, v[188:191] offset:31744
    s_waitcnt lgkmcnt(0)
    s_add_u32 s19, s16, 0
    s_lshl_b32 s19, s19, 3
    s_lshl_b32 s20, s18, 1
    s_add_u32 s19, s19, s20
    s_add_u32 s19, s19, 0
    s_lshl_b32 s19, s19, 14
    buffer_load_dwordx4 a[0:3], v2, s[12:15], s19 offen offset:0
    buffer_load_dwordx4 a[4:7], v2, s[12:15], s19 offen offset:1024
    buffer_load_dwordx4 a[8:11], v2, s[12:15], s19 offen offset:2048
    buffer_load_dwordx4 a[12:15], v2, s[12:15], s19 offen offset:3072
    s_add_u32 s19, s19, 4096
    buffer_load_dwordx4 a[16:19], v2, s[12:15], s19 offen offset:0
    buffer_load_dwordx4 a[20:23], v2, s[12:15], s19 offen offset:1024
    buffer_load_dwordx4 a[24:27], v2, s[12:15], s19 offen offset:2048
    buffer_load_dwordx4 a[28:31], v2, s[12:15], s19 offen offset:3072
    s_add_u32 s19, s19, 4096
    buffer_load_dwordx4 a[32:35], v2, s[12:15], s19 offen offset:0
    buffer_load_dwordx4 a[36:39], v2, s[12:15], s19 offen offset:1024
    buffer_load_dwordx4 a[40:43], v2, s[12:15], s19 offen offset:2048
    buffer_load_dwordx4 a[44:47], v2, s[12:15], s19 offen offset:3072
    s_add_u32 s19, s19, 4096
    buffer_load_dwordx4 a[48:51], v2, s[12:15], s19 offen offset:0
    buffer_load_dwordx4 a[52:55], v2, s[12:15], s19 offen offset:1024
    buffer_load_dwordx4 a[56:59], v2, s[12:15], s19 offen offset:2048
    buffer_load_dwordx4 a[60:63], v2, s[12:15], s19 offen offset:3072
    s_add_u32 s19, s16, 0
    s_lshl_b32 s19, s19, 3
    s_lshl_b32 s20, s18, 1
    s_add_u32 s19, s19, s20
    s_add_u32 s19, s19, 1
    s_lshl_b32 s19, s19, 14
    buffer_load_dwordx4 a[64:67], v2, s[12:15], s19 offen offset:0
    buffer_load_dwordx4 a[68:71], v2, s[12:15], s19 offen offset:1024
    buffer_load_dwordx4 a[72:75], v2, s[12:15], s19 offen offset:2048
    buffer_load_dwordx4 a[76:79], v2, s[12:15], s19 offen offset:3072
    s_add_u32 s19, s19, 4096
    buffer_load_dwordx4 a[80:83], v2, s[12:15], s19 offen offset:0
    buffer_load_dwordx4 a[84:87], v2, s[12:15], s19 offen offset:1024
    buffer_load_dwordx4 a[88:91], v2, s[12:15], s19 offen offset:2048
    buffer_load_dwordx4 a[92:95], v2, s[12:15], s19 offen offset:3072
    s_add_u32 s19, s19, 4096
    buffer_load_dwordx4 a[96:99], v2, s[12:15], s19 offen offset:0
    buffer_load_dwordx4 a[100:103], v2, s[12:15], s19 offen offset:1024
    buffer_load_dwordx4 a[104:107], v2, s[12:15], s19 offen offset:2048
    buffer_load_dwordx4 a[108:111], v2, s[12:15], s19 offen offset:3072
    s_add_u32 s19, s19, 4096
    buffer_load_dwordx4 a[112:115], v2, s[12:15], s19 offen offset:0
    buffer_load_dwordx4 a[116:119], v2, s[12:15], s19 offen offset:1024
    buffer_load_dwordx4 a[120:123], v2, s[12:15], s19 offen offset:2048
    buffer_load_dwordx4 a[124:127], v2, s[12:15], s19 offen offset:3072
    s_add_u32 s19, s16, 32
    s_lshl_b32 s19, s19, 3
    s_lshl_b32 s20, s18, 1
    s_add_u32 s19, s19, s20
    s_add_u32 s19, s19, 0
    s_lshl_b32 s19, s19, 14
    buffer_load_dwordx4 a[128:131], v2, s[12:15], s19 offen offset:0
    buffer_load_dwordx4 a[132:135], v2, s[12:15], s19 offen offset:1024
    buffer_load_dwordx4 a[136:139], v2, s[12:15], s19 offen offset:2048
    buffer_load_dwordx4 a[140:143], v2, s[12:15], s19 offen offset:3072
    s_add_u32 s19, s19, 4096
    buffer_load_dwordx4 a[144:147], v2, s[12:15], s19 offen offset:0
    buffer_load_dwordx4 a[148:151], v2, s[12:15], s19 offen offset:1024
    buffer_load_dwordx4 a[152:155], v2, s[12:15], s19 offen offset:2048
    buffer_load_dwordx4 a[156:159], v2, s[12:15], s19 offen offset:3072
    s_add_u32 s19, s19, 4096
    buffer_load_dwordx4 a[160:163], v2, s[12:15], s19 offen offset:0
    buffer_load_dwordx4 a[164:167], v2, s[12:15], s19 offen offset:1024
    buffer_load_dwordx4 a[168:171], v2, s[12:15], s19 offen offset:2048
    buffer_load_dwordx4 a[172:175], v2, s[12:15], s19 offen offset:3072
    s_add_u32 s19, s19, 4096
    buffer_load_dwordx4 a[176:179], v2, s[12:15], s19 offen offset:0
    buffer_load_dwordx4 a[180:183], v2, s[12:15], s19 offen offset:1024
    buffer_load_dwordx4 a[184:187], v2, s[12:15], s19 offen offset:2048
    buffer_load_dwordx4 a[188:191], v2, s[12:15], s19 offen offset:3072
    s_add_u32 s19, s16, 32
    s_lshl_b32 s19, s19, 3
    s_lshl_b32 s20, s18, 1
    s_add_u32 s19, s19, s20
    s_add_u32 s19, s19, 1
    s_lshl_b32 s19, s19, 14
    buffer_load_dwordx4 a[192:195], v2, s[12:15], s19 offen offset:0
    buffer_load_dwordx4 a[196:199], v2, s[12:15], s19 offen offset:1024
    buffer_load_dwordx4 a[200:203], v2, s[12:15], s19 offen offset:2048
    buffer_load_dwordx4 a[204:207], v2, s[12:15], s19 offen offset:3072
    s_add_u32 s19, s19, 4096
    buffer_load_dwordx4 a[208:211], v2, s[12:15], s19 offen offset:0
    buffer_load_dwordx4 a[212:215], v2, s[12:15], s19 offen offset:1024
    buffer_load_dwordx4 a[216:219], v2, s[12:15], s19 offen offset:2048
    buffer_load_dwordx4 a[220:223], v2, s[12:15], s19 offen offset:3072
    s_add_u32 s19, s19, 4096
    buffer_load_dwordx4 a[224:227], v2, s[12:15], s19 offen offset:0
    buffer_load_dwordx4 a[228:231], v2, s[12:15], s19 offen offset:1024
    buffer_load_dwordx4 a[232:235], v2, s[12:15], s19 offen offset:2048
    buffer_load_dwordx4 a[236:239], v2, s[12:15], s19 offen offset:3072
    s_add_u32 s19, s19, 4096
    buffer_load_dwordx4 a[240:243], v2, s[12:15], s19 offen offset:0
    buffer_load_dwordx4 a[244:247], v2, s[12:15], s19 offen offset:1024
    buffer_load_dwordx4 a[248:251], v2, s[12:15], s19 offen offset:2048
    buffer_load_dwordx4 a[252:255], v2, s[12:15], s19 offen offset:3072
    s_add_u32 s19, s16, 64
    s_lshl_b32 s19, s19, 3
    s_lshl_b32 s20, s18, 1
    s_add_u32 s19, s19, s20
    s_add_u32 s19, s19, 0
    s_lshl_b32 s19, s19, 14
    buffer_load_dwordx4 v[128:131], v2, s[12:15], s19 offen offset:0
    buffer_load_dwordx4 v[132:135], v2, s[12:15], s19 offen offset:1024
    buffer_load_dwordx4 v[136:139], v2, s[12:15], s19 offen offset:2048
    buffer_load_dwordx4 v[140:143], v2, s[12:15], s19 offen offset:3072
    s_add_u32 s19, s19, 4096
    buffer_load_dwordx4 v[144:147], v2, s[12:15], s19 offen offset:0
    buffer_load_dwordx4 v[148:151], v2, s[12:15], s19 offen offset:1024
    buffer_load_dwordx4 v[152:155], v2, s[12:15], s19 offen offset:2048
    buffer_load_dwordx4 v[156:159], v2, s[12:15], s19 offen offset:3072
    s_add_u32 s19, s19, 4096
    buffer_load_dwordx4 v[160:163], v2, s[12:15], s19 offen offset:0
    buffer_load_dwordx4 v[164:167], v2, s[12:15], s19 offen offset:1024
    buffer_load_dwordx4 v[168:171], v2, s[12:15], s19 offen offset:2048
    buffer_load_dwordx4 v[172:175], v2, s[12:15], s19 offen offset:3072
    s_add_u32 s19, s19, 4096
    buffer_load_dwordx4 v[176:179], v2, s[12:15], s19 offen offset:0
    buffer_load_dwordx4 v[180:183], v2, s[12:15], s19 offen offset:1024
    buffer_load_dwordx4 v[184:187], v2, s[12:15], s19 offen offset:2048
    buffer_load_dwordx4 v[188:191], v2, s[12:15], s19 offen offset:3072
    s_add_u32 s19, s16, 64
    s_lshl_b32 s19, s19, 3
    s_lshl_b32 s20, s18, 1
    s_add_u32 s19, s19, s20
    s_add_u32 s19, s19, 1
    s_lshl_b32 s19, s19, 14
    buffer_load_dwordx4 v[192:195], v2, s[12:15], s19 offen offset:0
    buffer_load_dwordx4 v[196:199], v2, s[12:15], s19 offen offset:1024
    buffer_load_dwordx4 v[200:203], v2, s[12:15], s19 offen offset:2048
    buffer_load_dwordx4 v[204:207], v2, s[12:15], s19 offen offset:3072
    s_add_u32 s19, s19, 4096
    buffer_load_dwordx4 v[208:211], v2, s[12:15], s19 offen offset:0
    buffer_load_dwordx4 v[212:215], v2, s[12:15], s19 offen offset:1024
    buffer_load_dwordx4 v[216:219], v2, s[12:15], s19 offen offset:2048
    buffer_load_dwordx4 v[220:223], v2, s[12:15], s19 offen offset:3072
    s_add_u32 s19, s19, 4096
    buffer_load_dwordx4 v[224:227], v2, s[12:15], s19 offen offset:0
    buffer_load_dwordx4 v[228:231], v2, s[12:15], s19 offen offset:1024
    buffer_load_dwordx4 v[232:235], v2, s[12:15], s19 offen offset:2048
    buffer_load_dwordx4 v[236:239], v2, s[12:15], s19 offen offset:3072
    s_add_u32 s19, s19, 4096
    buffer_load_dwordx4 v[240:243], v2, s[12:15], s19 offen offset:0
    buffer_load_dwordx4 v[244:247], v2, s[12:15], s19 offen offset:1024
    buffer_load_dwordx4 v[248:251], v2, s[12:15], s19 offen offset:2048
    buffer_load_dwordx4 v[252:255], v2, s[12:15], s19 offen offset:3072
    v_and_b32 v4, 7, v1
    v_lshlrev_b32 v122, 4, v4
    v_lshrrev_b32 v4, 4, v1
    v_lshl_add_u32 v122, v4, 7, v122
    v_bfe_u32 v4, v1, 3, 1
    v_lshl_add_u32 v122, v4, 14, v122
    v_lshrrev_b32 v4, 3, v1
    v_lshlrev_b32 v123, 11, v4
    v_and_b32 v4, 7, v1
    v_lshl_add_u32 v123, v4, 4, v123
    v_and_b32 v4, 0x37, v1
    v_lshlrev_b32 v125, 4, v4
    v_bfe_u32 v4, v1, 3, 1
    v_lshl_add_u32 v126, v4, 3, v125
    v_add_u32 v126, 148480, v126
    v_lshl_add_u32 v125, v4, 11, v125
    v_add_u32 v125, 147456, v125
    s_lshl_b32 s20, s18, 15
    v_add_u32 v127, s20, v2
    s_mul_i32 s20, s18, 3072
    s_add_u32 s20, s20, 147456
    v_add_u32 v124, s20, v2
    s_lshl_b32 s20, s18, 10
    s_add_u32 s20, s20, 159744
    v_add_u32 v121, s20, v2
    v_lshrrev_b32 v4, 4, v0
    v_lshlrev_b32 v120, 10, v4
    v_bfe_u32 v4, v0, 2, 2
    v_lshl_add_u32 v120, v4, 8, v120
    v_and_b32 v4, 3, v0
    v_lshl_add_u32 v120, v4, 5, v120
    v_add_u32 v120, 0x20000, v120
    s_mov_b32 s24, 0
    s_mov_b32 s25, 0x3db504f3
    s_mov_b32 s26, 0x3fb8aa3b
    s_mov_b32 s27, 0xce6e6b28
    s_mov_b32 s36, -1
    s_mov_b32 s37, 0xff00ff00
    s_mov_b32 s38, -1
    s_mov_b32 s39, 0
    s_mov_b32 s42, 0xff
    s_mov_b32 s43, 0
    s_lshl_b32 s28, s16, 13
    s_lshl_b32 s19, s18, 10
    s_add_u32 s29, s28, s19
    s_add_u32 s29, s29, 0x3000000
    s_lshl_b32 s19, s18, 11
    s_add_u32 s30, s28, s19
    s_add_u32 s30, s30, 0x4000000
    s_lshl_b32 s31, s16, 12
    s_lshl_b32 s19, s18, 10
    s_add_u32 s31, s31, s19
    s_add_u32 s32, s31, 0x6000000
    s_add_u32 s31, s31, 0x5800000
    s_lshl_b32 s33, s18, 17
    s_lshl_b32 s19, s16, 9
    s_add_u32 s33, s33, s19
    s_add_u32 s33, s33, 0x7800000
    s_lshl_b32 s34, s16, 14
    s_lshl_b32 s19, s18, 7
    s_add_u32 s34, s34, s19
    s_add_u32 s34, s34, 0x7800000
    s_lshr_b32 s35, s16, 1
    s_lshl_b32 s35, s35, 9
    s_lshl_b32 s19, s18, 7
    s_add_u32 s35, s35, s19
    s_and_b32 s19, s16, 1
    s_lshl_b32 s19, s19, 3
    s_add_u32 s35, s35, s19
    s_mov_b32 s40, 0x7900000
    s_mov_b32 s45, 0x7902000
    s_mov_b32 s46, 0x7904000
    v_and_b32 v4, 7, v1
    v_lshlrev_b32 v4, 10, v4
    v_lshrrev_b32 v5, 4, v1
    v_lshl_add_u32 v4, v5, 3, v4
    buffer_load_dwordx2 v[32:33], v4, s[8:11], 0 offen offset:0
    buffer_load_dwordx2 v[34:35], v4, s[8:11], 0 offen offset:32
    buffer_load_dwordx2 v[36:37], v4, s[8:11], 0 offen offset:64
    buffer_load_dwordx2 v[38:39], v4, s[8:11], 0 offen offset:96
    buffer_load_dwordx2 v[40:41], v4, s[8:11], 0 offen offset:128
    buffer_load_dwordx2 v[42:43], v4, s[8:11], 0 offen offset:160
    buffer_load_dwordx2 v[44:45], v4, s[8:11], 0 offen offset:192
    buffer_load_dwordx2 v[46:47], v4, s[8:11], 0 offen offset:224
    buffer_load_dwordx2 v[48:49], v4, s[8:11], 0 offen offset:256
    buffer_load_dwordx2 v[50:51], v4, s[8:11], 0 offen offset:288
    buffer_load_dwordx2 v[52:53], v4, s[8:11], 0 offen offset:320
    buffer_load_dwordx2 v[54:55], v4, s[8:11], 0 offen offset:352
    buffer_load_dwordx2 v[56:57], v4, s[8:11], 0 offen offset:384
    buffer_load_dwordx2 v[58:59], v4, s[8:11], 0 offen offset:416
    buffer_load_dwordx2 v[60:61], v4, s[8:11], 0 offen offset:448
    buffer_load_dwordx2 v[62:63], v4, s[8:11], 0 offen offset:480
    buffer_load_dwordx2 v[64:65], v4, s[8:11], 0 offen offset:512
    buffer_load_dwordx2 v[66:67], v4, s[8:11], 0 offen offset:544
    buffer_load_dwordx2 v[68:69], v4, s[8:11], 0 offen offset:576
    buffer_load_dwordx2 v[70:71], v4, s[8:11], 0 offen offset:608
    buffer_load_dwordx2 v[72:73], v4, s[8:11], 0 offen offset:640
    buffer_load_dwordx2 v[74:75], v4, s[8:11], 0 offen offset:672
    buffer_load_dwordx2 v[76:77], v4, s[8:11], 0 offen offset:704
    buffer_load_dwordx2 v[78:79], v4, s[8:11], 0 offen offset:736
    buffer_load_dwordx2 v[80:81], v4, s[8:11], 0 offen offset:768
    buffer_load_dwordx2 v[82:83], v4, s[8:11], 0 offen offset:800
    buffer_load_dwordx2 v[84:85], v4, s[8:11], 0 offen offset:832
    buffer_load_dwordx2 v[86:87], v4, s[8:11], 0 offen offset:864
    buffer_load_dwordx2 v[88:89], v4, s[8:11], 0 offen offset:896
    buffer_load_dwordx2 v[90:91], v4, s[8:11], 0 offen offset:928
    buffer_load_dwordx2 v[92:93], v4, s[8:11], 0 offen offset:960
    buffer_load_dwordx2 v[94:95], v4, s[8:11], 0 offen offset:992
    s_mov_b32 s56, 0
    s_lshl_b32 s55, s16, 2
    s_add_u32 s55, s55, s18
    s_lshl_b32 s55, s55, 2
    s_add_u32 s55, s55, 0x7906400
    s_lshr_b32 s53, s16, 1
    s_lshl_b32 s53, s53, 4
    s_and_b32 s19, s16, 1
    s_lshl_b32 s19, s19, 3
    s_add_u32 s53, s53, s19
    s_add_u32 s53, s53, 0x7907000
    v_and_b32 v5, 31, v1
    v_lshlrev_b32 v5, 2, v5
    s_mov_b32 s20, 0x7906000
    s_mov_b32 s41, 0
L_ch_census:
    buffer_load_dword v4, v5, s[12:15], s20 offen sc0 sc1
    s_add_u32 s41, s41, 1
    s_waitcnt vmcnt(0)
    v_cmp_ne_u32 vcc, -1, v4
    s_cmp_eq_u64 vcc, exec
    s_cbranch_scc1 L_ch_census_ok
    s_cmp_lt_u32 s41, 200000
    s_cbranch_scc1 L_ch_census
    s_branch L_ch_done
L_ch_census_ok:
    s_barrier
    v_cmp_eq_u32 vcc, s52, v4
    s_cmp_eq_u64 vcc, exec
    s_cselect_b32 s54, 0, 1
    v_min_u32 v104, 27, v1
    v_lshrrev_b32 v105, 1, v104
    v_lshlrev_b32 v105, 8, v105
    v_and_b32 v104, 1, v104
    v_lshl_add_u32 v104, v104, 2, v105
    s_add_u32 s19, s53, 0
    s_mov_b32 s41, 0
L_ch_kvpolli:
    buffer_load_dword v105, v104, s[12:15], s19 offen sc0 sc1
    s_add_u32 s41, s41, 1
    s_waitcnt vmcnt(0)
    v_cmp_eq_u32 vcc, 1, v105
    s_cmp_eq_u64 vcc, exec
    s_cbranch_scc1 L_ch_kvoki
    s_cmp_lt_u32 s41, 200000
    s_cbranch_scc1 L_ch_kvpolli
    s_branch L_ch_done
L_ch_kvoki:
    s_lshl_b32 s19, s24, 18
    s_add_u32 s20, s19, s29
    buffer_load_dwordx4 v[16:19], v2, s[12:15], s20 offen
    s_add_u32 s20, s20, 4096
    buffer_load_dwordx4 v[20:23], v2, s[12:15], s20 offen
    s_add_u32 s20, s19, s30
    buffer_load_dwordx4 v[24:27], v2, s[12:15], s20 offen
    buffer_load_dwordx4 v[28:31], v2, s[12:15], s20 offen offset:1024
    s_waitcnt vmcnt(0)
    s_cmp_eq_u32 s54, 0
    s_cbranch_scc0 L_ch_step1
L_ch_step0:
    s_and_b32 s49, s24, 1
    s_lshl_b32 s49, s49, 19
    s_cmp_eq_u32 s24, 0
    s_cbranch_scc1 L_ch_memready0
    s_mov_b32 s41, 0
    v_lshlrev_b32 v3, 5, v0
L_ch_pollmem0:
    buffer_load_dwordx4 v[96:99], v3, s[12:15], s40 offen sc1
    buffer_load_dwordx4 v[100:103], v3, s[12:15], s40 offen offset:16 sc1
    s_add_u32 s41, s41, 1
    s_waitcnt vmcnt(0)
    v_max3_u32 v104, v96, v97, v98
    v_max3_u32 v105, v99, v100, v101
    v_max3_u32 v104, v104, v102, v103
    v_max_u32 v104, v104, v105
    v_cmp_ne_u32 vcc, -1, v104
    s_cmp_eq_u64 vcc, exec
    s_cbranch_scc1 L_ch_pollmem_ok0
    s_cmp_lt_u32 s41, 200000
    s_cbranch_scc1 L_ch_pollmem0
    s_branch L_ch_done
L_ch_pollmem_ok0:
    ds_write_b128 v120, v[96:99]
    ds_write_b128 v120, v[100:103] offset:16
    v_add_u32 v3, 0x20000, v2
    s_waitcnt lgkmcnt(0)
    s_barrier
    ds_read_b128 v[32:35], v3 offset:0
    ds_read_b128 v[36:39], v3 offset:1024
    ds_read_b128 v[40:43], v3 offset:2048
    ds_read_b128 v[44:47], v3 offset:3072
    ds_read_b128 v[48:51], v3 offset:4096
    ds_read_b128 v[52:55], v3 offset:5120
    ds_read_b128 v[56:59], v3 offset:6144
    ds_read_b128 v[60:63], v3 offset:7168
    ds_read_b128 v[64:67], v3 offset:8192
    ds_read_b128 v[68:71], v3 offset:9216
    ds_read_b128 v[72:75], v3 offset:10240
    ds_read_b128 v[76:79], v3 offset:11264
    ds_read_b128 v[80:83], v3 offset:12288
    ds_read_b128 v[84:87], v3 offset:13312
    ds_read_b128 v[88:91], v3 offset:14336
    ds_read_b128 v[92:95], v3 offset:15360
    s_cmp_lg_u32 s24, 56
    s_cbranch_scc1 L_ch_kvok0
    v_min_u32 v104, 3, v1
    v_lshrrev_b32 v105, 1, v104
    v_lshlrev_b32 v105, 8, v105
    v_and_b32 v104, 1, v104
    v_lshl_add_u32 v104, v104, 2, v105
    s_add_u32 s19, s53, 3584
    s_mov_b32 s41, 0
L_ch_kvpoll0:
    buffer_load_dword v105, v104, s[12:15], s19 offen sc0 sc1
    s_add_u32 s41, s41, 1
    s_waitcnt vmcnt(0)
    v_cmp_eq_u32 vcc, 1, v105
    s_cmp_eq_u64 vcc, exec
    s_cbranch_scc1 L_ch_kvok0
    s_cmp_lt_u32 s41, 200000
    s_cbranch_scc1 L_ch_kvpoll0
    s_branch L_ch_done
L_ch_kvok0:
    s_waitcnt lgkmcnt(15)
    v_mfma_f32_16x16x32_bf16 v[96:99], a[0:3], v[32:35], 0
    v_mfma_f32_16x16x32_bf16 v[104:107], a[128:131], v[32:35], 0
    v_mfma_f32_16x16x32_bf16 v[100:103], a[64:67], v[32:35], 0
    v_mfma_f32_16x16x32_bf16 v[108:111], a[192:195], v[32:35], 0
    s_lshl_b32 s19, s24, 18
    s_add_u32 s20, s19, s29
    buffer_load_dwordx4 v[16:19], v2, s[12:15], s20 offen
    s_waitcnt lgkmcnt(14)
    v_mfma_f32_16x16x32_bf16 v[96:99], a[4:7], v[36:39], v[96:99]
    v_mfma_f32_16x16x32_bf16 v[104:107], a[132:135], v[36:39], v[104:107]
    v_mfma_f32_16x16x32_bf16 v[100:103], a[68:71], v[36:39], v[100:103]
    v_mfma_f32_16x16x32_bf16 v[108:111], a[196:199], v[36:39], v[108:111]
    s_add_u32 s20, s20, 4096
    buffer_load_dwordx4 v[20:23], v2, s[12:15], s20 offen
    s_waitcnt lgkmcnt(13)
    v_mfma_f32_16x16x32_bf16 v[96:99], a[8:11], v[40:43], v[96:99]
    v_mfma_f32_16x16x32_bf16 v[104:107], a[136:139], v[40:43], v[104:107]
    v_mfma_f32_16x16x32_bf16 v[100:103], a[72:75], v[40:43], v[100:103]
    v_mfma_f32_16x16x32_bf16 v[108:111], a[200:203], v[40:43], v[108:111]
    s_add_u32 s20, s19, s30
    buffer_load_dwordx4 v[24:27], v2, s[12:15], s20 offen
    s_waitcnt lgkmcnt(12)
    v_mfma_f32_16x16x32_bf16 v[96:99], a[12:15], v[44:47], v[96:99]
    v_mfma_f32_16x16x32_bf16 v[104:107], a[140:143], v[44:47], v[104:107]
    v_mfma_f32_16x16x32_bf16 v[100:103], a[76:79], v[44:47], v[100:103]
    v_mfma_f32_16x16x32_bf16 v[108:111], a[204:207], v[44:47], v[108:111]
    buffer_load_dwordx4 v[28:31], v2, s[12:15], s20 offen offset:1024
    s_waitcnt lgkmcnt(11)
    v_mfma_f32_16x16x32_bf16 v[96:99], a[16:19], v[48:51], v[96:99]
    v_mfma_f32_16x16x32_bf16 v[104:107], a[144:147], v[48:51], v[104:107]
    v_mfma_f32_16x16x32_bf16 v[100:103], a[80:83], v[48:51], v[100:103]
    v_mfma_f32_16x16x32_bf16 v[108:111], a[208:211], v[48:51], v[108:111]
    s_sub_u32 s19, s24, 1
    s_lshl_b32 s19, s19, 17
    s_add_u32 s20, s19, s31
    buffer_store_dwordx4 v[8:11], v2, s[12:15], s20 offen sc0 sc1
    s_waitcnt lgkmcnt(10)
    v_mfma_f32_16x16x32_bf16 v[96:99], a[20:23], v[52:55], v[96:99]
    v_mfma_f32_16x16x32_bf16 v[104:107], a[148:151], v[52:55], v[104:107]
    v_mfma_f32_16x16x32_bf16 v[100:103], a[84:87], v[52:55], v[100:103]
    v_mfma_f32_16x16x32_bf16 v[108:111], a[212:215], v[52:55], v[108:111]
    s_add_u32 s20, s19, s32
    v_lshlrev_b32 v3, 3, v1
    buffer_store_dwordx2 v[12:13], v3, s[12:15], s20 offen sc0 sc1
    s_waitcnt lgkmcnt(9)
    v_mfma_f32_16x16x32_bf16 v[96:99], a[24:27], v[56:59], v[96:99]
    v_mfma_f32_16x16x32_bf16 v[104:107], a[152:155], v[56:59], v[104:107]
    v_mfma_f32_16x16x32_bf16 v[100:103], a[88:91], v[56:59], v[100:103]
    v_mfma_f32_16x16x32_bf16 v[108:111], a[216:219], v[56:59], v[108:111]
    buffer_store_dwordx2 v[14:15], v3, s[12:15], s20 offen offset:512 sc0 sc1
    s_waitcnt lgkmcnt(8)
    v_mfma_f32_16x16x32_bf16 v[96:99], a[28:31], v[60:63], v[96:99]
    v_mfma_f32_16x16x32_bf16 v[104:107], a[156:159], v[60:63], v[104:107]
    v_mfma_f32_16x16x32_bf16 v[100:103], a[92:95], v[60:63], v[100:103]
    v_mfma_f32_16x16x32_bf16 v[108:111], a[220:223], v[60:63], v[108:111]
    s_sub_u32 s19, s24, 1
    v_mov_b32 v6, s19
    v_mov_b32 v7, 0
    s_mov_b64 exec, 1
    buffer_store_dword v6, v7, s[12:15], s55 offen sc0 sc1
    s_mov_b64 exec, -1
    s_waitcnt lgkmcnt(7)
    v_mfma_f32_16x16x32_bf16 v[96:99], a[32:35], v[64:67], v[96:99]
    v_mfma_f32_16x16x32_bf16 v[104:107], a[160:163], v[64:67], v[104:107]
    v_mfma_f32_16x16x32_bf16 v[100:103], a[96:99], v[64:67], v[100:103]
    v_mfma_f32_16x16x32_bf16 v[108:111], a[224:227], v[64:67], v[108:111]
    v_mov_b32 v112, -1
    v_mov_b32 v113, -1
    v_mov_b32 v114, -1
    v_mov_b32 v115, -1
    buffer_store_dwordx4 v[112:115], v123, s[12:15], s51 offen offset:0
    s_waitcnt lgkmcnt(6)
    v_mfma_f32_16x16x32_bf16 v[96:99], a[36:39], v[68:71], v[96:99]
    v_mfma_f32_16x16x32_bf16 v[104:107], a[164:167], v[68:71], v[104:107]
    v_mfma_f32_16x16x32_bf16 v[100:103], a[100:103], v[68:71], v[100:103]
    v_mfma_f32_16x16x32_bf16 v[108:111], a[228:231], v[68:71], v[108:111]
    buffer_store_dwordx4 v[112:115], v123, s[12:15], s51 offen offset:512
    s_waitcnt lgkmcnt(5)
    v_mfma_f32_16x16x32_bf16 v[96:99], a[40:43], v[72:75], v[96:99]
    v_mfma_f32_16x16x32_bf16 v[104:107], a[168:171], v[72:75], v[104:107]
    v_mfma_f32_16x16x32_bf16 v[100:103], a[104:107], v[72:75], v[100:103]
    v_mfma_f32_16x16x32_bf16 v[108:111], a[232:235], v[72:75], v[108:111]
    buffer_store_dwordx4 v[112:115], v123, s[12:15], s51 offen offset:1024
    s_waitcnt lgkmcnt(4)
    v_mfma_f32_16x16x32_bf16 v[96:99], a[44:47], v[76:79], v[96:99]
    v_mfma_f32_16x16x32_bf16 v[104:107], a[172:175], v[76:79], v[104:107]
    v_mfma_f32_16x16x32_bf16 v[100:103], a[108:111], v[76:79], v[100:103]
    v_mfma_f32_16x16x32_bf16 v[108:111], a[236:239], v[76:79], v[108:111]
    buffer_store_dwordx4 v[112:115], v123, s[12:15], s51 offen offset:1536
    s_waitcnt lgkmcnt(3)
    v_mfma_f32_16x16x32_bf16 v[96:99], a[48:51], v[80:83], v[96:99]
    v_mfma_f32_16x16x32_bf16 v[104:107], a[176:179], v[80:83], v[104:107]
    v_mfma_f32_16x16x32_bf16 v[100:103], a[112:115], v[80:83], v[100:103]
    v_mfma_f32_16x16x32_bf16 v[108:111], a[240:243], v[80:83], v[108:111]
    s_add_u32 s20, s46, s35
    s_mov_b64 exec, s[42:43]
    buffer_store_dwordx2 v[112:113], v2, s[12:15], s20 offen
    s_mov_b64 exec, -1
    s_waitcnt lgkmcnt(2)
    v_mfma_f32_16x16x32_bf16 v[96:99], a[52:55], v[84:87], v[96:99]
    v_mfma_f32_16x16x32_bf16 v[104:107], a[180:183], v[84:87], v[104:107]
    v_mfma_f32_16x16x32_bf16 v[100:103], a[116:119], v[84:87], v[100:103]
    v_mfma_f32_16x16x32_bf16 v[108:111], a[244:247], v[84:87], v[108:111]
    s_waitcnt lgkmcnt(1)
    v_mfma_f32_16x16x32_bf16 v[96:99], a[56:59], v[88:91], v[96:99]
    v_mfma_f32_16x16x32_bf16 v[104:107], a[184:187], v[88:91], v[104:107]
    v_mfma_f32_16x16x32_bf16 v[100:103], a[120:123], v[88:91], v[100:103]
    v_mfma_f32_16x16x32_bf16 v[108:111], a[248:251], v[88:91], v[108:111]
    s_waitcnt lgkmcnt(0)
    v_mfma_f32_16x16x32_bf16 v[96:99], a[60:63], v[92:95], v[96:99]
    v_mfma_f32_16x16x32_bf16 v[104:107], a[188:191], v[92:95], v[104:107]
    v_mfma_f32_16x16x32_bf16 v[100:103], a[124:127], v[92:95], v[100:103]
    v_mfma_f32_16x16x32_bf16 v[108:111], a[252:255], v[92:95], v[108:111]
    s_branch L_ch_qkdone0
L_ch_memready0:
    v_mfma_f32_16x16x32_bf16 v[96:99], a[0:3], v[32:35], 0
    v_mfma_f32_16x16x32_bf16 v[104:107], a[128:131], v[32:35], 0
    v_mfma_f32_16x16x32_bf16 v[100:103], a[64:67], v[32:35], 0
    v_mfma_f32_16x16x32_bf16 v[108:111], a[192:195], v[32:35], 0
    v_mfma_f32_16x16x32_bf16 v[96:99], a[4:7], v[36:39], v[96:99]
    v_mfma_f32_16x16x32_bf16 v[104:107], a[132:135], v[36:39], v[104:107]
    v_mfma_f32_16x16x32_bf16 v[100:103], a[68:71], v[36:39], v[100:103]
    v_mfma_f32_16x16x32_bf16 v[108:111], a[196:199], v[36:39], v[108:111]
    v_mfma_f32_16x16x32_bf16 v[96:99], a[8:11], v[40:43], v[96:99]
    v_mfma_f32_16x16x32_bf16 v[104:107], a[136:139], v[40:43], v[104:107]
    v_mfma_f32_16x16x32_bf16 v[100:103], a[72:75], v[40:43], v[100:103]
    v_mfma_f32_16x16x32_bf16 v[108:111], a[200:203], v[40:43], v[108:111]
    v_mfma_f32_16x16x32_bf16 v[96:99], a[12:15], v[44:47], v[96:99]
    v_mfma_f32_16x16x32_bf16 v[104:107], a[140:143], v[44:47], v[104:107]
    v_mfma_f32_16x16x32_bf16 v[100:103], a[76:79], v[44:47], v[100:103]
    v_mfma_f32_16x16x32_bf16 v[108:111], a[204:207], v[44:47], v[108:111]
    v_mfma_f32_16x16x32_bf16 v[96:99], a[16:19], v[48:51], v[96:99]
    v_mfma_f32_16x16x32_bf16 v[104:107], a[144:147], v[48:51], v[104:107]
    v_mfma_f32_16x16x32_bf16 v[100:103], a[80:83], v[48:51], v[100:103]
    v_mfma_f32_16x16x32_bf16 v[108:111], a[208:211], v[48:51], v[108:111]
    v_mfma_f32_16x16x32_bf16 v[96:99], a[20:23], v[52:55], v[96:99]
    v_mfma_f32_16x16x32_bf16 v[104:107], a[148:151], v[52:55], v[104:107]
    v_mfma_f32_16x16x32_bf16 v[100:103], a[84:87], v[52:55], v[100:103]
    v_mfma_f32_16x16x32_bf16 v[108:111], a[212:215], v[52:55], v[108:111]
    v_mfma_f32_16x16x32_bf16 v[96:99], a[24:27], v[56:59], v[96:99]
    v_mfma_f32_16x16x32_bf16 v[104:107], a[152:155], v[56:59], v[104:107]
    v_mfma_f32_16x16x32_bf16 v[100:103], a[88:91], v[56:59], v[100:103]
    v_mfma_f32_16x16x32_bf16 v[108:111], a[216:219], v[56:59], v[108:111]
    v_mfma_f32_16x16x32_bf16 v[96:99], a[28:31], v[60:63], v[96:99]
    v_mfma_f32_16x16x32_bf16 v[104:107], a[156:159], v[60:63], v[104:107]
    v_mfma_f32_16x16x32_bf16 v[100:103], a[92:95], v[60:63], v[100:103]
    v_mfma_f32_16x16x32_bf16 v[108:111], a[220:223], v[60:63], v[108:111]
    v_mfma_f32_16x16x32_bf16 v[96:99], a[32:35], v[64:67], v[96:99]
    v_mfma_f32_16x16x32_bf16 v[104:107], a[160:163], v[64:67], v[104:107]
    v_mfma_f32_16x16x32_bf16 v[100:103], a[96:99], v[64:67], v[100:103]
    v_mfma_f32_16x16x32_bf16 v[108:111], a[224:227], v[64:67], v[108:111]
    v_mfma_f32_16x16x32_bf16 v[96:99], a[36:39], v[68:71], v[96:99]
    v_mfma_f32_16x16x32_bf16 v[104:107], a[164:167], v[68:71], v[104:107]
    v_mfma_f32_16x16x32_bf16 v[100:103], a[100:103], v[68:71], v[100:103]
    v_mfma_f32_16x16x32_bf16 v[108:111], a[228:231], v[68:71], v[108:111]
    v_mfma_f32_16x16x32_bf16 v[96:99], a[40:43], v[72:75], v[96:99]
    v_mfma_f32_16x16x32_bf16 v[104:107], a[168:171], v[72:75], v[104:107]
    v_mfma_f32_16x16x32_bf16 v[100:103], a[104:107], v[72:75], v[100:103]
    v_mfma_f32_16x16x32_bf16 v[108:111], a[232:235], v[72:75], v[108:111]
    v_mfma_f32_16x16x32_bf16 v[96:99], a[44:47], v[76:79], v[96:99]
    v_mfma_f32_16x16x32_bf16 v[104:107], a[172:175], v[76:79], v[104:107]
    v_mfma_f32_16x16x32_bf16 v[100:103], a[108:111], v[76:79], v[100:103]
    v_mfma_f32_16x16x32_bf16 v[108:111], a[236:239], v[76:79], v[108:111]
    v_mfma_f32_16x16x32_bf16 v[96:99], a[48:51], v[80:83], v[96:99]
    v_mfma_f32_16x16x32_bf16 v[104:107], a[176:179], v[80:83], v[104:107]
    v_mfma_f32_16x16x32_bf16 v[100:103], a[112:115], v[80:83], v[100:103]
    v_mfma_f32_16x16x32_bf16 v[108:111], a[240:243], v[80:83], v[108:111]
    v_mfma_f32_16x16x32_bf16 v[96:99], a[52:55], v[84:87], v[96:99]
    v_mfma_f32_16x16x32_bf16 v[104:107], a[180:183], v[84:87], v[104:107]
    v_mfma_f32_16x16x32_bf16 v[100:103], a[116:119], v[84:87], v[100:103]
    v_mfma_f32_16x16x32_bf16 v[108:111], a[244:247], v[84:87], v[108:111]
    v_mfma_f32_16x16x32_bf16 v[96:99], a[56:59], v[88:91], v[96:99]
    v_mfma_f32_16x16x32_bf16 v[104:107], a[184:187], v[88:91], v[104:107]
    v_mfma_f32_16x16x32_bf16 v[100:103], a[120:123], v[88:91], v[100:103]
    v_mfma_f32_16x16x32_bf16 v[108:111], a[248:251], v[88:91], v[108:111]
    v_mfma_f32_16x16x32_bf16 v[96:99], a[60:63], v[92:95], v[96:99]
    v_mfma_f32_16x16x32_bf16 v[104:107], a[188:191], v[92:95], v[104:107]
    v_mfma_f32_16x16x32_bf16 v[100:103], a[124:127], v[92:95], v[100:103]
    v_mfma_f32_16x16x32_bf16 v[108:111], a[252:255], v[92:95], v[108:111]
L_ch_qkdone0:
    v_mfma_f32_16x16x32_bf16 v[112:115], v[32:35], v[128:131], 0
    v_mfma_f32_16x16x32_bf16 v[116:119], v[32:35], v[192:195], 0
    s_waitcnt vmcnt(9)
    s_nop 5
    v_cvt_pk_bf16_f32 v4, v96, v97
    v_cvt_pk_bf16_f32 v5, v98, v99
    v_cvt_pk_bf16_f32 v8, v104, v105
    v_cvt_pk_bf16_f32 v9, v106, v107
    v_cvt_pk_bf16_f32 v6, v100, v101
    v_cvt_pk_bf16_f32 v7, v102, v103
    v_cvt_pk_bf16_f32 v10, v108, v109
    v_cvt_pk_bf16_f32 v11, v110, v111
    s_nop 1
    v_mfma_f32_16x16x32_bf16 v[96:99], v[8:11], v[4:7], 0
    v_mfma_f32_16x16x32_bf16 v[100:103], v[16:19], v[4:7], 0
    v_mfma_f32_16x16x32_bf16 v[104:107], v[20:23], v[4:7], 0
    v_mfma_f32_16x16x32_bf16 v[112:115], v[36:39], v[132:135], v[112:115]
    v_mfma_f32_16x16x32_bf16 v[116:119], v[36:39], v[196:199], v[116:119]
    v_mfma_f32_16x16x32_bf16 v[112:115], v[40:43], v[136:139], v[112:115]
    v_mfma_f32_16x16x32_bf16 v[116:119], v[40:43], v[200:203], v[116:119]
    s_nop 4
    ds_write_b128 v124, v[96:99] offset:0
    ds_write_b128 v124, v[100:103] offset:1024
    ds_write_b128 v124, v[104:107] offset:2048
    v_mfma_f32_16x16x32_bf16 v[112:115], v[44:47], v[140:143], v[112:115]
    v_mfma_f32_16x16x32_bf16 v[116:119], v[44:47], v[204:207], v[116:119]
    v_mfma_f32_16x16x32_bf16 v[112:115], v[48:51], v[144:147], v[112:115]
    v_mfma_f32_16x16x32_bf16 v[116:119], v[48:51], v[208:211], v[116:119]
    v_mfma_f32_16x16x32_bf16 v[112:115], v[52:55], v[148:151], v[112:115]
    v_mfma_f32_16x16x32_bf16 v[116:119], v[52:55], v[212:215], v[116:119]
    s_waitcnt lgkmcnt(0)
    s_barrier
    ds_read_b128 v[32:35], v125 offset:0
    ds_read_b64 v[48:49], v126 offset:0
    ds_read_b128 v[36:39], v125 offset:3072
    ds_read_b64 v[50:51], v126 offset:3072
    ds_read_b128 v[40:43], v125 offset:6144
    ds_read_b64 v[52:53], v126 offset:6144
    ds_read_b128 v[44:47], v125 offset:9216
    ds_read_b64 v[54:55], v126 offset:9216
    v_mfma_f32_16x16x32_bf16 v[112:115], v[56:59], v[152:155], v[112:115]
    v_mfma_f32_16x16x32_bf16 v[116:119], v[56:59], v[216:219], v[116:119]
    v_mfma_f32_16x16x32_bf16 v[112:115], v[60:63], v[156:159], v[112:115]
    v_mfma_f32_16x16x32_bf16 v[116:119], v[60:63], v[220:223], v[116:119]
    v_mfma_f32_16x16x32_bf16 v[112:115], v[64:67], v[160:163], v[112:115]
    v_mfma_f32_16x16x32_bf16 v[116:119], v[64:67], v[224:227], v[116:119]
    v_mfma_f32_16x16x32_bf16 v[112:115], v[68:71], v[164:167], v[112:115]
    v_mfma_f32_16x16x32_bf16 v[116:119], v[68:71], v[228:231], v[116:119]
    s_waitcnt lgkmcnt(0)
    v_pk_add_f32 v[32:33], v[32:33], v[36:37]
    v_pk_add_f32 v[34:35], v[34:35], v[38:39]
    v_pk_add_f32 v[40:41], v[40:41], v[44:45]
    v_mfma_f32_16x16x32_bf16 v[112:115], v[72:75], v[168:171], v[112:115]
    v_pk_add_f32 v[42:43], v[42:43], v[46:47]
    v_pk_add_f32 v[48:49], v[48:49], v[50:51]
    v_pk_add_f32 v[52:53], v[52:53], v[54:55]
    v_pk_add_f32 v[32:33], v[32:33], v[40:41]
    v_mfma_f32_16x16x32_bf16 v[116:119], v[72:75], v[232:235], v[116:119]
    v_pk_add_f32 v[34:35], v[34:35], v[42:43]
    v_pk_add_f32 v[36:37], v[48:49], v[52:53]
    v_cvt_pk_bf16_f32 v40, v32, v33
    v_cvt_pk_bf16_f32 v41, v34, v35
    v_mfma_f32_16x16x32_bf16 v[112:115], v[76:79], v[172:175], v[112:115]
    v_cvt_pk_bf16_f32 v42, v36, v37
    v_lshlrev_b32 v32, 16, v40
    v_and_b32 v33, 0xffff0000, v40
    v_lshlrev_b32 v34, 16, v41
    v_mfma_f32_16x16x32_bf16 v[116:119], v[76:79], v[236:239], v[116:119]
    v_and_b32 v35, 0xffff0000, v41
    v_lshlrev_b32 v36, 16, v42
    v_and_b32 v37, 0xffff0000, v42
    v_mul_f32 v32, s25, v32
    v_mfma_f32_16x16x32_bf16 v[112:115], v[80:83], v[176:179], v[112:115]
    v_mul_f32 v33, s25, v33
    v_mul_f32 v34, s25, v34
    v_mul_f32 v35, s25, v35
    v_mul_f32 v36, s25, v36
    v_mfma_f32_16x16x32_bf16 v[116:119], v[80:83], v[240:243], v[116:119]
    v_mul_f32 v37, s25, v37
    v_cvt_pk_bf16_f32 v40, v32, v33
    v_cvt_pk_bf16_f32 v41, v34, v35
    v_cvt_pk_bf16_f32 v42, v36, v37
    v_mfma_f32_16x16x32_bf16 v[112:115], v[84:87], v[180:183], v[112:115]
    v_lshlrev_b32 v32, 16, v40
    v_and_b32 v33, 0xffff0000, v40
    v_lshlrev_b32 v34, 16, v41
    v_and_b32 v35, 0xffff0000, v41
    v_mfma_f32_16x16x32_bf16 v[116:119], v[84:87], v[244:247], v[116:119]
    v_lshlrev_b32 v36, 16, v42
    v_and_b32 v37, 0xffff0000, v42
    v_mov_b32 v44, s27
    v_cndmask_b32 v32, v44, v32, s[36:37]
    v_mfma_f32_16x16x32_bf16 v[112:115], v[88:91], v[184:187], v[112:115]
    v_cndmask_b32 v33, v44, v33, s[36:37]
    v_cndmask_b32 v34, v44, v34, s[36:37]
    v_cndmask_b32 v35, v44, v35, s[36:37]
    v_max3_f32 v45, v32, v33, v34
    v_mfma_f32_16x16x32_bf16 v[116:119], v[88:91], v[248:251], v[116:119]
    v_max3_f32 v45, v45, v35, v36
    v_max_f32 v45, v45, v37
    s_nop 1
    v_max_f32_dpp v45, v45, v45 row_ror:8 row_mask:0xf bank_mask:0xf
    v_mfma_f32_16x16x32_bf16 v[112:115], v[92:95], v[188:191], v[112:115]
    v_mov_b32 v46, v45
    s_nop 1
    v_permlane16_swap_b32 v45, v46
    s_nop 1
    v_mfma_f32_16x16x32_bf16 v[116:119], v[92:95], v[252:255], v[116:119]
    v_max_f32 v45, v45, v46
    v_mov_b32 v46, v45
    s_nop 1
    v_permlane32_swap_b32 v45, v46
    s_nop 1
    v_max_f32 v45, v45, v46
    v_mul_f32 v45, s26, v45
    v_fma_f32 v32, v32, s26, -v45
    v_fma_f32 v33, v33, s26, -v45
    v_fma_f32 v34, v34, s26, -v45
    v_fma_f32 v35, v35, s26, -v45
    v_fma_f32 v36, v36, s26, -v45
    v_fma_f32 v37, v37, s26, -v45
    v_exp_f32 v32, v32
    v_exp_f32 v33, v33
    v_exp_f32 v34, v34
    v_exp_f32 v35, v35
    v_exp_f32 v36, v36
    v_exp_f32 v37, v37
    v_add_f32 v45, v32, v33
    v_add_f32 v46, v34, v35
    v_add_f32 v45, v45, v36
    v_add_f32 v46, v46, v37
    v_add_f32 v45, v45, v46
    s_nop 1
    v_add_f32_dpp v45, v45, v45 row_ror:8 row_mask:0xf bank_mask:0xf
    v_mov_b32 v46, v45
    s_nop 1
    v_permlane16_swap_b32 v45, v46
    s_nop 1
    v_add_f32 v45, v45, v46
    v_mov_b32 v46, v45
    s_nop 1
    v_permlane32_swap_b32 v45, v46
    s_nop 1
    v_add_f32 v45, v45, v46
    v_rcp_f32 v45, v45
    s_nop 0
    v_mul_f32 v32, v32, v45
    v_mul_f32 v33, v33, v45
    v_mul_f32 v34, v34, v45
    v_mul_f32 v35, v35, v45
    v_mul_f32 v36, v36, v45
    v_mul_f32 v37, v37, v45
    v_cvt_pk_bf16_f32 v40, v32, v33
    v_cvt_pk_bf16_f32 v41, v34, v35
    v_cvt_pk_bf16_f32 v48, v36, v37
    s_nop 1
    v_mov_b32_dpp v49, v48 row_ror:8 row_mask:0xf bank_mask:0xf
    v_mov_b32_dpp v50, v40 row_ror:8 row_mask:0xf bank_mask:0xf
    v_mov_b32_dpp v51, v41 row_ror:8 row_mask:0xf bank_mask:0xf
    ds_read_b128 v[52:55], v127 offset:0
    ds_read_b128 v[56:59], v127 offset:1024
    ds_read_b128 v[60:63], v127 offset:2048
    ds_read_b128 v[64:67], v127 offset:3072
    ds_read_b128 v[68:71], v127 offset:4096
    ds_read_b128 v[72:75], v127 offset:5120
    ds_read_b128 v[76:79], v127 offset:6144
    ds_read_b128 v[80:83], v127 offset:7168
    ds_read_b128 v[84:87], v127 offset:8192
    ds_read_b128 v[88:91], v127 offset:9216
    ds_read_b128 v[92:95], v127 offset:10240
    v_cvt_pk_bf16_f32 v12, v112, v113
    v_cvt_pk_bf16_f32 v13, v114, v115
    v_cvt_pk_bf16_f32 v14, v116, v117
    v_cvt_pk_bf16_f32 v15, v118, v119
    v_cndmask_b32 v12, 0, v12, s[38:39]
    v_cndmask_b32 v13, 0, v13, s[38:39]
    v_cndmask_b32 v14, 0, v14, s[38:39]
    v_cndmask_b32 v15, 0, v15, s[38:39]
    s_nop 1
    v_mfma_f32_16x16x16_bf16 v[96:99], v[12:13], v[40:41], 0
    v_mfma_f32_16x16x16_bf16 v[100:103], v[14:15], v[40:41], 0
    v_mfma_f32_16x16x32_bf16 v[96:99], v[24:27], v[48:51], v[96:99]
    v_mfma_f32_16x16x32_bf16 v[100:103], v[28:31], v[48:51], v[100:103]
    s_cmp_eq_u32 s24, 63
    s_cbranch_scc1 L_ch_last
    s_add_u32 s44, s33, s49
    v_add_u32 v3, 159744, v2
    s_nop 4
    v_cvt_pk_bf16_f32 v104, v96, v97
    v_cvt_pk_bf16_f32 v105, v98, v99
    v_cvt_pk_bf16_f32 v106, v100, v101
    v_cvt_pk_bf16_f32 v107, v102, v103
    ds_write_b128 v121, v[104:107]
    s_waitcnt lgkmcnt(0)
    s_barrier
    ds_read_b128 v[96:99], v3 offset:0
    ds_read_b128 v[100:103], v3 offset:1024
    ds_read_b128 v[104:107], v3 offset:2048
    ds_read_b128 v[108:111], v3 offset:3072
    s_waitcnt lgkmcnt(0)
    v_mfma_f32_16x16x32_bf16 v[16:19], v[52:55], v[96:99], 0
    s_waitcnt lgkmcnt(9)
    v_mfma_f32_16x16x32_bf16 v[16:19], v[56:59], v[100:103], v[16:19]
    s_waitcnt lgkmcnt(8)
    v_mfma_f32_16x16x32_bf16 v[16:19], v[60:63], v[104:107], v[16:19]
    ds_read_b128 v[52:55], v127 offset:11264
    s_waitcnt lgkmcnt(8)
    v_mfma_f32_16x16x32_bf16 v[16:19], v[64:67], v[108:111], v[16:19]
    ds_read_b128 v[56:59], v127 offset:12288
    s_waitcnt lgkmcnt(8)
    v_mfma_f32_16x16x32_bf16 v[20:23], v[68:71], v[96:99], 0
    ds_read_b128 v[60:63], v127 offset:13312
    s_waitcnt lgkmcnt(8)
    v_mfma_f32_16x16x32_bf16 v[20:23], v[72:75], v[100:103], v[20:23]
    ds_read_b128 v[64:67], v127 offset:14336
    s_waitcnt lgkmcnt(8)
    v_mfma_f32_16x16x32_bf16 v[20:23], v[76:79], v[104:107], v[20:23]
    ds_read_b128 v[68:71], v127 offset:15360
    s_waitcnt lgkmcnt(8)
    v_mfma_f32_16x16x32_bf16 v[20:23], v[80:83], v[108:111], v[20:23]
    ds_read_b128 v[72:75], v127 offset:16384
    s_waitcnt lgkmcnt(8)
    v_mfma_f32_16x16x32_bf16 v[24:27], v[84:87], v[96:99], 0
    ds_read_b128 v[76:79], v127 offset:17408
    s_waitcnt lgkmcnt(8)
    v_mfma_f32_16x16x32_bf16 v[24:27], v[88:91], v[100:103], v[24:27]
    ds_read_b128 v[80:83], v127 offset:18432
    s_waitcnt lgkmcnt(8)
    v_mfma_f32_16x16x32_bf16 v[24:27], v[92:95], v[104:107], v[24:27]
    ds_read_b128 v[84:87], v127 offset:19456
    s_waitcnt lgkmcnt(8)
    v_mfma_f32_16x16x32_bf16 v[24:27], v[52:55], v[108:111], v[24:27]
    ds_read_b128 v[88:91], v127 offset:20480
    s_waitcnt lgkmcnt(8)
    v_mfma_f32_16x16x32_bf16 v[28:31], v[56:59], v[96:99], 0
    ds_read_b128 v[92:95], v127 offset:21504
    s_waitcnt lgkmcnt(8)
    v_mfma_f32_16x16x32_bf16 v[28:31], v[60:63], v[100:103], v[28:31]
    ds_read_b128 v[52:55], v127 offset:22528
    s_waitcnt lgkmcnt(8)
    v_mfma_f32_16x16x32_bf16 v[28:31], v[64:67], v[104:107], v[28:31]
    ds_read_b128 v[56:59], v127 offset:23552
    s_waitcnt lgkmcnt(8)
    v_mfma_f32_16x16x32_bf16 v[28:31], v[68:71], v[108:111], v[28:31]
    ds_read_b128 v[60:63], v127 offset:24576
    v_mov_b32_dpp v16, v20 row_ror:8 row_mask:0xf bank_mask:0xc
    v_mov_b32_dpp v17, v21 row_ror:8 row_mask:0xf bank_mask:0xc
    v_mov_b32_dpp v18, v22 row_ror:8 row_mask:0xf bank_mask:0xc
    v_mov_b32_dpp v19, v23 row_ror:8 row_mask:0xf bank_mask:0xc
    v_min_u32 v16, -2, v16
    v_min_u32 v17, -2, v17
    v_min_u32 v18, -2, v18
    v_min_u32 v19, -2, v19
    s_add_u32 s20, s44, 0
    buffer_store_dwordx4 v[16:19], v122, s[12:15], s20 offen
    s_waitcnt lgkmcnt(8)
    v_mfma_f32_16x16x32_bf16 v[32:35], v[72:75], v[96:99], 0
    ds_read_b128 v[64:67], v127 offset:25600
    s_waitcnt lgkmcnt(8)
    v_mfma_f32_16x16x32_bf16 v[32:35], v[76:79], v[100:103], v[32:35]
    ds_read_b128 v[68:71], v127 offset:26624
    s_waitcnt lgkmcnt(8)
    v_mfma_f32_16x16x32_bf16 v[32:35], v[80:83], v[104:107], v[32:35]
    ds_read_b128 v[72:75], v127 offset:27648
    s_waitcnt lgkmcnt(8)
    v_mfma_f32_16x16x32_bf16 v[32:35], v[84:87], v[108:111], v[32:35]
    ds_read_b128 v[76:79], v127 offset:28672
    s_waitcnt lgkmcnt(8)
    v_mfma_f32_16x16x32_bf16 v[36:39], v[88:91], v[96:99], 0
    ds_read_b128 v[80:83], v127 offset:29696
    s_waitcnt lgkmcnt(8)
    v_mfma_f32_16x16x32_bf16 v[36:39], v[92:95], v[100:103], v[36:39]
    ds_read_b128 v[84:87], v127 offset:30720
    s_waitcnt lgkmcnt(8)
    v_mfma_f32_16x16x32_bf16 v[36:39], v[52:55], v[104:107], v[36:39]
    ds_read_b128 v[88:91], v127 offset:31744
    s_waitcnt lgkmcnt(8)
    v_mfma_f32_16x16x32_bf16 v[36:39], v[56:59], v[108:111], v[36:39]
    v_mov_b32_dpp v24, v28 row_ror:8 row_mask:0xf bank_mask:0xc
    v_mov_b32_dpp v25, v29 row_ror:8 row_mask:0xf bank_mask:0xc
    v_mov_b32_dpp v26, v30 row_ror:8 row_mask:0xf bank_mask:0xc
    v_mov_b32_dpp v27, v31 row_ror:8 row_mask:0xf bank_mask:0xc
    v_min_u32 v24, -2, v24
    v_min_u32 v25, -2, v25
    v_min_u32 v26, -2, v26
    v_min_u32 v27, -2, v27
    s_add_u32 s20, s44, 32768
    buffer_store_dwordx4 v[24:27], v122, s[12:15], s20 offen
    s_waitcnt lgkmcnt(7)
    v_mfma_f32_16x16x32_bf16 v[40:43], v[60:63], v[96:99], 0
    s_waitcnt lgkmcnt(6)
    v_mfma_f32_16x16x32_bf16 v[40:43], v[64:67], v[100:103], v[40:43]
    s_waitcnt lgkmcnt(5)
    v_mfma_f32_16x16x32_bf16 v[40:43], v[68:71], v[104:107], v[40:43]
    s_waitcnt lgkmcnt(4)
    v_mfma_f32_16x16x32_bf16 v[40:43], v[72:75], v[108:111], v[40:43]
    s_waitcnt lgkmcnt(3)
    v_mfma_f32_16x16x32_bf16 v[44:47], v[76:79], v[96:99], 0
    s_waitcnt lgkmcnt(2)
    v_mfma_f32_16x16x32_bf16 v[44:47], v[80:83], v[100:103], v[44:47]
    s_waitcnt lgkmcnt(1)
    v_mfma_f32_16x16x32_bf16 v[44:47], v[84:87], v[104:107], v[44:47]
    s_waitcnt lgkmcnt(0)
    v_mfma_f32_16x16x32_bf16 v[44:47], v[88:91], v[108:111], v[44:47]
    s_nop 1
    v_mov_b32_dpp v32, v36 row_ror:8 row_mask:0xf bank_mask:0xc
    v_mov_b32_dpp v33, v37 row_ror:8 row_mask:0xf bank_mask:0xc
    v_mov_b32_dpp v34, v38 row_ror:8 row_mask:0xf bank_mask:0xc
    v_mov_b32_dpp v35, v39 row_ror:8 row_mask:0xf bank_mask:0xc
    v_min_u32 v32, -2, v32
    v_min_u32 v33, -2, v33
    v_min_u32 v34, -2, v34
    v_min_u32 v35, -2, v35
    s_add_u32 s20, s44, 65536
    buffer_store_dwordx4 v[32:35], v122, s[12:15], s20 offen
    s_nop 1
    v_mov_b32_dpp v40, v44 row_ror:8 row_mask:0xf bank_mask:0xc
    v_mov_b32_dpp v41, v45 row_ror:8 row_mask:0xf bank_mask:0xc
    v_mov_b32_dpp v42, v46 row_ror:8 row_mask:0xf bank_mask:0xc
    v_mov_b32_dpp v43, v47 row_ror:8 row_mask:0xf bank_mask:0xc
    v_min_u32 v40, -2, v40
    v_min_u32 v41, -2, v41
    v_min_u32 v42, -2, v42
    v_min_u32 v43, -2, v43
    s_add_u32 s20, s44, 98304
    buffer_store_dwordx4 v[40:43], v122, s[12:15], s20 offen
    s_add_u32 s44, s34, s49
    s_xor_b32 s51, s44, 0x80000
    s_mov_b32 s41, 0
    buffer_load_dwordx4 v[48:51], v123, s[12:15], s44 offen offset:0 sc1
    buffer_load_dwordx4 v[52:55], v123, s[12:15], s44 offen offset:512 sc1
    buffer_load_dwordx4 v[56:59], v123, s[12:15], s44 offen offset:1024 sc1
    buffer_load_dwordx4 v[60:63], v123, s[12:15], s44 offen offset:1536 sc1
    s_waitcnt vmcnt(0)
    s_branch L_ch_pollchk0
L_ch_pollpart0:
    buffer_load_dwordx4 v[48:51], v123, s[12:15], s44 offen offset:0 sc1
    buffer_load_dwordx4 v[52:55], v123, s[12:15], s44 offen offset:512 sc1
    buffer_load_dwordx4 v[56:59], v123, s[12:15], s44 offen offset:1024 sc1
    buffer_load_dwordx4 v[60:63], v123, s[12:15], s44 offen offset:1536 sc1
    s_add_u32 s41, s41, 1
    s_waitcnt vmcnt(0)
L_ch_pollchk0:
    v_max3_u32 v32, v48, v49, v50
    v_max3_u32 v33, v51, v52, v53
    v_max3_u32 v32, v32, v54, v55
    v_max3_u32 v33, v33, v56, v57
    v_max3_u32 v32, v32, v58, v59
    v_max3_u32 v33, v33, v60, v61
    v_max3_u32 v32, v32, v62, v63
    v_max_u32 v32, v32, v33
    v_cmp_ne_u32 vcc, -1, v32
    s_cmp_eq_u64 vcc, exec
    s_cbranch_scc1 L_ch_pollpart_ok0
    s_cmp_lt_u32 s41, 200000
    s_cbranch_scc1 L_ch_pollpart0
    s_branch L_ch_done
L_ch_pollpart_ok0:
    v_pk_add_f32 v[32:33], v[48:49], v[52:53]
    v_pk_add_f32 v[34:35], v[50:51], v[54:55]
    v_pk_add_f32 v[36:37], v[56:57], v[60:61]
    v_pk_add_f32 v[38:39], v[58:59], v[62:63]
    v_pk_add_f32 v[32:33], v[32:33], v[36:37]
    v_pk_add_f32 v[34:35], v[34:35], v[38:39]
    s_add_u32 s20, s45, s35
    s_nop 0
    v_add_f32_dpp v32, v32, v32 row_ror:8 row_mask:0xf bank_mask:0xf
    v_add_f32_dpp v33, v33, v33 row_ror:8 row_mask:0xf bank_mask:0xf
    v_add_f32_dpp v34, v34, v34 row_ror:8 row_mask:0xf bank_mask:0xf
    v_add_f32_dpp v35, v35, v35 row_ror:8 row_mask:0xf bank_mask:0xf
    v_mov_b32 v36, v32
    v_mov_b32 v37, v33
    v_mov_b32 v38, v34
    v_mov_b32 v39, v35
    s_nop 0
    v_permlane16_swap_b32 v32, v36
    v_permlane16_swap_b32 v33, v37
    v_permlane16_swap_b32 v34, v38
    v_permlane16_swap_b32 v35, v39
    s_nop 0
    v_add_f32 v32, v32, v36
    v_add_f32 v33, v33, v37
    v_add_f32 v34, v34, v38
    v_add_f32 v35, v35, v39
    v_mov_b32 v36, v32
    v_mov_b32 v37, v33
    v_mov_b32 v38, v34
    v_mov_b32 v39, v35
    s_nop 0
    v_permlane32_swap_b32 v32, v36
    v_permlane32_swap_b32 v33, v37
    v_permlane32_swap_b32 v34, v38
    v_permlane32_swap_b32 v35, v39
    s_nop 0
    v_add_f32 v32, v32, v36
    v_add_f32 v33, v33, v37
    v_add_f32 v34, v34, v38
    v_add_f32 v35, v35, v39
    v_cvt_pk_bf16_f32 v32, v32, v33
    v_cvt_pk_bf16_f32 v33, v34, v35
    v_min_u32 v32, -2, v32
    v_min_u32 v33, -2, v33
    s_mov_b64 exec, s[42:43]
    buffer_store_dwordx2 v[32:33], v2, s[12:15], s20 offen
    s_mov_b64 exec, -1
    s_mov_b32 s51, s44
    s_mov_b32 s20, s40
    s_mov_b32 s40, s45
    s_mov_b32 s45, s46
    s_mov_b32 s46, s20
    s_add_u32 s24, s24, 1
    s_branch L_ch_step0
L_ch_step1:
    s_and_b32 s49, s24, 1
    s_lshl_b32 s49, s49, 19
    s_cmp_eq_u32 s24, 0
    s_cbranch_scc1 L_ch_memready1
    s_mov_b32 s41, 0
    v_lshlrev_b32 v3, 5, v0
L_ch_pollmem1:
    buffer_load_dwordx4 v[96:99], v3, s[12:15], s40 offen sc0 sc1
    buffer_load_dwordx4 v[100:103], v3, s[12:15], s40 offen offset:16 sc0 sc1
    s_add_u32 s41, s41, 1
    s_waitcnt vmcnt(0)
    v_max3_u32 v104, v96, v97, v98
    v_max3_u32 v105, v99, v100, v101
    v_max3_u32 v104, v104, v102, v103
    v_max_u32 v104, v104, v105
    v_cmp_ne_u32 vcc, -1, v104
    s_cmp_eq_u64 vcc, exec
    s_cbranch_scc1 L_ch_pollmem_ok1
    s_cmp_lt_u32 s41, 200000
    s_cbranch_scc1 L_ch_pollmem1
    s_branch L_ch_done
L_ch_pollmem_ok1:
    ds_write_b128 v120, v[96:99]
    ds_write_b128 v120, v[100:103] offset:16
    v_add_u32 v3, 0x20000, v2
    s_waitcnt lgkmcnt(0)
    s_barrier
    ds_read_b128 v[32:35], v3 offset:0
    ds_read_b128 v[36:39], v3 offset:1024
    ds_read_b128 v[40:43], v3 offset:2048
    ds_read_b128 v[44:47], v3 offset:3072
    ds_read_b128 v[48:51], v3 offset:4096
    ds_read_b128 v[52:55], v3 offset:5120
    ds_read_b128 v[56:59], v3 offset:6144
    ds_read_b128 v[60:63], v3 offset:7168
    ds_read_b128 v[64:67], v3 offset:8192
    ds_read_b128 v[68:71], v3 offset:9216
    ds_read_b128 v[72:75], v3 offset:10240
    ds_read_b128 v[76:79], v3 offset:11264
    ds_read_b128 v[80:83], v3 offset:12288
    ds_read_b128 v[84:87], v3 offset:13312
    ds_read_b128 v[88:91], v3 offset:14336
    ds_read_b128 v[92:95], v3 offset:15360
    s_cmp_lg_u32 s24, 56
    s_cbranch_scc1 L_ch_kvok1
    v_min_u32 v104, 3, v1
    v_lshrrev_b32 v105, 1, v104
    v_lshlrev_b32 v105, 8, v105
    v_and_b32 v104, 1, v104
    v_lshl_add_u32 v104, v104, 2, v105
    s_add_u32 s19, s53, 3584
    s_mov_b32 s41, 0
L_ch_kvpoll1:
    buffer_load_dword v105, v104, s[12:15], s19 offen sc0 sc1
    s_add_u32 s41, s41, 1
    s_waitcnt vmcnt(0)
    v_cmp_eq_u32 vcc, 1, v105
    s_cmp_eq_u64 vcc, exec
    s_cbranch_scc1 L_ch_kvok1
    s_cmp_lt_u32 s41, 200000
    s_cbranch_scc1 L_ch_kvpoll1
    s_branch L_ch_done
L_ch_kvok1:
    s_waitcnt lgkmcnt(15)
    v_mfma_f32_16x16x32_bf16 v[96:99], a[0:3], v[32:35], 0
    v_mfma_f32_16x16x32_bf16 v[104:107], a[128:131], v[32:35], 0
    v_mfma_f32_16x16x32_bf16 v[100:103], a[64:67], v[32:35], 0
    v_mfma_f32_16x16x32_bf16 v[108:111], a[192:195], v[32:35], 0
    s_lshl_b32 s19, s24, 18
    s_add_u32 s20, s19, s29
    buffer_load_dwordx4 v[16:19], v2, s[12:15], s20 offen
    s_waitcnt lgkmcnt(14)
    v_mfma_f32_16x16x32_bf16 v[96:99], a[4:7], v[36:39], v[96:99]
    v_mfma_f32_16x16x32_bf16 v[104:107], a[132:135], v[36:39], v[104:107]
    v_mfma_f32_16x16x32_bf16 v[100:103], a[68:71], v[36:39], v[100:103]
    v_mfma_f32_16x16x32_bf16 v[108:111], a[196:199], v[36:39], v[108:111]
    s_add_u32 s20, s20, 4096
    buffer_load_dwordx4 v[20:23], v2, s[12:15], s20 offen
    s_waitcnt lgkmcnt(13)
    v_mfma_f32_16x16x32_bf16 v[96:99], a[8:11], v[40:43], v[96:99]
    v_mfma_f32_16x16x32_bf16 v[104:107], a[136:139], v[40:43], v[104:107]
    v_mfma_f32_16x16x32_bf16 v[100:103], a[72:75], v[40:43], v[100:103]
    v_mfma_f32_16x16x32_bf16 v[108:111], a[200:203], v[40:43], v[108:111]
    s_add_u32 s20, s19, s30
    buffer_load_dwordx4 v[24:27], v2, s[12:15], s20 offen
    s_waitcnt lgkmcnt(12)
    v_mfma_f32_16x16x32_bf16 v[96:99], a[12:15], v[44:47], v[96:99]
    v_mfma_f32_16x16x32_bf16 v[104:107], a[140:143], v[44:47], v[104:107]
    v_mfma_f32_16x16x32_bf16 v[100:103], a[76:79], v[44:47], v[100:103]
    v_mfma_f32_16x16x32_bf16 v[108:111], a[204:207], v[44:47], v[108:111]
    buffer_load_dwordx4 v[28:31], v2, s[12:15], s20 offen offset:1024
    s_waitcnt lgkmcnt(11)
    v_mfma_f32_16x16x32_bf16 v[96:99], a[16:19], v[48:51], v[96:99]
    v_mfma_f32_16x16x32_bf16 v[104:107], a[144:147], v[48:51], v[104:107]
    v_mfma_f32_16x16x32_bf16 v[100:103], a[80:83], v[48:51], v[100:103]
    v_mfma_f32_16x16x32_bf16 v[108:111], a[208:211], v[48:51], v[108:111]
    s_sub_u32 s19, s24, 1
    s_lshl_b32 s19, s19, 17
    s_add_u32 s20, s19, s31
    buffer_store_dwordx4 v[8:11], v2, s[12:15], s20 offen sc0 sc1
    s_waitcnt lgkmcnt(10)
    v_mfma_f32_16x16x32_bf16 v[96:99], a[20:23], v[52:55], v[96:99]
    v_mfma_f32_16x16x32_bf16 v[104:107], a[148:151], v[52:55], v[104:107]
    v_mfma_f32_16x16x32_bf16 v[100:103], a[84:87], v[52:55], v[100:103]
    v_mfma_f32_16x16x32_bf16 v[108:111], a[212:215], v[52:55], v[108:111]
    s_add_u32 s20, s19, s32
    v_lshlrev_b32 v3, 3, v1
    buffer_store_dwordx2 v[12:13], v3, s[12:15], s20 offen sc0 sc1
    s_waitcnt lgkmcnt(9)
    v_mfma_f32_16x16x32_bf16 v[96:99], a[24:27], v[56:59], v[96:99]
    v_mfma_f32_16x16x32_bf16 v[104:107], a[152:155], v[56:59], v[104:107]
    v_mfma_f32_16x16x32_bf16 v[100:103], a[88:91], v[56:59], v[100:103]
    v_mfma_f32_16x16x32_bf16 v[108:111], a[216:219], v[56:59], v[108:111]
    buffer_store_dwordx2 v[14:15], v3, s[12:15], s20 offen offset:512 sc0 sc1
    s_waitcnt lgkmcnt(8)
    v_mfma_f32_16x16x32_bf16 v[96:99], a[28:31], v[60:63], v[96:99]
    v_mfma_f32_16x16x32_bf16 v[104:107], a[156:159], v[60:63], v[104:107]
    v_mfma_f32_16x16x32_bf16 v[100:103], a[92:95], v[60:63], v[100:103]
    v_mfma_f32_16x16x32_bf16 v[108:111], a[220:223], v[60:63], v[108:111]
    s_sub_u32 s19, s24, 1
    v_mov_b32 v6, s19
    v_mov_b32 v7, 0
    s_mov_b64 exec, 1
    buffer_store_dword v6, v7, s[12:15], s55 offen sc0 sc1
    s_mov_b64 exec, -1
    s_waitcnt lgkmcnt(7)
    v_mfma_f32_16x16x32_bf16 v[96:99], a[32:35], v[64:67], v[96:99]
    v_mfma_f32_16x16x32_bf16 v[104:107], a[160:163], v[64:67], v[104:107]
    v_mfma_f32_16x16x32_bf16 v[100:103], a[96:99], v[64:67], v[100:103]
    v_mfma_f32_16x16x32_bf16 v[108:111], a[224:227], v[64:67], v[108:111]
    v_mov_b32 v112, -1
    v_mov_b32 v113, -1
    v_mov_b32 v114, -1
    v_mov_b32 v115, -1
    buffer_store_dwordx4 v[112:115], v123, s[12:15], s51 offen offset:0 sc0 sc1
    s_waitcnt lgkmcnt(6)
    v_mfma_f32_16x16x32_bf16 v[96:99], a[36:39], v[68:71], v[96:99]
    v_mfma_f32_16x16x32_bf16 v[104:107], a[164:167], v[68:71], v[104:107]
    v_mfma_f32_16x16x32_bf16 v[100:103], a[100:103], v[68:71], v[100:103]
    v_mfma_f32_16x16x32_bf16 v[108:111], a[228:231], v[68:71], v[108:111]
    buffer_store_dwordx4 v[112:115], v123, s[12:15], s51 offen offset:512 sc0 sc1
    s_waitcnt lgkmcnt(5)
    v_mfma_f32_16x16x32_bf16 v[96:99], a[40:43], v[72:75], v[96:99]
    v_mfma_f32_16x16x32_bf16 v[104:107], a[168:171], v[72:75], v[104:107]
    v_mfma_f32_16x16x32_bf16 v[100:103], a[104:107], v[72:75], v[100:103]
    v_mfma_f32_16x16x32_bf16 v[108:111], a[232:235], v[72:75], v[108:111]
    buffer_store_dwordx4 v[112:115], v123, s[12:15], s51 offen offset:1024 sc0 sc1
    s_waitcnt lgkmcnt(4)
    v_mfma_f32_16x16x32_bf16 v[96:99], a[44:47], v[76:79], v[96:99]
    v_mfma_f32_16x16x32_bf16 v[104:107], a[172:175], v[76:79], v[104:107]
    v_mfma_f32_16x16x32_bf16 v[100:103], a[108:111], v[76:79], v[100:103]
    v_mfma_f32_16x16x32_bf16 v[108:111], a[236:239], v[76:79], v[108:111]
    buffer_store_dwordx4 v[112:115], v123, s[12:15], s51 offen offset:1536 sc0 sc1
    s_waitcnt lgkmcnt(3)
    v_mfma_f32_16x16x32_bf16 v[96:99], a[48:51], v[80:83], v[96:99]
    v_mfma_f32_16x16x32_bf16 v[104:107], a[176:179], v[80:83], v[104:107]
    v_mfma_f32_16x16x32_bf16 v[100:103], a[112:115], v[80:83], v[100:103]
    v_mfma_f32_16x16x32_bf16 v[108:111], a[240:243], v[80:83], v[108:111]
    s_add_u32 s20, s46, s35
    s_mov_b64 exec, s[42:43]
    buffer_store_dwordx2 v[112:113], v2, s[12:15], s20 offen sc0 sc1
    s_mov_b64 exec, -1
    s_waitcnt lgkmcnt(2)
    v_mfma_f32_16x16x32_bf16 v[96:99], a[52:55], v[84:87], v[96:99]
    v_mfma_f32_16x16x32_bf16 v[104:107], a[180:183], v[84:87], v[104:107]
    v_mfma_f32_16x16x32_bf16 v[100:103], a[116:119], v[84:87], v[100:103]
    v_mfma_f32_16x16x32_bf16 v[108:111], a[244:247], v[84:87], v[108:111]
    s_waitcnt lgkmcnt(1)
    v_mfma_f32_16x16x32_bf16 v[96:99], a[56:59], v[88:91], v[96:99]
    v_mfma_f32_16x16x32_bf16 v[104:107], a[184:187], v[88:91], v[104:107]
    v_mfma_f32_16x16x32_bf16 v[100:103], a[120:123], v[88:91], v[100:103]
    v_mfma_f32_16x16x32_bf16 v[108:111], a[248:251], v[88:91], v[108:111]
    s_waitcnt lgkmcnt(0)
    v_mfma_f32_16x16x32_bf16 v[96:99], a[60:63], v[92:95], v[96:99]
    v_mfma_f32_16x16x32_bf16 v[104:107], a[188:191], v[92:95], v[104:107]
    v_mfma_f32_16x16x32_bf16 v[100:103], a[124:127], v[92:95], v[100:103]
    v_mfma_f32_16x16x32_bf16 v[108:111], a[252:255], v[92:95], v[108:111]
    s_branch L_ch_qkdone1
L_ch_memready1:
    v_mfma_f32_16x16x32_bf16 v[96:99], a[0:3], v[32:35], 0
    v_mfma_f32_16x16x32_bf16 v[104:107], a[128:131], v[32:35], 0
    v_mfma_f32_16x16x32_bf16 v[100:103], a[64:67], v[32:35], 0
    v_mfma_f32_16x16x32_bf16 v[108:111], a[192:195], v[32:35], 0
    v_mfma_f32_16x16x32_bf16 v[96:99], a[4:7], v[36:39], v[96:99]
    v_mfma_f32_16x16x32_bf16 v[104:107], a[132:135], v[36:39], v[104:107]
    v_mfma_f32_16x16x32_bf16 v[100:103], a[68:71], v[36:39], v[100:103]
    v_mfma_f32_16x16x32_bf16 v[108:111], a[196:199], v[36:39], v[108:111]
    v_mfma_f32_16x16x32_bf16 v[96:99], a[8:11], v[40:43], v[96:99]
    v_mfma_f32_16x16x32_bf16 v[104:107], a[136:139], v[40:43], v[104:107]
    v_mfma_f32_16x16x32_bf16 v[100:103], a[72:75], v[40:43], v[100:103]
    v_mfma_f32_16x16x32_bf16 v[108:111], a[200:203], v[40:43], v[108:111]
    v_mfma_f32_16x16x32_bf16 v[96:99], a[12:15], v[44:47], v[96:99]
    v_mfma_f32_16x16x32_bf16 v[104:107], a[140:143], v[44:47], v[104:107]
    v_mfma_f32_16x16x32_bf16 v[100:103], a[76:79], v[44:47], v[100:103]
    v_mfma_f32_16x16x32_bf16 v[108:111], a[204:207], v[44:47], v[108:111]
    v_mfma_f32_16x16x32_bf16 v[96:99], a[16:19], v[48:51], v[96:99]
    v_mfma_f32_16x16x32_bf16 v[104:107], a[144:147], v[48:51], v[104:107]
    v_mfma_f32_16x16x32_bf16 v[100:103], a[80:83], v[48:51], v[100:103]
    v_mfma_f32_16x16x32_bf16 v[108:111], a[208:211], v[48:51], v[108:111]
    v_mfma_f32_16x16x32_bf16 v[96:99], a[20:23], v[52:55], v[96:99]
    v_mfma_f32_16x16x32_bf16 v[104:107], a[148:151], v[52:55], v[104:107]
    v_mfma_f32_16x16x32_bf16 v[100:103], a[84:87], v[52:55], v[100:103]
    v_mfma_f32_16x16x32_bf16 v[108:111], a[212:215], v[52:55], v[108:111]
    v_mfma_f32_16x16x32_bf16 v[96:99], a[24:27], v[56:59], v[96:99]
    v_mfma_f32_16x16x32_bf16 v[104:107], a[152:155], v[56:59], v[104:107]
    v_mfma_f32_16x16x32_bf16 v[100:103], a[88:91], v[56:59], v[100:103]
    v_mfma_f32_16x16x32_bf16 v[108:111], a[216:219], v[56:59], v[108:111]
    v_mfma_f32_16x16x32_bf16 v[96:99], a[28:31], v[60:63], v[96:99]
    v_mfma_f32_16x16x32_bf16 v[104:107], a[156:159], v[60:63], v[104:107]
    v_mfma_f32_16x16x32_bf16 v[100:103], a[92:95], v[60:63], v[100:103]
    v_mfma_f32_16x16x32_bf16 v[108:111], a[220:223], v[60:63], v[108:111]
    v_mfma_f32_16x16x32_bf16 v[96:99], a[32:35], v[64:67], v[96:99]
    v_mfma_f32_16x16x32_bf16 v[104:107], a[160:163], v[64:67], v[104:107]
    v_mfma_f32_16x16x32_bf16 v[100:103], a[96:99], v[64:67], v[100:103]
    v_mfma_f32_16x16x32_bf16 v[108:111], a[224:227], v[64:67], v[108:111]
    v_mfma_f32_16x16x32_bf16 v[96:99], a[36:39], v[68:71], v[96:99]
    v_mfma_f32_16x16x32_bf16 v[104:107], a[164:167], v[68:71], v[104:107]
    v_mfma_f32_16x16x32_bf16 v[100:103], a[100:103], v[68:71], v[100:103]
    v_mfma_f32_16x16x32_bf16 v[108:111], a[228:231], v[68:71], v[108:111]
    v_mfma_f32_16x16x32_bf16 v[96:99], a[40:43], v[72:75], v[96:99]
    v_mfma_f32_16x16x32_bf16 v[104:107], a[168:171], v[72:75], v[104:107]
    v_mfma_f32_16x16x32_bf16 v[100:103], a[104:107], v[72:75], v[100:103]
    v_mfma_f32_16x16x32_bf16 v[108:111], a[232:235], v[72:75], v[108:111]
    v_mfma_f32_16x16x32_bf16 v[96:99], a[44:47], v[76:79], v[96:99]
    v_mfma_f32_16x16x32_bf16 v[104:107], a[172:175], v[76:79], v[104:107]
    v_mfma_f32_16x16x32_bf16 v[100:103], a[108:111], v[76:79], v[100:103]
    v_mfma_f32_16x16x32_bf16 v[108:111], a[236:239], v[76:79], v[108:111]
    v_mfma_f32_16x16x32_bf16 v[96:99], a[48:51], v[80:83], v[96:99]
    v_mfma_f32_16x16x32_bf16 v[104:107], a[176:179], v[80:83], v[104:107]
    v_mfma_f32_16x16x32_bf16 v[100:103], a[112:115], v[80:83], v[100:103]
    v_mfma_f32_16x16x32_bf16 v[108:111], a[240:243], v[80:83], v[108:111]
    v_mfma_f32_16x16x32_bf16 v[96:99], a[52:55], v[84:87], v[96:99]
    v_mfma_f32_16x16x32_bf16 v[104:107], a[180:183], v[84:87], v[104:107]
    v_mfma_f32_16x16x32_bf16 v[100:103], a[116:119], v[84:87], v[100:103]
    v_mfma_f32_16x16x32_bf16 v[108:111], a[244:247], v[84:87], v[108:111]
    v_mfma_f32_16x16x32_bf16 v[96:99], a[56:59], v[88:91], v[96:99]
    v_mfma_f32_16x16x32_bf16 v[104:107], a[184:187], v[88:91], v[104:107]
    v_mfma_f32_16x16x32_bf16 v[100:103], a[120:123], v[88:91], v[100:103]
    v_mfma_f32_16x16x32_bf16 v[108:111], a[248:251], v[88:91], v[108:111]
    v_mfma_f32_16x16x32_bf16 v[96:99], a[60:63], v[92:95], v[96:99]
    v_mfma_f32_16x16x32_bf16 v[104:107], a[188:191], v[92:95], v[104:107]
    v_mfma_f32_16x16x32_bf16 v[100:103], a[124:127], v[92:95], v[100:103]
    v_mfma_f32_16x16x32_bf16 v[108:111], a[252:255], v[92:95], v[108:111]
L_ch_qkdone1:
    v_mfma_f32_16x16x32_bf16 v[112:115], v[32:35], v[128:131], 0
    v_mfma_f32_16x16x32_bf16 v[116:119], v[32:35], v[192:195], 0
    s_waitcnt vmcnt(9)
    s_nop 5
    v_cvt_pk_bf16_f32 v4, v96, v97
    v_cvt_pk_bf16_f32 v5, v98, v99
    v_cvt_pk_bf16_f32 v8, v104, v105
    v_cvt_pk_bf16_f32 v9, v106, v107
    v_cvt_pk_bf16_f32 v6, v100, v101
    v_cvt_pk_bf16_f32 v7, v102, v103
    v_cvt_pk_bf16_f32 v10, v108, v109
    v_cvt_pk_bf16_f32 v11, v110, v111
    s_nop 1
    v_mfma_f32_16x16x32_bf16 v[96:99], v[8:11], v[4:7], 0
    v_mfma_f32_16x16x32_bf16 v[100:103], v[16:19], v[4:7], 0
    v_mfma_f32_16x16x32_bf16 v[104:107], v[20:23], v[4:7], 0
    v_mfma_f32_16x16x32_bf16 v[112:115], v[36:39], v[132:135], v[112:115]
    v_mfma_f32_16x16x32_bf16 v[116:119], v[36:39], v[196:199], v[116:119]
    v_mfma_f32_16x16x32_bf16 v[112:115], v[40:43], v[136:139], v[112:115]
    v_mfma_f32_16x16x32_bf16 v[116:119], v[40:43], v[200:203], v[116:119]
    s_nop 4
    ds_write_b128 v124, v[96:99] offset:0
    ds_write_b128 v124, v[100:103] offset:1024
    ds_write_b128 v124, v[104:107] offset:2048
    v_mfma_f32_16x16x32_bf16 v[112:115], v[44:47], v[140:143], v[112:115]
    v_mfma_f32_16x16x32_bf16 v[116:119], v[44:47], v[204:207], v[116:119]
    v_mfma_f32_16x16x32_bf16 v[112:115], v[48:51], v[144:147], v[112:115]
    v_mfma_f32_16x16x32_bf16 v[116:119], v[48:51], v[208:211], v[116:119]
    v_mfma_f32_16x16x32_bf16 v[112:115], v[52:55], v[148:151], v[112:115]
    v_mfma_f32_16x16x32_bf16 v[116:119], v[52:55], v[212:215], v[116:119]
    s_waitcnt lgkmcnt(0)
    s_barrier
    ds_read_b128 v[32:35], v125 offset:0
    ds_read_b64 v[48:49], v126 offset:0
    ds_read_b128 v[36:39], v125 offset:3072
    ds_read_b64 v[50:51], v126 offset:3072
    ds_read_b128 v[40:43], v125 offset:6144
    ds_read_b64 v[52:53], v126 offset:6144
    ds_read_b128 v[44:47], v125 offset:9216
    ds_read_b64 v[54:55], v126 offset:9216
    v_mfma_f32_16x16x32_bf16 v[112:115], v[56:59], v[152:155], v[112:115]
    v_mfma_f32_16x16x32_bf16 v[116:119], v[56:59], v[216:219], v[116:119]
    v_mfma_f32_16x16x32_bf16 v[112:115], v[60:63], v[156:159], v[112:115]
    v_mfma_f32_16x16x32_bf16 v[116:119], v[60:63], v[220:223], v[116:119]
    v_mfma_f32_16x16x32_bf16 v[112:115], v[64:67], v[160:163], v[112:115]
    v_mfma_f32_16x16x32_bf16 v[116:119], v[64:67], v[224:227], v[116:119]
    v_mfma_f32_16x16x32_bf16 v[112:115], v[68:71], v[164:167], v[112:115]
    v_mfma_f32_16x16x32_bf16 v[116:119], v[68:71], v[228:231], v[116:119]
    s_waitcnt lgkmcnt(0)
    v_pk_add_f32 v[32:33], v[32:33], v[36:37]
    v_pk_add_f32 v[34:35], v[34:35], v[38:39]
    v_pk_add_f32 v[40:41], v[40:41], v[44:45]
    v_mfma_f32_16x16x32_bf16 v[112:115], v[72:75], v[168:171], v[112:115]
    v_pk_add_f32 v[42:43], v[42:43], v[46:47]
    v_pk_add_f32 v[48:49], v[48:49], v[50:51]
    v_pk_add_f32 v[52:53], v[52:53], v[54:55]
    v_pk_add_f32 v[32:33], v[32:33], v[40:41]
    v_mfma_f32_16x16x32_bf16 v[116:119], v[72:75], v[232:235], v[116:119]
    v_pk_add_f32 v[34:35], v[34:35], v[42:43]
    v_pk_add_f32 v[36:37], v[48:49], v[52:53]
    v_cvt_pk_bf16_f32 v40, v32, v33
    v_cvt_pk_bf16_f32 v41, v34, v35
    v_mfma_f32_16x16x32_bf16 v[112:115], v[76:79], v[172:175], v[112:115]
    v_cvt_pk_bf16_f32 v42, v36, v37
    v_lshlrev_b32 v32, 16, v40
    v_and_b32 v33, 0xffff0000, v40
    v_lshlrev_b32 v34, 16, v41
    v_mfma_f32_16x16x32_bf16 v[116:119], v[76:79], v[236:239], v[116:119]
    v_and_b32 v35, 0xffff0000, v41
    v_lshlrev_b32 v36, 16, v42
    v_and_b32 v37, 0xffff0000, v42
    v_mul_f32 v32, s25, v32
    v_mfma_f32_16x16x32_bf16 v[112:115], v[80:83], v[176:179], v[112:115]
    v_mul_f32 v33, s25, v33
    v_mul_f32 v34, s25, v34
    v_mul_f32 v35, s25, v35
    v_mul_f32 v36, s25, v36
    v_mfma_f32_16x16x32_bf16 v[116:119], v[80:83], v[240:243], v[116:119]
    v_mul_f32 v37, s25, v37
    v_cvt_pk_bf16_f32 v40, v32, v33
    v_cvt_pk_bf16_f32 v41, v34, v35
    v_cvt_pk_bf16_f32 v42, v36, v37
    v_mfma_f32_16x16x32_bf16 v[112:115], v[84:87], v[180:183], v[112:115]
    v_lshlrev_b32 v32, 16, v40
    v_and_b32 v33, 0xffff0000, v40
    v_lshlrev_b32 v34, 16, v41
    v_and_b32 v35, 0xffff0000, v41
    v_mfma_f32_16x16x32_bf16 v[116:119], v[84:87], v[244:247], v[116:119]
    v_lshlrev_b32 v36, 16, v42
    v_and_b32 v37, 0xffff0000, v42
    v_mov_b32 v44, s27
    v_cndmask_b32 v32, v44, v32, s[36:37]
    v_mfma_f32_16x16x32_bf16 v[112:115], v[88:91], v[184:187], v[112:115]
    v_cndmask_b32 v33, v44, v33, s[36:37]
    v_cndmask_b32 v34, v44, v34, s[36:37]
    v_cndmask_b32 v35, v44, v35, s[36:37]
    v_max3_f32 v45, v32, v33, v34
    v_mfma_f32_16x16x32_bf16 v[116:119], v[88:91], v[248:251], v[116:119]
    v_max3_f32 v45, v45, v35, v36
    v_max_f32 v45, v45, v37
    s_nop 1
    v_max_f32_dpp v45, v45, v45 row_ror:8 row_mask:0xf bank_mask:0xf
    v_mfma_f32_16x16x32_bf16 v[112:115], v[92:95], v[188:191], v[112:115]
    v_mov_b32 v46, v45
    s_nop 1
    v_permlane16_swap_b32 v45, v46
    s_nop 1
    v_mfma_f32_16x16x32_bf16 v[116:119], v[92:95], v[252:255], v[116:119]
    v_max_f32 v45, v45, v46
    v_mov_b32 v46, v45
    s_nop 1
    v_permlane32_swap_b32 v45, v46
    s_nop 1
    v_max_f32 v45, v45, v46
    v_mul_f32 v45, s26, v45
    v_fma_f32 v32, v32, s26, -v45
    v_fma_f32 v33, v33, s26, -v45
    v_fma_f32 v34, v34, s26, -v45
    v_fma_f32 v35, v35, s26, -v45
    v_fma_f32 v36, v36, s26, -v45
    v_fma_f32 v37, v37, s26, -v45
    v_exp_f32 v32, v32
    v_exp_f32 v33, v33
    v_exp_f32 v34, v34
    v_exp_f32 v35, v35
    v_exp_f32 v36, v36
    v_exp_f32 v37, v37
    v_add_f32 v45, v32, v33
    v_add_f32 v46, v34, v35
    v_add_f32 v45, v45, v36
    v_add_f32 v46, v46, v37
    v_add_f32 v45, v45, v46
    s_nop 1
    v_add_f32_dpp v45, v45, v45 row_ror:8 row_mask:0xf bank_mask:0xf
    v_mov_b32 v46, v45
    s_nop 1
    v_permlane16_swap_b32 v45, v46
    s_nop 1
    v_add_f32 v45, v45, v46
    v_mov_b32 v46, v45
    s_nop 1
    v_permlane32_swap_b32 v45, v46
    s_nop 1
    v_add_f32 v45, v45, v46
    v_rcp_f32 v45, v45
    s_nop 0
    v_mul_f32 v32, v32, v45
    v_mul_f32 v33, v33, v45
    v_mul_f32 v34, v34, v45
    v_mul_f32 v35, v35, v45
    v_mul_f32 v36, v36, v45
    v_mul_f32 v37, v37, v45
    v_cvt_pk_bf16_f32 v40, v32, v33
    v_cvt_pk_bf16_f32 v41, v34, v35
    v_cvt_pk_bf16_f32 v48, v36, v37
    s_nop 1
    v_mov_b32_dpp v49, v48 row_ror:8 row_mask:0xf bank_mask:0xf
    v_mov_b32_dpp v50, v40 row_ror:8 row_mask:0xf bank_mask:0xf
    v_mov_b32_dpp v51, v41 row_ror:8 row_mask:0xf bank_mask:0xf
    ds_read_b128 v[52:55], v127 offset:0
    ds_read_b128 v[56:59], v127 offset:1024
    ds_read_b128 v[60:63], v127 offset:2048
    ds_read_b128 v[64:67], v127 offset:3072
    ds_read_b128 v[68:71], v127 offset:4096
    ds_read_b128 v[72:75], v127 offset:5120
    ds_read_b128 v[76:79], v127 offset:6144
    ds_read_b128 v[80:83], v127 offset:7168
    ds_read_b128 v[84:87], v127 offset:8192
    ds_read_b128 v[88:91], v127 offset:9216
    ds_read_b128 v[92:95], v127 offset:10240
    v_cvt_pk_bf16_f32 v12, v112, v113
    v_cvt_pk_bf16_f32 v13, v114, v115
    v_cvt_pk_bf16_f32 v14, v116, v117
    v_cvt_pk_bf16_f32 v15, v118, v119
    v_cndmask_b32 v12, 0, v12, s[38:39]
    v_cndmask_b32 v13, 0, v13, s[38:39]
    v_cndmask_b32 v14, 0, v14, s[38:39]
    v_cndmask_b32 v15, 0, v15, s[38:39]
    s_nop 1
    v_mfma_f32_16x16x16_bf16 v[96:99], v[12:13], v[40:41], 0
    v_mfma_f32_16x16x16_bf16 v[100:103], v[14:15], v[40:41], 0
    v_mfma_f32_16x16x32_bf16 v[96:99], v[24:27], v[48:51], v[96:99]
    v_mfma_f32_16x16x32_bf16 v[100:103], v[28:31], v[48:51], v[100:103]
    s_cmp_eq_u32 s24, 63
    s_cbranch_scc1 L_ch_last
    s_add_u32 s44, s33, s49
    v_add_u32 v3, 159744, v2
    s_nop 4
    v_cvt_pk_bf16_f32 v104, v96, v97
    v_cvt_pk_bf16_f32 v105, v98, v99
    v_cvt_pk_bf16_f32 v106, v100, v101
    v_cvt_pk_bf16_f32 v107, v102, v103
    ds_write_b128 v121, v[104:107]
    s_waitcnt lgkmcnt(0)
    s_barrier
    ds_read_b128 v[96:99], v3 offset:0
    ds_read_b128 v[100:103], v3 offset:1024
    ds_read_b128 v[104:107], v3 offset:2048
    ds_read_b128 v[108:111], v3 offset:3072
    s_waitcnt lgkmcnt(0)
    v_mfma_f32_16x16x32_bf16 v[16:19], v[52:55], v[96:99], 0
    s_waitcnt lgkmcnt(9)
    v_mfma_f32_16x16x32_bf16 v[16:19], v[56:59], v[100:103], v[16:19]
    s_waitcnt lgkmcnt(8)
    v_mfma_f32_16x16x32_bf16 v[16:19], v[60:63], v[104:107], v[16:19]
    ds_read_b128 v[52:55], v127 offset:11264
    s_waitcnt lgkmcnt(8)
    v_mfma_f32_16x16x32_bf16 v[16:19], v[64:67], v[108:111], v[16:19]
    ds_read_b128 v[56:59], v127 offset:12288
    s_waitcnt lgkmcnt(8)
    v_mfma_f32_16x16x32_bf16 v[20:23], v[68:71], v[96:99], 0
    ds_read_b128 v[60:63], v127 offset:13312
    s_waitcnt lgkmcnt(8)
    v_mfma_f32_16x16x32_bf16 v[20:23], v[72:75], v[100:103], v[20:23]
    ds_read_b128 v[64:67], v127 offset:14336
    s_waitcnt lgkmcnt(8)
    v_mfma_f32_16x16x32_bf16 v[20:23], v[76:79], v[104:107], v[20:23]
    ds_read_b128 v[68:71], v127 offset:15360
    s_waitcnt lgkmcnt(8)
    v_mfma_f32_16x16x32_bf16 v[20:23], v[80:83], v[108:111], v[20:23]
    ds_read_b128 v[72:75], v127 offset:16384
    s_waitcnt lgkmcnt(8)
    v_mfma_f32_16x16x32_bf16 v[24:27], v[84:87], v[96:99], 0
    ds_read_b128 v[76:79], v127 offset:17408
    s_waitcnt lgkmcnt(8)
    v_mfma_f32_16x16x32_bf16 v[24:27], v[88:91], v[100:103], v[24:27]
    ds_read_b128 v[80:83], v127 offset:18432
    s_waitcnt lgkmcnt(8)
    v_mfma_f32_16x16x32_bf16 v[24:27], v[92:95], v[104:107], v[24:27]
    ds_read_b128 v[84:87], v127 offset:19456
    s_waitcnt lgkmcnt(8)
    v_mfma_f32_16x16x32_bf16 v[24:27], v[52:55], v[108:111], v[24:27]
    ds_read_b128 v[88:91], v127 offset:20480
    s_waitcnt lgkmcnt(8)
    v_mfma_f32_16x16x32_bf16 v[28:31], v[56:59], v[96:99], 0
    ds_read_b128 v[92:95], v127 offset:21504
    s_waitcnt lgkmcnt(8)
    v_mfma_f32_16x16x32_bf16 v[28:31], v[60:63], v[100:103], v[28:31]
    ds_read_b128 v[52:55], v127 offset:22528
    s_waitcnt lgkmcnt(8)
    v_mfma_f32_16x16x32_bf16 v[28:31], v[64:67], v[104:107], v[28:31]
    ds_read_b128 v[56:59], v127 offset:23552
    s_waitcnt lgkmcnt(8)
    v_mfma_f32_16x16x32_bf16 v[28:31], v[68:71], v[108:111], v[28:31]
    ds_read_b128 v[60:63], v127 offset:24576
    v_mov_b32_dpp v16, v20 row_ror:8 row_mask:0xf bank_mask:0xc
    v_mov_b32_dpp v17, v21 row_ror:8 row_mask:0xf bank_mask:0xc
    v_mov_b32_dpp v18, v22 row_ror:8 row_mask:0xf bank_mask:0xc
    v_mov_b32_dpp v19, v23 row_ror:8 row_mask:0xf bank_mask:0xc
    v_min_u32 v16, -2, v16
    v_min_u32 v17, -2, v17
    v_min_u32 v18, -2, v18
    v_min_u32 v19, -2, v19
    s_add_u32 s20, s44, 0
    buffer_store_dwordx4 v[16:19], v122, s[12:15], s20 offen sc0 sc1
    s_waitcnt lgkmcnt(8)
    v_mfma_f32_16x16x32_bf16 v[32:35], v[72:75], v[96:99], 0
    ds_read_b128 v[64:67], v127 offset:25600
    s_waitcnt lgkmcnt(8)
    v_mfma_f32_16x16x32_bf16 v[32:35], v[76:79], v[100:103], v[32:35]
    ds_read_b128 v[68:71], v127 offset:26624
    s_waitcnt lgkmcnt(8)
    v_mfma_f32_16x16x32_bf16 v[32:35], v[80:83], v[104:107], v[32:35]
    ds_read_b128 v[72:75], v127 offset:27648
    s_waitcnt lgkmcnt(8)
    v_mfma_f32_16x16x32_bf16 v[32:35], v[84:87], v[108:111], v[32:35]
    ds_read_b128 v[76:79], v127 offset:28672
    s_waitcnt lgkmcnt(8)
    v_mfma_f32_16x16x32_bf16 v[36:39], v[88:91], v[96:99], 0
    ds_read_b128 v[80:83], v127 offset:29696
    s_waitcnt lgkmcnt(8)
    v_mfma_f32_16x16x32_bf16 v[36:39], v[92:95], v[100:103], v[36:39]
    ds_read_b128 v[84:87], v127 offset:30720
    s_waitcnt lgkmcnt(8)
    v_mfma_f32_16x16x32_bf16 v[36:39], v[52:55], v[104:107], v[36:39]
    ds_read_b128 v[88:91], v127 offset:31744
    s_waitcnt lgkmcnt(8)
    v_mfma_f32_16x16x32_bf16 v[36:39], v[56:59], v[108:111], v[36:39]
    v_mov_b32_dpp v24, v28 row_ror:8 row_mask:0xf bank_mask:0xc
    v_mov_b32_dpp v25, v29 row_ror:8 row_mask:0xf bank_mask:0xc
    v_mov_b32_dpp v26, v30 row_ror:8 row_mask:0xf bank_mask:0xc
    v_mov_b32_dpp v27, v31 row_ror:8 row_mask:0xf bank_mask:0xc
    v_min_u32 v24, -2, v24
    v_min_u32 v25, -2, v25
    v_min_u32 v26, -2, v26
    v_min_u32 v27, -2, v27
    s_add_u32 s20, s44, 32768
    buffer_store_dwordx4 v[24:27], v122, s[12:15], s20 offen sc0 sc1
    s_waitcnt lgkmcnt(7)
    v_mfma_f32_16x16x32_bf16 v[40:43], v[60:63], v[96:99], 0
    s_waitcnt lgkmcnt(6)
    v_mfma_f32_16x16x32_bf16 v[40:43], v[64:67], v[100:103], v[40:43]
    s_waitcnt lgkmcnt(5)
    v_mfma_f32_16x16x32_bf16 v[40:43], v[68:71], v[104:107], v[40:43]
    s_waitcnt lgkmcnt(4)
    v_mfma_f32_16x16x32_bf16 v[40:43], v[72:75], v[108:111], v[40:43]
    s_waitcnt lgkmcnt(3)
    v_mfma_f32_16x16x32_bf16 v[44:47], v[76:79], v[96:99], 0
    s_waitcnt lgkmcnt(2)
    v_mfma_f32_16x16x32_bf16 v[44:47], v[80:83], v[100:103], v[44:47]
    s_waitcnt lgkmcnt(1)
    v_mfma_f32_16x16x32_bf16 v[44:47], v[84:87], v[104:107], v[44:47]
    s_waitcnt lgkmcnt(0)
    v_mfma_f32_16x16x32_bf16 v[44:47], v[88:91], v[108:111], v[44:47]
    s_nop 1
    v_mov_b32_dpp v32, v36 row_ror:8 row_mask:0xf bank_mask:0xc
    v_mov_b32_dpp v33, v37 row_ror:8 row_mask:0xf bank_mask:0xc
    v_mov_b32_dpp v34, v38 row_ror:8 row_mask:0xf bank_mask:0xc
    v_mov_b32_dpp v35, v39 row_ror:8 row_mask:0xf bank_mask:0xc
    v_min_u32 v32, -2, v32
    v_min_u32 v33, -2, v33
    v_min_u32 v34, -2, v34
    v_min_u32 v35, -2, v35
    s_add_u32 s20, s44, 65536
    buffer_store_dwordx4 v[32:35], v122, s[12:15], s20 offen sc0 sc1
    s_nop 1
    v_mov_b32_dpp v40, v44 row_ror:8 row_mask:0xf bank_mask:0xc
    v_mov_b32_dpp v41, v45 row_ror:8 row_mask:0xf bank_mask:0xc
    v_mov_b32_dpp v42, v46 row_ror:8 row_mask:0xf bank_mask:0xc
    v_mov_b32_dpp v43, v47 row_ror:8 row_mask:0xf bank_mask:0xc
    v_min_u32 v40, -2, v40
    v_min_u32 v41, -2, v41
    v_min_u32 v42, -2, v42
    v_min_u32 v43, -2, v43
    s_add_u32 s20, s44, 98304
    buffer_store_dwordx4 v[40:43], v122, s[12:15], s20 offen sc0 sc1
    s_add_u32 s44, s34, s49
    s_xor_b32 s51, s44, 0x80000
    s_mov_b32 s41, 0
    buffer_load_dwordx4 v[48:51], v123, s[12:15], s44 offen offset:0 sc0 sc1
    buffer_load_dwordx4 v[52:55], v123, s[12:15], s44 offen offset:512 sc0 sc1
    buffer_load_dwordx4 v[56:59], v123, s[12:15], s44 offen offset:1024 sc0 sc1
    buffer_load_dwordx4 v[60:63], v123, s[12:15], s44 offen offset:1536 sc0 sc1
    s_waitcnt vmcnt(0)
    s_branch L_ch_pollchk1
L_ch_pollpart1:
    buffer_load_dwordx4 v[48:51], v123, s[12:15], s44 offen offset:0 sc0 sc1
    buffer_load_dwordx4 v[52:55], v123, s[12:15], s44 offen offset:512 sc0 sc1
    buffer_load_dwordx4 v[56:59], v123, s[12:15], s44 offen offset:1024 sc0 sc1
    buffer_load_dwordx4 v[60:63], v123, s[12:15], s44 offen offset:1536 sc0 sc1
    s_add_u32 s41, s41, 1
    s_waitcnt vmcnt(0)
L_ch_pollchk1:
    v_max3_u32 v32, v48, v49, v50
    v_max3_u32 v33, v51, v52, v53
    v_max3_u32 v32, v32, v54, v55
    v_max3_u32 v33, v33, v56, v57
    v_max3_u32 v32, v32, v58, v59
    v_max3_u32 v33, v33, v60, v61
    v_max3_u32 v32, v32, v62, v63
    v_max_u32 v32, v32, v33
    v_cmp_ne_u32 vcc, -1, v32
    s_cmp_eq_u64 vcc, exec
    s_cbranch_scc1 L_ch_pollpart_ok1
    s_cmp_lt_u32 s41, 200000
    s_cbranch_scc1 L_ch_pollpart1
    s_branch L_ch_done
L_ch_pollpart_ok1:
    v_pk_add_f32 v[32:33], v[48:49], v[52:53]
    v_pk_add_f32 v[34:35], v[50:51], v[54:55]
    v_pk_add_f32 v[36:37], v[56:57], v[60:61]
    v_pk_add_f32 v[38:39], v[58:59], v[62:63]
    v_pk_add_f32 v[32:33], v[32:33], v[36:37]
    v_pk_add_f32 v[34:35], v[34:35], v[38:39]
    s_add_u32 s20, s45, s35
    s_nop 0
    v_add_f32_dpp v32, v32, v32 row_ror:8 row_mask:0xf bank_mask:0xf
    v_add_f32_dpp v33, v33, v33 row_ror:8 row_mask:0xf bank_mask:0xf
    v_add_f32_dpp v34, v34, v34 row_ror:8 row_mask:0xf bank_mask:0xf
    v_add_f32_dpp v35, v35, v35 row_ror:8 row_mask:0xf bank_mask:0xf
    v_mov_b32 v36, v32
    v_mov_b32 v37, v33
    v_mov_b32 v38, v34
    v_mov_b32 v39, v35
    s_nop 0
    v_permlane16_swap_b32 v32, v36
    v_permlane16_swap_b32 v33, v37
    v_permlane16_swap_b32 v34, v38
    v_permlane16_swap_b32 v35, v39
    s_nop 0
    v_add_f32 v32, v32, v36
    v_add_f32 v33, v33, v37
    v_add_f32 v34, v34, v38
    v_add_f32 v35, v35, v39
    v_mov_b32 v36, v32
    v_mov_b32 v37, v33
    v_mov_b32 v38, v34
    v_mov_b32 v39, v35
    s_nop 0
    v_permlane32_swap_b32 v32, v36
    v_permlane32_swap_b32 v33, v37
    v_permlane32_swap_b32 v34, v38
    v_permlane32_swap_b32 v35, v39
    s_nop 0
    v_add_f32 v32, v32, v36
    v_add_f32 v33, v33, v37
    v_add_f32 v34, v34, v38
    v_add_f32 v35, v35, v39
    v_cvt_pk_bf16_f32 v32, v32, v33
    v_cvt_pk_bf16_f32 v33, v34, v35
    v_min_u32 v32, -2, v32
    v_min_u32 v33, -2, v33
    s_mov_b64 exec, s[42:43]
    buffer_store_dwordx2 v[32:33], v2, s[12:15], s20 offen sc0 sc1
    s_mov_b64 exec, -1
    s_mov_b32 s51, s44
    s_mov_b32 s20, s40
    s_mov_b32 s40, s45
    s_mov_b32 s45, s46
    s_mov_b32 s46, s20
    s_add_u32 s24, s24, 1
    s_branch L_ch_step1
L_ch_last:
    s_lshl_b32 s19, s24, 17
    s_add_u32 s20, s19, s31
    buffer_store_dwordx4 v[8:11], v2, s[12:15], s20 offen sc0 sc1
    s_add_u32 s20, s19, s32
    v_lshlrev_b32 v3, 3, v1
    buffer_store_dwordx2 v[12:13], v3, s[12:15], s20 offen sc0 sc1
    buffer_store_dwordx2 v[14:15], v3, s[12:15], s20 offen offset:512 sc0 sc1
    s_waitcnt vmcnt(0)
    v_mov_b32 v14, 64
    v_mov_b32 v15, 0
    s_mov_b64 exec, 1
    buffer_store_dword v14, v15, s[12:15], s55 offen sc0 sc1
L_ch_done:
    s_endpgm
L_g1_entry:
    s_lshr_b32 s50, s2, 3
    s_mul_i32 s50, s50, 7
    s_and_b32 s3, s2, 7
    s_add_u32 s50, s50, s3
    s_sub_u32 s50, s50, 1
    s_load_dwordx2 s[4:5], s[0:1], 0
    s_load_dwordx2 s[6:7], s[0:1], 104
    s_load_dwordx2 s[44:45], s[0:1], 88
    v_lshrrev_b32 v1, 6, v0
    s_nop 1
    v_readfirstlane_b32 s18, v1
    v_and_b32 v1, 63, v0
    v_lshlrev_b32 v2, 4, v1
    s_waitcnt lgkmcnt(0)
    s_mov_b32 s8, s4
    s_and_b32 s9, s5, 0xffff
    s_mov_b32 s10, 0x200000
    s_mov_b32 s11, 0x00020000
    s_mov_b32 s12, s6
    s_and_b32 s13, s7, 0xffff
    s_mov_b32 s14, 0x10000000
    s_mov_b32 s15, 0x00020000
    s_mov_b32 s40, s44
    s_and_b32 s41, s45, 0xffff
    s_mov_b32 s42, 0x200000
    s_mov_b32 s43, 0x00020000
L_g1_task:
    s_lshr_b32 s16, s50, 4
    s_and_b32 s17, s50, 15
    s_lshl_b32 s19, s16, 17
    s_lshl_b32 s20, s18, 15
    s_add_u32 s19, s19, s20
    s_add_u32 s19, s19, 0x7e00000
    v_add_u32 v21, s20, v2
    buffer_load_dwordx4 v[32:35], v2, s[12:15], s19 offen offset:0
    buffer_load_dwordx4 v[36:39], v2, s[12:15], s19 offen offset:1024
    buffer_load_dwordx4 v[40:43], v2, s[12:15], s19 offen offset:2048
    buffer_load_dwordx4 v[44:47], v2, s[12:15], s19 offen offset:3072
    s_add_u32 s19, s19, 4096
    buffer_load_dwordx4 v[48:51], v2, s[12:15], s19 offen offset:0
    buffer_load_dwordx4 v[52:55], v2, s[12:15], s19 offen offset:1024
    buffer_load_dwordx4 v[56:59], v2, s[12:15], s19 offen offset:2048
    buffer_load_dwordx4 v[60:63], v2, s[12:15], s19 offen offset:3072
    s_add_u32 s19, s19, 4096
    buffer_load_dwordx4 v[64:67], v2, s[12:15], s19 offen offset:0
    buffer_load_dwordx4 v[68:71], v2, s[12:15], s19 offen offset:1024
    buffer_load_dwordx4 v[72:75], v2, s[12:15], s19 offen offset:2048
    buffer_load_dwordx4 v[76:79], v2, s[12:15], s19 offen offset:3072
    s_add_u32 s19, s19, 4096
    buffer_load_dwordx4 v[80:83], v2, s[12:15], s19 offen offset:0
    buffer_load_dwordx4 v[84:87], v2, s[12:15], s19 offen offset:1024
    buffer_load_dwordx4 v[88:91], v2, s[12:15], s19 offen offset:2048
    buffer_load_dwordx4 v[92:95], v2, s[12:15], s19 offen offset:3072
    s_add_u32 s19, s19, 4096
    buffer_load_dwordx4 v[96:99], v2, s[12:15], s19 offen offset:0
    buffer_load_dwordx4 v[100:103], v2, s[12:15], s19 offen offset:1024
    buffer_load_dwordx4 v[104:107], v2, s[12:15], s19 offen offset:2048
    buffer_load_dwordx4 v[108:111], v2, s[12:15], s19 offen offset:3072
    s_add_u32 s19, s19, 4096
    buffer_load_dwordx4 v[112:115], v2, s[12:15], s19 offen offset:0
    buffer_load_dwordx4 v[116:119], v2, s[12:15], s19 offen offset:1024
    buffer_load_dwordx4 v[120:123], v2, s[12:15], s19 offen offset:2048
    buffer_load_dwordx4 v[124:127], v2, s[12:15], s19 offen offset:3072
    s_add_u32 s19, s19, 4096
    buffer_load_dwordx4 v[128:131], v2, s[12:15], s19 offen offset:0
    buffer_load_dwordx4 v[132:135], v2, s[12:15], s19 offen offset:1024
    buffer_load_dwordx4 v[136:139], v2, s[12:15], s19 offen offset:2048
    buffer_load_dwordx4 v[140:143], v2, s[12:15], s19 offen offset:3072
    s_add_u32 s19, s19, 4096
    buffer_load_dwordx4 v[144:147], v2, s[12:15], s19 offen offset:0
    buffer_load_dwordx4 v[148:151], v2, s[12:15], s19 offen offset:1024
    buffer_load_dwordx4 v[152:155], v2, s[12:15], s19 offen offset:2048
    buffer_load_dwordx4 v[156:159], v2, s[12:15], s19 offen offset:3072
    s_waitcnt vmcnt(31)
    ds_write_b128 v21, v[32:35] offset:0
    s_waitcnt vmcnt(30)
    ds_write_b128 v21, v[36:39] offset:1024
    s_waitcnt vmcnt(29)
    ds_write_b128 v21, v[40:43] offset:2048
    s_waitcnt vmcnt(28)
    ds_write_b128 v21, v[44:47] offset:3072
    s_waitcnt vmcnt(27)
    ds_write_b128 v21, v[48:51] offset:4096
    s_waitcnt vmcnt(26)
    ds_write_b128 v21, v[52:55] offset:5120
    s_waitcnt vmcnt(25)
    ds_write_b128 v21, v[56:59] offset:6144
    s_waitcnt vmcnt(24)
    ds_write_b128 v21, v[60:63] offset:7168
    s_waitcnt vmcnt(23)
    ds_write_b128 v21, v[64:67] offset:8192
    s_waitcnt vmcnt(22)
    ds_write_b128 v21, v[68:71] offset:9216
    s_waitcnt vmcnt(21)
    ds_write_b128 v21, v[72:75] offset:10240
    s_waitcnt vmcnt(20)
    ds_write_b128 v21, v[76:79] offset:11264
    s_waitcnt vmcnt(19)
    ds_write_b128 v21, v[80:83] offset:12288
    s_waitcnt vmcnt(18)
    ds_write_b128 v21, v[84:87] offset:13312
    s_waitcnt vmcnt(17)
    ds_write_b128 v21, v[88:91] offset:14336
    s_waitcnt vmcnt(16)
    ds_write_b128 v21, v[92:95] offset:15360
    s_waitcnt vmcnt(15)
    ds_write_b128 v21, v[96:99] offset:16384
    s_waitcnt vmcnt(14)
    ds_write_b128 v21, v[100:103] offset:17408
    s_waitcnt vmcnt(13)
    ds_write_b128 v21, v[104:107] offset:18432
    s_waitcnt vmcnt(12)
    ds_write_b128 v21, v[108:111] offset:19456
    s_waitcnt vmcnt(11)
    ds_write_b128 v21, v[112:115] offset:20480
    s_waitcnt vmcnt(10)
    ds_write_b128 v21, v[116:119] offset:21504
    s_waitcnt vmcnt(9)
    ds_write_b128 v21, v[120:123] offset:22528
    s_waitcnt vmcnt(8)
    ds_write_b128 v21, v[124:127] offset:23552
    s_waitcnt vmcnt(7)
    ds_write_b128 v21, v[128:131] offset:24576
    s_waitcnt vmcnt(6)
    ds_write_b128 v21, v[132:135] offset:25600
    s_waitcnt vmcnt(5)
    ds_write_b128 v21, v[136:139] offset:26624
    s_waitcnt vmcnt(4)
    ds_write_b128 v21, v[140:143] offset:27648
    s_waitcnt vmcnt(3)
    ds_write_b128 v21, v[144:147] offset:28672
    s_waitcnt vmcnt(2)
    ds_write_b128 v21, v[148:151] offset:29696
    s_waitcnt vmcnt(1)
    ds_write_b128 v21, v[152:155] offset:30720
    s_waitcnt vmcnt(0)
    ds_write_b128 v21, v[156:159] offset:31744
    s_waitcnt lgkmcnt(0)
    s_barrier
    v_mov_b32 v3, v2
    v_add_u32 v4, 0x10000, v2
    s_lshr_b32 s28, s18, 1
    s_lshl_b32 s19, s17, 1
    s_add_u32 s28, s28, s19
    s_and_b32 s29, s18, 1
    s_lshl_b32 s29, s29, 2
    s_add_u32 s19, s28, 32
    s_lshl_b32 s19, s19, 3
    s_add_u32 s19, s19, s29
    s_lshl_b32 s24, s19, 14
    s_add_u32 s25, s24, 16384
    s_add_u32 s26, s24, 32768
    s_add_u32 s27, s24, 49152
    v_add_u32 v5, 0, v2
    buffer_load_dwordx4 v[32:35], v5, s[12:15], s24 offen
    buffer_load_dwordx4 v[36:39], v5, s[12:15], s25 offen
    buffer_load_dwordx4 v[40:43], v5, s[12:15], s26 offen
    buffer_load_dwordx4 v[44:47], v5, s[12:15], s27 offen
    v_add_u32 v5, 1024, v2
    buffer_load_dwordx4 v[48:51], v5, s[12:15], s24 offen
    buffer_load_dwordx4 v[52:55], v5, s[12:15], s25 offen
    buffer_load_dwordx4 v[56:59], v5, s[12:15], s26 offen
    buffer_load_dwordx4 v[60:63], v5, s[12:15], s27 offen
    ds_read_b128 v[80:83], v3 offset:0
    ds_read_b128 v[84:87], v3 offset:16384
    ds_read_b128 v[88:91], v3 offset:32768
    ds_read_b128 v[92:95], v3 offset:49152
    ds_read_b128 v[96:99], v4 offset:0
    ds_read_b128 v[100:103], v4 offset:16384
    ds_read_b128 v[104:107], v4 offset:32768
    ds_read_b128 v[108:111], v4 offset:49152
    v_add_u32 v5, 2048, v2
    buffer_load_dwordx4 v[64:67], v5, s[12:15], s24 offen
    buffer_load_dwordx4 v[68:71], v5, s[12:15], s25 offen
    buffer_load_dwordx4 v[72:75], v5, s[12:15], s26 offen
    buffer_load_dwordx4 v[76:79], v5, s[12:15], s27 offen
    ds_read_b128 v[112:115], v3 offset:1024
    ds_read_b128 v[116:119], v3 offset:17408
    ds_read_b128 v[120:123], v3 offset:33792
    ds_read_b128 v[124:127], v3 offset:50176
    ds_read_b128 v[128:131], v4 offset:1024
    ds_read_b128 v[132:135], v4 offset:17408
    ds_read_b128 v[136:139], v4 offset:33792
    ds_read_b128 v[140:143], v4 offset:50176
    s_waitcnt vmcnt(8) lgkmcnt(8)
    v_mfma_f32_16x16x32_bf16 a[0:3], v[32:35], v[80:83], 0
    v_mfma_f32_16x16x32_bf16 a[4:7], v[32:35], v[84:87], 0
    v_mfma_f32_16x16x32_bf16 a[8:11], v[32:35], v[88:91], 0
    v_mfma_f32_16x16x32_bf16 a[12:15], v[32:35], v[92:95], 0
    v_mfma_f32_16x16x32_bf16 a[16:19], v[32:35], v[96:99], 0
    v_mfma_f32_16x16x32_bf16 a[20:23], v[32:35], v[100:103], 0
    v_mfma_f32_16x16x32_bf16 a[24:27], v[32:35], v[104:107], 0
    v_mfma_f32_16x16x32_bf16 a[28:31], v[32:35], v[108:111], 0
    v_mfma_f32_16x16x32_bf16 a[32:35], v[36:39], v[80:83], 0
    v_mfma_f32_16x16x32_bf16 a[36:39], v[36:39], v[84:87], 0
    v_mfma_f32_16x16x32_bf16 a[40:43], v[36:39], v[88:91], 0
    v_mfma_f32_16x16x32_bf16 a[44:47], v[36:39], v[92:95], 0
    v_mfma_f32_16x16x32_bf16 a[48:51], v[36:39], v[96:99], 0
    v_mfma_f32_16x16x32_bf16 a[52:55], v[36:39], v[100:103], 0
    v_mfma_f32_16x16x32_bf16 a[56:59], v[36:39], v[104:107], 0
    v_mfma_f32_16x16x32_bf16 a[60:63], v[36:39], v[108:111], 0
    v_mfma_f32_16x16x32_bf16 a[64:67], v[40:43], v[80:83], 0
    v_mfma_f32_16x16x32_bf16 a[68:71], v[40:43], v[84:87], 0
    v_mfma_f32_16x16x32_bf16 a[72:75], v[40:43], v[88:91], 0
    v_mfma_f32_16x16x32_bf16 a[76:79], v[40:43], v[92:95], 0
    v_mfma_f32_16x16x32_bf16 a[80:83], v[40:43], v[96:99], 0
    v_mfma_f32_16x16x32_bf16 a[84:87], v[40:43], v[100:103], 0
    v_mfma_f32_16x16x32_bf16 a[88:91], v[40:43], v[104:107], 0
    v_mfma_f32_16x16x32_bf16 a[92:95], v[40:43], v[108:111], 0
    v_mfma_f32_16x16x32_bf16 a[96:99], v[44:47], v[80:83], 0
    v_mfma_f32_16x16x32_bf16 a[100:103], v[44:47], v[84:87], 0
    v_mfma_f32_16x16x32_bf16 a[104:107], v[44:47], v[88:91], 0
    v_mfma_f32_16x16x32_bf16 a[108:111], v[44:47], v[92:95], 0
    v_mfma_f32_16x16x32_bf16 a[112:115], v[44:47], v[96:99], 0
    v_mfma_f32_16x16x32_bf16 a[116:119], v[44:47], v[100:103], 0
    v_mfma_f32_16x16x32_bf16 a[120:123], v[44:47], v[104:107], 0
    v_mfma_f32_16x16x32_bf16 a[124:127], v[44:47], v[108:111], 0
    v_add_u32 v5, 3072, v2
    buffer_load_dwordx4 v[32:35], v5, s[12:15], s24 offen
    buffer_load_dwordx4 v[36:39], v5, s[12:15], s25 offen
    buffer_load_dwordx4 v[40:43], v5, s[12:15], s26 offen
    buffer_load_dwordx4 v[44:47], v5, s[12:15], s27 offen
    ds_read_b128 v[80:83], v3 offset:2048
    ds_read_b128 v[84:87], v3 offset:18432
    ds_read_b128 v[88:91], v3 offset:34816
    ds_read_b128 v[92:95], v3 offset:51200
    ds_read_b128 v[96:99], v4 offset:2048
    ds_read_b128 v[100:103], v4 offset:18432
    ds_read_b128 v[104:107], v4 offset:34816
    ds_read_b128 v[108:111], v4 offset:51200
    s_waitcnt vmcnt(8) lgkmcnt(8)
    v_mfma_f32_16x16x32_bf16 a[0:3], v[48:51], v[112:115], a[0:3]
    v_mfma_f32_16x16x32_bf16 a[4:7], v[48:51], v[116:119], a[4:7]
    v_mfma_f32_16x16x32_bf16 a[8:11], v[48:51], v[120:123], a[8:11]
    v_mfma_f32_16x16x32_bf16 a[12:15], v[48:51], v[124:127], a[12:15]
    v_mfma_f32_16x16x32_bf16 a[16:19], v[48:51], v[128:131], a[16:19]
    v_mfma_f32_16x16x32_bf16 a[20:23], v[48:51], v[132:135], a[20:23]
    v_mfma_f32_16x16x32_bf16 a[24:27], v[48:51], v[136:139], a[24:27]
    v_mfma_f32_16x16x32_bf16 a[28:31], v[48:51], v[140:143], a[28:31]
    v_mfma_f32_16x16x32_bf16 a[32:35], v[52:55], v[112:115], a[32:35]
    v_mfma_f32_16x16x32_bf16 a[36:39], v[52:55], v[116:119], a[36:39]
    v_mfma_f32_16x16x32_bf16 a[40:43], v[52:55], v[120:123], a[40:43]
    v_mfma_f32_16x16x32_bf16 a[44:47], v[52:55], v[124:127], a[44:47]
    v_mfma_f32_16x16x32_bf16 a[48:51], v[52:55], v[128:131], a[48:51]
    v_mfma_f32_16x16x32_bf16 a[52:55], v[52:55], v[132:135], a[52:55]
    v_mfma_f32_16x16x32_bf16 a[56:59], v[52:55], v[136:139], a[56:59]
    v_mfma_f32_16x16x32_bf16 a[60:63], v[52:55], v[140:143], a[60:63]
    v_mfma_f32_16x16x32_bf16 a[64:67], v[56:59], v[112:115], a[64:67]
    v_mfma_f32_16x16x32_bf16 a[68:71], v[56:59], v[116:119], a[68:71]
    v_mfma_f32_16x16x32_bf16 a[72:75], v[56:59], v[120:123], a[72:75]
    v_mfma_f32_16x16x32_bf16 a[76:79], v[56:59], v[124:127], a[76:79]
    v_mfma_f32_16x16x32_bf16 a[80:83], v[56:59], v[128:131], a[80:83]
    v_mfma_f32_16x16x32_bf16 a[84:87], v[56:59], v[132:135], a[84:87]
    v_mfma_f32_16x16x32_bf16 a[88:91], v[56:59], v[136:139], a[88:91]
    v_mfma_f32_16x16x32_bf16 a[92:95], v[56:59], v[140:143], a[92:95]
    v_mfma_f32_16x16x32_bf16 a[96:99], v[60:63], v[112:115], a[96:99]
    v_mfma_f32_16x16x32_bf16 a[100:103], v[60:63], v[116:119], a[100:103]
    v_mfma_f32_16x16x32_bf16 a[104:107], v[60:63], v[120:123], a[104:107]
    v_mfma_f32_16x16x32_bf16 a[108:111], v[60:63], v[124:127], a[108:111]
    v_mfma_f32_16x16x32_bf16 a[112:115], v[60:63], v[128:131], a[112:115]
    v_mfma_f32_16x16x32_bf16 a[116:119], v[60:63], v[132:135], a[116:119]
    v_mfma_f32_16x16x32_bf16 a[120:123], v[60:63], v[136:139], a[120:123]
    v_mfma_f32_16x16x32_bf16 a[124:127], v[60:63], v[140:143], a[124:127]
    v_add_u32 v5, 4096, v2
    buffer_load_dwordx4 v[48:51], v5, s[12:15], s24 offen
    buffer_load_dwordx4 v[52:55], v5, s[12:15], s25 offen
    buffer_load_dwordx4 v[56:59], v5, s[12:15], s26 offen
    buffer_load_dwordx4 v[60:63], v5, s[12:15], s27 offen
    ds_read_b128 v[112:115], v3 offset:3072
    ds_read_b128 v[116:119], v3 offset:19456
    ds_read_b128 v[120:123], v3 offset:35840
    ds_read_b128 v[124:127], v3 offset:52224
    ds_read_b128 v[128:131], v4 offset:3072
    ds_read_b128 v[132:135], v4 offset:19456
    ds_read_b128 v[136:139], v4 offset:35840
    ds_read_b128 v[140:143], v4 offset:52224
    s_waitcnt vmcnt(8) lgkmcnt(8)
    v_mfma_f32_16x16x32_bf16 a[0:3], v[64:67], v[80:83], a[0:3]
    v_mfma_f32_16x16x32_bf16 a[4:7], v[64:67], v[84:87], a[4:7]
    v_mfma_f32_16x16x32_bf16 a[8:11], v[64:67], v[88:91], a[8:11]
    v_mfma_f32_16x16x32_bf16 a[12:15], v[64:67], v[92:95], a[12:15]
    v_mfma_f32_16x16x32_bf16 a[16:19], v[64:67], v[96:99], a[16:19]
    v_mfma_f32_16x16x32_bf16 a[20:23], v[64:67], v[100:103], a[20:23]
    v_mfma_f32_16x16x32_bf16 a[24:27], v[64:67], v[104:107], a[24:27]
    v_mfma_f32_16x16x32_bf16 a[28:31], v[64:67], v[108:111], a[28:31]
    v_mfma_f32_16x16x32_bf16 a[32:35], v[68:71], v[80:83], a[32:35]
    v_mfma_f32_16x16x32_bf16 a[36:39], v[68:71], v[84:87], a[36:39]
    v_mfma_f32_16x16x32_bf16 a[40:43], v[68:71], v[88:91], a[40:43]
    v_mfma_f32_16x16x32_bf16 a[44:47], v[68:71], v[92:95], a[44:47]
    v_mfma_f32_16x16x32_bf16 a[48:51], v[68:71], v[96:99], a[48:51]
    v_mfma_f32_16x16x32_bf16 a[52:55], v[68:71], v[100:103], a[52:55]
    v_mfma_f32_16x16x32_bf16 a[56:59], v[68:71], v[104:107], a[56:59]
    v_mfma_f32_16x16x32_bf16 a[60:63], v[68:71], v[108:111], a[60:63]
    v_mfma_f32_16x16x32_bf16 a[64:67], v[72:75], v[80:83], a[64:67]
    v_mfma_f32_16x16x32_bf16 a[68:71], v[72:75], v[84:87], a[68:71]
    v_mfma_f32_16x16x32_bf16 a[72:75], v[72:75], v[88:91], a[72:75]
    v_mfma_f32_16x16x32_bf16 a[76:79], v[72:75], v[92:95], a[76:79]
    v_mfma_f32_16x16x32_bf16 a[80:83], v[72:75], v[96:99], a[80:83]
    v_mfma_f32_16x16x32_bf16 a[84:87], v[72:75], v[100:103], a[84:87]
    v_mfma_f32_16x16x32_bf16 a[88:91], v[72:75], v[104:107], a[88:91]
    v_mfma_f32_16x16x32_bf16 a[92:95], v[72:75], v[108:111], a[92:95]
    v_mfma_f32_16x16x32_bf16 a[96:99], v[76:79], v[80:83], a[96:99]
    v_mfma_f32_16x16x32_bf16 a[100:103], v[76:79], v[84:87], a[100:103]
    v_mfma_f32_16x16x32_bf16 a[104:107], v[76:79], v[88:91], a[104:107]
    v_mfma_f32_16x16x32_bf16 a[108:111], v[76:79], v[92:95], a[108:111]
    v_mfma_f32_16x16x32_bf16 a[112:115], v[76:79], v[96:99], a[112:115]
    v_mfma_f32_16x16x32_bf16 a[116:119], v[76:79], v[100:103], a[116:119]
    v_mfma_f32_16x16x32_bf16 a[120:123], v[76:79], v[104:107], a[120:123]
    v_mfma_f32_16x16x32_bf16 a[124:127], v[76:79], v[108:111], a[124:127]
    v_add_u32 v5, 5120, v2
    buffer_load_dwordx4 v[64:67], v5, s[12:15], s24 offen
    buffer_load_dwordx4 v[68:71], v5, s[12:15], s25 offen
    buffer_load_dwordx4 v[72:75], v5, s[12:15], s26 offen
    buffer_load_dwordx4 v[76:79], v5, s[12:15], s27 offen
    ds_read_b128 v[80:83], v3 offset:4096
    ds_read_b128 v[84:87], v3 offset:20480
    ds_read_b128 v[88:91], v3 offset:36864
    ds_read_b128 v[92:95], v3 offset:53248
    ds_read_b128 v[96:99], v4 offset:4096
    ds_read_b128 v[100:103], v4 offset:20480
    ds_read_b128 v[104:107], v4 offset:36864
    ds_read_b128 v[108:111], v4 offset:53248
    s_waitcnt vmcnt(8) lgkmcnt(8)
    v_mfma_f32_16x16x32_bf16 a[0:3], v[32:35], v[112:115], a[0:3]
    v_mfma_f32_16x16x32_bf16 a[4:7], v[32:35], v[116:119], a[4:7]
    v_mfma_f32_16x16x32_bf16 a[8:11], v[32:35], v[120:123], a[8:11]
    v_mfma_f32_16x16x32_bf16 a[12:15], v[32:35], v[124:127], a[12:15]
    v_mfma_f32_16x16x32_bf16 a[16:19], v[32:35], v[128:131], a[16:19]
    v_mfma_f32_16x16x32_bf16 a[20:23], v[32:35], v[132:135], a[20:23]
    v_mfma_f32_16x16x32_bf16 a[24:27], v[32:35], v[136:139], a[24:27]
    v_mfma_f32_16x16x32_bf16 a[28:31], v[32:35], v[140:143], a[28:31]
    v_mfma_f32_16x16x32_bf16 a[32:35], v[36:39], v[112:115], a[32:35]
    v_mfma_f32_16x16x32_bf16 a[36:39], v[36:39], v[116:119], a[36:39]
    v_mfma_f32_16x16x32_bf16 a[40:43], v[36:39], v[120:123], a[40:43]
    v_mfma_f32_16x16x32_bf16 a[44:47], v[36:39], v[124:127], a[44:47]
    v_mfma_f32_16x16x32_bf16 a[48:51], v[36:39], v[128:131], a[48:51]
    v_mfma_f32_16x16x32_bf16 a[52:55], v[36:39], v[132:135], a[52:55]
    v_mfma_f32_16x16x32_bf16 a[56:59], v[36:39], v[136:139], a[56:59]
    v_mfma_f32_16x16x32_bf16 a[60:63], v[36:39], v[140:143], a[60:63]
    v_mfma_f32_16x16x32_bf16 a[64:67], v[40:43], v[112:115], a[64:67]
    v_mfma_f32_16x16x32_bf16 a[68:71], v[40:43], v[116:119], a[68:71]
    v_mfma_f32_16x16x32_bf16 a[72:75], v[40:43], v[120:123], a[72:75]
    v_mfma_f32_16x16x32_bf16 a[76:79], v[40:43], v[124:127], a[76:79]
    v_mfma_f32_16x16x32_bf16 a[80:83], v[40:43], v[128:131], a[80:83]
    v_mfma_f32_16x16x32_bf16 a[84:87], v[40:43], v[132:135], a[84:87]
    v_mfma_f32_16x16x32_bf16 a[88:91], v[40:43], v[136:139], a[88:91]
    v_mfma_f32_16x16x32_bf16 a[92:95], v[40:43], v[140:143], a[92:95]
    v_mfma_f32_16x16x32_bf16 a[96:99], v[44:47], v[112:115], a[96:99]
    v_mfma_f32_16x16x32_bf16 a[100:103], v[44:47], v[116:119], a[100:103]
    v_mfma_f32_16x16x32_bf16 a[104:107], v[44:47], v[120:123], a[104:107]
    v_mfma_f32_16x16x32_bf16 a[108:111], v[44:47], v[124:127], a[108:111]
    v_mfma_f32_16x16x32_bf16 a[112:115], v[44:47], v[128:131], a[112:115]
    v_mfma_f32_16x16x32_bf16 a[116:119], v[44:47], v[132:135], a[116:119]
    v_mfma_f32_16x16x32_bf16 a[120:123], v[44:47], v[136:139], a[120:123]
    v_mfma_f32_16x16x32_bf16 a[124:127], v[44:47], v[140:143], a[124:127]
    v_add_u32 v5, 6144, v2
    buffer_load_dwordx4 v[32:35], v5, s[12:15], s24 offen
    buffer_load_dwordx4 v[36:39], v5, s[12:15], s25 offen
    buffer_load_dwordx4 v[40:43], v5, s[12:15], s26 offen
    buffer_load_dwordx4 v[44:47], v5, s[12:15], s27 offen
    ds_read_b128 v[112:115], v3 offset:5120
    ds_read_b128 v[116:119], v3 offset:21504
    ds_read_b128 v[120:123], v3 offset:37888
    ds_read_b128 v[124:127], v3 offset:54272
    ds_read_b128 v[128:131], v4 offset:5120
    ds_read_b128 v[132:135], v4 offset:21504
    ds_read_b128 v[136:139], v4 offset:37888
    ds_read_b128 v[140:143], v4 offset:54272
    s_waitcnt vmcnt(8) lgkmcnt(8)
    v_mfma_f32_16x16x32_bf16 a[0:3], v[48:51], v[80:83], a[0:3]
    v_mfma_f32_16x16x32_bf16 a[4:7], v[48:51], v[84:87], a[4:7]
    v_mfma_f32_16x16x32_bf16 a[8:11], v[48:51], v[88:91], a[8:11]
    v_mfma_f32_16x16x32_bf16 a[12:15], v[48:51], v[92:95], a[12:15]
    v_mfma_f32_16x16x32_bf16 a[16:19], v[48:51], v[96:99], a[16:19]
    v_mfma_f32_16x16x32_bf16 a[20:23], v[48:51], v[100:103], a[20:23]
    v_mfma_f32_16x16x32_bf16 a[24:27], v[48:51], v[104:107], a[24:27]
    v_mfma_f32_16x16x32_bf16 a[28:31], v[48:51], v[108:111], a[28:31]
    v_mfma_f32_16x16x32_bf16 a[32:35], v[52:55], v[80:83], a[32:35]
    v_mfma_f32_16x16x32_bf16 a[36:39], v[52:55], v[84:87], a[36:39]
    v_mfma_f32_16x16x32_bf16 a[40:43], v[52:55], v[88:91], a[40:43]
    v_mfma_f32_16x16x32_bf16 a[44:47], v[52:55], v[92:95], a[44:47]
    v_mfma_f32_16x16x32_bf16 a[48:51], v[52:55], v[96:99], a[48:51]
    v_mfma_f32_16x16x32_bf16 a[52:55], v[52:55], v[100:103], a[52:55]
    v_mfma_f32_16x16x32_bf16 a[56:59], v[52:55], v[104:107], a[56:59]
    v_mfma_f32_16x16x32_bf16 a[60:63], v[52:55], v[108:111], a[60:63]
    v_mfma_f32_16x16x32_bf16 a[64:67], v[56:59], v[80:83], a[64:67]
    v_mfma_f32_16x16x32_bf16 a[68:71], v[56:59], v[84:87], a[68:71]
    v_mfma_f32_16x16x32_bf16 a[72:75], v[56:59], v[88:91], a[72:75]
    v_mfma_f32_16x16x32_bf16 a[76:79], v[56:59], v[92:95], a[76:79]
    v_mfma_f32_16x16x32_bf16 a[80:83], v[56:59], v[96:99], a[80:83]
    v_mfma_f32_16x16x32_bf16 a[84:87], v[56:59], v[100:103], a[84:87]
    v_mfma_f32_16x16x32_bf16 a[88:91], v[56:59], v[104:107], a[88:91]
    v_mfma_f32_16x16x32_bf16 a[92:95], v[56:59], v[108:111], a[92:95]
    v_mfma_f32_16x16x32_bf16 a[96:99], v[60:63], v[80:83], a[96:99]
    v_mfma_f32_16x16x32_bf16 a[100:103], v[60:63], v[84:87], a[100:103]
    v_mfma_f32_16x16x32_bf16 a[104:107], v[60:63], v[88:91], a[104:107]
    v_mfma_f32_16x16x32_bf16 a[108:111], v[60:63], v[92:95], a[108:111]
    v_mfma_f32_16x16x32_bf16 a[112:115], v[60:63], v[96:99], a[112:115]
    v_mfma_f32_16x16x32_bf16 a[116:119], v[60:63], v[100:103], a[116:119]
    v_mfma_f32_16x16x32_bf16 a[120:123], v[60:63], v[104:107], a[120:123]
    v_mfma_f32_16x16x32_bf16 a[124:127], v[60:63], v[108:111], a[124:127]
    v_add_u32 v5, 7168, v2
    buffer_load_dwordx4 v[48:51], v5, s[12:15], s24 offen
    buffer_load_dwordx4 v[52:55], v5, s[12:15], s25 offen
    buffer_load_dwordx4 v[56:59], v5, s[12:15], s26 offen
    buffer_load_dwordx4 v[60:63], v5, s[12:15], s27 offen
    ds_read_b128 v[80:83], v3 offset:6144
    ds_read_b128 v[84:87], v3 offset:22528
    ds_read_b128 v[88:91], v3 offset:38912
    ds_read_b128 v[92:95], v3 offset:55296
    ds_read_b128 v[96:99], v4 offset:6144
    ds_read_b128 v[100:103], v4 offset:22528
    ds_read_b128 v[104:107], v4 offset:38912
    ds_read_b128 v[108:111], v4 offset:55296
    s_waitcnt vmcnt(8) lgkmcnt(8)
    v_mfma_f32_16x16x32_bf16 a[0:3], v[64:67], v[112:115], a[0:3]
    v_mfma_f32_16x16x32_bf16 a[4:7], v[64:67], v[116:119], a[4:7]
    v_mfma_f32_16x16x32_bf16 a[8:11], v[64:67], v[120:123], a[8:11]
    v_mfma_f32_16x16x32_bf16 a[12:15], v[64:67], v[124:127], a[12:15]
    v_mfma_f32_16x16x32_bf16 a[16:19], v[64:67], v[128:131], a[16:19]
    v_mfma_f32_16x16x32_bf16 a[20:23], v[64:67], v[132:135], a[20:23]
    v_mfma_f32_16x16x32_bf16 a[24:27], v[64:67], v[136:139], a[24:27]
    v_mfma_f32_16x16x32_bf16 a[28:31], v[64:67], v[140:143], a[28:31]
    v_mfma_f32_16x16x32_bf16 a[32:35], v[68:71], v[112:115], a[32:35]
    v_mfma_f32_16x16x32_bf16 a[36:39], v[68:71], v[116:119], a[36:39]
    v_mfma_f32_16x16x32_bf16 a[40:43], v[68:71], v[120:123], a[40:43]
    v_mfma_f32_16x16x32_bf16 a[44:47], v[68:71], v[124:127], a[44:47]
    v_mfma_f32_16x16x32_bf16 a[48:51], v[68:71], v[128:131], a[48:51]
    v_mfma_f32_16x16x32_bf16 a[52:55], v[68:71], v[132:135], a[52:55]
    v_mfma_f32_16x16x32_bf16 a[56:59], v[68:71], v[136:139], a[56:59]
    v_mfma_f32_16x16x32_bf16 a[60:63], v[68:71], v[140:143], a[60:63]
    v_mfma_f32_16x16x32_bf16 a[64:67], v[72:75], v[112:115], a[64:67]
    v_mfma_f32_16x16x32_bf16 a[68:71], v[72:75], v[116:119], a[68:71]
    v_mfma_f32_16x16x32_bf16 a[72:75], v[72:75], v[120:123], a[72:75]
    v_mfma_f32_16x16x32_bf16 a[76:79], v[72:75], v[124:127], a[76:79]
    v_mfma_f32_16x16x32_bf16 a[80:83], v[72:75], v[128:131], a[80:83]
    v_mfma_f32_16x16x32_bf16 a[84:87], v[72:75], v[132:135], a[84:87]
    v_mfma_f32_16x16x32_bf16 a[88:91], v[72:75], v[136:139], a[88:91]
    v_mfma_f32_16x16x32_bf16 a[92:95], v[72:75], v[140:143], a[92:95]
    v_mfma_f32_16x16x32_bf16 a[96:99], v[76:79], v[112:115], a[96:99]
    v_mfma_f32_16x16x32_bf16 a[100:103], v[76:79], v[116:119], a[100:103]
    v_mfma_f32_16x16x32_bf16 a[104:107], v[76:79], v[120:123], a[104:107]
    v_mfma_f32_16x16x32_bf16 a[108:111], v[76:79], v[124:127], a[108:111]
    v_mfma_f32_16x16x32_bf16 a[112:115], v[76:79], v[128:131], a[112:115]
    v_mfma_f32_16x16x32_bf16 a[116:119], v[76:79], v[132:135], a[116:119]
    v_mfma_f32_16x16x32_bf16 a[120:123], v[76:79], v[136:139], a[120:123]
    v_mfma_f32_16x16x32_bf16 a[124:127], v[76:79], v[140:143], a[124:127]
    v_add_u32 v5, 8192, v2
    buffer_load_dwordx4 v[64:67], v5, s[12:15], s24 offen
    buffer_load_dwordx4 v[68:71], v5, s[12:15], s25 offen
    buffer_load_dwordx4 v[72:75], v5, s[12:15], s26 offen
    buffer_load_dwordx4 v[76:79], v5, s[12:15], s27 offen
    ds_read_b128 v[112:115], v3 offset:7168
    ds_read_b128 v[116:119], v3 offset:23552
    ds_read_b128 v[120:123], v3 offset:39936
    ds_read_b128 v[124:127], v3 offset:56320
    ds_read_b128 v[128:131], v4 offset:7168
    ds_read_b128 v[132:135], v4 offset:23552
    ds_read_b128 v[136:139], v4 offset:39936
    ds_read_b128 v[140:143], v4 offset:56320
    s_waitcnt vmcnt(8) lgkmcnt(8)
    v_mfma_f32_16x16x32_bf16 a[0:3], v[32:35], v[80:83], a[0:3]
    v_mfma_f32_16x16x32_bf16 a[4:7], v[32:35], v[84:87], a[4:7]
    v_mfma_f32_16x16x32_bf16 a[8:11], v[32:35], v[88:91], a[8:11]
    v_mfma_f32_16x16x32_bf16 a[12:15], v[32:35], v[92:95], a[12:15]
    v_mfma_f32_16x16x32_bf16 a[16:19], v[32:35], v[96:99], a[16:19]
    v_mfma_f32_16x16x32_bf16 a[20:23], v[32:35], v[100:103], a[20:23]
    v_mfma_f32_16x16x32_bf16 a[24:27], v[32:35], v[104:107], a[24:27]
    v_mfma_f32_16x16x32_bf16 a[28:31], v[32:35], v[108:111], a[28:31]
    v_mfma_f32_16x16x32_bf16 a[32:35], v[36:39], v[80:83], a[32:35]
    v_mfma_f32_16x16x32_bf16 a[36:39], v[36:39], v[84:87], a[36:39]
    v_mfma_f32_16x16x32_bf16 a[40:43], v[36:39], v[88:91], a[40:43]
    v_mfma_f32_16x16x32_bf16 a[44:47], v[36:39], v[92:95], a[44:47]
    v_mfma_f32_16x16x32_bf16 a[48:51], v[36:39], v[96:99], a[48:51]
    v_mfma_f32_16x16x32_bf16 a[52:55], v[36:39], v[100:103], a[52:55]
    v_mfma_f32_16x16x32_bf16 a[56:59], v[36:39], v[104:107], a[56:59]
    v_mfma_f32_16x16x32_bf16 a[60:63], v[36:39], v[108:111], a[60:63]
    v_mfma_f32_16x16x32_bf16 a[64:67], v[40:43], v[80:83], a[64:67]
    v_mfma_f32_16x16x32_bf16 a[68:71], v[40:43], v[84:87], a[68:71]
    v_mfma_f32_16x16x32_bf16 a[72:75], v[40:43], v[88:91], a[72:75]
    v_mfma_f32_16x16x32_bf16 a[76:79], v[40:43], v[92:95], a[76:79]
    v_mfma_f32_16x16x32_bf16 a[80:83], v[40:43], v[96:99], a[80:83]
    v_mfma_f32_16x16x32_bf16 a[84:87], v[40:43], v[100:103], a[84:87]
    v_mfma_f32_16x16x32_bf16 a[88:91], v[40:43], v[104:107], a[88:91]
    v_mfma_f32_16x16x32_bf16 a[92:95], v[40:43], v[108:111], a[92:95]
    v_mfma_f32_16x16x32_bf16 a[96:99], v[44:47], v[80:83], a[96:99]
    v_mfma_f32_16x16x32_bf16 a[100:103], v[44:47], v[84:87], a[100:103]
    v_mfma_f32_16x16x32_bf16 a[104:107], v[44:47], v[88:91], a[104:107]
    v_mfma_f32_16x16x32_bf16 a[108:111], v[44:47], v[92:95], a[108:111]
    v_mfma_f32_16x16x32_bf16 a[112:115], v[44:47], v[96:99], a[112:115]
    v_mfma_f32_16x16x32_bf16 a[116:119], v[44:47], v[100:103], a[116:119]
    v_mfma_f32_16x16x32_bf16 a[120:123], v[44:47], v[104:107], a[120:123]
    v_mfma_f32_16x16x32_bf16 a[124:127], v[44:47], v[108:111], a[124:127]
    v_add_u32 v5, 9216, v2
    buffer_load_dwordx4 v[32:35], v5, s[12:15], s24 offen
    buffer_load_dwordx4 v[36:39], v5, s[12:15], s25 offen
    buffer_load_dwordx4 v[40:43], v5, s[12:15], s26 offen
    buffer_load_dwordx4 v[44:47], v5, s[12:15], s27 offen
    ds_read_b128 v[80:83], v3 offset:8192
    ds_read_b128 v[84:87], v3 offset:24576
    ds_read_b128 v[88:91], v3 offset:40960
    ds_read_b128 v[92:95], v3 offset:57344
    ds_read_b128 v[96:99], v4 offset:8192
    ds_read_b128 v[100:103], v4 offset:24576
    ds_read_b128 v[104:107], v4 offset:40960
    ds_read_b128 v[108:111], v4 offset:57344
    s_waitcnt vmcnt(8) lgkmcnt(8)
    v_mfma_f32_16x16x32_bf16 a[0:3], v[48:51], v[112:115], a[0:3]
    v_mfma_f32_16x16x32_bf16 a[4:7], v[48:51], v[116:119], a[4:7]
    v_mfma_f32_16x16x32_bf16 a[8:11], v[48:51], v[120:123], a[8:11]
    v_mfma_f32_16x16x32_bf16 a[12:15], v[48:51], v[124:127], a[12:15]
    v_mfma_f32_16x16x32_bf16 a[16:19], v[48:51], v[128:131], a[16:19]
    v_mfma_f32_16x16x32_bf16 a[20:23], v[48:51], v[132:135], a[20:23]
    v_mfma_f32_16x16x32_bf16 a[24:27], v[48:51], v[136:139], a[24:27]
    v_mfma_f32_16x16x32_bf16 a[28:31], v[48:51], v[140:143], a[28:31]
    v_mfma_f32_16x16x32_bf16 a[32:35], v[52:55], v[112:115], a[32:35]
    v_mfma_f32_16x16x32_bf16 a[36:39], v[52:55], v[116:119], a[36:39]
    v_mfma_f32_16x16x32_bf16 a[40:43], v[52:55], v[120:123], a[40:43]
    v_mfma_f32_16x16x32_bf16 a[44:47], v[52:55], v[124:127], a[44:47]
    v_mfma_f32_16x16x32_bf16 a[48:51], v[52:55], v[128:131], a[48:51]
    v_mfma_f32_16x16x32_bf16 a[52:55], v[52:55], v[132:135], a[52:55]
    v_mfma_f32_16x16x32_bf16 a[56:59], v[52:55], v[136:139], a[56:59]
    v_mfma_f32_16x16x32_bf16 a[60:63], v[52:55], v[140:143], a[60:63]
    v_mfma_f32_16x16x32_bf16 a[64:67], v[56:59], v[112:115], a[64:67]
    v_mfma_f32_16x16x32_bf16 a[68:71], v[56:59], v[116:119], a[68:71]
    v_mfma_f32_16x16x32_bf16 a[72:75], v[56:59], v[120:123], a[72:75]
    v_mfma_f32_16x16x32_bf16 a[76:79], v[56:59], v[124:127], a[76:79]
    v_mfma_f32_16x16x32_bf16 a[80:83], v[56:59], v[128:131], a[80:83]
    v_mfma_f32_16x16x32_bf16 a[84:87], v[56:59], v[132:135], a[84:87]
    v_mfma_f32_16x16x32_bf16 a[88:91], v[56:59], v[136:139], a[88:91]
    v_mfma_f32_16x16x32_bf16 a[92:95], v[56:59], v[140:143], a[92:95]
    v_mfma_f32_16x16x32_bf16 a[96:99], v[60:63], v[112:115], a[96:99]
    v_mfma_f32_16x16x32_bf16 a[100:103], v[60:63], v[116:119], a[100:103]
    v_mfma_f32_16x16x32_bf16 a[104:107], v[60:63], v[120:123], a[104:107]
    v_mfma_f32_16x16x32_bf16 a[108:111], v[60:63], v[124:127], a[108:111]
    v_mfma_f32_16x16x32_bf16 a[112:115], v[60:63], v[128:131], a[112:115]
    v_mfma_f32_16x16x32_bf16 a[116:119], v[60:63], v[132:135], a[116:119]
    v_mfma_f32_16x16x32_bf16 a[120:123], v[60:63], v[136:139], a[120:123]
    v_mfma_f32_16x16x32_bf16 a[124:127], v[60:63], v[140:143], a[124:127]
    v_add_u32 v5, 10240, v2
    buffer_load_dwordx4 v[48:51], v5, s[12:15], s24 offen
    buffer_load_dwordx4 v[52:55], v5, s[12:15], s25 offen
    buffer_load_dwordx4 v[56:59], v5, s[12:15], s26 offen
    buffer_load_dwordx4 v[60:63], v5, s[12:15], s27 offen
    ds_read_b128 v[112:115], v3 offset:9216
    ds_read_b128 v[116:119], v3 offset:25600
    ds_read_b128 v[120:123], v3 offset:41984
    ds_read_b128 v[124:127], v3 offset:58368
    ds_read_b128 v[128:131], v4 offset:9216
    ds_read_b128 v[132:135], v4 offset:25600
    ds_read_b128 v[136:139], v4 offset:41984
    ds_read_b128 v[140:143], v4 offset:58368
    s_waitcnt vmcnt(8) lgkmcnt(8)
    v_mfma_f32_16x16x32_bf16 a[0:3], v[64:67], v[80:83], a[0:3]
    v_mfma_f32_16x16x32_bf16 a[4:7], v[64:67], v[84:87], a[4:7]
    v_mfma_f32_16x16x32_bf16 a[8:11], v[64:67], v[88:91], a[8:11]
    v_mfma_f32_16x16x32_bf16 a[12:15], v[64:67], v[92:95], a[12:15]
    v_mfma_f32_16x16x32_bf16 a[16:19], v[64:67], v[96:99], a[16:19]
    v_mfma_f32_16x16x32_bf16 a[20:23], v[64:67], v[100:103], a[20:23]
    v_mfma_f32_16x16x32_bf16 a[24:27], v[64:67], v[104:107], a[24:27]
    v_mfma_f32_16x16x32_bf16 a[28:31], v[64:67], v[108:111], a[28:31]
    v_mfma_f32_16x16x32_bf16 a[32:35], v[68:71], v[80:83], a[32:35]
    v_mfma_f32_16x16x32_bf16 a[36:39], v[68:71], v[84:87], a[36:39]
    v_mfma_f32_16x16x32_bf16 a[40:43], v[68:71], v[88:91], a[40:43]
    v_mfma_f32_16x16x32_bf16 a[44:47], v[68:71], v[92:95], a[44:47]
    v_mfma_f32_16x16x32_bf16 a[48:51], v[68:71], v[96:99], a[48:51]
    v_mfma_f32_16x16x32_bf16 a[52:55], v[68:71], v[100:103], a[52:55]
    v_mfma_f32_16x16x32_bf16 a[56:59], v[68:71], v[104:107], a[56:59]
    v_mfma_f32_16x16x32_bf16 a[60:63], v[68:71], v[108:111], a[60:63]
    v_mfma_f32_16x16x32_bf16 a[64:67], v[72:75], v[80:83], a[64:67]
    v_mfma_f32_16x16x32_bf16 a[68:71], v[72:75], v[84:87], a[68:71]
    v_mfma_f32_16x16x32_bf16 a[72:75], v[72:75], v[88:91], a[72:75]
    v_mfma_f32_16x16x32_bf16 a[76:79], v[72:75], v[92:95], a[76:79]
    v_mfma_f32_16x16x32_bf16 a[80:83], v[72:75], v[96:99], a[80:83]
    v_mfma_f32_16x16x32_bf16 a[84:87], v[72:75], v[100:103], a[84:87]
    v_mfma_f32_16x16x32_bf16 a[88:91], v[72:75], v[104:107], a[88:91]
    v_mfma_f32_16x16x32_bf16 a[92:95], v[72:75], v[108:111], a[92:95]
    v_mfma_f32_16x16x32_bf16 a[96:99], v[76:79], v[80:83], a[96:99]
    v_mfma_f32_16x16x32_bf16 a[100:103], v[76:79], v[84:87], a[100:103]
    v_mfma_f32_16x16x32_bf16 a[104:107], v[76:79], v[88:91], a[104:107]
    v_mfma_f32_16x16x32_bf16 a[108:111], v[76:79], v[92:95], a[108:111]
    v_mfma_f32_16x16x32_bf16 a[112:115], v[76:79], v[96:99], a[112:115]
    v_mfma_f32_16x16x32_bf16 a[116:119], v[76:79], v[100:103], a[116:119]
    v_mfma_f32_16x16x32_bf16 a[120:123], v[76:79], v[104:107], a[120:123]
    v_mfma_f32_16x16x32_bf16 a[124:127], v[76:79], v[108:111], a[124:127]
    v_add_u32 v5, 11264, v2
    buffer_load_dwordx4 v[64:67], v5, s[12:15], s24 offen
    buffer_load_dwordx4 v[68:71], v5, s[12:15], s25 offen
    buffer_load_dwordx4 v[72:75], v5, s[12:15], s26 offen
    buffer_load_dwordx4 v[76:79], v5, s[12:15], s27 offen
    ds_read_b128 v[80:83], v3 offset:10240
    ds_read_b128 v[84:87], v3 offset:26624
    ds_read_b128 v[88:91], v3 offset:43008
    ds_read_b128 v[92:95], v3 offset:59392
    ds_read_b128 v[96:99], v4 offset:10240
    ds_read_b128 v[100:103], v4 offset:26624
    ds_read_b128 v[104:107], v4 offset:43008
    ds_read_b128 v[108:111], v4 offset:59392
    s_waitcnt vmcnt(8) lgkmcnt(8)
    v_mfma_f32_16x16x32_bf16 a[0:3], v[32:35], v[112:115], a[0:3]
    v_mfma_f32_16x16x32_bf16 a[4:7], v[32:35], v[116:119], a[4:7]
    v_mfma_f32_16x16x32_bf16 a[8:11], v[32:35], v[120:123], a[8:11]
    v_mfma_f32_16x16x32_bf16 a[12:15], v[32:35], v[124:127], a[12:15]
    v_mfma_f32_16x16x32_bf16 a[16:19], v[32:35], v[128:131], a[16:19]
    v_mfma_f32_16x16x32_bf16 a[20:23], v[32:35], v[132:135], a[20:23]
    v_mfma_f32_16x16x32_bf16 a[24:27], v[32:35], v[136:139], a[24:27]
    v_mfma_f32_16x16x32_bf16 a[28:31], v[32:35], v[140:143], a[28:31]
    v_mfma_f32_16x16x32_bf16 a[32:35], v[36:39], v[112:115], a[32:35]
    v_mfma_f32_16x16x32_bf16 a[36:39], v[36:39], v[116:119], a[36:39]
    v_mfma_f32_16x16x32_bf16 a[40:43], v[36:39], v[120:123], a[40:43]
    v_mfma_f32_16x16x32_bf16 a[44:47], v[36:39], v[124:127], a[44:47]
    v_mfma_f32_16x16x32_bf16 a[48:51], v[36:39], v[128:131], a[48:51]
    v_mfma_f32_16x16x32_bf16 a[52:55], v[36:39], v[132:135], a[52:55]
    v_mfma_f32_16x16x32_bf16 a[56:59], v[36:39], v[136:139], a[56:59]
    v_mfma_f32_16x16x32_bf16 a[60:63], v[36:39], v[140:143], a[60:63]
    v_mfma_f32_16x16x32_bf16 a[64:67], v[40:43], v[112:115], a[64:67]
    v_mfma_f32_16x16x32_bf16 a[68:71], v[40:43], v[116:119], a[68:71]
    v_mfma_f32_16x16x32_bf16 a[72:75], v[40:43], v[120:123], a[72:75]
    v_mfma_f32_16x16x32_bf16 a[76:79], v[40:43], v[124:127], a[76:79]
    v_mfma_f32_16x16x32_bf16 a[80:83], v[40:43], v[128:131], a[80:83]
    v_mfma_f32_16x16x32_bf16 a[84:87], v[40:43], v[132:135], a[84:87]
    v_mfma_f32_16x16x32_bf16 a[88:91], v[40:43], v[136:139], a[88:91]
    v_mfma_f32_16x16x32_bf16 a[92:95], v[40:43], v[140:143], a[92:95]
    v_mfma_f32_16x16x32_bf16 a[96:99], v[44:47], v[112:115], a[96:99]
    v_mfma_f32_16x16x32_bf16 a[100:103], v[44:47], v[116:119], a[100:103]
    v_mfma_f32_16x16x32_bf16 a[104:107], v[44:47], v[120:123], a[104:107]
    v_mfma_f32_16x16x32_bf16 a[108:111], v[44:47], v[124:127], a[108:111]
    v_mfma_f32_16x16x32_bf16 a[112:115], v[44:47], v[128:131], a[112:115]
    v_mfma_f32_16x16x32_bf16 a[116:119], v[44:47], v[132:135], a[116:119]
    v_mfma_f32_16x16x32_bf16 a[120:123], v[44:47], v[136:139], a[120:123]
    v_mfma_f32_16x16x32_bf16 a[124:127], v[44:47], v[140:143], a[124:127]
    v_add_u32 v5, 12288, v2
    buffer_load_dwordx4 v[32:35], v5, s[12:15], s24 offen
    buffer_load_dwordx4 v[36:39], v5, s[12:15], s25 offen
    buffer_load_dwordx4 v[40:43], v5, s[12:15], s26 offen
    buffer_load_dwordx4 v[44:47], v5, s[12:15], s27 offen
    ds_read_b128 v[112:115], v3 offset:11264
    ds_read_b128 v[116:119], v3 offset:27648
    ds_read_b128 v[120:123], v3 offset:44032
    ds_read_b128 v[124:127], v3 offset:60416
    ds_read_b128 v[128:131], v4 offset:11264
    ds_read_b128 v[132:135], v4 offset:27648
    ds_read_b128 v[136:139], v4 offset:44032
    ds_read_b128 v[140:143], v4 offset:60416
    s_waitcnt vmcnt(8) lgkmcnt(8)
    v_mfma_f32_16x16x32_bf16 a[0:3], v[48:51], v[80:83], a[0:3]
    v_mfma_f32_16x16x32_bf16 a[4:7], v[48:51], v[84:87], a[4:7]
    v_mfma_f32_16x16x32_bf16 a[8:11], v[48:51], v[88:91], a[8:11]
    v_mfma_f32_16x16x32_bf16 a[12:15], v[48:51], v[92:95], a[12:15]
    v_mfma_f32_16x16x32_bf16 a[16:19], v[48:51], v[96:99], a[16:19]
    v_mfma_f32_16x16x32_bf16 a[20:23], v[48:51], v[100:103], a[20:23]
    v_mfma_f32_16x16x32_bf16 a[24:27], v[48:51], v[104:107], a[24:27]
    v_mfma_f32_16x16x32_bf16 a[28:31], v[48:51], v[108:111], a[28:31]
    v_mfma_f32_16x16x32_bf16 a[32:35], v[52:55], v[80:83], a[32:35]
    v_mfma_f32_16x16x32_bf16 a[36:39], v[52:55], v[84:87], a[36:39]
    v_mfma_f32_16x16x32_bf16 a[40:43], v[52:55], v[88:91], a[40:43]
    v_mfma_f32_16x16x32_bf16 a[44:47], v[52:55], v[92:95], a[44:47]
    v_mfma_f32_16x16x32_bf16 a[48:51], v[52:55], v[96:99], a[48:51]
    v_mfma_f32_16x16x32_bf16 a[52:55], v[52:55], v[100:103], a[52:55]
    v_mfma_f32_16x16x32_bf16 a[56:59], v[52:55], v[104:107], a[56:59]
    v_mfma_f32_16x16x32_bf16 a[60:63], v[52:55], v[108:111], a[60:63]
    v_mfma_f32_16x16x32_bf16 a[64:67], v[56:59], v[80:83], a[64:67]
    v_mfma_f32_16x16x32_bf16 a[68:71], v[56:59], v[84:87], a[68:71]
    v_mfma_f32_16x16x32_bf16 a[72:75], v[56:59], v[88:91], a[72:75]
    v_mfma_f32_16x16x32_bf16 a[76:79], v[56:59], v[92:95], a[76:79]
    v_mfma_f32_16x16x32_bf16 a[80:83], v[56:59], v[96:99], a[80:83]
    v_mfma_f32_16x16x32_bf16 a[84:87], v[56:59], v[100:103], a[84:87]
    v_mfma_f32_16x16x32_bf16 a[88:91], v[56:59], v[104:107], a[88:91]
    v_mfma_f32_16x16x32_bf16 a[92:95], v[56:59], v[108:111], a[92:95]
    v_mfma_f32_16x16x32_bf16 a[96:99], v[60:63], v[80:83], a[96:99]
    v_mfma_f32_16x16x32_bf16 a[100:103], v[60:63], v[84:87], a[100:103]
    v_mfma_f32_16x16x32_bf16 a[104:107], v[60:63], v[88:91], a[104:107]
    v_mfma_f32_16x16x32_bf16 a[108:111], v[60:63], v[92:95], a[108:111]
    v_mfma_f32_16x16x32_bf16 a[112:115], v[60:63], v[96:99], a[112:115]
    v_mfma_f32_16x16x32_bf16 a[116:119], v[60:63], v[100:103], a[116:119]
    v_mfma_f32_16x16x32_bf16 a[120:123], v[60:63], v[104:107], a[120:123]
    v_mfma_f32_16x16x32_bf16 a[124:127], v[60:63], v[108:111], a[124:127]
    v_add_u32 v5, 13312, v2
    buffer_load_dwordx4 v[48:51], v5, s[12:15], s24 offen
    buffer_load_dwordx4 v[52:55], v5, s[12:15], s25 offen
    buffer_load_dwordx4 v[56:59], v5, s[12:15], s26 offen
    buffer_load_dwordx4 v[60:63], v5, s[12:15], s27 offen
    ds_read_b128 v[80:83], v3 offset:12288
    ds_read_b128 v[84:87], v3 offset:28672
    ds_read_b128 v[88:91], v3 offset:45056
    ds_read_b128 v[92:95], v3 offset:61440
    ds_read_b128 v[96:99], v4 offset:12288
    ds_read_b128 v[100:103], v4 offset:28672
    ds_read_b128 v[104:107], v4 offset:45056
    ds_read_b128 v[108:111], v4 offset:61440
    s_waitcnt vmcnt(8) lgkmcnt(8)
    v_mfma_f32_16x16x32_bf16 a[0:3], v[64:67], v[112:115], a[0:3]
    v_mfma_f32_16x16x32_bf16 a[4:7], v[64:67], v[116:119], a[4:7]
    v_mfma_f32_16x16x32_bf16 a[8:11], v[64:67], v[120:123], a[8:11]
    v_mfma_f32_16x16x32_bf16 a[12:15], v[64:67], v[124:127], a[12:15]
    v_mfma_f32_16x16x32_bf16 a[16:19], v[64:67], v[128:131], a[16:19]
    v_mfma_f32_16x16x32_bf16 a[20:23], v[64:67], v[132:135], a[20:23]
    v_mfma_f32_16x16x32_bf16 a[24:27], v[64:67], v[136:139], a[24:27]
    v_mfma_f32_16x16x32_bf16 a[28:31], v[64:67], v[140:143], a[28:31]
    v_mfma_f32_16x16x32_bf16 a[32:35], v[68:71], v[112:115], a[32:35]
    v_mfma_f32_16x16x32_bf16 a[36:39], v[68:71], v[116:119], a[36:39]
    v_mfma_f32_16x16x32_bf16 a[40:43], v[68:71], v[120:123], a[40:43]
    v_mfma_f32_16x16x32_bf16 a[44:47], v[68:71], v[124:127], a[44:47]
    v_mfma_f32_16x16x32_bf16 a[48:51], v[68:71], v[128:131], a[48:51]
    v_mfma_f32_16x16x32_bf16 a[52:55], v[68:71], v[132:135], a[52:55]
    v_mfma_f32_16x16x32_bf16 a[56:59], v[68:71], v[136:139], a[56:59]
    v_mfma_f32_16x16x32_bf16 a[60:63], v[68:71], v[140:143], a[60:63]
    v_mfma_f32_16x16x32_bf16 a[64:67], v[72:75], v[112:115], a[64:67]
    v_mfma_f32_16x16x32_bf16 a[68:71], v[72:75], v[116:119], a[68:71]
    v_mfma_f32_16x16x32_bf16 a[72:75], v[72:75], v[120:123], a[72:75]
    v_mfma_f32_16x16x32_bf16 a[76:79], v[72:75], v[124:127], a[76:79]
    v_mfma_f32_16x16x32_bf16 a[80:83], v[72:75], v[128:131], a[80:83]
    v_mfma_f32_16x16x32_bf16 a[84:87], v[72:75], v[132:135], a[84:87]
    v_mfma_f32_16x16x32_bf16 a[88:91], v[72:75], v[136:139], a[88:91]
    v_mfma_f32_16x16x32_bf16 a[92:95], v[72:75], v[140:143], a[92:95]
    v_mfma_f32_16x16x32_bf16 a[96:99], v[76:79], v[112:115], a[96:99]
    v_mfma_f32_16x16x32_bf16 a[100:103], v[76:79], v[116:119], a[100:103]
    v_mfma_f32_16x16x32_bf16 a[104:107], v[76:79], v[120:123], a[104:107]
    v_mfma_f32_16x16x32_bf16 a[108:111], v[76:79], v[124:127], a[108:111]
    v_mfma_f32_16x16x32_bf16 a[112:115], v[76:79], v[128:131], a[112:115]
    v_mfma_f32_16x16x32_bf16 a[116:119], v[76:79], v[132:135], a[116:119]
    v_mfma_f32_16x16x32_bf16 a[120:123], v[76:79], v[136:139], a[120:123]
    v_mfma_f32_16x16x32_bf16 a[124:127], v[76:79], v[140:143], a[124:127]
    v_add_u32 v5, 14336, v2
    buffer_load_dwordx4 v[64:67], v5, s[12:15], s24 offen
    buffer_load_dwordx4 v[68:71], v5, s[12:15], s25 offen
    buffer_load_dwordx4 v[72:75], v5, s[12:15], s26 offen
    buffer_load_dwordx4 v[76:79], v5, s[12:15], s27 offen
    ds_read_b128 v[112:115], v3 offset:13312
    ds_read_b128 v[116:119], v3 offset:29696
    ds_read_b128 v[120:123], v3 offset:46080
    ds_read_b128 v[124:127], v3 offset:62464
    ds_read_b128 v[128:131], v4 offset:13312
    ds_read_b128 v[132:135], v4 offset:29696
    ds_read_b128 v[136:139], v4 offset:46080
    ds_read_b128 v[140:143], v4 offset:62464
    s_waitcnt vmcnt(8) lgkmcnt(8)
    v_mfma_f32_16x16x32_bf16 a[0:3], v[32:35], v[80:83], a[0:3]
    v_mfma_f32_16x16x32_bf16 a[4:7], v[32:35], v[84:87], a[4:7]
    v_mfma_f32_16x16x32_bf16 a[8:11], v[32:35], v[88:91], a[8:11]
    v_mfma_f32_16x16x32_bf16 a[12:15], v[32:35], v[92:95], a[12:15]
    v_mfma_f32_16x16x32_bf16 a[16:19], v[32:35], v[96:99], a[16:19]
    v_mfma_f32_16x16x32_bf16 a[20:23], v[32:35], v[100:103], a[20:23]
    v_mfma_f32_16x16x32_bf16 a[24:27], v[32:35], v[104:107], a[24:27]
    v_mfma_f32_16x16x32_bf16 a[28:31], v[32:35], v[108:111], a[28:31]
    v_mfma_f32_16x16x32_bf16 a[32:35], v[36:39], v[80:83], a[32:35]
    v_mfma_f32_16x16x32_bf16 a[36:39], v[36:39], v[84:87], a[36:39]
    v_mfma_f32_16x16x32_bf16 a[40:43], v[36:39], v[88:91], a[40:43]
    v_mfma_f32_16x16x32_bf16 a[44:47], v[36:39], v[92:95], a[44:47]
    v_mfma_f32_16x16x32_bf16 a[48:51], v[36:39], v[96:99], a[48:51]
    v_mfma_f32_16x16x32_bf16 a[52:55], v[36:39], v[100:103], a[52:55]
    v_mfma_f32_16x16x32_bf16 a[56:59], v[36:39], v[104:107], a[56:59]
    v_mfma_f32_16x16x32_bf16 a[60:63], v[36:39], v[108:111], a[60:63]
    v_mfma_f32_16x16x32_bf16 a[64:67], v[40:43], v[80:83], a[64:67]
    v_mfma_f32_16x16x32_bf16 a[68:71], v[40:43], v[84:87], a[68:71]
    v_mfma_f32_16x16x32_bf16 a[72:75], v[40:43], v[88:91], a[72:75]
    v_mfma_f32_16x16x32_bf16 a[76:79], v[40:43], v[92:95], a[76:79]
    v_mfma_f32_16x16x32_bf16 a[80:83], v[40:43], v[96:99], a[80:83]
    v_mfma_f32_16x16x32_bf16 a[84:87], v[40:43], v[100:103], a[84:87]
    v_mfma_f32_16x16x32_bf16 a[88:91], v[40:43], v[104:107], a[88:91]
    v_mfma_f32_16x16x32_bf16 a[92:95], v[40:43], v[108:111], a[92:95]
    v_mfma_f32_16x16x32_bf16 a[96:99], v[44:47], v[80:83], a[96:99]
    v_mfma_f32_16x16x32_bf16 a[100:103], v[44:47], v[84:87], a[100:103]
    v_mfma_f32_16x16x32_bf16 a[104:107], v[44:47], v[88:91], a[104:107]
    v_mfma_f32_16x16x32_bf16 a[108:111], v[44:47], v[92:95], a[108:111]
    v_mfma_f32_16x16x32_bf16 a[112:115], v[44:47], v[96:99], a[112:115]
    v_mfma_f32_16x16x32_bf16 a[116:119], v[44:47], v[100:103], a[116:119]
    v_mfma_f32_16x16x32_bf16 a[120:123], v[44:47], v[104:107], a[120:123]
    v_mfma_f32_16x16x32_bf16 a[124:127], v[44:47], v[108:111], a[124:127]
    v_add_u32 v5, 15360, v2
    buffer_load_dwordx4 v[32:35], v5, s[12:15], s24 offen
    buffer_load_dwordx4 v[36:39], v5, s[12:15], s25 offen
    buffer_load_dwordx4 v[40:43], v5, s[12:15], s26 offen
    buffer_load_dwordx4 v[44:47], v5, s[12:15], s27 offen
    ds_read_b128 v[80:83], v3 offset:14336
    ds_read_b128 v[84:87], v3 offset:30720
    ds_read_b128 v[88:91], v3 offset:47104
    ds_read_b128 v[92:95], v3 offset:63488
    ds_read_b128 v[96:99], v4 offset:14336
    ds_read_b128 v[100:103], v4 offset:30720
    ds_read_b128 v[104:107], v4 offset:47104
    ds_read_b128 v[108:111], v4 offset:63488
    s_waitcnt vmcnt(8) lgkmcnt(8)
    v_mfma_f32_16x16x32_bf16 a[0:3], v[48:51], v[112:115], a[0:3]
    v_mfma_f32_16x16x32_bf16 a[4:7], v[48:51], v[116:119], a[4:7]
    v_mfma_f32_16x16x32_bf16 a[8:11], v[48:51], v[120:123], a[8:11]
    v_mfma_f32_16x16x32_bf16 a[12:15], v[48:51], v[124:127], a[12:15]
    v_mfma_f32_16x16x32_bf16 a[16:19], v[48:51], v[128:131], a[16:19]
    v_mfma_f32_16x16x32_bf16 a[20:23], v[48:51], v[132:135], a[20:23]
    v_mfma_f32_16x16x32_bf16 a[24:27], v[48:51], v[136:139], a[24:27]
    v_mfma_f32_16x16x32_bf16 a[28:31], v[48:51], v[140:143], a[28:31]
    v_mfma_f32_16x16x32_bf16 a[32:35], v[52:55], v[112:115], a[32:35]
    v_mfma_f32_16x16x32_bf16 a[36:39], v[52:55], v[116:119], a[36:39]
    v_mfma_f32_16x16x32_bf16 a[40:43], v[52:55], v[120:123], a[40:43]
    v_mfma_f32_16x16x32_bf16 a[44:47], v[52:55], v[124:127], a[44:47]
    v_mfma_f32_16x16x32_bf16 a[48:51], v[52:55], v[128:131], a[48:51]
    v_mfma_f32_16x16x32_bf16 a[52:55], v[52:55], v[132:135], a[52:55]
    v_mfma_f32_16x16x32_bf16 a[56:59], v[52:55], v[136:139], a[56:59]
    v_mfma_f32_16x16x32_bf16 a[60:63], v[52:55], v[140:143], a[60:63]
    v_mfma_f32_16x16x32_bf16 a[64:67], v[56:59], v[112:115], a[64:67]
    v_mfma_f32_16x16x32_bf16 a[68:71], v[56:59], v[116:119], a[68:71]
    v_mfma_f32_16x16x32_bf16 a[72:75], v[56:59], v[120:123], a[72:75]
    v_mfma_f32_16x16x32_bf16 a[76:79], v[56:59], v[124:127], a[76:79]
    v_mfma_f32_16x16x32_bf16 a[80:83], v[56:59], v[128:131], a[80:83]
    v_mfma_f32_16x16x32_bf16 a[84:87], v[56:59], v[132:135], a[84:87]
    v_mfma_f32_16x16x32_bf16 a[88:91], v[56:59], v[136:139], a[88:91]
    v_mfma_f32_16x16x32_bf16 a[92:95], v[56:59], v[140:143], a[92:95]
    v_mfma_f32_16x16x32_bf16 a[96:99], v[60:63], v[112:115], a[96:99]
    v_mfma_f32_16x16x32_bf16 a[100:103], v[60:63], v[116:119], a[100:103]
    v_mfma_f32_16x16x32_bf16 a[104:107], v[60:63], v[120:123], a[104:107]
    v_mfma_f32_16x16x32_bf16 a[108:111], v[60:63], v[124:127], a[108:111]
    v_mfma_f32_16x16x32_bf16 a[112:115], v[60:63], v[128:131], a[112:115]
    v_mfma_f32_16x16x32_bf16 a[116:119], v[60:63], v[132:135], a[116:119]
    v_mfma_f32_16x16x32_bf16 a[120:123], v[60:63], v[136:139], a[120:123]
    v_mfma_f32_16x16x32_bf16 a[124:127], v[60:63], v[140:143], a[124:127]
    ds_read_b128 v[112:115], v3 offset:15360
    ds_read_b128 v[116:119], v3 offset:31744
    ds_read_b128 v[120:123], v3 offset:48128
    ds_read_b128 v[124:127], v3 offset:64512
    ds_read_b128 v[128:131], v4 offset:15360
    ds_read_b128 v[132:135], v4 offset:31744
    ds_read_b128 v[136:139], v4 offset:48128
    ds_read_b128 v[140:143], v4 offset:64512
    s_waitcnt vmcnt(4) lgkmcnt(8)
    v_mfma_f32_16x16x32_bf16 a[0:3], v[64:67], v[80:83], a[0:3]
    v_mfma_f32_16x16x32_bf16 a[4:7], v[64:67], v[84:87], a[4:7]
    v_mfma_f32_16x16x32_bf16 a[8:11], v[64:67], v[88:91], a[8:11]
    v_mfma_f32_16x16x32_bf16 a[12:15], v[64:67], v[92:95], a[12:15]
    v_mfma_f32_16x16x32_bf16 a[16:19], v[64:67], v[96:99], a[16:19]
    v_mfma_f32_16x16x32_bf16 a[20:23], v[64:67], v[100:103], a[20:23]
    v_mfma_f32_16x16x32_bf16 a[24:27], v[64:67], v[104:107], a[24:27]
    v_mfma_f32_16x16x32_bf16 a[28:31], v[64:67], v[108:111], a[28:31]
    v_mfma_f32_16x16x32_bf16 a[32:35], v[68:71], v[80:83], a[32:35]
    v_mfma_f32_16x16x32_bf16 a[36:39], v[68:71], v[84:87], a[36:39]
    v_mfma_f32_16x16x32_bf16 a[40:43], v[68:71], v[88:91], a[40:43]
    v_mfma_f32_16x16x32_bf16 a[44:47], v[68:71], v[92:95], a[44:47]
    v_mfma_f32_16x16x32_bf16 a[48:51], v[68:71], v[96:99], a[48:51]
    v_mfma_f32_16x16x32_bf16 a[52:55], v[68:71], v[100:103], a[52:55]
    v_mfma_f32_16x16x32_bf16 a[56:59], v[68:71], v[104:107], a[56:59]
    v_mfma_f32_16x16x32_bf16 a[60:63], v[68:71], v[108:111], a[60:63]
    v_mfma_f32_16x16x32_bf16 a[64:67], v[72:75], v[80:83], a[64:67]
    v_mfma_f32_16x16x32_bf16 a[68:71], v[72:75], v[84:87], a[68:71]
    v_mfma_f32_16x16x32_bf16 a[72:75], v[72:75], v[88:91], a[72:75]
    v_mfma_f32_16x16x32_bf16 a[76:79], v[72:75], v[92:95], a[76:79]
    v_mfma_f32_16x16x32_bf16 a[80:83], v[72:75], v[96:99], a[80:83]
    v_mfma_f32_16x16x32_bf16 a[84:87], v[72:75], v[100:103], a[84:87]
    v_mfma_f32_16x16x32_bf16 a[88:91], v[72:75], v[104:107], a[88:91]
    v_mfma_f32_16x16x32_bf16 a[92:95], v[72:75], v[108:111], a[92:95]
    v_mfma_f32_16x16x32_bf16 a[96:99], v[76:79], v[80:83], a[96:99]
    v_mfma_f32_16x16x32_bf16 a[100:103], v[76:79], v[84:87], a[100:103]
    v_mfma_f32_16x16x32_bf16 a[104:107], v[76:79], v[88:91], a[104:107]
    v_mfma_f32_16x16x32_bf16 a[108:111], v[76:79], v[92:95], a[108:111]
    v_mfma_f32_16x16x32_bf16 a[112:115], v[76:79], v[96:99], a[112:115]
    v_mfma_f32_16x16x32_bf16 a[116:119], v[76:79], v[100:103], a[116:119]
    v_mfma_f32_16x16x32_bf16 a[120:123], v[76:79], v[104:107], a[120:123]
    v_mfma_f32_16x16x32_bf16 a[124:127], v[76:79], v[108:111], a[124:127]
    s_waitcnt vmcnt(0) lgkmcnt(0)
    v_mfma_f32_16x16x32_bf16 a[0:3], v[32:35], v[112:115], a[0:3]
    v_mfma_f32_16x16x32_bf16 a[4:7], v[32:35], v[116:119], a[4:7]
    v_mfma_f32_16x16x32_bf16 a[8:11], v[32:35], v[120:123], a[8:11]
    v_mfma_f32_16x16x32_bf16 a[12:15], v[32:35], v[124:127], a[12:15]
    v_mfma_f32_16x16x32_bf16 a[16:19], v[32:35], v[128:131], a[16:19]
    v_mfma_f32_16x16x32_bf16 a[20:23], v[32:35], v[132:135], a[20:23]
    v_mfma_f32_16x16x32_bf16 a[24:27], v[32:35], v[136:139], a[24:27]
    v_mfma_f32_16x16x32_bf16 a[28:31], v[32:35], v[140:143], a[28:31]
    v_mfma_f32_16x16x32_bf16 a[32:35], v[36:39], v[112:115], a[32:35]
    v_mfma_f32_16x16x32_bf16 a[36:39], v[36:39], v[116:119], a[36:39]
    v_mfma_f32_16x16x32_bf16 a[40:43], v[36:39], v[120:123], a[40:43]
    v_mfma_f32_16x16x32_bf16 a[44:47], v[36:39], v[124:127], a[44:47]
    v_mfma_f32_16x16x32_bf16 a[48:51], v[36:39], v[128:131], a[48:51]
    v_mfma_f32_16x16x32_bf16 a[52:55], v[36:39], v[132:135], a[52:55]
    v_mfma_f32_16x16x32_bf16 a[56:59], v[36:39], v[136:139], a[56:59]
    v_mfma_f32_16x16x32_bf16 a[60:63], v[36:39], v[140:143], a[60:63]
    v_mfma_f32_16x16x32_bf16 a[64:67], v[40:43], v[112:115], a[64:67]
    v_mfma_f32_16x16x32_bf16 a[68:71], v[40:43], v[116:119], a[68:71]
    v_mfma_f32_16x16x32_bf16 a[72:75], v[40:43], v[120:123], a[72:75]
    v_mfma_f32_16x16x32_bf16 a[76:79], v[40:43], v[124:127], a[76:79]
    v_mfma_f32_16x16x32_bf16 a[80:83], v[40:43], v[128:131], a[80:83]
    v_mfma_f32_16x16x32_bf16 a[84:87], v[40:43], v[132:135], a[84:87]
    v_mfma_f32_16x16x32_bf16 a[88:91], v[40:43], v[136:139], a[88:91]
    v_mfma_f32_16x16x32_bf16 a[92:95], v[40:43], v[140:143], a[92:95]
    v_mfma_f32_16x16x32_bf16 a[96:99], v[44:47], v[112:115], a[96:99]
    v_mfma_f32_16x16x32_bf16 a[100:103], v[44:47], v[116:119], a[100:103]
    v_mfma_f32_16x16x32_bf16 a[104:107], v[44:47], v[120:123], a[104:107]
    v_mfma_f32_16x16x32_bf16 a[108:111], v[44:47], v[124:127], a[108:111]
    v_mfma_f32_16x16x32_bf16 a[112:115], v[44:47], v[128:131], a[112:115]
    v_mfma_f32_16x16x32_bf16 a[116:119], v[44:47], v[132:135], a[116:119]
    v_mfma_f32_16x16x32_bf16 a[120:123], v[44:47], v[136:139], a[120:123]
    v_mfma_f32_16x16x32_bf16 a[124:127], v[44:47], v[140:143], a[124:127]
    s_nop 9
    s_lshl_b32 s30, s16, 7
    s_add_u32 s30, s30, s28
    s_lshl_b32 s30, s30, 3
    s_lshr_b32 s19, s29, 1
    s_add_u32 s30, s30, s19
    s_lshl_b32 s30, s30, 10
    s_add_u32 s30, s30, 0x3000000
    v_accvgpr_read_b32 v144, a0
    v_accvgpr_read_b32 v145, a1
    v_accvgpr_read_b32 v146, a2
    v_accvgpr_read_b32 v147, a3
    v_accvgpr_read_b32 v148, a32
    v_accvgpr_read_b32 v149, a33
    v_accvgpr_read_b32 v150, a34
    v_accvgpr_read_b32 v151, a35
    v_cvt_pk_bf16_f32 v152, v144, v145
    v_cvt_pk_bf16_f32 v153, v146, v147
    v_cvt_pk_bf16_f32 v154, v148, v149
    v_cvt_pk_bf16_f32 v155, v150, v151
    s_add_u32 s19, s30, 0
    buffer_store_dwordx4 v[152:155], v2, s[12:15], s19 offen sc0 sc1
    v_accvgpr_read_b32 v156, a64
    v_accvgpr_read_b32 v157, a65
    v_accvgpr_read_b32 v158, a66
    v_accvgpr_read_b32 v159, a67
    v_accvgpr_read_b32 v160, a96
    v_accvgpr_read_b32 v161, a97
    v_accvgpr_read_b32 v162, a98
    v_accvgpr_read_b32 v163, a99
    v_cvt_pk_bf16_f32 v164, v156, v157
    v_cvt_pk_bf16_f32 v165, v158, v159
    v_cvt_pk_bf16_f32 v166, v160, v161
    v_cvt_pk_bf16_f32 v167, v162, v163
    s_add_u32 s19, s30, 1024
    buffer_store_dwordx4 v[164:167], v2, s[12:15], s19 offen sc0 sc1
    v_accvgpr_read_b32 v144, a4
    v_accvgpr_read_b32 v145, a5
    v_accvgpr_read_b32 v146, a6
    v_accvgpr_read_b32 v147, a7
    v_accvgpr_read_b32 v148, a36
    v_accvgpr_read_b32 v149, a37
    v_accvgpr_read_b32 v150, a38
    v_accvgpr_read_b32 v151, a39
    v_cvt_pk_bf16_f32 v152, v144, v145
    v_cvt_pk_bf16_f32 v153, v146, v147
    v_cvt_pk_bf16_f32 v154, v148, v149
    v_cvt_pk_bf16_f32 v155, v150, v151
    s_add_u32 s19, s30, 4096
    buffer_store_dwordx4 v[152:155], v2, s[12:15], s19 offen sc0 sc1
    v_accvgpr_read_b32 v156, a68
    v_accvgpr_read_b32 v157, a69
    v_accvgpr_read_b32 v158, a70
    v_accvgpr_read_b32 v159, a71
    v_accvgpr_read_b32 v160, a100
    v_accvgpr_read_b32 v161, a101
    v_accvgpr_read_b32 v162, a102
    v_accvgpr_read_b32 v163, a103
    v_cvt_pk_bf16_f32 v164, v156, v157
    v_cvt_pk_bf16_f32 v165, v158, v159
    v_cvt_pk_bf16_f32 v166, v160, v161
    v_cvt_pk_bf16_f32 v167, v162, v163
    s_add_u32 s19, s30, 5120
    buffer_store_dwordx4 v[164:167], v2, s[12:15], s19 offen sc0 sc1
    v_accvgpr_read_b32 v144, a8
    v_accvgpr_read_b32 v145, a9
    v_accvgpr_read_b32 v146, a10
    v_accvgpr_read_b32 v147, a11
    v_accvgpr_read_b32 v148, a40
    v_accvgpr_read_b32 v149, a41
    v_accvgpr_read_b32 v150, a42
    v_accvgpr_read_b32 v151, a43
    v_cvt_pk_bf16_f32 v152, v144, v145
    v_cvt_pk_bf16_f32 v153, v146, v147
    v_cvt_pk_bf16_f32 v154, v148, v149
    v_cvt_pk_bf16_f32 v155, v150, v151
    s_add_u32 s19, s30, 262144
    buffer_store_dwordx4 v[152:155], v2, s[12:15], s19 offen sc0 sc1
    v_accvgpr_read_b32 v156, a72
    v_accvgpr_read_b32 v157, a73
    v_accvgpr_read_b32 v158, a74
    v_accvgpr_read_b32 v159, a75
    v_accvgpr_read_b32 v160, a104
    v_accvgpr_read_b32 v161, a105
    v_accvgpr_read_b32 v162, a106
    v_accvgpr_read_b32 v163, a107
    v_cvt_pk_bf16_f32 v164, v156, v157
    v_cvt_pk_bf16_f32 v165, v158, v159
    v_cvt_pk_bf16_f32 v166, v160, v161
    v_cvt_pk_bf16_f32 v167, v162, v163
    s_add_u32 s19, s30, 263168
    buffer_store_dwordx4 v[164:167], v2, s[12:15], s19 offen sc0 sc1
    v_accvgpr_read_b32 v144, a12
    v_accvgpr_read_b32 v145, a13
    v_accvgpr_read_b32 v146, a14
    v_accvgpr_read_b32 v147, a15
    v_accvgpr_read_b32 v148, a44
    v_accvgpr_read_b32 v149, a45
    v_accvgpr_read_b32 v150, a46
    v_accvgpr_read_b32 v151, a47
    v_cvt_pk_bf16_f32 v152, v144, v145
    v_cvt_pk_bf16_f32 v153, v146, v147
    v_cvt_pk_bf16_f32 v154, v148, v149
    v_cvt_pk_bf16_f32 v155, v150, v151
    s_add_u32 s19, s30, 266240
    buffer_store_dwordx4 v[152:155], v2, s[12:15], s19 offen sc0 sc1
    v_accvgpr_read_b32 v156, a76
    v_accvgpr_read_b32 v157, a77
    v_accvgpr_read_b32 v158, a78
    v_accvgpr_read_b32 v159, a79
    v_accvgpr_read_b32 v160, a108
    v_accvgpr_read_b32 v161, a109
    v_accvgpr_read_b32 v162, a110
    v_accvgpr_read_b32 v163, a111
    v_cvt_pk_bf16_f32 v164, v156, v157
    v_cvt_pk_bf16_f32 v165, v158, v159
    v_cvt_pk_bf16_f32 v166, v160, v161
    v_cvt_pk_bf16_f32 v167, v162, v163
    s_add_u32 s19, s30, 267264
    buffer_store_dwordx4 v[164:167], v2, s[12:15], s19 offen sc0 sc1
    v_accvgpr_read_b32 v144, a16
    v_accvgpr_read_b32 v145, a17
    v_accvgpr_read_b32 v146, a18
    v_accvgpr_read_b32 v147, a19
    v_accvgpr_read_b32 v148, a48
    v_accvgpr_read_b32 v149, a49
    v_accvgpr_read_b32 v150, a50
    v_accvgpr_read_b32 v151, a51
    v_cvt_pk_bf16_f32 v152, v144, v145
    v_cvt_pk_bf16_f32 v153, v146, v147
    v_cvt_pk_bf16_f32 v154, v148, v149
    v_cvt_pk_bf16_f32 v155, v150, v151
    s_add_u32 s19, s30, 524288
    buffer_store_dwordx4 v[152:155], v2, s[12:15], s19 offen sc0 sc1
    v_accvgpr_read_b32 v156, a80
    v_accvgpr_read_b32 v157, a81
    v_accvgpr_read_b32 v158, a82
    v_accvgpr_read_b32 v159, a83
    v_accvgpr_read_b32 v160, a112
    v_accvgpr_read_b32 v161, a113
    v_accvgpr_read_b32 v162, a114
    v_accvgpr_read_b32 v163, a115
    v_cvt_pk_bf16_f32 v164, v156, v157
    v_cvt_pk_bf16_f32 v165, v158, v159
    v_cvt_pk_bf16_f32 v166, v160, v161
    v_cvt_pk_bf16_f32 v167, v162, v163
    s_add_u32 s19, s30, 525312
    buffer_store_dwordx4 v[164:167], v2, s[12:15], s19 offen sc0 sc1
    v_accvgpr_read_b32 v144, a20
    v_accvgpr_read_b32 v145, a21
    v_accvgpr_read_b32 v146, a22
    v_accvgpr_read_b32 v147, a23
    v_accvgpr_read_b32 v148, a52
    v_accvgpr_read_b32 v149, a53
    v_accvgpr_read_b32 v150, a54
    v_accvgpr_read_b32 v151, a55
    v_cvt_pk_bf16_f32 v152, v144, v145
    v_cvt_pk_bf16_f32 v153, v146, v147
    v_cvt_pk_bf16_f32 v154, v148, v149
    v_cvt_pk_bf16_f32 v155, v150, v151
    s_add_u32 s19, s30, 528384
    buffer_store_dwordx4 v[152:155], v2, s[12:15], s19 offen sc0 sc1
    v_accvgpr_read_b32 v156, a84
    v_accvgpr_read_b32 v157, a85
    v_accvgpr_read_b32 v158, a86
    v_accvgpr_read_b32 v159, a87
    v_accvgpr_read_b32 v160, a116
    v_accvgpr_read_b32 v161, a117
    v_accvgpr_read_b32 v162, a118
    v_accvgpr_read_b32 v163, a119
    v_cvt_pk_bf16_f32 v164, v156, v157
    v_cvt_pk_bf16_f32 v165, v158, v159
    v_cvt_pk_bf16_f32 v166, v160, v161
    v_cvt_pk_bf16_f32 v167, v162, v163
    s_add_u32 s19, s30, 529408
    buffer_store_dwordx4 v[164:167], v2, s[12:15], s19 offen sc0 sc1
    v_accvgpr_read_b32 v144, a24
    v_accvgpr_read_b32 v145, a25
    v_accvgpr_read_b32 v146, a26
    v_accvgpr_read_b32 v147, a27
    v_accvgpr_read_b32 v148, a56
    v_accvgpr_read_b32 v149, a57
    v_accvgpr_read_b32 v150, a58
    v_accvgpr_read_b32 v151, a59
    v_cvt_pk_bf16_f32 v152, v144, v145
    v_cvt_pk_bf16_f32 v153, v146, v147
    v_cvt_pk_bf16_f32 v154, v148, v149
    v_cvt_pk_bf16_f32 v155, v150, v151
    s_add_u32 s19, s30, 786432
    buffer_store_dwordx4 v[152:155], v2, s[12:15], s19 offen sc0 sc1
    v_accvgpr_read_b32 v156, a88
    v_accvgpr_read_b32 v157, a89
    v_accvgpr_read_b32 v158, a90
    v_accvgpr_read_b32 v159, a91
    v_accvgpr_read_b32 v160, a120
    v_accvgpr_read_b32 v161, a121
    v_accvgpr_read_b32 v162, a122
    v_accvgpr_read_b32 v163, a123
    v_cvt_pk_bf16_f32 v164, v156, v157
    v_cvt_pk_bf16_f32 v165, v158, v159
    v_cvt_pk_bf16_f32 v166, v160, v161
    v_cvt_pk_bf16_f32 v167, v162, v163
    s_add_u32 s19, s30, 787456
    buffer_store_dwordx4 v[164:167], v2, s[12:15], s19 offen sc0 sc1
    v_accvgpr_read_b32 v144, a28
    v_accvgpr_read_b32 v145, a29
    v_accvgpr_read_b32 v146, a30
    v_accvgpr_read_b32 v147, a31
    v_accvgpr_read_b32 v148, a60
    v_accvgpr_read_b32 v149, a61
    v_accvgpr_read_b32 v150, a62
    v_accvgpr_read_b32 v151, a63
    v_cvt_pk_bf16_f32 v152, v144, v145
    v_cvt_pk_bf16_f32 v153, v146, v147
    v_cvt_pk_bf16_f32 v154, v148, v149
    v_cvt_pk_bf16_f32 v155, v150, v151
    s_add_u32 s19, s30, 790528
    buffer_store_dwordx4 v[152:155], v2, s[12:15], s19 offen sc0 sc1
    v_accvgpr_read_b32 v156, a92
    v_accvgpr_read_b32 v157, a93
    v_accvgpr_read_b32 v158, a94
    v_accvgpr_read_b32 v159, a95
    v_accvgpr_read_b32 v160, a124
    v_accvgpr_read_b32 v161, a125
    v_accvgpr_read_b32 v162, a126
    v_accvgpr_read_b32 v163, a127
    v_cvt_pk_bf16_f32 v164, v156, v157
    v_cvt_pk_bf16_f32 v165, v158, v159
    v_cvt_pk_bf16_f32 v166, v160, v161
    v_cvt_pk_bf16_f32 v167, v162, v163
    s_add_u32 s19, s30, 791552
    buffer_store_dwordx4 v[164:167], v2, s[12:15], s19 offen sc0 sc1
    s_add_u32 s19, s28, 64
    s_lshl_b32 s19, s19, 3
    s_add_u32 s19, s19, s29
    s_lshl_b32 s24, s19, 14
    s_add_u32 s25, s24, 16384
    s_add_u32 s26, s24, 32768
    s_add_u32 s27, s24, 49152
    v_add_u32 v5, 0, v2
    buffer_load_dwordx4 v[32:35], v5, s[12:15], s24 offen
    buffer_load_dwordx4 v[36:39], v5, s[12:15], s25 offen
    buffer_load_dwordx4 v[40:43], v5, s[12:15], s26 offen
    buffer_load_dwordx4 v[44:47], v5, s[12:15], s27 offen
    v_add_u32 v5, 1024, v2
    buffer_load_dwordx4 v[48:51], v5, s[12:15], s24 offen
    buffer_load_dwordx4 v[52:55], v5, s[12:15], s25 offen
    buffer_load_dwordx4 v[56:59], v5, s[12:15], s26 offen
    buffer_load_dwordx4 v[60:63], v5, s[12:15], s27 offen
    ds_read_b128 v[80:83], v3 offset:0
    ds_read_b128 v[84:87], v3 offset:16384
    ds_read_b128 v[88:91], v3 offset:32768
    ds_read_b128 v[92:95], v3 offset:49152
    ds_read_b128 v[96:99], v4 offset:0
    ds_read_b128 v[100:103], v4 offset:16384
    ds_read_b128 v[104:107], v4 offset:32768
    ds_read_b128 v[108:111], v4 offset:49152
    v_add_u32 v5, 2048, v2
    buffer_load_dwordx4 v[64:67], v5, s[12:15], s24 offen
    buffer_load_dwordx4 v[68:71], v5, s[12:15], s25 offen
    buffer_load_dwordx4 v[72:75], v5, s[12:15], s26 offen
    buffer_load_dwordx4 v[76:79], v5, s[12:15], s27 offen
    ds_read_b128 v[112:115], v3 offset:1024
    ds_read_b128 v[116:119], v3 offset:17408
    ds_read_b128 v[120:123], v3 offset:33792
    ds_read_b128 v[124:127], v3 offset:50176
    ds_read_b128 v[128:131], v4 offset:1024
    ds_read_b128 v[132:135], v4 offset:17408
    ds_read_b128 v[136:139], v4 offset:33792
    ds_read_b128 v[140:143], v4 offset:50176
    s_waitcnt vmcnt(8) lgkmcnt(8)
    v_mfma_f32_16x16x32_bf16 a[0:3], v[80:83], v[32:35], 0
    v_mfma_f32_16x16x32_bf16 a[4:7], v[84:87], v[32:35], 0
    v_mfma_f32_16x16x32_bf16 a[8:11], v[88:91], v[32:35], 0
    v_mfma_f32_16x16x32_bf16 a[12:15], v[92:95], v[32:35], 0
    v_mfma_f32_16x16x32_bf16 a[16:19], v[96:99], v[32:35], 0
    v_mfma_f32_16x16x32_bf16 a[20:23], v[100:103], v[32:35], 0
    v_mfma_f32_16x16x32_bf16 a[24:27], v[104:107], v[32:35], 0
    v_mfma_f32_16x16x32_bf16 a[28:31], v[108:111], v[32:35], 0
    v_mfma_f32_16x16x32_bf16 a[32:35], v[80:83], v[36:39], 0
    v_mfma_f32_16x16x32_bf16 a[36:39], v[84:87], v[36:39], 0
    v_mfma_f32_16x16x32_bf16 a[40:43], v[88:91], v[36:39], 0
    v_mfma_f32_16x16x32_bf16 a[44:47], v[92:95], v[36:39], 0
    v_mfma_f32_16x16x32_bf16 a[48:51], v[96:99], v[36:39], 0
    v_mfma_f32_16x16x32_bf16 a[52:55], v[100:103], v[36:39], 0
    v_mfma_f32_16x16x32_bf16 a[56:59], v[104:107], v[36:39], 0
    v_mfma_f32_16x16x32_bf16 a[60:63], v[108:111], v[36:39], 0
    v_mfma_f32_16x16x32_bf16 a[64:67], v[80:83], v[40:43], 0
    v_mfma_f32_16x16x32_bf16 a[68:71], v[84:87], v[40:43], 0
    v_mfma_f32_16x16x32_bf16 a[72:75], v[88:91], v[40:43], 0
    v_mfma_f32_16x16x32_bf16 a[76:79], v[92:95], v[40:43], 0
    v_mfma_f32_16x16x32_bf16 a[80:83], v[96:99], v[40:43], 0
    v_mfma_f32_16x16x32_bf16 a[84:87], v[100:103], v[40:43], 0
    v_mfma_f32_16x16x32_bf16 a[88:91], v[104:107], v[40:43], 0
    v_mfma_f32_16x16x32_bf16 a[92:95], v[108:111], v[40:43], 0
    v_mfma_f32_16x16x32_bf16 a[96:99], v[80:83], v[44:47], 0
    v_mfma_f32_16x16x32_bf16 a[100:103], v[84:87], v[44:47], 0
    v_mfma_f32_16x16x32_bf16 a[104:107], v[88:91], v[44:47], 0
    v_mfma_f32_16x16x32_bf16 a[108:111], v[92:95], v[44:47], 0
    v_mfma_f32_16x16x32_bf16 a[112:115], v[96:99], v[44:47], 0
    v_mfma_f32_16x16x32_bf16 a[116:119], v[100:103], v[44:47], 0
    v_mfma_f32_16x16x32_bf16 a[120:123], v[104:107], v[44:47], 0
    v_mfma_f32_16x16x32_bf16 a[124:127], v[108:111], v[44:47], 0
    v_add_u32 v5, 3072, v2
    buffer_load_dwordx4 v[32:35], v5, s[12:15], s24 offen
    buffer_load_dwordx4 v[36:39], v5, s[12:15], s25 offen
    buffer_load_dwordx4 v[40:43], v5, s[12:15], s26 offen
    buffer_load_dwordx4 v[44:47], v5, s[12:15], s27 offen
    ds_read_b128 v[80:83], v3 offset:2048
    ds_read_b128 v[84:87], v3 offset:18432
    ds_read_b128 v[88:91], v3 offset:34816
    ds_read_b128 v[92:95], v3 offset:51200
    ds_read_b128 v[96:99], v4 offset:2048
    ds_read_b128 v[100:103], v4 offset:18432
    ds_read_b128 v[104:107], v4 offset:34816
    ds_read_b128 v[108:111], v4 offset:51200
    s_waitcnt vmcnt(8) lgkmcnt(8)
    v_mfma_f32_16x16x32_bf16 a[0:3], v[112:115], v[48:51], a[0:3]
    v_mfma_f32_16x16x32_bf16 a[4:7], v[116:119], v[48:51], a[4:7]
    v_mfma_f32_16x16x32_bf16 a[8:11], v[120:123], v[48:51], a[8:11]
    v_mfma_f32_16x16x32_bf16 a[12:15], v[124:127], v[48:51], a[12:15]
    v_mfma_f32_16x16x32_bf16 a[16:19], v[128:131], v[48:51], a[16:19]
    v_mfma_f32_16x16x32_bf16 a[20:23], v[132:135], v[48:51], a[20:23]
    v_mfma_f32_16x16x32_bf16 a[24:27], v[136:139], v[48:51], a[24:27]
    v_mfma_f32_16x16x32_bf16 a[28:31], v[140:143], v[48:51], a[28:31]
    v_mfma_f32_16x16x32_bf16 a[32:35], v[112:115], v[52:55], a[32:35]
    v_mfma_f32_16x16x32_bf16 a[36:39], v[116:119], v[52:55], a[36:39]
    v_mfma_f32_16x16x32_bf16 a[40:43], v[120:123], v[52:55], a[40:43]
    v_mfma_f32_16x16x32_bf16 a[44:47], v[124:127], v[52:55], a[44:47]
    v_mfma_f32_16x16x32_bf16 a[48:51], v[128:131], v[52:55], a[48:51]
    v_mfma_f32_16x16x32_bf16 a[52:55], v[132:135], v[52:55], a[52:55]
    v_mfma_f32_16x16x32_bf16 a[56:59], v[136:139], v[52:55], a[56:59]
    v_mfma_f32_16x16x32_bf16 a[60:63], v[140:143], v[52:55], a[60:63]
    v_mfma_f32_16x16x32_bf16 a[64:67], v[112:115], v[56:59], a[64:67]
    v_mfma_f32_16x16x32_bf16 a[68:71], v[116:119], v[56:59], a[68:71]
    v_mfma_f32_16x16x32_bf16 a[72:75], v[120:123], v[56:59], a[72:75]
    v_mfma_f32_16x16x32_bf16 a[76:79], v[124:127], v[56:59], a[76:79]
    v_mfma_f32_16x16x32_bf16 a[80:83], v[128:131], v[56:59], a[80:83]
    v_mfma_f32_16x16x32_bf16 a[84:87], v[132:135], v[56:59], a[84:87]
    v_mfma_f32_16x16x32_bf16 a[88:91], v[136:139], v[56:59], a[88:91]
    v_mfma_f32_16x16x32_bf16 a[92:95], v[140:143], v[56:59], a[92:95]
    v_mfma_f32_16x16x32_bf16 a[96:99], v[112:115], v[60:63], a[96:99]
    v_mfma_f32_16x16x32_bf16 a[100:103], v[116:119], v[60:63], a[100:103]
    v_mfma_f32_16x16x32_bf16 a[104:107], v[120:123], v[60:63], a[104:107]
    v_mfma_f32_16x16x32_bf16 a[108:111], v[124:127], v[60:63], a[108:111]
    v_mfma_f32_16x16x32_bf16 a[112:115], v[128:131], v[60:63], a[112:115]
    v_mfma_f32_16x16x32_bf16 a[116:119], v[132:135], v[60:63], a[116:119]
    v_mfma_f32_16x16x32_bf16 a[120:123], v[136:139], v[60:63], a[120:123]
    v_mfma_f32_16x16x32_bf16 a[124:127], v[140:143], v[60:63], a[124:127]
    v_add_u32 v5, 4096, v2
    buffer_load_dwordx4 v[48:51], v5, s[12:15], s24 offen
    buffer_load_dwordx4 v[52:55], v5, s[12:15], s25 offen
    buffer_load_dwordx4 v[56:59], v5, s[12:15], s26 offen
    buffer_load_dwordx4 v[60:63], v5, s[12:15], s27 offen
    ds_read_b128 v[112:115], v3 offset:3072
    ds_read_b128 v[116:119], v3 offset:19456
    ds_read_b128 v[120:123], v3 offset:35840
    ds_read_b128 v[124:127], v3 offset:52224
    ds_read_b128 v[128:131], v4 offset:3072
    ds_read_b128 v[132:135], v4 offset:19456
    ds_read_b128 v[136:139], v4 offset:35840
    ds_read_b128 v[140:143], v4 offset:52224
    s_waitcnt vmcnt(8) lgkmcnt(8)
    v_mfma_f32_16x16x32_bf16 a[0:3], v[80:83], v[64:67], a[0:3]
    v_mfma_f32_16x16x32_bf16 a[4:7], v[84:87], v[64:67], a[4:7]
    v_mfma_f32_16x16x32_bf16 a[8:11], v[88:91], v[64:67], a[8:11]
    v_mfma_f32_16x16x32_bf16 a[12:15], v[92:95], v[64:67], a[12:15]
    v_mfma_f32_16x16x32_bf16 a[16:19], v[96:99], v[64:67], a[16:19]
    v_mfma_f32_16x16x32_bf16 a[20:23], v[100:103], v[64:67], a[20:23]
    v_mfma_f32_16x16x32_bf16 a[24:27], v[104:107], v[64:67], a[24:27]
    v_mfma_f32_16x16x32_bf16 a[28:31], v[108:111], v[64:67], a[28:31]
    v_mfma_f32_16x16x32_bf16 a[32:35], v[80:83], v[68:71], a[32:35]
    v_mfma_f32_16x16x32_bf16 a[36:39], v[84:87], v[68:71], a[36:39]
    v_mfma_f32_16x16x32_bf16 a[40:43], v[88:91], v[68:71], a[40:43]
    v_mfma_f32_16x16x32_bf16 a[44:47], v[92:95], v[68:71], a[44:47]
    v_mfma_f32_16x16x32_bf16 a[48:51], v[96:99], v[68:71], a[48:51]
    v_mfma_f32_16x16x32_bf16 a[52:55], v[100:103], v[68:71], a[52:55]
    v_mfma_f32_16x16x32_bf16 a[56:59], v[104:107], v[68:71], a[56:59]
    v_mfma_f32_16x16x32_bf16 a[60:63], v[108:111], v[68:71], a[60:63]
    v_mfma_f32_16x16x32_bf16 a[64:67], v[80:83], v[72:75], a[64:67]
    v_mfma_f32_16x16x32_bf16 a[68:71], v[84:87], v[72:75], a[68:71]
    v_mfma_f32_16x16x32_bf16 a[72:75], v[88:91], v[72:75], a[72:75]
    v_mfma_f32_16x16x32_bf16 a[76:79], v[92:95], v[72:75], a[76:79]
    v_mfma_f32_16x16x32_bf16 a[80:83], v[96:99], v[72:75], a[80:83]
    v_mfma_f32_16x16x32_bf16 a[84:87], v[100:103], v[72:75], a[84:87]
    v_mfma_f32_16x16x32_bf16 a[88:91], v[104:107], v[72:75], a[88:91]
    v_mfma_f32_16x16x32_bf16 a[92:95], v[108:111], v[72:75], a[92:95]
    v_mfma_f32_16x16x32_bf16 a[96:99], v[80:83], v[76:79], a[96:99]
    v_mfma_f32_16x16x32_bf16 a[100:103], v[84:87], v[76:79], a[100:103]
    v_mfma_f32_16x16x32_bf16 a[104:107], v[88:91], v[76:79], a[104:107]
    v_mfma_f32_16x16x32_bf16 a[108:111], v[92:95], v[76:79], a[108:111]
    v_mfma_f32_16x16x32_bf16 a[112:115], v[96:99], v[76:79], a[112:115]
    v_mfma_f32_16x16x32_bf16 a[116:119], v[100:103], v[76:79], a[116:119]
    v_mfma_f32_16x16x32_bf16 a[120:123], v[104:107], v[76:79], a[120:123]
    v_mfma_f32_16x16x32_bf16 a[124:127], v[108:111], v[76:79], a[124:127]
    v_add_u32 v5, 5120, v2
    buffer_load_dwordx4 v[64:67], v5, s[12:15], s24 offen
    buffer_load_dwordx4 v[68:71], v5, s[12:15], s25 offen
    buffer_load_dwordx4 v[72:75], v5, s[12:15], s26 offen
    buffer_load_dwordx4 v[76:79], v5, s[12:15], s27 offen
    ds_read_b128 v[80:83], v3 offset:4096
    ds_read_b128 v[84:87], v3 offset:20480
    ds_read_b128 v[88:91], v3 offset:36864
    ds_read_b128 v[92:95], v3 offset:53248
    ds_read_b128 v[96:99], v4 offset:4096
    ds_read_b128 v[100:103], v4 offset:20480
    ds_read_b128 v[104:107], v4 offset:36864
    ds_read_b128 v[108:111], v4 offset:53248
    s_waitcnt vmcnt(8) lgkmcnt(8)
    v_mfma_f32_16x16x32_bf16 a[0:3], v[112:115], v[32:35], a[0:3]
    v_mfma_f32_16x16x32_bf16 a[4:7], v[116:119], v[32:35], a[4:7]
    v_mfma_f32_16x16x32_bf16 a[8:11], v[120:123], v[32:35], a[8:11]
    v_mfma_f32_16x16x32_bf16 a[12:15], v[124:127], v[32:35], a[12:15]
    v_mfma_f32_16x16x32_bf16 a[16:19], v[128:131], v[32:35], a[16:19]
    v_mfma_f32_16x16x32_bf16 a[20:23], v[132:135], v[32:35], a[20:23]
    v_mfma_f32_16x16x32_bf16 a[24:27], v[136:139], v[32:35], a[24:27]
    v_mfma_f32_16x16x32_bf16 a[28:31], v[140:143], v[32:35], a[28:31]
    v_mfma_f32_16x16x32_bf16 a[32:35], v[112:115], v[36:39], a[32:35]
    v_mfma_f32_16x16x32_bf16 a[36:39], v[116:119], v[36:39], a[36:39]
    v_mfma_f32_16x16x32_bf16 a[40:43], v[120:123], v[36:39], a[40:43]
    v_mfma_f32_16x16x32_bf16 a[44:47], v[124:127], v[36:39], a[44:47]
    v_mfma_f32_16x16x32_bf16 a[48:51], v[128:131], v[36:39], a[48:51]
    v_mfma_f32_16x16x32_bf16 a[52:55], v[132:135], v[36:39], a[52:55]
    v_mfma_f32_16x16x32_bf16 a[56:59], v[136:139], v[36:39], a[56:59]
    v_mfma_f32_16x16x32_bf16 a[60:63], v[140:143], v[36:39], a[60:63]
    v_mfma_f32_16x16x32_bf16 a[64:67], v[112:115], v[40:43], a[64:67]
    v_mfma_f32_16x16x32_bf16 a[68:71], v[116:119], v[40:43], a[68:71]
    v_mfma_f32_16x16x32_bf16 a[72:75], v[120:123], v[40:43], a[72:75]
    v_mfma_f32_16x16x32_bf16 a[76:79], v[124:127], v[40:43], a[76:79]
    v_mfma_f32_16x16x32_bf16 a[80:83], v[128:131], v[40:43], a[80:83]
    v_mfma_f32_16x16x32_bf16 a[84:87], v[132:135], v[40:43], a[84:87]
    v_mfma_f32_16x16x32_bf16 a[88:91], v[136:139], v[40:43], a[88:91]
    v_mfma_f32_16x16x32_bf16 a[92:95], v[140:143], v[40:43], a[92:95]
    v_mfma_f32_16x16x32_bf16 a[96:99], v[112:115], v[44:47], a[96:99]
    v_mfma_f32_16x16x32_bf16 a[100:103], v[116:119], v[44:47], a[100:103]
    v_mfma_f32_16x16x32_bf16 a[104:107], v[120:123], v[44:47], a[104:107]
    v_mfma_f32_16x16x32_bf16 a[108:111], v[124:127], v[44:47], a[108:111]
    v_mfma_f32_16x16x32_bf16 a[112:115], v[128:131], v[44:47], a[112:115]
    v_mfma_f32_16x16x32_bf16 a[116:119], v[132:135], v[44:47], a[116:119]
    v_mfma_f32_16x16x32_bf16 a[120:123], v[136:139], v[44:47], a[120:123]
    v_mfma_f32_16x16x32_bf16 a[124:127], v[140:143], v[44:47], a[124:127]
    v_add_u32 v5, 6144, v2
    buffer_load_dwordx4 v[32:35], v5, s[12:15], s24 offen
    buffer_load_dwordx4 v[36:39], v5, s[12:15], s25 offen
    buffer_load_dwordx4 v[40:43], v5, s[12:15], s26 offen
    buffer_load_dwordx4 v[44:47], v5, s[12:15], s27 offen
    ds_read_b128 v[112:115], v3 offset:5120
    ds_read_b128 v[116:119], v3 offset:21504
    ds_read_b128 v[120:123], v3 offset:37888
    ds_read_b128 v[124:127], v3 offset:54272
    ds_read_b128 v[128:131], v4 offset:5120
    ds_read_b128 v[132:135], v4 offset:21504
    ds_read_b128 v[136:139], v4 offset:37888
    ds_read_b128 v[140:143], v4 offset:54272
    s_waitcnt vmcnt(8) lgkmcnt(8)
    v_mfma_f32_16x16x32_bf16 a[0:3], v[80:83], v[48:51], a[0:3]
    v_mfma_f32_16x16x32_bf16 a[4:7], v[84:87], v[48:51], a[4:7]
    v_mfma_f32_16x16x32_bf16 a[8:11], v[88:91], v[48:51], a[8:11]
    v_mfma_f32_16x16x32_bf16 a[12:15], v[92:95], v[48:51], a[12:15]
    v_mfma_f32_16x16x32_bf16 a[16:19], v[96:99], v[48:51], a[16:19]
    v_mfma_f32_16x16x32_bf16 a[20:23], v[100:103], v[48:51], a[20:23]
    v_mfma_f32_16x16x32_bf16 a[24:27], v[104:107], v[48:51], a[24:27]
    v_mfma_f32_16x16x32_bf16 a[28:31], v[108:111], v[48:51], a[28:31]
    v_mfma_f32_16x16x32_bf16 a[32:35], v[80:83], v[52:55], a[32:35]
    v_mfma_f32_16x16x32_bf16 a[36:39], v[84:87], v[52:55], a[36:39]
    v_mfma_f32_16x16x32_bf16 a[40:43], v[88:91], v[52:55], a[40:43]
    v_mfma_f32_16x16x32_bf16 a[44:47], v[92:95], v[52:55], a[44:47]
    v_mfma_f32_16x16x32_bf16 a[48:51], v[96:99], v[52:55], a[48:51]
    v_mfma_f32_16x16x32_bf16 a[52:55], v[100:103], v[52:55], a[52:55]
    v_mfma_f32_16x16x32_bf16 a[56:59], v[104:107], v[52:55], a[56:59]
    v_mfma_f32_16x16x32_bf16 a[60:63], v[108:111], v[52:55], a[60:63]
    v_mfma_f32_16x16x32_bf16 a[64:67], v[80:83], v[56:59], a[64:67]
    v_mfma_f32_16x16x32_bf16 a[68:71], v[84:87], v[56:59], a[68:71]
    v_mfma_f32_16x16x32_bf16 a[72:75], v[88:91], v[56:59], a[72:75]
    v_mfma_f32_16x16x32_bf16 a[76:79], v[92:95], v[56:59], a[76:79]
    v_mfma_f32_16x16x32_bf16 a[80:83], v[96:99], v[56:59], a[80:83]
    v_mfma_f32_16x16x32_bf16 a[84:87], v[100:103], v[56:59], a[84:87]
    v_mfma_f32_16x16x32_bf16 a[88:91], v[104:107], v[56:59], a[88:91]
    v_mfma_f32_16x16x32_bf16 a[92:95], v[108:111], v[56:59], a[92:95]
    v_mfma_f32_16x16x32_bf16 a[96:99], v[80:83], v[60:63], a[96:99]
    v_mfma_f32_16x16x32_bf16 a[100:103], v[84:87], v[60:63], a[100:103]
    v_mfma_f32_16x16x32_bf16 a[104:107], v[88:91], v[60:63], a[104:107]
    v_mfma_f32_16x16x32_bf16 a[108:111], v[92:95], v[60:63], a[108:111]
    v_mfma_f32_16x16x32_bf16 a[112:115], v[96:99], v[60:63], a[112:115]
    v_mfma_f32_16x16x32_bf16 a[116:119], v[100:103], v[60:63], a[116:119]
    v_mfma_f32_16x16x32_bf16 a[120:123], v[104:107], v[60:63], a[120:123]
    v_mfma_f32_16x16x32_bf16 a[124:127], v[108:111], v[60:63], a[124:127]
    v_add_u32 v5, 7168, v2
    buffer_load_dwordx4 v[48:51], v5, s[12:15], s24 offen
    buffer_load_dwordx4 v[52:55], v5, s[12:15], s25 offen
    buffer_load_dwordx4 v[56:59], v5, s[12:15], s26 offen
    buffer_load_dwordx4 v[60:63], v5, s[12:15], s27 offen
    ds_read_b128 v[80:83], v3 offset:6144
    ds_read_b128 v[84:87], v3 offset:22528
    ds_read_b128 v[88:91], v3 offset:38912
    ds_read_b128 v[92:95], v3 offset:55296
    ds_read_b128 v[96:99], v4 offset:6144
    ds_read_b128 v[100:103], v4 offset:22528
    ds_read_b128 v[104:107], v4 offset:38912
    ds_read_b128 v[108:111], v4 offset:55296
    s_waitcnt vmcnt(8) lgkmcnt(8)
    v_mfma_f32_16x16x32_bf16 a[0:3], v[112:115], v[64:67], a[0:3]
    v_mfma_f32_16x16x32_bf16 a[4:7], v[116:119], v[64:67], a[4:7]
    v_mfma_f32_16x16x32_bf16 a[8:11], v[120:123], v[64:67], a[8:11]
    v_mfma_f32_16x16x32_bf16 a[12:15], v[124:127], v[64:67], a[12:15]
    v_mfma_f32_16x16x32_bf16 a[16:19], v[128:131], v[64:67], a[16:19]
    v_mfma_f32_16x16x32_bf16 a[20:23], v[132:135], v[64:67], a[20:23]
    v_mfma_f32_16x16x32_bf16 a[24:27], v[136:139], v[64:67], a[24:27]
    v_mfma_f32_16x16x32_bf16 a[28:31], v[140:143], v[64:67], a[28:31]
    v_mfma_f32_16x16x32_bf16 a[32:35], v[112:115], v[68:71], a[32:35]
    v_mfma_f32_16x16x32_bf16 a[36:39], v[116:119], v[68:71], a[36:39]
    v_mfma_f32_16x16x32_bf16 a[40:43], v[120:123], v[68:71], a[40:43]
    v_mfma_f32_16x16x32_bf16 a[44:47], v[124:127], v[68:71], a[44:47]
    v_mfma_f32_16x16x32_bf16 a[48:51], v[128:131], v[68:71], a[48:51]
    v_mfma_f32_16x16x32_bf16 a[52:55], v[132:135], v[68:71], a[52:55]
    v_mfma_f32_16x16x32_bf16 a[56:59], v[136:139], v[68:71], a[56:59]
    v_mfma_f32_16x16x32_bf16 a[60:63], v[140:143], v[68:71], a[60:63]
    v_mfma_f32_16x16x32_bf16 a[64:67], v[112:115], v[72:75], a[64:67]
    v_mfma_f32_16x16x32_bf16 a[68:71], v[116:119], v[72:75], a[68:71]
    v_mfma_f32_16x16x32_bf16 a[72:75], v[120:123], v[72:75], a[72:75]
    v_mfma_f32_16x16x32_bf16 a[76:79], v[124:127], v[72:75], a[76:79]
    v_mfma_f32_16x16x32_bf16 a[80:83], v[128:131], v[72:75], a[80:83]
    v_mfma_f32_16x16x32_bf16 a[84:87], v[132:135], v[72:75], a[84:87]
    v_mfma_f32_16x16x32_bf16 a[88:91], v[136:139], v[72:75], a[88:91]
    v_mfma_f32_16x16x32_bf16 a[92:95], v[140:143], v[72:75], a[92:95]
    v_mfma_f32_16x16x32_bf16 a[96:99], v[112:115], v[76:79], a[96:99]
    v_mfma_f32_16x16x32_bf16 a[100:103], v[116:119], v[76:79], a[100:103]
    v_mfma_f32_16x16x32_bf16 a[104:107], v[120:123], v[76:79], a[104:107]
    v_mfma_f32_16x16x32_bf16 a[108:111], v[124:127], v[76:79], a[108:111]
    v_mfma_f32_16x16x32_bf16 a[112:115], v[128:131], v[76:79], a[112:115]
    v_mfma_f32_16x16x32_bf16 a[116:119], v[132:135], v[76:79], a[116:119]
    v_mfma_f32_16x16x32_bf16 a[120:123], v[136:139], v[76:79], a[120:123]
    v_mfma_f32_16x16x32_bf16 a[124:127], v[140:143], v[76:79], a[124:127]
    v_add_u32 v5, 8192, v2
    buffer_load_dwordx4 v[64:67], v5, s[12:15], s24 offen
    buffer_load_dwordx4 v[68:71], v5, s[12:15], s25 offen
    buffer_load_dwordx4 v[72:75], v5, s[12:15], s26 offen
    buffer_load_dwordx4 v[76:79], v5, s[12:15], s27 offen
    ds_read_b128 v[112:115], v3 offset:7168
    ds_read_b128 v[116:119], v3 offset:23552
    ds_read_b128 v[120:123], v3 offset:39936
    ds_read_b128 v[124:127], v3 offset:56320
    ds_read_b128 v[128:131], v4 offset:7168
    ds_read_b128 v[132:135], v4 offset:23552
    ds_read_b128 v[136:139], v4 offset:39936
    ds_read_b128 v[140:143], v4 offset:56320
    s_waitcnt vmcnt(8) lgkmcnt(8)
    v_mfma_f32_16x16x32_bf16 a[0:3], v[80:83], v[32:35], a[0:3]
    v_mfma_f32_16x16x32_bf16 a[4:7], v[84:87], v[32:35], a[4:7]
    v_mfma_f32_16x16x32_bf16 a[8:11], v[88:91], v[32:35], a[8:11]
    v_mfma_f32_16x16x32_bf16 a[12:15], v[92:95], v[32:35], a[12:15]
    v_mfma_f32_16x16x32_bf16 a[16:19], v[96:99], v[32:35], a[16:19]
    v_mfma_f32_16x16x32_bf16 a[20:23], v[100:103], v[32:35], a[20:23]
    v_mfma_f32_16x16x32_bf16 a[24:27], v[104:107], v[32:35], a[24:27]
    v_mfma_f32_16x16x32_bf16 a[28:31], v[108:111], v[32:35], a[28:31]
    v_mfma_f32_16x16x32_bf16 a[32:35], v[80:83], v[36:39], a[32:35]
    v_mfma_f32_16x16x32_bf16 a[36:39], v[84:87], v[36:39], a[36:39]
    v_mfma_f32_16x16x32_bf16 a[40:43], v[88:91], v[36:39], a[40:43]
    v_mfma_f32_16x16x32_bf16 a[44:47], v[92:95], v[36:39], a[44:47]
    v_mfma_f32_16x16x32_bf16 a[48:51], v[96:99], v[36:39], a[48:51]
    v_mfma_f32_16x16x32_bf16 a[52:55], v[100:103], v[36:39], a[52:55]
    v_mfma_f32_16x16x32_bf16 a[56:59], v[104:107], v[36:39], a[56:59]
    v_mfma_f32_16x16x32_bf16 a[60:63], v[108:111], v[36:39], a[60:63]
    v_mfma_f32_16x16x32_bf16 a[64:67], v[80:83], v[40:43], a[64:67]
    v_mfma_f32_16x16x32_bf16 a[68:71], v[84:87], v[40:43], a[68:71]
    v_mfma_f32_16x16x32_bf16 a[72:75], v[88:91], v[40:43], a[72:75]
    v_mfma_f32_16x16x32_bf16 a[76:79], v[92:95], v[40:43], a[76:79]
    v_mfma_f32_16x16x32_bf16 a[80:83], v[96:99], v[40:43], a[80:83]
    v_mfma_f32_16x16x32_bf16 a[84:87], v[100:103], v[40:43], a[84:87]
    v_mfma_f32_16x16x32_bf16 a[88:91], v[104:107], v[40:43], a[88:91]
    v_mfma_f32_16x16x32_bf16 a[92:95], v[108:111], v[40:43], a[92:95]
    v_mfma_f32_16x16x32_bf16 a[96:99], v[80:83], v[44:47], a[96:99]
    v_mfma_f32_16x16x32_bf16 a[100:103], v[84:87], v[44:47], a[100:103]
    v_mfma_f32_16x16x32_bf16 a[104:107], v[88:91], v[44:47], a[104:107]
    v_mfma_f32_16x16x32_bf16 a[108:111], v[92:95], v[44:47], a[108:111]
    v_mfma_f32_16x16x32_bf16 a[112:115], v[96:99], v[44:47], a[112:115]
    v_mfma_f32_16x16x32_bf16 a[116:119], v[100:103], v[44:47], a[116:119]
    v_mfma_f32_16x16x32_bf16 a[120:123], v[104:107], v[44:47], a[120:123]
    v_mfma_f32_16x16x32_bf16 a[124:127], v[108:111], v[44:47], a[124:127]
    v_add_u32 v5, 9216, v2
    buffer_load_dwordx4 v[32:35], v5, s[12:15], s24 offen
    buffer_load_dwordx4 v[36:39], v5, s[12:15], s25 offen
    buffer_load_dwordx4 v[40:43], v5, s[12:15], s26 offen
    buffer_load_dwordx4 v[44:47], v5, s[12:15], s27 offen
    ds_read_b128 v[80:83], v3 offset:8192
    ds_read_b128 v[84:87], v3 offset:24576
    ds_read_b128 v[88:91], v3 offset:40960
    ds_read_b128 v[92:95], v3 offset:57344
    ds_read_b128 v[96:99], v4 offset:8192
    ds_read_b128 v[100:103], v4 offset:24576
    ds_read_b128 v[104:107], v4 offset:40960
    ds_read_b128 v[108:111], v4 offset:57344
    s_waitcnt vmcnt(8) lgkmcnt(8)
    v_mfma_f32_16x16x32_bf16 a[0:3], v[112:115], v[48:51], a[0:3]
    v_mfma_f32_16x16x32_bf16 a[4:7], v[116:119], v[48:51], a[4:7]
    v_mfma_f32_16x16x32_bf16 a[8:11], v[120:123], v[48:51], a[8:11]
    v_mfma_f32_16x16x32_bf16 a[12:15], v[124:127], v[48:51], a[12:15]
    v_mfma_f32_16x16x32_bf16 a[16:19], v[128:131], v[48:51], a[16:19]
    v_mfma_f32_16x16x32_bf16 a[20:23], v[132:135], v[48:51], a[20:23]
    v_mfma_f32_16x16x32_bf16 a[24:27], v[136:139], v[48:51], a[24:27]
    v_mfma_f32_16x16x32_bf16 a[28:31], v[140:143], v[48:51], a[28:31]
    v_mfma_f32_16x16x32_bf16 a[32:35], v[112:115], v[52:55], a[32:35]
    v_mfma_f32_16x16x32_bf16 a[36:39], v[116:119], v[52:55], a[36:39]
    v_mfma_f32_16x16x32_bf16 a[40:43], v[120:123], v[52:55], a[40:43]
    v_mfma_f32_16x16x32_bf16 a[44:47], v[124:127], v[52:55], a[44:47]
    v_mfma_f32_16x16x32_bf16 a[48:51], v[128:131], v[52:55], a[48:51]
    v_mfma_f32_16x16x32_bf16 a[52:55], v[132:135], v[52:55], a[52:55]
    v_mfma_f32_16x16x32_bf16 a[56:59], v[136:139], v[52:55], a[56:59]
    v_mfma_f32_16x16x32_bf16 a[60:63], v[140:143], v[52:55], a[60:63]
    v_mfma_f32_16x16x32_bf16 a[64:67], v[112:115], v[56:59], a[64:67]
    v_mfma_f32_16x16x32_bf16 a[68:71], v[116:119], v[56:59], a[68:71]
    v_mfma_f32_16x16x32_bf16 a[72:75], v[120:123], v[56:59], a[72:75]
    v_mfma_f32_16x16x32_bf16 a[76:79], v[124:127], v[56:59], a[76:79]
    v_mfma_f32_16x16x32_bf16 a[80:83], v[128:131], v[56:59], a[80:83]
    v_mfma_f32_16x16x32_bf16 a[84:87], v[132:135], v[56:59], a[84:87]
    v_mfma_f32_16x16x32_bf16 a[88:91], v[136:139], v[56:59], a[88:91]
    v_mfma_f32_16x16x32_bf16 a[92:95], v[140:143], v[56:59], a[92:95]
    v_mfma_f32_16x16x32_bf16 a[96:99], v[112:115], v[60:63], a[96:99]
    v_mfma_f32_16x16x32_bf16 a[100:103], v[116:119], v[60:63], a[100:103]
    v_mfma_f32_16x16x32_bf16 a[104:107], v[120:123], v[60:63], a[104:107]
    v_mfma_f32_16x16x32_bf16 a[108:111], v[124:127], v[60:63], a[108:111]
    v_mfma_f32_16x16x32_bf16 a[112:115], v[128:131], v[60:63], a[112:115]
    v_mfma_f32_16x16x32_bf16 a[116:119], v[132:135], v[60:63], a[116:119]
    v_mfma_f32_16x16x32_bf16 a[120:123], v[136:139], v[60:63], a[120:123]
    v_mfma_f32_16x16x32_bf16 a[124:127], v[140:143], v[60:63], a[124:127]
    v_add_u32 v5, 10240, v2
    buffer_load_dwordx4 v[48:51], v5, s[12:15], s24 offen
    buffer_load_dwordx4 v[52:55], v5, s[12:15], s25 offen
    buffer_load_dwordx4 v[56:59], v5, s[12:15], s26 offen
    buffer_load_dwordx4 v[60:63], v5, s[12:15], s27 offen
    ds_read_b128 v[112:115], v3 offset:9216
    ds_read_b128 v[116:119], v3 offset:25600
    ds_read_b128 v[120:123], v3 offset:41984
    ds_read_b128 v[124:127], v3 offset:58368
    ds_read_b128 v[128:131], v4 offset:9216
    ds_read_b128 v[132:135], v4 offset:25600
    ds_read_b128 v[136:139], v4 offset:41984
    ds_read_b128 v[140:143], v4 offset:58368
    s_waitcnt vmcnt(8) lgkmcnt(8)
    v_mfma_f32_16x16x32_bf16 a[0:3], v[80:83], v[64:67], a[0:3]
    v_mfma_f32_16x16x32_bf16 a[4:7], v[84:87], v[64:67], a[4:7]
    v_mfma_f32_16x16x32_bf16 a[8:11], v[88:91], v[64:67], a[8:11]
    v_mfma_f32_16x16x32_bf16 a[12:15], v[92:95], v[64:67], a[12:15]
    v_mfma_f32_16x16x32_bf16 a[16:19], v[96:99], v[64:67], a[16:19]
    v_mfma_f32_16x16x32_bf16 a[20:23], v[100:103], v[64:67], a[20:23]
    v_mfma_f32_16x16x32_bf16 a[24:27], v[104:107], v[64:67], a[24:27]
    v_mfma_f32_16x16x32_bf16 a[28:31], v[108:111], v[64:67], a[28:31]
    v_mfma_f32_16x16x32_bf16 a[32:35], v[80:83], v[68:71], a[32:35]
    v_mfma_f32_16x16x32_bf16 a[36:39], v[84:87], v[68:71], a[36:39]
    v_mfma_f32_16x16x32_bf16 a[40:43], v[88:91], v[68:71], a[40:43]
    v_mfma_f32_16x16x32_bf16 a[44:47], v[92:95], v[68:71], a[44:47]
    v_mfma_f32_16x16x32_bf16 a[48:51], v[96:99], v[68:71], a[48:51]
    v_mfma_f32_16x16x32_bf16 a[52:55], v[100:103], v[68:71], a[52:55]
    v_mfma_f32_16x16x32_bf16 a[56:59], v[104:107], v[68:71], a[56:59]
    v_mfma_f32_16x16x32_bf16 a[60:63], v[108:111], v[68:71], a[60:63]
    v_mfma_f32_16x16x32_bf16 a[64:67], v[80:83], v[72:75], a[64:67]
    v_mfma_f32_16x16x32_bf16 a[68:71], v[84:87], v[72:75], a[68:71]
    v_mfma_f32_16x16x32_bf16 a[72:75], v[88:91], v[72:75], a[72:75]
    v_mfma_f32_16x16x32_bf16 a[76:79], v[92:95], v[72:75], a[76:79]
    v_mfma_f32_16x16x32_bf16 a[80:83], v[96:99], v[72:75], a[80:83]
    v_mfma_f32_16x16x32_bf16 a[84:87], v[100:103], v[72:75], a[84:87]
    v_mfma_f32_16x16x32_bf16 a[88:91], v[104:107], v[72:75], a[88:91]
    v_mfma_f32_16x16x32_bf16 a[92:95], v[108:111], v[72:75], a[92:95]
    v_mfma_f32_16x16x32_bf16 a[96:99], v[80:83], v[76:79], a[96:99]
    v_mfma_f32_16x16x32_bf16 a[100:103], v[84:87], v[76:79], a[100:103]
    v_mfma_f32_16x16x32_bf16 a[104:107], v[88:91], v[76:79], a[104:107]
    v_mfma_f32_16x16x32_bf16 a[108:111], v[92:95], v[76:79], a[108:111]
    v_mfma_f32_16x16x32_bf16 a[112:115], v[96:99], v[76:79], a[112:115]
    v_mfma_f32_16x16x32_bf16 a[116:119], v[100:103], v[76:79], a[116:119]
    v_mfma_f32_16x16x32_bf16 a[120:123], v[104:107], v[76:79], a[120:123]
    v_mfma_f32_16x16x32_bf16 a[124:127], v[108:111], v[76:79], a[124:127]
    v_add_u32 v5, 11264, v2
    buffer_load_dwordx4 v[64:67], v5, s[12:15], s24 offen
    buffer_load_dwordx4 v[68:71], v5, s[12:15], s25 offen
    buffer_load_dwordx4 v[72:75], v5, s[12:15], s26 offen
    buffer_load_dwordx4 v[76:79], v5, s[12:15], s27 offen
    ds_read_b128 v[80:83], v3 offset:10240
    ds_read_b128 v[84:87], v3 offset:26624
    ds_read_b128 v[88:91], v3 offset:43008
    ds_read_b128 v[92:95], v3 offset:59392
    ds_read_b128 v[96:99], v4 offset:10240
    ds_read_b128 v[100:103], v4 offset:26624
    ds_read_b128 v[104:107], v4 offset:43008
    ds_read_b128 v[108:111], v4 offset:59392
    s_waitcnt vmcnt(8) lgkmcnt(8)
    v_mfma_f32_16x16x32_bf16 a[0:3], v[112:115], v[32:35], a[0:3]
    v_mfma_f32_16x16x32_bf16 a[4:7], v[116:119], v[32:35], a[4:7]
    v_mfma_f32_16x16x32_bf16 a[8:11], v[120:123], v[32:35], a[8:11]
    v_mfma_f32_16x16x32_bf16 a[12:15], v[124:127], v[32:35], a[12:15]
    v_mfma_f32_16x16x32_bf16 a[16:19], v[128:131], v[32:35], a[16:19]
    v_mfma_f32_16x16x32_bf16 a[20:23], v[132:135], v[32:35], a[20:23]
    v_mfma_f32_16x16x32_bf16 a[24:27], v[136:139], v[32:35], a[24:27]
    v_mfma_f32_16x16x32_bf16 a[28:31], v[140:143], v[32:35], a[28:31]
    v_mfma_f32_16x16x32_bf16 a[32:35], v[112:115], v[36:39], a[32:35]
    v_mfma_f32_16x16x32_bf16 a[36:39], v[116:119], v[36:39], a[36:39]
    v_mfma_f32_16x16x32_bf16 a[40:43], v[120:123], v[36:39], a[40:43]
    v_mfma_f32_16x16x32_bf16 a[44:47], v[124:127], v[36:39], a[44:47]
    v_mfma_f32_16x16x32_bf16 a[48:51], v[128:131], v[36:39], a[48:51]
    v_mfma_f32_16x16x32_bf16 a[52:55], v[132:135], v[36:39], a[52:55]
    v_mfma_f32_16x16x32_bf16 a[56:59], v[136:139], v[36:39], a[56:59]
    v_mfma_f32_16x16x32_bf16 a[60:63], v[140:143], v[36:39], a[60:63]
    v_mfma_f32_16x16x32_bf16 a[64:67], v[112:115], v[40:43], a[64:67]
    v_mfma_f32_16x16x32_bf16 a[68:71], v[116:119], v[40:43], a[68:71]
    v_mfma_f32_16x16x32_bf16 a[72:75], v[120:123], v[40:43], a[72:75]
    v_mfma_f32_16x16x32_bf16 a[76:79], v[124:127], v[40:43], a[76:79]
    v_mfma_f32_16x16x32_bf16 a[80:83], v[128:131], v[40:43], a[80:83]
    v_mfma_f32_16x16x32_bf16 a[84:87], v[132:135], v[40:43], a[84:87]
    v_mfma_f32_16x16x32_bf16 a[88:91], v[136:139], v[40:43], a[88:91]
    v_mfma_f32_16x16x32_bf16 a[92:95], v[140:143], v[40:43], a[92:95]
    v_mfma_f32_16x16x32_bf16 a[96:99], v[112:115], v[44:47], a[96:99]
    v_mfma_f32_16x16x32_bf16 a[100:103], v[116:119], v[44:47], a[100:103]
    v_mfma_f32_16x16x32_bf16 a[104:107], v[120:123], v[44:47], a[104:107]
    v_mfma_f32_16x16x32_bf16 a[108:111], v[124:127], v[44:47], a[108:111]
    v_mfma_f32_16x16x32_bf16 a[112:115], v[128:131], v[44:47], a[112:115]
    v_mfma_f32_16x16x32_bf16 a[116:119], v[132:135], v[44:47], a[116:119]
    v_mfma_f32_16x16x32_bf16 a[120:123], v[136:139], v[44:47], a[120:123]
    v_mfma_f32_16x16x32_bf16 a[124:127], v[140:143], v[44:47], a[124:127]
    v_add_u32 v5, 12288, v2
    buffer_load_dwordx4 v[32:35], v5, s[12:15], s24 offen
    buffer_load_dwordx4 v[36:39], v5, s[12:15], s25 offen
    buffer_load_dwordx4 v[40:43], v5, s[12:15], s26 offen
    buffer_load_dwordx4 v[44:47], v5, s[12:15], s27 offen
    ds_read_b128 v[112:115], v3 offset:11264
    ds_read_b128 v[116:119], v3 offset:27648
    ds_read_b128 v[120:123], v3 offset:44032
    ds_read_b128 v[124:127], v3 offset:60416
    ds_read_b128 v[128:131], v4 offset:11264
    ds_read_b128 v[132:135], v4 offset:27648
    ds_read_b128 v[136:139], v4 offset:44032
    ds_read_b128 v[140:143], v4 offset:60416
    s_waitcnt vmcnt(8) lgkmcnt(8)
    v_mfma_f32_16x16x32_bf16 a[0:3], v[80:83], v[48:51], a[0:3]
    v_mfma_f32_16x16x32_bf16 a[4:7], v[84:87], v[48:51], a[4:7]
    v_mfma_f32_16x16x32_bf16 a[8:11], v[88:91], v[48:51], a[8:11]
    v_mfma_f32_16x16x32_bf16 a[12:15], v[92:95], v[48:51], a[12:15]
    v_mfma_f32_16x16x32_bf16 a[16:19], v[96:99], v[48:51], a[16:19]
    v_mfma_f32_16x16x32_bf16 a[20:23], v[100:103], v[48:51], a[20:23]
    v_mfma_f32_16x16x32_bf16 a[24:27], v[104:107], v[48:51], a[24:27]
    v_mfma_f32_16x16x32_bf16 a[28:31], v[108:111], v[48:51], a[28:31]
    v_mfma_f32_16x16x32_bf16 a[32:35], v[80:83], v[52:55], a[32:35]
    v_mfma_f32_16x16x32_bf16 a[36:39], v[84:87], v[52:55], a[36:39]
    v_mfma_f32_16x16x32_bf16 a[40:43], v[88:91], v[52:55], a[40:43]
    v_mfma_f32_16x16x32_bf16 a[44:47], v[92:95], v[52:55], a[44:47]
    v_mfma_f32_16x16x32_bf16 a[48:51], v[96:99], v[52:55], a[48:51]
    v_mfma_f32_16x16x32_bf16 a[52:55], v[100:103], v[52:55], a[52:55]
    v_mfma_f32_16x16x32_bf16 a[56:59], v[104:107], v[52:55], a[56:59]
    v_mfma_f32_16x16x32_bf16 a[60:63], v[108:111], v[52:55], a[60:63]
    v_mfma_f32_16x16x32_bf16 a[64:67], v[80:83], v[56:59], a[64:67]
    v_mfma_f32_16x16x32_bf16 a[68:71], v[84:87], v[56:59], a[68:71]
    v_mfma_f32_16x16x32_bf16 a[72:75], v[88:91], v[56:59], a[72:75]
    v_mfma_f32_16x16x32_bf16 a[76:79], v[92:95], v[56:59], a[76:79]
    v_mfma_f32_16x16x32_bf16 a[80:83], v[96:99], v[56:59], a[80:83]
    v_mfma_f32_16x16x32_bf16 a[84:87], v[100:103], v[56:59], a[84:87]
    v_mfma_f32_16x16x32_bf16 a[88:91], v[104:107], v[56:59], a[88:91]
    v_mfma_f32_16x16x32_bf16 a[92:95], v[108:111], v[56:59], a[92:95]
    v_mfma_f32_16x16x32_bf16 a[96:99], v[80:83], v[60:63], a[96:99]
    v_mfma_f32_16x16x32_bf16 a[100:103], v[84:87], v[60:63], a[100:103]
    v_mfma_f32_16x16x32_bf16 a[104:107], v[88:91], v[60:63], a[104:107]
    v_mfma_f32_16x16x32_bf16 a[108:111], v[92:95], v[60:63], a[108:111]
    v_mfma_f32_16x16x32_bf16 a[112:115], v[96:99], v[60:63], a[112:115]
    v_mfma_f32_16x16x32_bf16 a[116:119], v[100:103], v[60:63], a[116:119]
    v_mfma_f32_16x16x32_bf16 a[120:123], v[104:107], v[60:63], a[120:123]
    v_mfma_f32_16x16x32_bf16 a[124:127], v[108:111], v[60:63], a[124:127]
    v_add_u32 v5, 13312, v2
    buffer_load_dwordx4 v[48:51], v5, s[12:15], s24 offen
    buffer_load_dwordx4 v[52:55], v5, s[12:15], s25 offen
    buffer_load_dwordx4 v[56:59], v5, s[12:15], s26 offen
    buffer_load_dwordx4 v[60:63], v5, s[12:15], s27 offen
    ds_read_b128 v[80:83], v3 offset:12288
    ds_read_b128 v[84:87], v3 offset:28672
    ds_read_b128 v[88:91], v3 offset:45056
    ds_read_b128 v[92:95], v3 offset:61440
    ds_read_b128 v[96:99], v4 offset:12288
    ds_read_b128 v[100:103], v4 offset:28672
    ds_read_b128 v[104:107], v4 offset:45056
    ds_read_b128 v[108:111], v4 offset:61440
    s_waitcnt vmcnt(8) lgkmcnt(8)
    v_mfma_f32_16x16x32_bf16 a[0:3], v[112:115], v[64:67], a[0:3]
    v_mfma_f32_16x16x32_bf16 a[4:7], v[116:119], v[64:67], a[4:7]
    v_mfma_f32_16x16x32_bf16 a[8:11], v[120:123], v[64:67], a[8:11]
    v_mfma_f32_16x16x32_bf16 a[12:15], v[124:127], v[64:67], a[12:15]
    v_mfma_f32_16x16x32_bf16 a[16:19], v[128:131], v[64:67], a[16:19]
    v_mfma_f32_16x16x32_bf16 a[20:23], v[132:135], v[64:67], a[20:23]
    v_mfma_f32_16x16x32_bf16 a[24:27], v[136:139], v[64:67], a[24:27]
    v_mfma_f32_16x16x32_bf16 a[28:31], v[140:143], v[64:67], a[28:31]
    v_mfma_f32_16x16x32_bf16 a[32:35], v[112:115], v[68:71], a[32:35]
    v_mfma_f32_16x16x32_bf16 a[36:39], v[116:119], v[68:71], a[36:39]
    v_mfma_f32_16x16x32_bf16 a[40:43], v[120:123], v[68:71], a[40:43]
    v_mfma_f32_16x16x32_bf16 a[44:47], v[124:127], v[68:71], a[44:47]
    v_mfma_f32_16x16x32_bf16 a[48:51], v[128:131], v[68:71], a[48:51]
    v_mfma_f32_16x16x32_bf16 a[52:55], v[132:135], v[68:71], a[52:55]
    v_mfma_f32_16x16x32_bf16 a[56:59], v[136:139], v[68:71], a[56:59]
    v_mfma_f32_16x16x32_bf16 a[60:63], v[140:143], v[68:71], a[60:63]
    v_mfma_f32_16x16x32_bf16 a[64:67], v[112:115], v[72:75], a[64:67]
    v_mfma_f32_16x16x32_bf16 a[68:71], v[116:119], v[72:75], a[68:71]
    v_mfma_f32_16x16x32_bf16 a[72:75], v[120:123], v[72:75], a[72:75]
    v_mfma_f32_16x16x32_bf16 a[76:79], v[124:127], v[72:75], a[76:79]
    v_mfma_f32_16x16x32_bf16 a[80:83], v[128:131], v[72:75], a[80:83]
    v_mfma_f32_16x16x32_bf16 a[84:87], v[132:135], v[72:75], a[84:87]
    v_mfma_f32_16x16x32_bf16 a[88:91], v[136:139], v[72:75], a[88:91]
    v_mfma_f32_16x16x32_bf16 a[92:95], v[140:143], v[72:75], a[92:95]
    v_mfma_f32_16x16x32_bf16 a[96:99], v[112:115], v[76:79], a[96:99]
    v_mfma_f32_16x16x32_bf16 a[100:103], v[116:119], v[76:79], a[100:103]
    v_mfma_f32_16x16x32_bf16 a[104:107], v[120:123], v[76:79], a[104:107]
    v_mfma_f32_16x16x32_bf16 a[108:111], v[124:127], v[76:79], a[108:111]
    v_mfma_f32_16x16x32_bf16 a[112:115], v[128:131], v[76:79], a[112:115]
    v_mfma_f32_16x16x32_bf16 a[116:119], v[132:135], v[76:79], a[116:119]
    v_mfma_f32_16x16x32_bf16 a[120:123], v[136:139], v[76:79], a[120:123]
    v_mfma_f32_16x16x32_bf16 a[124:127], v[140:143], v[76:79], a[124:127]
    v_add_u32 v5, 14336, v2
    buffer_load_dwordx4 v[64:67], v5, s[12:15], s24 offen
    buffer_load_dwordx4 v[68:71], v5, s[12:15], s25 offen
    buffer_load_dwordx4 v[72:75], v5, s[12:15], s26 offen
    buffer_load_dwordx4 v[76:79], v5, s[12:15], s27 offen
    ds_read_b128 v[112:115], v3 offset:13312
    ds_read_b128 v[116:119], v3 offset:29696
    ds_read_b128 v[120:123], v3 offset:46080
    ds_read_b128 v[124:127], v3 offset:62464
    ds_read_b128 v[128:131], v4 offset:13312
    ds_read_b128 v[132:135], v4 offset:29696
    ds_read_b128 v[136:139], v4 offset:46080
    ds_read_b128 v[140:143], v4 offset:62464
    s_waitcnt vmcnt(8) lgkmcnt(8)
    v_mfma_f32_16x16x32_bf16 a[0:3], v[80:83], v[32:35], a[0:3]
    v_mfma_f32_16x16x32_bf16 a[4:7], v[84:87], v[32:35], a[4:7]
    v_mfma_f32_16x16x32_bf16 a[8:11], v[88:91], v[32:35], a[8:11]
    v_mfma_f32_16x16x32_bf16 a[12:15], v[92:95], v[32:35], a[12:15]
    v_mfma_f32_16x16x32_bf16 a[16:19], v[96:99], v[32:35], a[16:19]
    v_mfma_f32_16x16x32_bf16 a[20:23], v[100:103], v[32:35], a[20:23]
    v_mfma_f32_16x16x32_bf16 a[24:27], v[104:107], v[32:35], a[24:27]
    v_mfma_f32_16x16x32_bf16 a[28:31], v[108:111], v[32:35], a[28:31]
    v_mfma_f32_16x16x32_bf16 a[32:35], v[80:83], v[36:39], a[32:35]
    v_mfma_f32_16x16x32_bf16 a[36:39], v[84:87], v[36:39], a[36:39]
    v_mfma_f32_16x16x32_bf16 a[40:43], v[88:91], v[36:39], a[40:43]
    v_mfma_f32_16x16x32_bf16 a[44:47], v[92:95], v[36:39], a[44:47]
    v_mfma_f32_16x16x32_bf16 a[48:51], v[96:99], v[36:39], a[48:51]
    v_mfma_f32_16x16x32_bf16 a[52:55], v[100:103], v[36:39], a[52:55]
    v_mfma_f32_16x16x32_bf16 a[56:59], v[104:107], v[36:39], a[56:59]
    v_mfma_f32_16x16x32_bf16 a[60:63], v[108:111], v[36:39], a[60:63]
    v_mfma_f32_16x16x32_bf16 a[64:67], v[80:83], v[40:43], a[64:67]
    v_mfma_f32_16x16x32_bf16 a[68:71], v[84:87], v[40:43], a[68:71]
    v_mfma_f32_16x16x32_bf16 a[72:75], v[88:91], v[40:43], a[72:75]
    v_mfma_f32_16x16x32_bf16 a[76:79], v[92:95], v[40:43], a[76:79]
    v_mfma_f32_16x16x32_bf16 a[80:83], v[96:99], v[40:43], a[80:83]
    v_mfma_f32_16x16x32_bf16 a[84:87], v[100:103], v[40:43], a[84:87]
    v_mfma_f32_16x16x32_bf16 a[88:91], v[104:107], v[40:43], a[88:91]
    v_mfma_f32_16x16x32_bf16 a[92:95], v[108:111], v[40:43], a[92:95]
    v_mfma_f32_16x16x32_bf16 a[96:99], v[80:83], v[44:47], a[96:99]
    v_mfma_f32_16x16x32_bf16 a[100:103], v[84:87], v[44:47], a[100:103]
    v_mfma_f32_16x16x32_bf16 a[104:107], v[88:91], v[44:47], a[104:107]
    v_mfma_f32_16x16x32_bf16 a[108:111], v[92:95], v[44:47], a[108:111]
    v_mfma_f32_16x16x32_bf16 a[112:115], v[96:99], v[44:47], a[112:115]
    v_mfma_f32_16x16x32_bf16 a[116:119], v[100:103], v[44:47], a[116:119]
    v_mfma_f32_16x16x32_bf16 a[120:123], v[104:107], v[44:47], a[120:123]
    v_mfma_f32_16x16x32_bf16 a[124:127], v[108:111], v[44:47], a[124:127]
    v_add_u32 v5, 15360, v2
    buffer_load_dwordx4 v[32:35], v5, s[12:15], s24 offen
    buffer_load_dwordx4 v[36:39], v5, s[12:15], s25 offen
    buffer_load_dwordx4 v[40:43], v5, s[12:15], s26 offen
    buffer_load_dwordx4 v[44:47], v5, s[12:15], s27 offen
    ds_read_b128 v[80:83], v3 offset:14336
    ds_read_b128 v[84:87], v3 offset:30720
    ds_read_b128 v[88:91], v3 offset:47104
    ds_read_b128 v[92:95], v3 offset:63488
    ds_read_b128 v[96:99], v4 offset:14336
    ds_read_b128 v[100:103], v4 offset:30720
    ds_read_b128 v[104:107], v4 offset:47104
    ds_read_b128 v[108:111], v4 offset:63488
    s_waitcnt vmcnt(8) lgkmcnt(8)
    v_mfma_f32_16x16x32_bf16 a[0:3], v[112:115], v[48:51], a[0:3]
    v_mfma_f32_16x16x32_bf16 a[4:7], v[116:119], v[48:51], a[4:7]
    v_mfma_f32_16x16x32_bf16 a[8:11], v[120:123], v[48:51], a[8:11]
    v_mfma_f32_16x16x32_bf16 a[12:15], v[124:127], v[48:51], a[12:15]
    v_mfma_f32_16x16x32_bf16 a[16:19], v[128:131], v[48:51], a[16:19]
    v_mfma_f32_16x16x32_bf16 a[20:23], v[132:135], v[48:51], a[20:23]
    v_mfma_f32_16x16x32_bf16 a[24:27], v[136:139], v[48:51], a[24:27]
    v_mfma_f32_16x16x32_bf16 a[28:31], v[140:143], v[48:51], a[28:31]
    v_mfma_f32_16x16x32_bf16 a[32:35], v[112:115], v[52:55], a[32:35]
    v_mfma_f32_16x16x32_bf16 a[36:39], v[116:119], v[52:55], a[36:39]
    v_mfma_f32_16x16x32_bf16 a[40:43], v[120:123], v[52:55], a[40:43]
    v_mfma_f32_16x16x32_bf16 a[44:47], v[124:127], v[52:55], a[44:47]
    v_mfma_f32_16x16x32_bf16 a[48:51], v[128:131], v[52:55], a[48:51]
    v_mfma_f32_16x16x32_bf16 a[52:55], v[132:135], v[52:55], a[52:55]
    v_mfma_f32_16x16x32_bf16 a[56:59], v[136:139], v[52:55], a[56:59]
    v_mfma_f32_16x16x32_bf16 a[60:63], v[140:143], v[52:55], a[60:63]
    v_mfma_f32_16x16x32_bf16 a[64:67], v[112:115], v[56:59], a[64:67]
    v_mfma_f32_16x16x32_bf16 a[68:71], v[116:119], v[56:59], a[68:71]
    v_mfma_f32_16x16x32_bf16 a[72:75], v[120:123], v[56:59], a[72:75]
    v_mfma_f32_16x16x32_bf16 a[76:79], v[124:127], v[56:59], a[76:79]
    v_mfma_f32_16x16x32_bf16 a[80:83], v[128:131], v[56:59], a[80:83]
    v_mfma_f32_16x16x32_bf16 a[84:87], v[132:135], v[56:59], a[84:87]
    v_mfma_f32_16x16x32_bf16 a[88:91], v[136:139], v[56:59], a[88:91]
    v_mfma_f32_16x16x32_bf16 a[92:95], v[140:143], v[56:59], a[92:95]
    v_mfma_f32_16x16x32_bf16 a[96:99], v[112:115], v[60:63], a[96:99]
    v_mfma_f32_16x16x32_bf16 a[100:103], v[116:119], v[60:63], a[100:103]
    v_mfma_f32_16x16x32_bf16 a[104:107], v[120:123], v[60:63], a[104:107]
    v_mfma_f32_16x16x32_bf16 a[108:111], v[124:127], v[60:63], a[108:111]
    v_mfma_f32_16x16x32_bf16 a[112:115], v[128:131], v[60:63], a[112:115]
    v_mfma_f32_16x16x32_bf16 a[116:119], v[132:135], v[60:63], a[116:119]
    v_mfma_f32_16x16x32_bf16 a[120:123], v[136:139], v[60:63], a[120:123]
    v_mfma_f32_16x16x32_bf16 a[124:127], v[140:143], v[60:63], a[124:127]
    ds_read_b128 v[112:115], v3 offset:15360
    ds_read_b128 v[116:119], v3 offset:31744
    ds_read_b128 v[120:123], v3 offset:48128
    ds_read_b128 v[124:127], v3 offset:64512
    ds_read_b128 v[128:131], v4 offset:15360
    ds_read_b128 v[132:135], v4 offset:31744
    ds_read_b128 v[136:139], v4 offset:48128
    ds_read_b128 v[140:143], v4 offset:64512
    s_waitcnt vmcnt(4) lgkmcnt(8)
    v_mfma_f32_16x16x32_bf16 a[0:3], v[80:83], v[64:67], a[0:3]
    v_mfma_f32_16x16x32_bf16 a[4:7], v[84:87], v[64:67], a[4:7]
    v_mfma_f32_16x16x32_bf16 a[8:11], v[88:91], v[64:67], a[8:11]
    v_mfma_f32_16x16x32_bf16 a[12:15], v[92:95], v[64:67], a[12:15]
    v_mfma_f32_16x16x32_bf16 a[16:19], v[96:99], v[64:67], a[16:19]
    v_mfma_f32_16x16x32_bf16 a[20:23], v[100:103], v[64:67], a[20:23]
    v_mfma_f32_16x16x32_bf16 a[24:27], v[104:107], v[64:67], a[24:27]
    v_mfma_f32_16x16x32_bf16 a[28:31], v[108:111], v[64:67], a[28:31]
    v_mfma_f32_16x16x32_bf16 a[32:35], v[80:83], v[68:71], a[32:35]
    v_mfma_f32_16x16x32_bf16 a[36:39], v[84:87], v[68:71], a[36:39]
    v_mfma_f32_16x16x32_bf16 a[40:43], v[88:91], v[68:71], a[40:43]
    v_mfma_f32_16x16x32_bf16 a[44:47], v[92:95], v[68:71], a[44:47]
    v_mfma_f32_16x16x32_bf16 a[48:51], v[96:99], v[68:71], a[48:51]
    v_mfma_f32_16x16x32_bf16 a[52:55], v[100:103], v[68:71], a[52:55]
    v_mfma_f32_16x16x32_bf16 a[56:59], v[104:107], v[68:71], a[56:59]
    v_mfma_f32_16x16x32_bf16 a[60:63], v[108:111], v[68:71], a[60:63]
    v_mfma_f32_16x16x32_bf16 a[64:67], v[80:83], v[72:75], a[64:67]
    v_mfma_f32_16x16x32_bf16 a[68:71], v[84:87], v[72:75], a[68:71]
    v_mfma_f32_16x16x32_bf16 a[72:75], v[88:91], v[72:75], a[72:75]
    v_mfma_f32_16x16x32_bf16 a[76:79], v[92:95], v[72:75], a[76:79]
    v_mfma_f32_16x16x32_bf16 a[80:83], v[96:99], v[72:75], a[80:83]
    v_mfma_f32_16x16x32_bf16 a[84:87], v[100:103], v[72:75], a[84:87]
    v_mfma_f32_16x16x32_bf16 a[88:91], v[104:107], v[72:75], a[88:91]
    v_mfma_f32_16x16x32_bf16 a[92:95], v[108:111], v[72:75], a[92:95]
    v_mfma_f32_16x16x32_bf16 a[96:99], v[80:83], v[76:79], a[96:99]
    v_mfma_f32_16x16x32_bf16 a[100:103], v[84:87], v[76:79], a[100:103]
    v_mfma_f32_16x16x32_bf16 a[104:107], v[88:91], v[76:79], a[104:107]
    v_mfma_f32_16x16x32_bf16 a[108:111], v[92:95], v[76:79], a[108:111]
    v_mfma_f32_16x16x32_bf16 a[112:115], v[96:99], v[76:79], a[112:115]
    v_mfma_f32_16x16x32_bf16 a[116:119], v[100:103], v[76:79], a[116:119]
    v_mfma_f32_16x16x32_bf16 a[120:123], v[104:107], v[76:79], a[120:123]
    v_mfma_f32_16x16x32_bf16 a[124:127], v[108:111], v[76:79], a[124:127]
    s_waitcnt vmcnt(0) lgkmcnt(0)
    v_mfma_f32_16x16x32_bf16 a[0:3], v[112:115], v[32:35], a[0:3]
    v_mfma_f32_16x16x32_bf16 a[4:7], v[116:119], v[32:35], a[4:7]
    v_mfma_f32_16x16x32_bf16 a[8:11], v[120:123], v[32:35], a[8:11]
    v_mfma_f32_16x16x32_bf16 a[12:15], v[124:127], v[32:35], a[12:15]
    v_mfma_f32_16x16x32_bf16 a[16:19], v[128:131], v[32:35], a[16:19]
    v_mfma_f32_16x16x32_bf16 a[20:23], v[132:135], v[32:35], a[20:23]
    v_mfma_f32_16x16x32_bf16 a[24:27], v[136:139], v[32:35], a[24:27]
    v_mfma_f32_16x16x32_bf16 a[28:31], v[140:143], v[32:35], a[28:31]
    v_mfma_f32_16x16x32_bf16 a[32:35], v[112:115], v[36:39], a[32:35]
    v_mfma_f32_16x16x32_bf16 a[36:39], v[116:119], v[36:39], a[36:39]
    v_mfma_f32_16x16x32_bf16 a[40:43], v[120:123], v[36:39], a[40:43]
    v_mfma_f32_16x16x32_bf16 a[44:47], v[124:127], v[36:39], a[44:47]
    v_mfma_f32_16x16x32_bf16 a[48:51], v[128:131], v[36:39], a[48:51]
    v_mfma_f32_16x16x32_bf16 a[52:55], v[132:135], v[36:39], a[52:55]
    v_mfma_f32_16x16x32_bf16 a[56:59], v[136:139], v[36:39], a[56:59]
    v_mfma_f32_16x16x32_bf16 a[60:63], v[140:143], v[36:39], a[60:63]
    v_mfma_f32_16x16x32_bf16 a[64:67], v[112:115], v[40:43], a[64:67]
    v_mfma_f32_16x16x32_bf16 a[68:71], v[116:119], v[40:43], a[68:71]
    v_mfma_f32_16x16x32_bf16 a[72:75], v[120:123], v[40:43], a[72:75]
    v_mfma_f32_16x16x32_bf16 a[76:79], v[124:127], v[40:43], a[76:79]
    v_mfma_f32_16x16x32_bf16 a[80:83], v[128:131], v[40:43], a[80:83]
    v_mfma_f32_16x16x32_bf16 a[84:87], v[132:135], v[40:43], a[84:87]
    v_mfma_f32_16x16x32_bf16 a[88:91], v[136:139], v[40:43], a[88:91]
    v_mfma_f32_16x16x32_bf16 a[92:95], v[140:143], v[40:43], a[92:95]
    v_mfma_f32_16x16x32_bf16 a[96:99], v[112:115], v[44:47], a[96:99]
    v_mfma_f32_16x16x32_bf16 a[100:103], v[116:119], v[44:47], a[100:103]
    v_mfma_f32_16x16x32_bf16 a[104:107], v[120:123], v[44:47], a[104:107]
    v_mfma_f32_16x16x32_bf16 a[108:111], v[124:127], v[44:47], a[108:111]
    v_mfma_f32_16x16x32_bf16 a[112:115], v[128:131], v[44:47], a[112:115]
    v_mfma_f32_16x16x32_bf16 a[116:119], v[132:135], v[44:47], a[116:119]
    v_mfma_f32_16x16x32_bf16 a[120:123], v[136:139], v[44:47], a[120:123]
    v_mfma_f32_16x16x32_bf16 a[124:127], v[140:143], v[44:47], a[124:127]
    s_nop 9
    s_lshl_b32 s30, s16, 7
    s_add_u32 s30, s30, s28
    s_lshl_b32 s30, s30, 3
    s_add_u32 s30, s30, s29
    s_lshl_b32 s30, s30, 10
    s_add_u32 s30, s30, 0x4000000
    v_accvgpr_read_b32 v144, a0
    v_accvgpr_read_b32 v145, a1
    v_accvgpr_read_b32 v146, a2
    v_accvgpr_read_b32 v147, a3
    v_accvgpr_read_b32 v148, a4
    v_accvgpr_read_b32 v149, a5
    v_accvgpr_read_b32 v150, a6
    v_accvgpr_read_b32 v151, a7
    v_cvt_pk_bf16_f32 v152, v144, v145
    v_cvt_pk_bf16_f32 v153, v146, v147
    v_cvt_pk_bf16_f32 v154, v148, v149
    v_cvt_pk_bf16_f32 v155, v150, v151
    s_add_u32 s19, s30, 0
    buffer_store_dwordx4 v[152:155], v2, s[12:15], s19 offen sc0 sc1
    v_accvgpr_read_b32 v156, a32
    v_accvgpr_read_b32 v157, a33
    v_accvgpr_read_b32 v158, a34
    v_accvgpr_read_b32 v159, a35
    v_accvgpr_read_b32 v160, a36
    v_accvgpr_read_b32 v161, a37
    v_accvgpr_read_b32 v162, a38
    v_accvgpr_read_b32 v163, a39
    v_cvt_pk_bf16_f32 v164, v156, v157
    v_cvt_pk_bf16_f32 v165, v158, v159
    v_cvt_pk_bf16_f32 v166, v160, v161
    v_cvt_pk_bf16_f32 v167, v162, v163
    s_add_u32 s19, s30, 1024
    buffer_store_dwordx4 v[164:167], v2, s[12:15], s19 offen sc0 sc1
    v_accvgpr_read_b32 v144, a64
    v_accvgpr_read_b32 v145, a65
    v_accvgpr_read_b32 v146, a66
    v_accvgpr_read_b32 v147, a67
    v_accvgpr_read_b32 v148, a68
    v_accvgpr_read_b32 v149, a69
    v_accvgpr_read_b32 v150, a70
    v_accvgpr_read_b32 v151, a71
    v_cvt_pk_bf16_f32 v152, v144, v145
    v_cvt_pk_bf16_f32 v153, v146, v147
    v_cvt_pk_bf16_f32 v154, v148, v149
    v_cvt_pk_bf16_f32 v155, v150, v151
    s_add_u32 s19, s30, 2048
    buffer_store_dwordx4 v[152:155], v2, s[12:15], s19 offen sc0 sc1
    v_accvgpr_read_b32 v156, a96
    v_accvgpr_read_b32 v157, a97
    v_accvgpr_read_b32 v158, a98
    v_accvgpr_read_b32 v159, a99
    v_accvgpr_read_b32 v160, a100
    v_accvgpr_read_b32 v161, a101
    v_accvgpr_read_b32 v162, a102
    v_accvgpr_read_b32 v163, a103
    v_cvt_pk_bf16_f32 v164, v156, v157
    v_cvt_pk_bf16_f32 v165, v158, v159
    v_cvt_pk_bf16_f32 v166, v160, v161
    v_cvt_pk_bf16_f32 v167, v162, v163
    s_add_u32 s19, s30, 3072
    buffer_store_dwordx4 v[164:167], v2, s[12:15], s19 offen sc0 sc1
    v_accvgpr_read_b32 v144, a8
    v_accvgpr_read_b32 v145, a9
    v_accvgpr_read_b32 v146, a10
    v_accvgpr_read_b32 v147, a11
    v_accvgpr_read_b32 v148, a12
    v_accvgpr_read_b32 v149, a13
    v_accvgpr_read_b32 v150, a14
    v_accvgpr_read_b32 v151, a15
    v_cvt_pk_bf16_f32 v152, v144, v145
    v_cvt_pk_bf16_f32 v153, v146, v147
    v_cvt_pk_bf16_f32 v154, v148, v149
    v_cvt_pk_bf16_f32 v155, v150, v151
    s_add_u32 s19, s30, 262144
    buffer_store_dwordx4 v[152:155], v2, s[12:15], s19 offen sc0 sc1
    v_accvgpr_read_b32 v156, a40
    v_accvgpr_read_b32 v157, a41
    v_accvgpr_read_b32 v158, a42
    v_accvgpr_read_b32 v159, a43
    v_accvgpr_read_b32 v160, a44
    v_accvgpr_read_b32 v161, a45
    v_accvgpr_read_b32 v162, a46
    v_accvgpr_read_b32 v163, a47
    v_cvt_pk_bf16_f32 v164, v156, v157
    v_cvt_pk_bf16_f32 v165, v158, v159
    v_cvt_pk_bf16_f32 v166, v160, v161
    v_cvt_pk_bf16_f32 v167, v162, v163
    s_add_u32 s19, s30, 263168
    buffer_store_dwordx4 v[164:167], v2, s[12:15], s19 offen sc0 sc1
    v_accvgpr_read_b32 v144, a72
    v_accvgpr_read_b32 v145, a73
    v_accvgpr_read_b32 v146, a74
    v_accvgpr_read_b32 v147, a75
    v_accvgpr_read_b32 v148, a76
    v_accvgpr_read_b32 v149, a77
    v_accvgpr_read_b32 v150, a78
    v_accvgpr_read_b32 v151, a79
    v_cvt_pk_bf16_f32 v152, v144, v145
    v_cvt_pk_bf16_f32 v153, v146, v147
    v_cvt_pk_bf16_f32 v154, v148, v149
    v_cvt_pk_bf16_f32 v155, v150, v151
    s_add_u32 s19, s30, 264192
    buffer_store_dwordx4 v[152:155], v2, s[12:15], s19 offen sc0 sc1
    v_accvgpr_read_b32 v156, a104
    v_accvgpr_read_b32 v157, a105
    v_accvgpr_read_b32 v158, a106
    v_accvgpr_read_b32 v159, a107
    v_accvgpr_read_b32 v160, a108
    v_accvgpr_read_b32 v161, a109
    v_accvgpr_read_b32 v162, a110
    v_accvgpr_read_b32 v163, a111
    v_cvt_pk_bf16_f32 v164, v156, v157
    v_cvt_pk_bf16_f32 v165, v158, v159
    v_cvt_pk_bf16_f32 v166, v160, v161
    v_cvt_pk_bf16_f32 v167, v162, v163
    s_add_u32 s19, s30, 265216
    buffer_store_dwordx4 v[164:167], v2, s[12:15], s19 offen sc0 sc1
    v_accvgpr_read_b32 v144, a16
    v_accvgpr_read_b32 v145, a17
    v_accvgpr_read_b32 v146, a18
    v_accvgpr_read_b32 v147, a19
    v_accvgpr_read_b32 v148, a20
    v_accvgpr_read_b32 v149, a21
    v_accvgpr_read_b32 v150, a22
    v_accvgpr_read_b32 v151, a23
    v_cvt_pk_bf16_f32 v152, v144, v145
    v_cvt_pk_bf16_f32 v153, v146, v147
    v_cvt_pk_bf16_f32 v154, v148, v149
    v_cvt_pk_bf16_f32 v155, v150, v151
    s_add_u32 s19, s30, 524288
    buffer_store_dwordx4 v[152:155], v2, s[12:15], s19 offen sc0 sc1
    v_accvgpr_read_b32 v156, a48
    v_accvgpr_read_b32 v157, a49
    v_accvgpr_read_b32 v158, a50
    v_accvgpr_read_b32 v159, a51
    v_accvgpr_read_b32 v160, a52
    v_accvgpr_read_b32 v161, a53
    v_accvgpr_read_b32 v162, a54
    v_accvgpr_read_b32 v163, a55
    v_cvt_pk_bf16_f32 v164, v156, v157
    v_cvt_pk_bf16_f32 v165, v158, v159
    v_cvt_pk_bf16_f32 v166, v160, v161
    v_cvt_pk_bf16_f32 v167, v162, v163
    s_add_u32 s19, s30, 525312
    buffer_store_dwordx4 v[164:167], v2, s[12:15], s19 offen sc0 sc1
    v_accvgpr_read_b32 v144, a80
    v_accvgpr_read_b32 v145, a81
    v_accvgpr_read_b32 v146, a82
    v_accvgpr_read_b32 v147, a83
    v_accvgpr_read_b32 v148, a84
    v_accvgpr_read_b32 v149, a85
    v_accvgpr_read_b32 v150, a86
    v_accvgpr_read_b32 v151, a87
    v_cvt_pk_bf16_f32 v152, v144, v145
    v_cvt_pk_bf16_f32 v153, v146, v147
    v_cvt_pk_bf16_f32 v154, v148, v149
    v_cvt_pk_bf16_f32 v155, v150, v151
    s_add_u32 s19, s30, 526336
    buffer_store_dwordx4 v[152:155], v2, s[12:15], s19 offen sc0 sc1
    v_accvgpr_read_b32 v156, a112
    v_accvgpr_read_b32 v157, a113
    v_accvgpr_read_b32 v158, a114
    v_accvgpr_read_b32 v159, a115
    v_accvgpr_read_b32 v160, a116
    v_accvgpr_read_b32 v161, a117
    v_accvgpr_read_b32 v162, a118
    v_accvgpr_read_b32 v163, a119
    v_cvt_pk_bf16_f32 v164, v156, v157
    v_cvt_pk_bf16_f32 v165, v158, v159
    v_cvt_pk_bf16_f32 v166, v160, v161
    v_cvt_pk_bf16_f32 v167, v162, v163
    s_add_u32 s19, s30, 527360
    buffer_store_dwordx4 v[164:167], v2, s[12:15], s19 offen sc0 sc1
    v_accvgpr_read_b32 v144, a24
    v_accvgpr_read_b32 v145, a25
    v_accvgpr_read_b32 v146, a26
    v_accvgpr_read_b32 v147, a27
    v_accvgpr_read_b32 v148, a28
    v_accvgpr_read_b32 v149, a29
    v_accvgpr_read_b32 v150, a30
    v_accvgpr_read_b32 v151, a31
    v_cvt_pk_bf16_f32 v152, v144, v145
    v_cvt_pk_bf16_f32 v153, v146, v147
    v_cvt_pk_bf16_f32 v154, v148, v149
    v_cvt_pk_bf16_f32 v155, v150, v151
    s_add_u32 s19, s30, 786432
    buffer_store_dwordx4 v[152:155], v2, s[12:15], s19 offen sc0 sc1
    v_accvgpr_read_b32 v156, a56
    v_accvgpr_read_b32 v157, a57
    v_accvgpr_read_b32 v158, a58
    v_accvgpr_read_b32 v159, a59
    v_accvgpr_read_b32 v160, a60
    v_accvgpr_read_b32 v161, a61
    v_accvgpr_read_b32 v162, a62
    v_accvgpr_read_b32 v163, a63
    v_cvt_pk_bf16_f32 v164, v156, v157
    v_cvt_pk_bf16_f32 v165, v158, v159
    v_cvt_pk_bf16_f32 v166, v160, v161
    v_cvt_pk_bf16_f32 v167, v162, v163
    s_add_u32 s19, s30, 787456
    buffer_store_dwordx4 v[164:167], v2, s[12:15], s19 offen sc0 sc1
    v_accvgpr_read_b32 v144, a88
    v_accvgpr_read_b32 v145, a89
    v_accvgpr_read_b32 v146, a90
    v_accvgpr_read_b32 v147, a91
    v_accvgpr_read_b32 v148, a92
    v_accvgpr_read_b32 v149, a93
    v_accvgpr_read_b32 v150, a94
    v_accvgpr_read_b32 v151, a95
    v_cvt_pk_bf16_f32 v152, v144, v145
    v_cvt_pk_bf16_f32 v153, v146, v147
    v_cvt_pk_bf16_f32 v154, v148, v149
    v_cvt_pk_bf16_f32 v155, v150, v151
    s_add_u32 s19, s30, 788480
    buffer_store_dwordx4 v[152:155], v2, s[12:15], s19 offen sc0 sc1
    v_accvgpr_read_b32 v156, a120
    v_accvgpr_read_b32 v157, a121
    v_accvgpr_read_b32 v158, a122
    v_accvgpr_read_b32 v159, a123
    v_accvgpr_read_b32 v160, a124
    v_accvgpr_read_b32 v161, a125
    v_accvgpr_read_b32 v162, a126
    v_accvgpr_read_b32 v163, a127
    v_cvt_pk_bf16_f32 v164, v156, v157
    v_cvt_pk_bf16_f32 v165, v158, v159
    v_cvt_pk_bf16_f32 v166, v160, v161
    v_cvt_pk_bf16_f32 v167, v162, v163
    s_add_u32 s19, s30, 789504
    buffer_store_dwordx4 v[164:167], v2, s[12:15], s19 offen sc0 sc1
    s_waitcnt vmcnt(0)
    s_lshl_b32 s19, s50, 2
    s_add_u32 s19, s19, s18
    s_lshl_b32 s19, s19, 2
    s_add_u32 s19, s19, 0x7907000
    v_mov_b32 v144, 1
    v_mov_b32 v145, 0
    buffer_store_dword v144, v145, s[12:15], s19 offen sc0 sc1
    s_add_u32 s19, s28, 0
    s_lshl_b32 s19, s19, 3
    s_add_u32 s19, s19, s29
    s_lshl_b32 s24, s19, 14
    s_add_u32 s25, s24, 16384
    s_add_u32 s26, s24, 32768
    s_add_u32 s27, s24, 49152
    v_add_u32 v5, 0, v2
    buffer_load_dwordx4 v[32:35], v5, s[12:15], s24 offen
    buffer_load_dwordx4 v[36:39], v5, s[12:15], s25 offen
    buffer_load_dwordx4 v[40:43], v5, s[12:15], s26 offen
    buffer_load_dwordx4 v[44:47], v5, s[12:15], s27 offen
    v_add_u32 v5, 1024, v2
    buffer_load_dwordx4 v[48:51], v5, s[12:15], s24 offen
    buffer_load_dwordx4 v[52:55], v5, s[12:15], s25 offen
    buffer_load_dwordx4 v[56:59], v5, s[12:15], s26 offen
    buffer_load_dwordx4 v[60:63], v5, s[12:15], s27 offen
    ds_read_b128 v[80:83], v3 offset:0
    ds_read_b128 v[84:87], v3 offset:16384
    ds_read_b128 v[88:91], v3 offset:32768
    ds_read_b128 v[92:95], v3 offset:49152
    ds_read_b128 v[96:99], v4 offset:0
    ds_read_b128 v[100:103], v4 offset:16384
    ds_read_b128 v[104:107], v4 offset:32768
    ds_read_b128 v[108:111], v4 offset:49152
    v_add_u32 v5, 2048, v2
    buffer_load_dwordx4 v[64:67], v5, s[12:15], s24 offen
    buffer_load_dwordx4 v[68:71], v5, s[12:15], s25 offen
    buffer_load_dwordx4 v[72:75], v5, s[12:15], s26 offen
    buffer_load_dwordx4 v[76:79], v5, s[12:15], s27 offen
    ds_read_b128 v[112:115], v3 offset:1024
    ds_read_b128 v[116:119], v3 offset:17408
    ds_read_b128 v[120:123], v3 offset:33792
    ds_read_b128 v[124:127], v3 offset:50176
    ds_read_b128 v[128:131], v4 offset:1024
    ds_read_b128 v[132:135], v4 offset:17408
    ds_read_b128 v[136:139], v4 offset:33792
    ds_read_b128 v[140:143], v4 offset:50176
    s_waitcnt vmcnt(8) lgkmcnt(8)
    v_mfma_f32_16x16x32_bf16 a[0:3], v[32:35], v[80:83], 0
    v_mfma_f32_16x16x32_bf16 a[4:7], v[32:35], v[84:87], 0
    v_mfma_f32_16x16x32_bf16 a[8:11], v[32:35], v[88:91], 0
    v_mfma_f32_16x16x32_bf16 a[12:15], v[32:35], v[92:95], 0
    v_mfma_f32_16x16x32_bf16 a[16:19], v[32:35], v[96:99], 0
    v_mfma_f32_16x16x32_bf16 a[20:23], v[32:35], v[100:103], 0
    v_mfma_f32_16x16x32_bf16 a[24:27], v[32:35], v[104:107], 0
    v_mfma_f32_16x16x32_bf16 a[28:31], v[32:35], v[108:111], 0
    v_mfma_f32_16x16x32_bf16 a[32:35], v[36:39], v[80:83], 0
    v_mfma_f32_16x16x32_bf16 a[36:39], v[36:39], v[84:87], 0
    v_mfma_f32_16x16x32_bf16 a[40:43], v[36:39], v[88:91], 0
    v_mfma_f32_16x16x32_bf16 a[44:47], v[36:39], v[92:95], 0
    v_mfma_f32_16x16x32_bf16 a[48:51], v[36:39], v[96:99], 0
    v_mfma_f32_16x16x32_bf16 a[52:55], v[36:39], v[100:103], 0
    v_mfma_f32_16x16x32_bf16 a[56:59], v[36:39], v[104:107], 0
    v_mfma_f32_16x16x32_bf16 a[60:63], v[36:39], v[108:111], 0
    v_mfma_f32_16x16x32_bf16 a[64:67], v[40:43], v[80:83], 0
    v_mfma_f32_16x16x32_bf16 a[68:71], v[40:43], v[84:87], 0
    v_mfma_f32_16x16x32_bf16 a[72:75], v[40:43], v[88:91], 0
    v_mfma_f32_16x16x32_bf16 a[76:79], v[40:43], v[92:95], 0
    v_mfma_f32_16x16x32_bf16 a[80:83], v[40:43], v[96:99], 0
    v_mfma_f32_16x16x32_bf16 a[84:87], v[40:43], v[100:103], 0
    v_mfma_f32_16x16x32_bf16 a[88:91], v[40:43], v[104:107], 0
    v_mfma_f32_16x16x32_bf16 a[92:95], v[40:43], v[108:111], 0
    v_mfma_f32_16x16x32_bf16 a[96:99], v[44:47], v[80:83], 0
    v_mfma_f32_16x16x32_bf16 a[100:103], v[44:47], v[84:87], 0
    v_mfma_f32_16x16x32_bf16 a[104:107], v[44:47], v[88:91], 0
    v_mfma_f32_16x16x32_bf16 a[108:111], v[44:47], v[92:95], 0
    v_mfma_f32_16x16x32_bf16 a[112:115], v[44:47], v[96:99], 0
    v_mfma_f32_16x16x32_bf16 a[116:119], v[44:47], v[100:103], 0
    v_mfma_f32_16x16x32_bf16 a[120:123], v[44:47], v[104:107], 0
    v_mfma_f32_16x16x32_bf16 a[124:127], v[44:47], v[108:111], 0
    v_add_u32 v5, 3072, v2
    buffer_load_dwordx4 v[32:35], v5, s[12:15], s24 offen
    buffer_load_dwordx4 v[36:39], v5, s[12:15], s25 offen
    buffer_load_dwordx4 v[40:43], v5, s[12:15], s26 offen
    buffer_load_dwordx4 v[44:47], v5, s[12:15], s27 offen
    ds_read_b128 v[80:83], v3 offset:2048
    ds_read_b128 v[84:87], v3 offset:18432
    ds_read_b128 v[88:91], v3 offset:34816
    ds_read_b128 v[92:95], v3 offset:51200
    ds_read_b128 v[96:99], v4 offset:2048
    ds_read_b128 v[100:103], v4 offset:18432
    ds_read_b128 v[104:107], v4 offset:34816
    ds_read_b128 v[108:111], v4 offset:51200
    s_waitcnt vmcnt(8) lgkmcnt(8)
    v_mfma_f32_16x16x32_bf16 a[0:3], v[48:51], v[112:115], a[0:3]
    v_mfma_f32_16x16x32_bf16 a[4:7], v[48:51], v[116:119], a[4:7]
    v_mfma_f32_16x16x32_bf16 a[8:11], v[48:51], v[120:123], a[8:11]
    v_mfma_f32_16x16x32_bf16 a[12:15], v[48:51], v[124:127], a[12:15]
    v_mfma_f32_16x16x32_bf16 a[16:19], v[48:51], v[128:131], a[16:19]
    v_mfma_f32_16x16x32_bf16 a[20:23], v[48:51], v[132:135], a[20:23]
    v_mfma_f32_16x16x32_bf16 a[24:27], v[48:51], v[136:139], a[24:27]
    v_mfma_f32_16x16x32_bf16 a[28:31], v[48:51], v[140:143], a[28:31]
    v_mfma_f32_16x16x32_bf16 a[32:35], v[52:55], v[112:115], a[32:35]
    v_mfma_f32_16x16x32_bf16 a[36:39], v[52:55], v[116:119], a[36:39]
    v_mfma_f32_16x16x32_bf16 a[40:43], v[52:55], v[120:123], a[40:43]
    v_mfma_f32_16x16x32_bf16 a[44:47], v[52:55], v[124:127], a[44:47]
    v_mfma_f32_16x16x32_bf16 a[48:51], v[52:55], v[128:131], a[48:51]
    v_mfma_f32_16x16x32_bf16 a[52:55], v[52:55], v[132:135], a[52:55]
    v_mfma_f32_16x16x32_bf16 a[56:59], v[52:55], v[136:139], a[56:59]
    v_mfma_f32_16x16x32_bf16 a[60:63], v[52:55], v[140:143], a[60:63]
    v_mfma_f32_16x16x32_bf16 a[64:67], v[56:59], v[112:115], a[64:67]
    v_mfma_f32_16x16x32_bf16 a[68:71], v[56:59], v[116:119], a[68:71]
    v_mfma_f32_16x16x32_bf16 a[72:75], v[56:59], v[120:123], a[72:75]
    v_mfma_f32_16x16x32_bf16 a[76:79], v[56:59], v[124:127], a[76:79]
    v_mfma_f32_16x16x32_bf16 a[80:83], v[56:59], v[128:131], a[80:83]
    v_mfma_f32_16x16x32_bf16 a[84:87], v[56:59], v[132:135], a[84:87]
    v_mfma_f32_16x16x32_bf16 a[88:91], v[56:59], v[136:139], a[88:91]
    v_mfma_f32_16x16x32_bf16 a[92:95], v[56:59], v[140:143], a[92:95]
    v_mfma_f32_16x16x32_bf16 a[96:99], v[60:63], v[112:115], a[96:99]
    v_mfma_f32_16x16x32_bf16 a[100:103], v[60:63], v[116:119], a[100:103]
    v_mfma_f32_16x16x32_bf16 a[104:107], v[60:63], v[120:123], a[104:107]
    v_mfma_f32_16x16x32_bf16 a[108:111], v[60:63], v[124:127], a[108:111]
    v_mfma_f32_16x16x32_bf16 a[112:115], v[60:63], v[128:131], a[112:115]
    v_mfma_f32_16x16x32_bf16 a[116:119], v[60:63], v[132:135], a[116:119]
    v_mfma_f32_16x16x32_bf16 a[120:123], v[60:63], v[136:139], a[120:123]
    v_mfma_f32_16x16x32_bf16 a[124:127], v[60:63], v[140:143], a[124:127]
    v_add_u32 v5, 4096, v2
    buffer_load_dwordx4 v[48:51], v5, s[12:15], s24 offen
    buffer_load_dwordx4 v[52:55], v5, s[12:15], s25 offen
    buffer_load_dwordx4 v[56:59], v5, s[12:15], s26 offen
    buffer_load_dwordx4 v[60:63], v5, s[12:15], s27 offen
    ds_read_b128 v[112:115], v3 offset:3072
    ds_read_b128 v[116:119], v3 offset:19456
    ds_read_b128 v[120:123], v3 offset:35840
    ds_read_b128 v[124:127], v3 offset:52224
    ds_read_b128 v[128:131], v4 offset:3072
    ds_read_b128 v[132:135], v4 offset:19456
    ds_read_b128 v[136:139], v4 offset:35840
    ds_read_b128 v[140:143], v4 offset:52224
    s_waitcnt vmcnt(8) lgkmcnt(8)
    v_mfma_f32_16x16x32_bf16 a[0:3], v[64:67], v[80:83], a[0:3]
    v_mfma_f32_16x16x32_bf16 a[4:7], v[64:67], v[84:87], a[4:7]
    v_mfma_f32_16x16x32_bf16 a[8:11], v[64:67], v[88:91], a[8:11]
    v_mfma_f32_16x16x32_bf16 a[12:15], v[64:67], v[92:95], a[12:15]
    v_mfma_f32_16x16x32_bf16 a[16:19], v[64:67], v[96:99], a[16:19]
    v_mfma_f32_16x16x32_bf16 a[20:23], v[64:67], v[100:103], a[20:23]
    v_mfma_f32_16x16x32_bf16 a[24:27], v[64:67], v[104:107], a[24:27]
    v_mfma_f32_16x16x32_bf16 a[28:31], v[64:67], v[108:111], a[28:31]
    v_mfma_f32_16x16x32_bf16 a[32:35], v[68:71], v[80:83], a[32:35]
    v_mfma_f32_16x16x32_bf16 a[36:39], v[68:71], v[84:87], a[36:39]
    v_mfma_f32_16x16x32_bf16 a[40:43], v[68:71], v[88:91], a[40:43]
    v_mfma_f32_16x16x32_bf16 a[44:47], v[68:71], v[92:95], a[44:47]
    v_mfma_f32_16x16x32_bf16 a[48:51], v[68:71], v[96:99], a[48:51]
    v_mfma_f32_16x16x32_bf16 a[52:55], v[68:71], v[100:103], a[52:55]
    v_mfma_f32_16x16x32_bf16 a[56:59], v[68:71], v[104:107], a[56:59]
    v_mfma_f32_16x16x32_bf16 a[60:63], v[68:71], v[108:111], a[60:63]
    v_mfma_f32_16x16x32_bf16 a[64:67], v[72:75], v[80:83], a[64:67]
    v_mfma_f32_16x16x32_bf16 a[68:71], v[72:75], v[84:87], a[68:71]
    v_mfma_f32_16x16x32_bf16 a[72:75], v[72:75], v[88:91], a[72:75]
    v_mfma_f32_16x16x32_bf16 a[76:79], v[72:75], v[92:95], a[76:79]
    v_mfma_f32_16x16x32_bf16 a[80:83], v[72:75], v[96:99], a[80:83]
    v_mfma_f32_16x16x32_bf16 a[84:87], v[72:75], v[100:103], a[84:87]
    v_mfma_f32_16x16x32_bf16 a[88:91], v[72:75], v[104:107], a[88:91]
    v_mfma_f32_16x16x32_bf16 a[92:95], v[72:75], v[108:111], a[92:95]
    v_mfma_f32_16x16x32_bf16 a[96:99], v[76:79], v[80:83], a[96:99]
    v_mfma_f32_16x16x32_bf16 a[100:103], v[76:79], v[84:87], a[100:103]
    v_mfma_f32_16x16x32_bf16 a[104:107], v[76:79], v[88:91], a[104:107]
    v_mfma_f32_16x16x32_bf16 a[108:111], v[76:79], v[92:95], a[108:111]
    v_mfma_f32_16x16x32_bf16 a[112:115], v[76:79], v[96:99], a[112:115]
    v_mfma_f32_16x16x32_bf16 a[116:119], v[76:79], v[100:103], a[116:119]
    v_mfma_f32_16x16x32_bf16 a[120:123], v[76:79], v[104:107], a[120:123]
    v_mfma_f32_16x16x32_bf16 a[124:127], v[76:79], v[108:111], a[124:127]
    v_add_u32 v5, 5120, v2
    buffer_load_dwordx4 v[64:67], v5, s[12:15], s24 offen
    buffer_load_dwordx4 v[68:71], v5, s[12:15], s25 offen
    buffer_load_dwordx4 v[72:75], v5, s[12:15], s26 offen
    buffer_load_dwordx4 v[76:79], v5, s[12:15], s27 offen
    ds_read_b128 v[80:83], v3 offset:4096
    ds_read_b128 v[84:87], v3 offset:20480
    ds_read_b128 v[88:91], v3 offset:36864
    ds_read_b128 v[92:95], v3 offset:53248
    ds_read_b128 v[96:99], v4 offset:4096
    ds_read_b128 v[100:103], v4 offset:20480
    ds_read_b128 v[104:107], v4 offset:36864
    ds_read_b128 v[108:111], v4 offset:53248
    s_waitcnt vmcnt(8) lgkmcnt(8)
    v_mfma_f32_16x16x32_bf16 a[0:3], v[32:35], v[112:115], a[0:3]
    v_mfma_f32_16x16x32_bf16 a[4:7], v[32:35], v[116:119], a[4:7]
    v_mfma_f32_16x16x32_bf16 a[8:11], v[32:35], v[120:123], a[8:11]
    v_mfma_f32_16x16x32_bf16 a[12:15], v[32:35], v[124:127], a[12:15]
    v_mfma_f32_16x16x32_bf16 a[16:19], v[32:35], v[128:131], a[16:19]
    v_mfma_f32_16x16x32_bf16 a[20:23], v[32:35], v[132:135], a[20:23]
    v_mfma_f32_16x16x32_bf16 a[24:27], v[32:35], v[136:139], a[24:27]
    v_mfma_f32_16x16x32_bf16 a[28:31], v[32:35], v[140:143], a[28:31]
    v_mfma_f32_16x16x32_bf16 a[32:35], v[36:39], v[112:115], a[32:35]
    v_mfma_f32_16x16x32_bf16 a[36:39], v[36:39], v[116:119], a[36:39]
    v_mfma_f32_16x16x32_bf16 a[40:43], v[36:39], v[120:123], a[40:43]
    v_mfma_f32_16x16x32_bf16 a[44:47], v[36:39], v[124:127], a[44:47]
    v_mfma_f32_16x16x32_bf16 a[48:51], v[36:39], v[128:131], a[48:51]
    v_mfma_f32_16x16x32_bf16 a[52:55], v[36:39], v[132:135], a[52:55]
    v_mfma_f32_16x16x32_bf16 a[56:59], v[36:39], v[136:139], a[56:59]
    v_mfma_f32_16x16x32_bf16 a[60:63], v[36:39], v[140:143], a[60:63]
    v_mfma_f32_16x16x32_bf16 a[64:67], v[40:43], v[112:115], a[64:67]
    v_mfma_f32_16x16x32_bf16 a[68:71], v[40:43], v[116:119], a[68:71]
    v_mfma_f32_16x16x32_bf16 a[72:75], v[40:43], v[120:123], a[72:75]
    v_mfma_f32_16x16x32_bf16 a[76:79], v[40:43], v[124:127], a[76:79]
    v_mfma_f32_16x16x32_bf16 a[80:83], v[40:43], v[128:131], a[80:83]
    v_mfma_f32_16x16x32_bf16 a[84:87], v[40:43], v[132:135], a[84:87]
    v_mfma_f32_16x16x32_bf16 a[88:91], v[40:43], v[136:139], a[88:91]
    v_mfma_f32_16x16x32_bf16 a[92:95], v[40:43], v[140:143], a[92:95]
    v_mfma_f32_16x16x32_bf16 a[96:99], v[44:47], v[112:115], a[96:99]
    v_mfma_f32_16x16x32_bf16 a[100:103], v[44:47], v[116:119], a[100:103]
    v_mfma_f32_16x16x32_bf16 a[104:107], v[44:47], v[120:123], a[104:107]
    v_mfma_f32_16x16x32_bf16 a[108:111], v[44:47], v[124:127], a[108:111]
    v_mfma_f32_16x16x32_bf16 a[112:115], v[44:47], v[128:131], a[112:115]
    v_mfma_f32_16x16x32_bf16 a[116:119], v[44:47], v[132:135], a[116:119]
    v_mfma_f32_16x16x32_bf16 a[120:123], v[44:47], v[136:139], a[120:123]
    v_mfma_f32_16x16x32_bf16 a[124:127], v[44:47], v[140:143], a[124:127]
    v_add_u32 v5, 6144, v2
    buffer_load_dwordx4 v[32:35], v5, s[12:15], s24 offen
    buffer_load_dwordx4 v[36:39], v5, s[12:15], s25 offen
    buffer_load_dwordx4 v[40:43], v5, s[12:15], s26 offen
    buffer_load_dwordx4 v[44:47], v5, s[12:15], s27 offen
    ds_read_b128 v[112:115], v3 offset:5120
    ds_read_b128 v[116:119], v3 offset:21504
    ds_read_b128 v[120:123], v3 offset:37888
    ds_read_b128 v[124:127], v3 offset:54272
    ds_read_b128 v[128:131], v4 offset:5120
    ds_read_b128 v[132:135], v4 offset:21504
    ds_read_b128 v[136:139], v4 offset:37888
    ds_read_b128 v[140:143], v4 offset:54272
    s_waitcnt vmcnt(8) lgkmcnt(8)
    v_mfma_f32_16x16x32_bf16 a[0:3], v[48:51], v[80:83], a[0:3]
    v_mfma_f32_16x16x32_bf16 a[4:7], v[48:51], v[84:87], a[4:7]
    v_mfma_f32_16x16x32_bf16 a[8:11], v[48:51], v[88:91], a[8:11]
    v_mfma_f32_16x16x32_bf16 a[12:15], v[48:51], v[92:95], a[12:15]
    v_mfma_f32_16x16x32_bf16 a[16:19], v[48:51], v[96:99], a[16:19]
    v_mfma_f32_16x16x32_bf16 a[20:23], v[48:51], v[100:103], a[20:23]
    v_mfma_f32_16x16x32_bf16 a[24:27], v[48:51], v[104:107], a[24:27]
    v_mfma_f32_16x16x32_bf16 a[28:31], v[48:51], v[108:111], a[28:31]
    v_mfma_f32_16x16x32_bf16 a[32:35], v[52:55], v[80:83], a[32:35]
    v_mfma_f32_16x16x32_bf16 a[36:39], v[52:55], v[84:87], a[36:39]
    v_mfma_f32_16x16x32_bf16 a[40:43], v[52:55], v[88:91], a[40:43]
    v_mfma_f32_16x16x32_bf16 a[44:47], v[52:55], v[92:95], a[44:47]
    v_mfma_f32_16x16x32_bf16 a[48:51], v[52:55], v[96:99], a[48:51]
    v_mfma_f32_16x16x32_bf16 a[52:55], v[52:55], v[100:103], a[52:55]
    v_mfma_f32_16x16x32_bf16 a[56:59], v[52:55], v[104:107], a[56:59]
    v_mfma_f32_16x16x32_bf16 a[60:63], v[52:55], v[108:111], a[60:63]
    v_mfma_f32_16x16x32_bf16 a[64:67], v[56:59], v[80:83], a[64:67]
    v_mfma_f32_16x16x32_bf16 a[68:71], v[56:59], v[84:87], a[68:71]
    v_mfma_f32_16x16x32_bf16 a[72:75], v[56:59], v[88:91], a[72:75]
    v_mfma_f32_16x16x32_bf16 a[76:79], v[56:59], v[92:95], a[76:79]
    v_mfma_f32_16x16x32_bf16 a[80:83], v[56:59], v[96:99], a[80:83]
    v_mfma_f32_16x16x32_bf16 a[84:87], v[56:59], v[100:103], a[84:87]
    v_mfma_f32_16x16x32_bf16 a[88:91], v[56:59], v[104:107], a[88:91]
    v_mfma_f32_16x16x32_bf16 a[92:95], v[56:59], v[108:111], a[92:95]
    v_mfma_f32_16x16x32_bf16 a[96:99], v[60:63], v[80:83], a[96:99]
    v_mfma_f32_16x16x32_bf16 a[100:103], v[60:63], v[84:87], a[100:103]
    v_mfma_f32_16x16x32_bf16 a[104:107], v[60:63], v[88:91], a[104:107]
    v_mfma_f32_16x16x32_bf16 a[108:111], v[60:63], v[92:95], a[108:111]
    v_mfma_f32_16x16x32_bf16 a[112:115], v[60:63], v[96:99], a[112:115]
    v_mfma_f32_16x16x32_bf16 a[116:119], v[60:63], v[100:103], a[116:119]
    v_mfma_f32_16x16x32_bf16 a[120:123], v[60:63], v[104:107], a[120:123]
    v_mfma_f32_16x16x32_bf16 a[124:127], v[60:63], v[108:111], a[124:127]
    v_add_u32 v5, 7168, v2
    buffer_load_dwordx4 v[48:51], v5, s[12:15], s24 offen
    buffer_load_dwordx4 v[52:55], v5, s[12:15], s25 offen
    buffer_load_dwordx4 v[56:59], v5, s[12:15], s26 offen
    buffer_load_dwordx4 v[60:63], v5, s[12:15], s27 offen
    ds_read_b128 v[80:83], v3 offset:6144
    ds_read_b128 v[84:87], v3 offset:22528
    ds_read_b128 v[88:91], v3 offset:38912
    ds_read_b128 v[92:95], v3 offset:55296
    ds_read_b128 v[96:99], v4 offset:6144
    ds_read_b128 v[100:103], v4 offset:22528
    ds_read_b128 v[104:107], v4 offset:38912
    ds_read_b128 v[108:111], v4 offset:55296
    s_waitcnt vmcnt(8) lgkmcnt(8)
    v_mfma_f32_16x16x32_bf16 a[0:3], v[64:67], v[112:115], a[0:3]
    v_mfma_f32_16x16x32_bf16 a[4:7], v[64:67], v[116:119], a[4:7]
    v_mfma_f32_16x16x32_bf16 a[8:11], v[64:67], v[120:123], a[8:11]
    v_mfma_f32_16x16x32_bf16 a[12:15], v[64:67], v[124:127], a[12:15]
    v_mfma_f32_16x16x32_bf16 a[16:19], v[64:67], v[128:131], a[16:19]
    v_mfma_f32_16x16x32_bf16 a[20:23], v[64:67], v[132:135], a[20:23]
    v_mfma_f32_16x16x32_bf16 a[24:27], v[64:67], v[136:139], a[24:27]
    v_mfma_f32_16x16x32_bf16 a[28:31], v[64:67], v[140:143], a[28:31]
    v_mfma_f32_16x16x32_bf16 a[32:35], v[68:71], v[112:115], a[32:35]
    v_mfma_f32_16x16x32_bf16 a[36:39], v[68:71], v[116:119], a[36:39]
    v_mfma_f32_16x16x32_bf16 a[40:43], v[68:71], v[120:123], a[40:43]
    v_mfma_f32_16x16x32_bf16 a[44:47], v[68:71], v[124:127], a[44:47]
    v_mfma_f32_16x16x32_bf16 a[48:51], v[68:71], v[128:131], a[48:51]
    v_mfma_f32_16x16x32_bf16 a[52:55], v[68:71], v[132:135], a[52:55]
    v_mfma_f32_16x16x32_bf16 a[56:59], v[68:71], v[136:139], a[56:59]
    v_mfma_f32_16x16x32_bf16 a[60:63], v[68:71], v[140:143], a[60:63]
    v_mfma_f32_16x16x32_bf16 a[64:67], v[72:75], v[112:115], a[64:67]
    v_mfma_f32_16x16x32_bf16 a[68:71], v[72:75], v[116:119], a[68:71]
    v_mfma_f32_16x16x32_bf16 a[72:75], v[72:75], v[120:123], a[72:75]
    v_mfma_f32_16x16x32_bf16 a[76:79], v[72:75], v[124:127], a[76:79]
    v_mfma_f32_16x16x32_bf16 a[80:83], v[72:75], v[128:131], a[80:83]
    v_mfma_f32_16x16x32_bf16 a[84:87], v[72:75], v[132:135], a[84:87]
    v_mfma_f32_16x16x32_bf16 a[88:91], v[72:75], v[136:139], a[88:91]
    v_mfma_f32_16x16x32_bf16 a[92:95], v[72:75], v[140:143], a[92:95]
    v_mfma_f32_16x16x32_bf16 a[96:99], v[76:79], v[112:115], a[96:99]
    v_mfma_f32_16x16x32_bf16 a[100:103], v[76:79], v[116:119], a[100:103]
    v_mfma_f32_16x16x32_bf16 a[104:107], v[76:79], v[120:123], a[104:107]
    v_mfma_f32_16x16x32_bf16 a[108:111], v[76:79], v[124:127], a[108:111]
    v_mfma_f32_16x16x32_bf16 a[112:115], v[76:79], v[128:131], a[112:115]
    v_mfma_f32_16x16x32_bf16 a[116:119], v[76:79], v[132:135], a[116:119]
    v_mfma_f32_16x16x32_bf16 a[120:123], v[76:79], v[136:139], a[120:123]
    v_mfma_f32_16x16x32_bf16 a[124:127], v[76:79], v[140:143], a[124:127]
    v_add_u32 v5, 8192, v2
    buffer_load_dwordx4 v[64:67], v5, s[12:15], s24 offen
    buffer_load_dwordx4 v[68:71], v5, s[12:15], s25 offen
    buffer_load_dwordx4 v[72:75], v5, s[12:15], s26 offen
    buffer_load_dwordx4 v[76:79], v5, s[12:15], s27 offen
    ds_read_b128 v[112:115], v3 offset:7168
    ds_read_b128 v[116:119], v3 offset:23552
    ds_read_b128 v[120:123], v3 offset:39936
    ds_read_b128 v[124:127], v3 offset:56320
    ds_read_b128 v[128:131], v4 offset:7168
    ds_read_b128 v[132:135], v4 offset:23552
    ds_read_b128 v[136:139], v4 offset:39936
    ds_read_b128 v[140:143], v4 offset:56320
    s_waitcnt vmcnt(8) lgkmcnt(8)
    v_mfma_f32_16x16x32_bf16 a[0:3], v[32:35], v[80:83], a[0:3]
    v_mfma_f32_16x16x32_bf16 a[4:7], v[32:35], v[84:87], a[4:7]
    v_mfma_f32_16x16x32_bf16 a[8:11], v[32:35], v[88:91], a[8:11]
    v_mfma_f32_16x16x32_bf16 a[12:15], v[32:35], v[92:95], a[12:15]
    v_mfma_f32_16x16x32_bf16 a[16:19], v[32:35], v[96:99], a[16:19]
    v_mfma_f32_16x16x32_bf16 a[20:23], v[32:35], v[100:103], a[20:23]
    v_mfma_f32_16x16x32_bf16 a[24:27], v[32:35], v[104:107], a[24:27]
    v_mfma_f32_16x16x32_bf16 a[28:31], v[32:35], v[108:111], a[28:31]
    v_mfma_f32_16x16x32_bf16 a[32:35], v[36:39], v[80:83], a[32:35]
    v_mfma_f32_16x16x32_bf16 a[36:39], v[36:39], v[84:87], a[36:39]
    v_mfma_f32_16x16x32_bf16 a[40:43], v[36:39], v[88:91], a[40:43]
    v_mfma_f32_16x16x32_bf16 a[44:47], v[36:39], v[92:95], a[44:47]
    v_mfma_f32_16x16x32_bf16 a[48:51], v[36:39], v[96:99], a[48:51]
    v_mfma_f32_16x16x32_bf16 a[52:55], v[36:39], v[100:103], a[52:55]
    v_mfma_f32_16x16x32_bf16 a[56:59], v[36:39], v[104:107], a[56:59]
    v_mfma_f32_16x16x32_bf16 a[60:63], v[36:39], v[108:111], a[60:63]
    v_mfma_f32_16x16x32_bf16 a[64:67], v[40:43], v[80:83], a[64:67]
    v_mfma_f32_16x16x32_bf16 a[68:71], v[40:43], v[84:87], a[68:71]
    v_mfma_f32_16x16x32_bf16 a[72:75], v[40:43], v[88:91], a[72:75]
    v_mfma_f32_16x16x32_bf16 a[76:79], v[40:43], v[92:95], a[76:79]
    v_mfma_f32_16x16x32_bf16 a[80:83], v[40:43], v[96:99], a[80:83]
    v_mfma_f32_16x16x32_bf16 a[84:87], v[40:43], v[100:103], a[84:87]
    v_mfma_f32_16x16x32_bf16 a[88:91], v[40:43], v[104:107], a[88:91]
    v_mfma_f32_16x16x32_bf16 a[92:95], v[40:43], v[108:111], a[92:95]
    v_mfma_f32_16x16x32_bf16 a[96:99], v[44:47], v[80:83], a[96:99]
    v_mfma_f32_16x16x32_bf16 a[100:103], v[44:47], v[84:87], a[100:103]
    v_mfma_f32_16x16x32_bf16 a[104:107], v[44:47], v[88:91], a[104:107]
    v_mfma_f32_16x16x32_bf16 a[108:111], v[44:47], v[92:95], a[108:111]
    v_mfma_f32_16x16x32_bf16 a[112:115], v[44:47], v[96:99], a[112:115]
    v_mfma_f32_16x16x32_bf16 a[116:119], v[44:47], v[100:103], a[116:119]
    v_mfma_f32_16x16x32_bf16 a[120:123], v[44:47], v[104:107], a[120:123]
    v_mfma_f32_16x16x32_bf16 a[124:127], v[44:47], v[108:111], a[124:127]
    v_add_u32 v5, 9216, v2
    buffer_load_dwordx4 v[32:35], v5, s[12:15], s24 offen
    buffer_load_dwordx4 v[36:39], v5, s[12:15], s25 offen
    buffer_load_dwordx4 v[40:43], v5, s[12:15], s26 offen
    buffer_load_dwordx4 v[44:47], v5, s[12:15], s27 offen
    ds_read_b128 v[80:83], v3 offset:8192
    ds_read_b128 v[84:87], v3 offset:24576
    ds_read_b128 v[88:91], v3 offset:40960
    ds_read_b128 v[92:95], v3 offset:57344
    ds_read_b128 v[96:99], v4 offset:8192
    ds_read_b128 v[100:103], v4 offset:24576
    ds_read_b128 v[104:107], v4 offset:40960
    ds_read_b128 v[108:111], v4 offset:57344
    s_waitcnt vmcnt(8) lgkmcnt(8)
    v_mfma_f32_16x16x32_bf16 a[0:3], v[48:51], v[112:115], a[0:3]
    v_mfma_f32_16x16x32_bf16 a[4:7], v[48:51], v[116:119], a[4:7]
    v_mfma_f32_16x16x32_bf16 a[8:11], v[48:51], v[120:123], a[8:11]
    v_mfma_f32_16x16x32_bf16 a[12:15], v[48:51], v[124:127], a[12:15]
    v_mfma_f32_16x16x32_bf16 a[16:19], v[48:51], v[128:131], a[16:19]
    v_mfma_f32_16x16x32_bf16 a[20:23], v[48:51], v[132:135], a[20:23]
    v_mfma_f32_16x16x32_bf16 a[24:27], v[48:51], v[136:139], a[24:27]
    v_mfma_f32_16x16x32_bf16 a[28:31], v[48:51], v[140:143], a[28:31]
    v_mfma_f32_16x16x32_bf16 a[32:35], v[52:55], v[112:115], a[32:35]
    v_mfma_f32_16x16x32_bf16 a[36:39], v[52:55], v[116:119], a[36:39]
    v_mfma_f32_16x16x32_bf16 a[40:43], v[52:55], v[120:123], a[40:43]
    v_mfma_f32_16x16x32_bf16 a[44:47], v[52:55], v[124:127], a[44:47]
    v_mfma_f32_16x16x32_bf16 a[48:51], v[52:55], v[128:131], a[48:51]
    v_mfma_f32_16x16x32_bf16 a[52:55], v[52:55], v[132:135], a[52:55]
    v_mfma_f32_16x16x32_bf16 a[56:59], v[52:55], v[136:139], a[56:59]
    v_mfma_f32_16x16x32_bf16 a[60:63], v[52:55], v[140:143], a[60:63]
    v_mfma_f32_16x16x32_bf16 a[64:67], v[56:59], v[112:115], a[64:67]
    v_mfma_f32_16x16x32_bf16 a[68:71], v[56:59], v[116:119], a[68:71]
    v_mfma_f32_16x16x32_bf16 a[72:75], v[56:59], v[120:123], a[72:75]
    v_mfma_f32_16x16x32_bf16 a[76:79], v[56:59], v[124:127], a[76:79]
    v_mfma_f32_16x16x32_bf16 a[80:83], v[56:59], v[128:131], a[80:83]
    v_mfma_f32_16x16x32_bf16 a[84:87], v[56:59], v[132:135], a[84:87]
    v_mfma_f32_16x16x32_bf16 a[88:91], v[56:59], v[136:139], a[88:91]
    v_mfma_f32_16x16x32_bf16 a[92:95], v[56:59], v[140:143], a[92:95]
    v_mfma_f32_16x16x32_bf16 a[96:99], v[60:63], v[112:115], a[96:99]
    v_mfma_f32_16x16x32_bf16 a[100:103], v[60:63], v[116:119], a[100:103]
    v_mfma_f32_16x16x32_bf16 a[104:107], v[60:63], v[120:123], a[104:107]
    v_mfma_f32_16x16x32_bf16 a[108:111], v[60:63], v[124:127], a[108:111]
    v_mfma_f32_16x16x32_bf16 a[112:115], v[60:63], v[128:131], a[112:115]
    v_mfma_f32_16x16x32_bf16 a[116:119], v[60:63], v[132:135], a[116:119]
    v_mfma_f32_16x16x32_bf16 a[120:123], v[60:63], v[136:139], a[120:123]
    v_mfma_f32_16x16x32_bf16 a[124:127], v[60:63], v[140:143], a[124:127]
    v_add_u32 v5, 10240, v2
    buffer_load_dwordx4 v[48:51], v5, s[12:15], s24 offen
    buffer_load_dwordx4 v[52:55], v5, s[12:15], s25 offen
    buffer_load_dwordx4 v[56:59], v5, s[12:15], s26 offen
    buffer_load_dwordx4 v[60:63], v5, s[12:15], s27 offen
    ds_read_b128 v[112:115], v3 offset:9216
    ds_read_b128 v[116:119], v3 offset:25600
    ds_read_b128 v[120:123], v3 offset:41984
    ds_read_b128 v[124:127], v3 offset:58368
    ds_read_b128 v[128:131], v4 offset:9216
    ds_read_b128 v[132:135], v4 offset:25600
    ds_read_b128 v[136:139], v4 offset:41984
    ds_read_b128 v[140:143], v4 offset:58368
    s_waitcnt vmcnt(8) lgkmcnt(8)
    v_mfma_f32_16x16x32_bf16 a[0:3], v[64:67], v[80:83], a[0:3]
    v_mfma_f32_16x16x32_bf16 a[4:7], v[64:67], v[84:87], a[4:7]
    v_mfma_f32_16x16x32_bf16 a[8:11], v[64:67], v[88:91], a[8:11]
    v_mfma_f32_16x16x32_bf16 a[12:15], v[64:67], v[92:95], a[12:15]
    v_mfma_f32_16x16x32_bf16 a[16:19], v[64:67], v[96:99], a[16:19]
    v_mfma_f32_16x16x32_bf16 a[20:23], v[64:67], v[100:103], a[20:23]
    v_mfma_f32_16x16x32_bf16 a[24:27], v[64:67], v[104:107], a[24:27]
    v_mfma_f32_16x16x32_bf16 a[28:31], v[64:67], v[108:111], a[28:31]
    v_mfma_f32_16x16x32_bf16 a[32:35], v[68:71], v[80:83], a[32:35]
    v_mfma_f32_16x16x32_bf16 a[36:39], v[68:71], v[84:87], a[36:39]
    v_mfma_f32_16x16x32_bf16 a[40:43], v[68:71], v[88:91], a[40:43]
    v_mfma_f32_16x16x32_bf16 a[44:47], v[68:71], v[92:95], a[44:47]
    v_mfma_f32_16x16x32_bf16 a[48:51], v[68:71], v[96:99], a[48:51]
    v_mfma_f32_16x16x32_bf16 a[52:55], v[68:71], v[100:103], a[52:55]
    v_mfma_f32_16x16x32_bf16 a[56:59], v[68:71], v[104:107], a[56:59]
    v_mfma_f32_16x16x32_bf16 a[60:63], v[68:71], v[108:111], a[60:63]
    v_mfma_f32_16x16x32_bf16 a[64:67], v[72:75], v[80:83], a[64:67]
    v_mfma_f32_16x16x32_bf16 a[68:71], v[72:75], v[84:87], a[68:71]
    v_mfma_f32_16x16x32_bf16 a[72:75], v[72:75], v[88:91], a[72:75]
    v_mfma_f32_16x16x32_bf16 a[76:79], v[72:75], v[92:95], a[76:79]
    v_mfma_f32_16x16x32_bf16 a[80:83], v[72:75], v[96:99], a[80:83]
    v_mfma_f32_16x16x32_bf16 a[84:87], v[72:75], v[100:103], a[84:87]
    v_mfma_f32_16x16x32_bf16 a[88:91], v[72:75], v[104:107], a[88:91]
    v_mfma_f32_16x16x32_bf16 a[92:95], v[72:75], v[108:111], a[92:95]
    v_mfma_f32_16x16x32_bf16 a[96:99], v[76:79], v[80:83], a[96:99]
    v_mfma_f32_16x16x32_bf16 a[100:103], v[76:79], v[84:87], a[100:103]
    v_mfma_f32_16x16x32_bf16 a[104:107], v[76:79], v[88:91], a[104:107]
    v_mfma_f32_16x16x32_bf16 a[108:111], v[76:79], v[92:95], a[108:111]
    v_mfma_f32_16x16x32_bf16 a[112:115], v[76:79], v[96:99], a[112:115]
    v_mfma_f32_16x16x32_bf16 a[116:119], v[76:79], v[100:103], a[116:119]
    v_mfma_f32_16x16x32_bf16 a[120:123], v[76:79], v[104:107], a[120:123]
    v_mfma_f32_16x16x32_bf16 a[124:127], v[76:79], v[108:111], a[124:127]
    v_add_u32 v5, 11264, v2
    buffer_load_dwordx4 v[64:67], v5, s[12:15], s24 offen
    buffer_load_dwordx4 v[68:71], v5, s[12:15], s25 offen
    buffer_load_dwordx4 v[72:75], v5, s[12:15], s26 offen
    buffer_load_dwordx4 v[76:79], v5, s[12:15], s27 offen
    ds_read_b128 v[80:83], v3 offset:10240
    ds_read_b128 v[84:87], v3 offset:26624
    ds_read_b128 v[88:91], v3 offset:43008
    ds_read_b128 v[92:95], v3 offset:59392
    ds_read_b128 v[96:99], v4 offset:10240
    ds_read_b128 v[100:103], v4 offset:26624
    ds_read_b128 v[104:107], v4 offset:43008
    ds_read_b128 v[108:111], v4 offset:59392
    s_waitcnt vmcnt(8) lgkmcnt(8)
    v_mfma_f32_16x16x32_bf16 a[0:3], v[32:35], v[112:115], a[0:3]
    v_mfma_f32_16x16x32_bf16 a[4:7], v[32:35], v[116:119], a[4:7]
    v_mfma_f32_16x16x32_bf16 a[8:11], v[32:35], v[120:123], a[8:11]
    v_mfma_f32_16x16x32_bf16 a[12:15], v[32:35], v[124:127], a[12:15]
    v_mfma_f32_16x16x32_bf16 a[16:19], v[32:35], v[128:131], a[16:19]
    v_mfma_f32_16x16x32_bf16 a[20:23], v[32:35], v[132:135], a[20:23]
    v_mfma_f32_16x16x32_bf16 a[24:27], v[32:35], v[136:139], a[24:27]
    v_mfma_f32_16x16x32_bf16 a[28:31], v[32:35], v[140:143], a[28:31]
    v_mfma_f32_16x16x32_bf16 a[32:35], v[36:39], v[112:115], a[32:35]
    v_mfma_f32_16x16x32_bf16 a[36:39], v[36:39], v[116:119], a[36:39]
    v_mfma_f32_16x16x32_bf16 a[40:43], v[36:39], v[120:123], a[40:43]
    v_mfma_f32_16x16x32_bf16 a[44:47], v[36:39], v[124:127], a[44:47]
    v_mfma_f32_16x16x32_bf16 a[48:51], v[36:39], v[128:131], a[48:51]
    v_mfma_f32_16x16x32_bf16 a[52:55], v[36:39], v[132:135], a[52:55]
    v_mfma_f32_16x16x32_bf16 a[56:59], v[36:39], v[136:139], a[56:59]
    v_mfma_f32_16x16x32_bf16 a[60:63], v[36:39], v[140:143], a[60:63]
    v_mfma_f32_16x16x32_bf16 a[64:67], v[40:43], v[112:115], a[64:67]
    v_mfma_f32_16x16x32_bf16 a[68:71], v[40:43], v[116:119], a[68:71]
    v_mfma_f32_16x16x32_bf16 a[72:75], v[40:43], v[120:123], a[72:75]
    v_mfma_f32_16x16x32_bf16 a[76:79], v[40:43], v[124:127], a[76:79]
    v_mfma_f32_16x16x32_bf16 a[80:83], v[40:43], v[128:131], a[80:83]
    v_mfma_f32_16x16x32_bf16 a[84:87], v[40:43], v[132:135], a[84:87]
    v_mfma_f32_16x16x32_bf16 a[88:91], v[40:43], v[136:139], a[88:91]
    v_mfma_f32_16x16x32_bf16 a[92:95], v[40:43], v[140:143], a[92:95]
    v_mfma_f32_16x16x32_bf16 a[96:99], v[44:47], v[112:115], a[96:99]
    v_mfma_f32_16x16x32_bf16 a[100:103], v[44:47], v[116:119], a[100:103]
    v_mfma_f32_16x16x32_bf16 a[104:107], v[44:47], v[120:123], a[104:107]
    v_mfma_f32_16x16x32_bf16 a[108:111], v[44:47], v[124:127], a[108:111]
    v_mfma_f32_16x16x32_bf16 a[112:115], v[44:47], v[128:131], a[112:115]
    v_mfma_f32_16x16x32_bf16 a[116:119], v[44:47], v[132:135], a[116:119]
    v_mfma_f32_16x16x32_bf16 a[120:123], v[44:47], v[136:139], a[120:123]
    v_mfma_f32_16x16x32_bf16 a[124:127], v[44:47], v[140:143], a[124:127]
    v_add_u32 v5, 12288, v2
    buffer_load_dwordx4 v[32:35], v5, s[12:15], s24 offen
    buffer_load_dwordx4 v[36:39], v5, s[12:15], s25 offen
    buffer_load_dwordx4 v[40:43], v5, s[12:15], s26 offen
    buffer_load_dwordx4 v[44:47], v5, s[12:15], s27 offen
    ds_read_b128 v[112:115], v3 offset:11264
    ds_read_b128 v[116:119], v3 offset:27648
    ds_read_b128 v[120:123], v3 offset:44032
    ds_read_b128 v[124:127], v3 offset:60416
    ds_read_b128 v[128:131], v4 offset:11264
    ds_read_b128 v[132:135], v4 offset:27648
    ds_read_b128 v[136:139], v4 offset:44032
    ds_read_b128 v[140:143], v4 offset:60416
    s_waitcnt vmcnt(8) lgkmcnt(8)
    v_mfma_f32_16x16x32_bf16 a[0:3], v[48:51], v[80:83], a[0:3]
    v_mfma_f32_16x16x32_bf16 a[4:7], v[48:51], v[84:87], a[4:7]
    v_mfma_f32_16x16x32_bf16 a[8:11], v[48:51], v[88:91], a[8:11]
    v_mfma_f32_16x16x32_bf16 a[12:15], v[48:51], v[92:95], a[12:15]
    v_mfma_f32_16x16x32_bf16 a[16:19], v[48:51], v[96:99], a[16:19]
    v_mfma_f32_16x16x32_bf16 a[20:23], v[48:51], v[100:103], a[20:23]
    v_mfma_f32_16x16x32_bf16 a[24:27], v[48:51], v[104:107], a[24:27]
    v_mfma_f32_16x16x32_bf16 a[28:31], v[48:51], v[108:111], a[28:31]
    v_mfma_f32_16x16x32_bf16 a[32:35], v[52:55], v[80:83], a[32:35]
    v_mfma_f32_16x16x32_bf16 a[36:39], v[52:55], v[84:87], a[36:39]
    v_mfma_f32_16x16x32_bf16 a[40:43], v[52:55], v[88:91], a[40:43]
    v_mfma_f32_16x16x32_bf16 a[44:47], v[52:55], v[92:95], a[44:47]
    v_mfma_f32_16x16x32_bf16 a[48:51], v[52:55], v[96:99], a[48:51]
    v_mfma_f32_16x16x32_bf16 a[52:55], v[52:55], v[100:103], a[52:55]
    v_mfma_f32_16x16x32_bf16 a[56:59], v[52:55], v[104:107], a[56:59]
    v_mfma_f32_16x16x32_bf16 a[60:63], v[52:55], v[108:111], a[60:63]
    v_mfma_f32_16x16x32_bf16 a[64:67], v[56:59], v[80:83], a[64:67]
    v_mfma_f32_16x16x32_bf16 a[68:71], v[56:59], v[84:87], a[68:71]
    v_mfma_f32_16x16x32_bf16 a[72:75], v[56:59], v[88:91], a[72:75]
    v_mfma_f32_16x16x32_bf16 a[76:79], v[56:59], v[92:95], a[76:79]
    v_mfma_f32_16x16x32_bf16 a[80:83], v[56:59], v[96:99], a[80:83]
    v_mfma_f32_16x16x32_bf16 a[84:87], v[56:59], v[100:103], a[84:87]
    v_mfma_f32_16x16x32_bf16 a[88:91], v[56:59], v[104:107], a[88:91]
    v_mfma_f32_16x16x32_bf16 a[92:95], v[56:59], v[108:111], a[92:95]
    v_mfma_f32_16x16x32_bf16 a[96:99], v[60:63], v[80:83], a[96:99]
    v_mfma_f32_16x16x32_bf16 a[100:103], v[60:63], v[84:87], a[100:103]
    v_mfma_f32_16x16x32_bf16 a[104:107], v[60:63], v[88:91], a[104:107]
    v_mfma_f32_16x16x32_bf16 a[108:111], v[60:63], v[92:95], a[108:111]
    v_mfma_f32_16x16x32_bf16 a[112:115], v[60:63], v[96:99], a[112:115]
    v_mfma_f32_16x16x32_bf16 a[116:119], v[60:63], v[100:103], a[116:119]
    v_mfma_f32_16x16x32_bf16 a[120:123], v[60:63], v[104:107], a[120:123]
    v_mfma_f32_16x16x32_bf16 a[124:127], v[60:63], v[108:111], a[124:127]
    v_add_u32 v5, 13312, v2
    buffer_load_dwordx4 v[48:51], v5, s[12:15], s24 offen
    buffer_load_dwordx4 v[52:55], v5, s[12:15], s25 offen
    buffer_load_dwordx4 v[56:59], v5, s[12:15], s26 offen
    buffer_load_dwordx4 v[60:63], v5, s[12:15], s27 offen
    ds_read_b128 v[80:83], v3 offset:12288
    ds_read_b128 v[84:87], v3 offset:28672
    ds_read_b128 v[88:91], v3 offset:45056
    ds_read_b128 v[92:95], v3 offset:61440
    ds_read_b128 v[96:99], v4 offset:12288
    ds_read_b128 v[100:103], v4 offset:28672
    ds_read_b128 v[104:107], v4 offset:45056
    ds_read_b128 v[108:111], v4 offset:61440
    s_waitcnt vmcnt(8) lgkmcnt(8)
    v_mfma_f32_16x16x32_bf16 a[0:3], v[64:67], v[112:115], a[0:3]
    v_mfma_f32_16x16x32_bf16 a[4:7], v[64:67], v[116:119], a[4:7]
    v_mfma_f32_16x16x32_bf16 a[8:11], v[64:67], v[120:123], a[8:11]
    v_mfma_f32_16x16x32_bf16 a[12:15], v[64:67], v[124:127], a[12:15]
    v_mfma_f32_16x16x32_bf16 a[16:19], v[64:67], v[128:131], a[16:19]
    v_mfma_f32_16x16x32_bf16 a[20:23], v[64:67], v[132:135], a[20:23]
    v_mfma_f32_16x16x32_bf16 a[24:27], v[64:67], v[136:139], a[24:27]
    v_mfma_f32_16x16x32_bf16 a[28:31], v[64:67], v[140:143], a[28:31]
    v_mfma_f32_16x16x32_bf16 a[32:35], v[68:71], v[112:115], a[32:35]
    v_mfma_f32_16x16x32_bf16 a[36:39], v[68:71], v[116:119], a[36:39]
    v_mfma_f32_16x16x32_bf16 a[40:43], v[68:71], v[120:123], a[40:43]
    v_mfma_f32_16x16x32_bf16 a[44:47], v[68:71], v[124:127], a[44:47]
    v_mfma_f32_16x16x32_bf16 a[48:51], v[68:71], v[128:131], a[48:51]
    v_mfma_f32_16x16x32_bf16 a[52:55], v[68:71], v[132:135], a[52:55]
    v_mfma_f32_16x16x32_bf16 a[56:59], v[68:71], v[136:139], a[56:59]
    v_mfma_f32_16x16x32_bf16 a[60:63], v[68:71], v[140:143], a[60:63]
    v_mfma_f32_16x16x32_bf16 a[64:67], v[72:75], v[112:115], a[64:67]
    v_mfma_f32_16x16x32_bf16 a[68:71], v[72:75], v[116:119], a[68:71]
    v_mfma_f32_16x16x32_bf16 a[72:75], v[72:75], v[120:123], a[72:75]
    v_mfma_f32_16x16x32_bf16 a[76:79], v[72:75], v[124:127], a[76:79]
    v_mfma_f32_16x16x32_bf16 a[80:83], v[72:75], v[128:131], a[80:83]
    v_mfma_f32_16x16x32_bf16 a[84:87], v[72:75], v[132:135], a[84:87]
    v_mfma_f32_16x16x32_bf16 a[88:91], v[72:75], v[136:139], a[88:91]
    v_mfma_f32_16x16x32_bf16 a[92:95], v[72:75], v[140:143], a[92:95]
    v_mfma_f32_16x16x32_bf16 a[96:99], v[76:79], v[112:115], a[96:99]
    v_mfma_f32_16x16x32_bf16 a[100:103], v[76:79], v[116:119], a[100:103]
    v_mfma_f32_16x16x32_bf16 a[104:107], v[76:79], v[120:123], a[104:107]
    v_mfma_f32_16x16x32_bf16 a[108:111], v[76:79], v[124:127], a[108:111]
    v_mfma_f32_16x16x32_bf16 a[112:115], v[76:79], v[128:131], a[112:115]
    v_mfma_f32_16x16x32_bf16 a[116:119], v[76:79], v[132:135], a[116:119]
    v_mfma_f32_16x16x32_bf16 a[120:123], v[76:79], v[136:139], a[120:123]
    v_mfma_f32_16x16x32_bf16 a[124:127], v[76:79], v[140:143], a[124:127]
    v_add_u32 v5, 14336, v2
    buffer_load_dwordx4 v[64:67], v5, s[12:15], s24 offen
    buffer_load_dwordx4 v[68:71], v5, s[12:15], s25 offen
    buffer_load_dwordx4 v[72:75], v5, s[12:15], s26 offen
    buffer_load_dwordx4 v[76:79], v5, s[12:15], s27 offen
    ds_read_b128 v[112:115], v3 offset:13312
    ds_read_b128 v[116:119], v3 offset:29696
    ds_read_b128 v[120:123], v3 offset:46080
    ds_read_b128 v[124:127], v3 offset:62464
    ds_read_b128 v[128:131], v4 offset:13312
    ds_read_b128 v[132:135], v4 offset:29696
    ds_read_b128 v[136:139], v4 offset:46080
    ds_read_b128 v[140:143], v4 offset:62464
    s_waitcnt vmcnt(8) lgkmcnt(8)
    v_mfma_f32_16x16x32_bf16 a[0:3], v[32:35], v[80:83], a[0:3]
    v_mfma_f32_16x16x32_bf16 a[4:7], v[32:35], v[84:87], a[4:7]
    v_mfma_f32_16x16x32_bf16 a[8:11], v[32:35], v[88:91], a[8:11]
    v_mfma_f32_16x16x32_bf16 a[12:15], v[32:35], v[92:95], a[12:15]
    v_mfma_f32_16x16x32_bf16 a[16:19], v[32:35], v[96:99], a[16:19]
    v_mfma_f32_16x16x32_bf16 a[20:23], v[32:35], v[100:103], a[20:23]
    v_mfma_f32_16x16x32_bf16 a[24:27], v[32:35], v[104:107], a[24:27]
    v_mfma_f32_16x16x32_bf16 a[28:31], v[32:35], v[108:111], a[28:31]
    v_mfma_f32_16x16x32_bf16 a[32:35], v[36:39], v[80:83], a[32:35]
    v_mfma_f32_16x16x32_bf16 a[36:39], v[36:39], v[84:87], a[36:39]
    v_mfma_f32_16x16x32_bf16 a[40:43], v[36:39], v[88:91], a[40:43]
    v_mfma_f32_16x16x32_bf16 a[44:47], v[36:39], v[92:95], a[44:47]
    v_mfma_f32_16x16x32_bf16 a[48:51], v[36:39], v[96:99], a[48:51]
    v_mfma_f32_16x16x32_bf16 a[52:55], v[36:39], v[100:103], a[52:55]
    v_mfma_f32_16x16x32_bf16 a[56:59], v[36:39], v[104:107], a[56:59]
    v_mfma_f32_16x16x32_bf16 a[60:63], v[36:39], v[108:111], a[60:63]
    v_mfma_f32_16x16x32_bf16 a[64:67], v[40:43], v[80:83], a[64:67]
    v_mfma_f32_16x16x32_bf16 a[68:71], v[40:43], v[84:87], a[68:71]
    v_mfma_f32_16x16x32_bf16 a[72:75], v[40:43], v[88:91], a[72:75]
    v_mfma_f32_16x16x32_bf16 a[76:79], v[40:43], v[92:95], a[76:79]
    v_mfma_f32_16x16x32_bf16 a[80:83], v[40:43], v[96:99], a[80:83]
    v_mfma_f32_16x16x32_bf16 a[84:87], v[40:43], v[100:103], a[84:87]
    v_mfma_f32_16x16x32_bf16 a[88:91], v[40:43], v[104:107], a[88:91]
    v_mfma_f32_16x16x32_bf16 a[92:95], v[40:43], v[108:111], a[92:95]
    v_mfma_f32_16x16x32_bf16 a[96:99], v[44:47], v[80:83], a[96:99]
    v_mfma_f32_16x16x32_bf16 a[100:103], v[44:47], v[84:87], a[100:103]
    v_mfma_f32_16x16x32_bf16 a[104:107], v[44:47], v[88:91], a[104:107]
    v_mfma_f32_16x16x32_bf16 a[108:111], v[44:47], v[92:95], a[108:111]
    v_mfma_f32_16x16x32_bf16 a[112:115], v[44:47], v[96:99], a[112:115]
    v_mfma_f32_16x16x32_bf16 a[116:119], v[44:47], v[100:103], a[116:119]
    v_mfma_f32_16x16x32_bf16 a[120:123], v[44:47], v[104:107], a[120:123]
    v_mfma_f32_16x16x32_bf16 a[124:127], v[44:47], v[108:111], a[124:127]
    v_add_u32 v5, 15360, v2
    buffer_load_dwordx4 v[32:35], v5, s[12:15], s24 offen
    buffer_load_dwordx4 v[36:39], v5, s[12:15], s25 offen
    buffer_load_dwordx4 v[40:43], v5, s[12:15], s26 offen
    buffer_load_dwordx4 v[44:47], v5, s[12:15], s27 offen
    ds_read_b128 v[80:83], v3 offset:14336
    ds_read_b128 v[84:87], v3 offset:30720
    ds_read_b128 v[88:91], v3 offset:47104
    ds_read_b128 v[92:95], v3 offset:63488
    ds_read_b128 v[96:99], v4 offset:14336
    ds_read_b128 v[100:103], v4 offset:30720
    ds_read_b128 v[104:107], v4 offset:47104
    ds_read_b128 v[108:111], v4 offset:63488
    s_waitcnt vmcnt(8) lgkmcnt(8)
    v_mfma_f32_16x16x32_bf16 a[0:3], v[48:51], v[112:115], a[0:3]
    v_mfma_f32_16x16x32_bf16 a[4:7], v[48:51], v[116:119], a[4:7]
    v_mfma_f32_16x16x32_bf16 a[8:11], v[48:51], v[120:123], a[8:11]
    v_mfma_f32_16x16x32_bf16 a[12:15], v[48:51], v[124:127], a[12:15]
    v_mfma_f32_16x16x32_bf16 a[16:19], v[48:51], v[128:131], a[16:19]
    v_mfma_f32_16x16x32_bf16 a[20:23], v[48:51], v[132:135], a[20:23]
    v_mfma_f32_16x16x32_bf16 a[24:27], v[48:51], v[136:139], a[24:27]
    v_mfma_f32_16x16x32_bf16 a[28:31], v[48:51], v[140:143], a[28:31]
    v_mfma_f32_16x16x32_bf16 a[32:35], v[52:55], v[112:115], a[32:35]
    v_mfma_f32_16x16x32_bf16 a[36:39], v[52:55], v[116:119], a[36:39]
    v_mfma_f32_16x16x32_bf16 a[40:43], v[52:55], v[120:123], a[40:43]
    v_mfma_f32_16x16x32_bf16 a[44:47], v[52:55], v[124:127], a[44:47]
    v_mfma_f32_16x16x32_bf16 a[48:51], v[52:55], v[128:131], a[48:51]
    v_mfma_f32_16x16x32_bf16 a[52:55], v[52:55], v[132:135], a[52:55]
    v_mfma_f32_16x16x32_bf16 a[56:59], v[52:55], v[136:139], a[56:59]
    v_mfma_f32_16x16x32_bf16 a[60:63], v[52:55], v[140:143], a[60:63]
    v_mfma_f32_16x16x32_bf16 a[64:67], v[56:59], v[112:115], a[64:67]
    v_mfma_f32_16x16x32_bf16 a[68:71], v[56:59], v[116:119], a[68:71]
    v_mfma_f32_16x16x32_bf16 a[72:75], v[56:59], v[120:123], a[72:75]
    v_mfma_f32_16x16x32_bf16 a[76:79], v[56:59], v[124:127], a[76:79]
    v_mfma_f32_16x16x32_bf16 a[80:83], v[56:59], v[128:131], a[80:83]
    v_mfma_f32_16x16x32_bf16 a[84:87], v[56:59], v[132:135], a[84:87]
    v_mfma_f32_16x16x32_bf16 a[88:91], v[56:59], v[136:139], a[88:91]
    v_mfma_f32_16x16x32_bf16 a[92:95], v[56:59], v[140:143], a[92:95]
    v_mfma_f32_16x16x32_bf16 a[96:99], v[60:63], v[112:115], a[96:99]
    v_mfma_f32_16x16x32_bf16 a[100:103], v[60:63], v[116:119], a[100:103]
    v_mfma_f32_16x16x32_bf16 a[104:107], v[60:63], v[120:123], a[104:107]
    v_mfma_f32_16x16x32_bf16 a[108:111], v[60:63], v[124:127], a[108:111]
    v_mfma_f32_16x16x32_bf16 a[112:115], v[60:63], v[128:131], a[112:115]
    v_mfma_f32_16x16x32_bf16 a[116:119], v[60:63], v[132:135], a[116:119]
    v_mfma_f32_16x16x32_bf16 a[120:123], v[60:63], v[136:139], a[120:123]
    v_mfma_f32_16x16x32_bf16 a[124:127], v[60:63], v[140:143], a[124:127]
    ds_read_b128 v[112:115], v3 offset:15360
    ds_read_b128 v[116:119], v3 offset:31744
    ds_read_b128 v[120:123], v3 offset:48128
    ds_read_b128 v[124:127], v3 offset:64512
    ds_read_b128 v[128:131], v4 offset:15360
    ds_read_b128 v[132:135], v4 offset:31744
    ds_read_b128 v[136:139], v4 offset:48128
    ds_read_b128 v[140:143], v4 offset:64512
    s_waitcnt vmcnt(4) lgkmcnt(8)
    v_mfma_f32_16x16x32_bf16 a[0:3], v[64:67], v[80:83], a[0:3]
    v_mfma_f32_16x16x32_bf16 a[4:7], v[64:67], v[84:87], a[4:7]
    v_mfma_f32_16x16x32_bf16 a[8:11], v[64:67], v[88:91], a[8:11]
    v_mfma_f32_16x16x32_bf16 a[12:15], v[64:67], v[92:95], a[12:15]
    v_mfma_f32_16x16x32_bf16 a[16:19], v[64:67], v[96:99], a[16:19]
    v_mfma_f32_16x16x32_bf16 a[20:23], v[64:67], v[100:103], a[20:23]
    v_mfma_f32_16x16x32_bf16 a[24:27], v[64:67], v[104:107], a[24:27]
    v_mfma_f32_16x16x32_bf16 a[28:31], v[64:67], v[108:111], a[28:31]
    v_mfma_f32_16x16x32_bf16 a[32:35], v[68:71], v[80:83], a[32:35]
    v_mfma_f32_16x16x32_bf16 a[36:39], v[68:71], v[84:87], a[36:39]
    v_mfma_f32_16x16x32_bf16 a[40:43], v[68:71], v[88:91], a[40:43]
    v_mfma_f32_16x16x32_bf16 a[44:47], v[68:71], v[92:95], a[44:47]
    v_mfma_f32_16x16x32_bf16 a[48:51], v[68:71], v[96:99], a[48:51]
    v_mfma_f32_16x16x32_bf16 a[52:55], v[68:71], v[100:103], a[52:55]
    v_mfma_f32_16x16x32_bf16 a[56:59], v[68:71], v[104:107], a[56:59]
    v_mfma_f32_16x16x32_bf16 a[60:63], v[68:71], v[108:111], a[60:63]
    v_mfma_f32_16x16x32_bf16 a[64:67], v[72:75], v[80:83], a[64:67]
    v_mfma_f32_16x16x32_bf16 a[68:71], v[72:75], v[84:87], a[68:71]
    v_mfma_f32_16x16x32_bf16 a[72:75], v[72:75], v[88:91], a[72:75]
    v_mfma_f32_16x16x32_bf16 a[76:79], v[72:75], v[92:95], a[76:79]
    v_mfma_f32_16x16x32_bf16 a[80:83], v[72:75], v[96:99], a[80:83]
    v_mfma_f32_16x16x32_bf16 a[84:87], v[72:75], v[100:103], a[84:87]
    v_mfma_f32_16x16x32_bf16 a[88:91], v[72:75], v[104:107], a[88:91]
    v_mfma_f32_16x16x32_bf16 a[92:95], v[72:75], v[108:111], a[92:95]
    v_mfma_f32_16x16x32_bf16 a[96:99], v[76:79], v[80:83], a[96:99]
    v_mfma_f32_16x16x32_bf16 a[100:103], v[76:79], v[84:87], a[100:103]
    v_mfma_f32_16x16x32_bf16 a[104:107], v[76:79], v[88:91], a[104:107]
    v_mfma_f32_16x16x32_bf16 a[108:111], v[76:79], v[92:95], a[108:111]
    v_mfma_f32_16x16x32_bf16 a[112:115], v[76:79], v[96:99], a[112:115]
    v_mfma_f32_16x16x32_bf16 a[116:119], v[76:79], v[100:103], a[116:119]
    v_mfma_f32_16x16x32_bf16 a[120:123], v[76:79], v[104:107], a[120:123]
    v_mfma_f32_16x16x32_bf16 a[124:127], v[76:79], v[108:111], a[124:127]
    s_waitcnt vmcnt(0) lgkmcnt(0)
    v_mfma_f32_16x16x32_bf16 a[0:3], v[32:35], v[112:115], a[0:3]
    v_mfma_f32_16x16x32_bf16 a[4:7], v[32:35], v[116:119], a[4:7]
    v_mfma_f32_16x16x32_bf16 a[8:11], v[32:35], v[120:123], a[8:11]
    v_mfma_f32_16x16x32_bf16 a[12:15], v[32:35], v[124:127], a[12:15]
    v_mfma_f32_16x16x32_bf16 a[16:19], v[32:35], v[128:131], a[16:19]
    v_mfma_f32_16x16x32_bf16 a[20:23], v[32:35], v[132:135], a[20:23]
    v_mfma_f32_16x16x32_bf16 a[24:27], v[32:35], v[136:139], a[24:27]
    v_mfma_f32_16x16x32_bf16 a[28:31], v[32:35], v[140:143], a[28:31]
    v_mfma_f32_16x16x32_bf16 a[32:35], v[36:39], v[112:115], a[32:35]
    v_mfma_f32_16x16x32_bf16 a[36:39], v[36:39], v[116:119], a[36:39]
    v_mfma_f32_16x16x32_bf16 a[40:43], v[36:39], v[120:123], a[40:43]
    v_mfma_f32_16x16x32_bf16 a[44:47], v[36:39], v[124:127], a[44:47]
    v_mfma_f32_16x16x32_bf16 a[48:51], v[36:39], v[128:131], a[48:51]
    v_mfma_f32_16x16x32_bf16 a[52:55], v[36:39], v[132:135], a[52:55]
    v_mfma_f32_16x16x32_bf16 a[56:59], v[36:39], v[136:139], a[56:59]
    v_mfma_f32_16x16x32_bf16 a[60:63], v[36:39], v[140:143], a[60:63]
    v_mfma_f32_16x16x32_bf16 a[64:67], v[40:43], v[112:115], a[64:67]
    v_mfma_f32_16x16x32_bf16 a[68:71], v[40:43], v[116:119], a[68:71]
    v_mfma_f32_16x16x32_bf16 a[72:75], v[40:43], v[120:123], a[72:75]
    v_mfma_f32_16x16x32_bf16 a[76:79], v[40:43], v[124:127], a[76:79]
    v_mfma_f32_16x16x32_bf16 a[80:83], v[40:43], v[128:131], a[80:83]
    v_mfma_f32_16x16x32_bf16 a[84:87], v[40:43], v[132:135], a[84:87]
    v_mfma_f32_16x16x32_bf16 a[88:91], v[40:43], v[136:139], a[88:91]
    v_mfma_f32_16x16x32_bf16 a[92:95], v[40:43], v[140:143], a[92:95]
    v_mfma_f32_16x16x32_bf16 a[96:99], v[44:47], v[112:115], a[96:99]
    v_mfma_f32_16x16x32_bf16 a[100:103], v[44:47], v[116:119], a[100:103]
    v_mfma_f32_16x16x32_bf16 a[104:107], v[44:47], v[120:123], a[104:107]
    v_mfma_f32_16x16x32_bf16 a[108:111], v[44:47], v[124:127], a[108:111]
    v_mfma_f32_16x16x32_bf16 a[112:115], v[44:47], v[128:131], a[112:115]
    v_mfma_f32_16x16x32_bf16 a[116:119], v[44:47], v[132:135], a[116:119]
    v_mfma_f32_16x16x32_bf16 a[120:123], v[44:47], v[136:139], a[120:123]
    v_mfma_f32_16x16x32_bf16 a[124:127], v[44:47], v[140:143], a[124:127]
    s_nop 9
    s_lshl_b32 s30, s16, 7
    s_add_u32 s30, s30, s28
    s_lshl_b32 s30, s30, 3
    s_lshr_b32 s19, s29, 1
    s_add_u32 s30, s30, s19
    s_lshl_b32 s30, s30, 10
    s_add_u32 s30, s30, 0x2000000
    v_accvgpr_read_b32 v144, a0
    v_accvgpr_read_b32 v145, a1
    v_accvgpr_read_b32 v146, a2
    v_accvgpr_read_b32 v147, a3
    v_accvgpr_read_b32 v148, a32
    v_accvgpr_read_b32 v149, a33
    v_accvgpr_read_b32 v150, a34
    v_accvgpr_read_b32 v151, a35
    v_cvt_pk_bf16_f32 v152, v144, v145
    v_cvt_pk_bf16_f32 v153, v146, v147
    v_cvt_pk_bf16_f32 v154, v148, v149
    v_cvt_pk_bf16_f32 v155, v150, v151
    s_add_u32 s19, s30, 0
    buffer_store_dwordx4 v[152:155], v2, s[12:15], s19 offen sc0 sc1
    v_accvgpr_read_b32 v156, a64
    v_accvgpr_read_b32 v157, a65
    v_accvgpr_read_b32 v158, a66
    v_accvgpr_read_b32 v159, a67
    v_accvgpr_read_b32 v160, a96
    v_accvgpr_read_b32 v161, a97
    v_accvgpr_read_b32 v162, a98
    v_accvgpr_read_b32 v163, a99
    v_cvt_pk_bf16_f32 v164, v156, v157
    v_cvt_pk_bf16_f32 v165, v158, v159
    v_cvt_pk_bf16_f32 v166, v160, v161
    v_cvt_pk_bf16_f32 v167, v162, v163
    s_add_u32 s19, s30, 1024
    buffer_store_dwordx4 v[164:167], v2, s[12:15], s19 offen sc0 sc1
    v_accvgpr_read_b32 v144, a4
    v_accvgpr_read_b32 v145, a5
    v_accvgpr_read_b32 v146, a6
    v_accvgpr_read_b32 v147, a7
    v_accvgpr_read_b32 v148, a36
    v_accvgpr_read_b32 v149, a37
    v_accvgpr_read_b32 v150, a38
    v_accvgpr_read_b32 v151, a39
    v_cvt_pk_bf16_f32 v152, v144, v145
    v_cvt_pk_bf16_f32 v153, v146, v147
    v_cvt_pk_bf16_f32 v154, v148, v149
    v_cvt_pk_bf16_f32 v155, v150, v151
    s_add_u32 s19, s30, 4096
    buffer_store_dwordx4 v[152:155], v2, s[12:15], s19 offen sc0 sc1
    v_accvgpr_read_b32 v156, a68
    v_accvgpr_read_b32 v157, a69
    v_accvgpr_read_b32 v158, a70
    v_accvgpr_read_b32 v159, a71
    v_accvgpr_read_b32 v160, a100
    v_accvgpr_read_b32 v161, a101
    v_accvgpr_read_b32 v162, a102
    v_accvgpr_read_b32 v163, a103
    v_cvt_pk_bf16_f32 v164, v156, v157
    v_cvt_pk_bf16_f32 v165, v158, v159
    v_cvt_pk_bf16_f32 v166, v160, v161
    v_cvt_pk_bf16_f32 v167, v162, v163
    s_add_u32 s19, s30, 5120
    buffer_store_dwordx4 v[164:167], v2, s[12:15], s19 offen sc0 sc1
    v_accvgpr_read_b32 v144, a8
    v_accvgpr_read_b32 v145, a9
    v_accvgpr_read_b32 v146, a10
    v_accvgpr_read_b32 v147, a11
    v_accvgpr_read_b32 v148, a40
    v_accvgpr_read_b32 v149, a41
    v_accvgpr_read_b32 v150, a42
    v_accvgpr_read_b32 v151, a43
    v_cvt_pk_bf16_f32 v152, v144, v145
    v_cvt_pk_bf16_f32 v153, v146, v147
    v_cvt_pk_bf16_f32 v154, v148, v149
    v_cvt_pk_bf16_f32 v155, v150, v151
    s_add_u32 s19, s30, 262144
    buffer_store_dwordx4 v[152:155], v2, s[12:15], s19 offen sc0 sc1
    v_accvgpr_read_b32 v156, a72
    v_accvgpr_read_b32 v157, a73
    v_accvgpr_read_b32 v158, a74
    v_accvgpr_read_b32 v159, a75
    v_accvgpr_read_b32 v160, a104
    v_accvgpr_read_b32 v161, a105
    v_accvgpr_read_b32 v162, a106
    v_accvgpr_read_b32 v163, a107
    v_cvt_pk_bf16_f32 v164, v156, v157
    v_cvt_pk_bf16_f32 v165, v158, v159
    v_cvt_pk_bf16_f32 v166, v160, v161
    v_cvt_pk_bf16_f32 v167, v162, v163
    s_add_u32 s19, s30, 263168
    buffer_store_dwordx4 v[164:167], v2, s[12:15], s19 offen sc0 sc1
    v_accvgpr_read_b32 v144, a12
    v_accvgpr_read_b32 v145, a13
    v_accvgpr_read_b32 v146, a14
    v_accvgpr_read_b32 v147, a15
    v_accvgpr_read_b32 v148, a44
    v_accvgpr_read_b32 v149, a45
    v_accvgpr_read_b32 v150, a46
    v_accvgpr_read_b32 v151, a47
    v_cvt_pk_bf16_f32 v152, v144, v145
    v_cvt_pk_bf16_f32 v153, v146, v147
    v_cvt_pk_bf16_f32 v154, v148, v149
    v_cvt_pk_bf16_f32 v155, v150, v151
    s_add_u32 s19, s30, 266240
    buffer_store_dwordx4 v[152:155], v2, s[12:15], s19 offen sc0 sc1
    v_accvgpr_read_b32 v156, a76
    v_accvgpr_read_b32 v157, a77
    v_accvgpr_read_b32 v158, a78
    v_accvgpr_read_b32 v159, a79
    v_accvgpr_read_b32 v160, a108
    v_accvgpr_read_b32 v161, a109
    v_accvgpr_read_b32 v162, a110
    v_accvgpr_read_b32 v163, a111
    v_cvt_pk_bf16_f32 v164, v156, v157
    v_cvt_pk_bf16_f32 v165, v158, v159
    v_cvt_pk_bf16_f32 v166, v160, v161
    v_cvt_pk_bf16_f32 v167, v162, v163
    s_add_u32 s19, s30, 267264
    buffer_store_dwordx4 v[164:167], v2, s[12:15], s19 offen sc0 sc1
    v_accvgpr_read_b32 v144, a16
    v_accvgpr_read_b32 v145, a17
    v_accvgpr_read_b32 v146, a18
    v_accvgpr_read_b32 v147, a19
    v_accvgpr_read_b32 v148, a48
    v_accvgpr_read_b32 v149, a49
    v_accvgpr_read_b32 v150, a50
    v_accvgpr_read_b32 v151, a51
    v_cvt_pk_bf16_f32 v152, v144, v145
    v_cvt_pk_bf16_f32 v153, v146, v147
    v_cvt_pk_bf16_f32 v154, v148, v149
    v_cvt_pk_bf16_f32 v155, v150, v151
    s_add_u32 s19, s30, 524288
    buffer_store_dwordx4 v[152:155], v2, s[12:15], s19 offen sc0 sc1
    v_accvgpr_read_b32 v156, a80
    v_accvgpr_read_b32 v157, a81
    v_accvgpr_read_b32 v158, a82
    v_accvgpr_read_b32 v159, a83
    v_accvgpr_read_b32 v160, a112
    v_accvgpr_read_b32 v161, a113
    v_accvgpr_read_b32 v162, a114
    v_accvgpr_read_b32 v163, a115
    v_cvt_pk_bf16_f32 v164, v156, v157
    v_cvt_pk_bf16_f32 v165, v158, v159
    v_cvt_pk_bf16_f32 v166, v160, v161
    v_cvt_pk_bf16_f32 v167, v162, v163
    s_add_u32 s19, s30, 525312
    buffer_store_dwordx4 v[164:167], v2, s[12:15], s19 offen sc0 sc1
    v_accvgpr_read_b32 v144, a20
    v_accvgpr_read_b32 v145, a21
    v_accvgpr_read_b32 v146, a22
    v_accvgpr_read_b32 v147, a23
    v_accvgpr_read_b32 v148, a52
    v_accvgpr_read_b32 v149, a53
    v_accvgpr_read_b32 v150, a54
    v_accvgpr_read_b32 v151, a55
    v_cvt_pk_bf16_f32 v152, v144, v145
    v_cvt_pk_bf16_f32 v153, v146, v147
    v_cvt_pk_bf16_f32 v154, v148, v149
    v_cvt_pk_bf16_f32 v155, v150, v151
    s_add_u32 s19, s30, 528384
    buffer_store_dwordx4 v[152:155], v2, s[12:15], s19 offen sc0 sc1
    v_accvgpr_read_b32 v156, a84
    v_accvgpr_read_b32 v157, a85
    v_accvgpr_read_b32 v158, a86
    v_accvgpr_read_b32 v159, a87
    v_accvgpr_read_b32 v160, a116
    v_accvgpr_read_b32 v161, a117
    v_accvgpr_read_b32 v162, a118
    v_accvgpr_read_b32 v163, a119
    v_cvt_pk_bf16_f32 v164, v156, v157
    v_cvt_pk_bf16_f32 v165, v158, v159
    v_cvt_pk_bf16_f32 v166, v160, v161
    v_cvt_pk_bf16_f32 v167, v162, v163
    s_add_u32 s19, s30, 529408
    buffer_store_dwordx4 v[164:167], v2, s[12:15], s19 offen sc0 sc1
    v_accvgpr_read_b32 v144, a24
    v_accvgpr_read_b32 v145, a25
    v_accvgpr_read_b32 v146, a26
    v_accvgpr_read_b32 v147, a27
    v_accvgpr_read_b32 v148, a56
    v_accvgpr_read_b32 v149, a57
    v_accvgpr_read_b32 v150, a58
    v_accvgpr_read_b32 v151, a59
    v_cvt_pk_bf16_f32 v152, v144, v145
    v_cvt_pk_bf16_f32 v153, v146, v147
    v_cvt_pk_bf16_f32 v154, v148, v149
    v_cvt_pk_bf16_f32 v155, v150, v151
    s_add_u32 s19, s30, 786432
    buffer_store_dwordx4 v[152:155], v2, s[12:15], s19 offen sc0 sc1
    v_accvgpr_read_b32 v156, a88
    v_accvgpr_read_b32 v157, a89
    v_accvgpr_read_b32 v158, a90
    v_accvgpr_read_b32 v159, a91
    v_accvgpr_read_b32 v160, a120
    v_accvgpr_read_b32 v161, a121
    v_accvgpr_read_b32 v162, a122
    v_accvgpr_read_b32 v163, a123
    v_cvt_pk_bf16_f32 v164, v156, v157
    v_cvt_pk_bf16_f32 v165, v158, v159
    v_cvt_pk_bf16_f32 v166, v160, v161
    v_cvt_pk_bf16_f32 v167, v162, v163
    s_add_u32 s19, s30, 787456
    buffer_store_dwordx4 v[164:167], v2, s[12:15], s19 offen sc0 sc1
    v_accvgpr_read_b32 v144, a28
    v_accvgpr_read_b32 v145, a29
    v_accvgpr_read_b32 v146, a30
    v_accvgpr_read_b32 v147, a31
    v_accvgpr_read_b32 v148, a60
    v_accvgpr_read_b32 v149, a61
    v_accvgpr_read_b32 v150, a62
    v_accvgpr_read_b32 v151, a63
    v_cvt_pk_bf16_f32 v152, v144, v145
    v_cvt_pk_bf16_f32 v153, v146, v147
    v_cvt_pk_bf16_f32 v154, v148, v149
    v_cvt_pk_bf16_f32 v155, v150, v151
    s_add_u32 s19, s30, 790528
    buffer_store_dwordx4 v[152:155], v2, s[12:15], s19 offen sc0 sc1
    v_accvgpr_read_b32 v156, a92
    v_accvgpr_read_b32 v157, a93
    v_accvgpr_read_b32 v158, a94
    v_accvgpr_read_b32 v159, a95
    v_accvgpr_read_b32 v160, a124
    v_accvgpr_read_b32 v161, a125
    v_accvgpr_read_b32 v162, a126
    v_accvgpr_read_b32 v163, a127
    v_cvt_pk_bf16_f32 v164, v156, v157
    v_cvt_pk_bf16_f32 v165, v158, v159
    v_cvt_pk_bf16_f32 v166, v160, v161
    v_cvt_pk_bf16_f32 v167, v162, v163
    s_add_u32 s19, s30, 791552
    buffer_store_dwordx4 v[164:167], v2, s[12:15], s19 offen sc0 sc1
    s_lshl_b32 s31, s17, 2
    s_add_u32 s31, s31, s18
    s_cmp_ge_u32 s31, 56
    s_cbranch_scc1 L_g1_next
    s_lshl_b32 s19, s31, 15
    s_add_u32 s24, s19, 0x1000000
    s_add_u32 s25, s24, 16384
    s_add_u32 s26, s19, 0x1200000
    s_add_u32 s27, s26, 16384
    v_add_u32 v5, 0, v2
    buffer_load_dwordx4 v[32:35], v5, s[12:15], s24 offen
    buffer_load_dwordx4 v[36:39], v5, s[12:15], s25 offen
    buffer_load_dwordx4 v[40:43], v5, s[12:15], s26 offen
    buffer_load_dwordx4 v[44:47], v5, s[12:15], s27 offen
    v_add_u32 v5, 1024, v2
    buffer_load_dwordx4 v[48:51], v5, s[12:15], s24 offen
    buffer_load_dwordx4 v[52:55], v5, s[12:15], s25 offen
    buffer_load_dwordx4 v[56:59], v5, s[12:15], s26 offen
    buffer_load_dwordx4 v[60:63], v5, s[12:15], s27 offen
    ds_read_b128 v[80:83], v3 offset:0
    ds_read_b128 v[84:87], v3 offset:16384
    ds_read_b128 v[88:91], v3 offset:32768
    ds_read_b128 v[92:95], v3 offset:49152
    ds_read_b128 v[96:99], v4 offset:0
    ds_read_b128 v[100:103], v4 offset:16384
    ds_read_b128 v[104:107], v4 offset:32768
    ds_read_b128 v[108:111], v4 offset:49152
    v_add_u32 v5, 2048, v2
    buffer_load_dwordx4 v[64:67], v5, s[12:15], s24 offen
    buffer_load_dwordx4 v[68:71], v5, s[12:15], s25 offen
    buffer_load_dwordx4 v[72:75], v5, s[12:15], s26 offen
    buffer_load_dwordx4 v[76:79], v5, s[12:15], s27 offen
    ds_read_b128 v[112:115], v3 offset:1024
    ds_read_b128 v[116:119], v3 offset:17408
    ds_read_b128 v[120:123], v3 offset:33792
    ds_read_b128 v[124:127], v3 offset:50176
    ds_read_b128 v[128:131], v4 offset:1024
    ds_read_b128 v[132:135], v4 offset:17408
    ds_read_b128 v[136:139], v4 offset:33792
    ds_read_b128 v[140:143], v4 offset:50176
    s_waitcnt vmcnt(8) lgkmcnt(8)
    v_mfma_f32_16x16x32_bf16 a[0:3], v[32:35], v[80:83], 0
    v_mfma_f32_16x16x32_bf16 a[4:7], v[32:35], v[84:87], 0
    v_mfma_f32_16x16x32_bf16 a[8:11], v[32:35], v[88:91], 0
    v_mfma_f32_16x16x32_bf16 a[12:15], v[32:35], v[92:95], 0
    v_mfma_f32_16x16x32_bf16 a[16:19], v[32:35], v[96:99], 0
    v_mfma_f32_16x16x32_bf16 a[20:23], v[32:35], v[100:103], 0
    v_mfma_f32_16x16x32_bf16 a[24:27], v[32:35], v[104:107], 0
    v_mfma_f32_16x16x32_bf16 a[28:31], v[32:35], v[108:111], 0
    v_mfma_f32_16x16x32_bf16 a[32:35], v[36:39], v[80:83], 0
    v_mfma_f32_16x16x32_bf16 a[36:39], v[36:39], v[84:87], 0
    v_mfma_f32_16x16x32_bf16 a[40:43], v[36:39], v[88:91], 0
    v_mfma_f32_16x16x32_bf16 a[44:47], v[36:39], v[92:95], 0
    v_mfma_f32_16x16x32_bf16 a[48:51], v[36:39], v[96:99], 0
    v_mfma_f32_16x16x32_bf16 a[52:55], v[36:39], v[100:103], 0
    v_mfma_f32_16x16x32_bf16 a[56:59], v[36:39], v[104:107], 0
    v_mfma_f32_16x16x32_bf16 a[60:63], v[36:39], v[108:111], 0
    v_mfma_f32_16x16x32_bf16 a[64:67], v[40:43], v[80:83], 0
    v_mfma_f32_16x16x32_bf16 a[68:71], v[40:43], v[84:87], 0
    v_mfma_f32_16x16x32_bf16 a[72:75], v[40:43], v[88:91], 0
    v_mfma_f32_16x16x32_bf16 a[76:79], v[40:43], v[92:95], 0
    v_mfma_f32_16x16x32_bf16 a[80:83], v[40:43], v[96:99], 0
    v_mfma_f32_16x16x32_bf16 a[84:87], v[40:43], v[100:103], 0
    v_mfma_f32_16x16x32_bf16 a[88:91], v[40:43], v[104:107], 0
    v_mfma_f32_16x16x32_bf16 a[92:95], v[40:43], v[108:111], 0
    v_mfma_f32_16x16x32_bf16 a[96:99], v[44:47], v[80:83], 0
    v_mfma_f32_16x16x32_bf16 a[100:103], v[44:47], v[84:87], 0
    v_mfma_f32_16x16x32_bf16 a[104:107], v[44:47], v[88:91], 0
    v_mfma_f32_16x16x32_bf16 a[108:111], v[44:47], v[92:95], 0
    v_mfma_f32_16x16x32_bf16 a[112:115], v[44:47], v[96:99], 0
    v_mfma_f32_16x16x32_bf16 a[116:119], v[44:47], v[100:103], 0
    v_mfma_f32_16x16x32_bf16 a[120:123], v[44:47], v[104:107], 0
    v_mfma_f32_16x16x32_bf16 a[124:127], v[44:47], v[108:111], 0
    v_add_u32 v5, 3072, v2
    buffer_load_dwordx4 v[32:35], v5, s[12:15], s24 offen
    buffer_load_dwordx4 v[36:39], v5, s[12:15], s25 offen
    buffer_load_dwordx4 v[40:43], v5, s[12:15], s26 offen
    buffer_load_dwordx4 v[44:47], v5, s[12:15], s27 offen
    ds_read_b128 v[80:83], v3 offset:2048
    ds_read_b128 v[84:87], v3 offset:18432
    ds_read_b128 v[88:91], v3 offset:34816
    ds_read_b128 v[92:95], v3 offset:51200
    ds_read_b128 v[96:99], v4 offset:2048
    ds_read_b128 v[100:103], v4 offset:18432
    ds_read_b128 v[104:107], v4 offset:34816
    ds_read_b128 v[108:111], v4 offset:51200
    s_waitcnt vmcnt(8) lgkmcnt(8)
    v_mfma_f32_16x16x32_bf16 a[0:3], v[48:51], v[112:115], a[0:3]
    v_mfma_f32_16x16x32_bf16 a[4:7], v[48:51], v[116:119], a[4:7]
    v_mfma_f32_16x16x32_bf16 a[8:11], v[48:51], v[120:123], a[8:11]
    v_mfma_f32_16x16x32_bf16 a[12:15], v[48:51], v[124:127], a[12:15]
    v_mfma_f32_16x16x32_bf16 a[16:19], v[48:51], v[128:131], a[16:19]
    v_mfma_f32_16x16x32_bf16 a[20:23], v[48:51], v[132:135], a[20:23]
    v_mfma_f32_16x16x32_bf16 a[24:27], v[48:51], v[136:139], a[24:27]
    v_mfma_f32_16x16x32_bf16 a[28:31], v[48:51], v[140:143], a[28:31]
    v_mfma_f32_16x16x32_bf16 a[32:35], v[52:55], v[112:115], a[32:35]
    v_mfma_f32_16x16x32_bf16 a[36:39], v[52:55], v[116:119], a[36:39]
    v_mfma_f32_16x16x32_bf16 a[40:43], v[52:55], v[120:123], a[40:43]
    v_mfma_f32_16x16x32_bf16 a[44:47], v[52:55], v[124:127], a[44:47]
    v_mfma_f32_16x16x32_bf16 a[48:51], v[52:55], v[128:131], a[48:51]
    v_mfma_f32_16x16x32_bf16 a[52:55], v[52:55], v[132:135], a[52:55]
    v_mfma_f32_16x16x32_bf16 a[56:59], v[52:55], v[136:139], a[56:59]
    v_mfma_f32_16x16x32_bf16 a[60:63], v[52:55], v[140:143], a[60:63]
    v_mfma_f32_16x16x32_bf16 a[64:67], v[56:59], v[112:115], a[64:67]
    v_mfma_f32_16x16x32_bf16 a[68:71], v[56:59], v[116:119], a[68:71]
    v_mfma_f32_16x16x32_bf16 a[72:75], v[56:59], v[120:123], a[72:75]
    v_mfma_f32_16x16x32_bf16 a[76:79], v[56:59], v[124:127], a[76:79]
    v_mfma_f32_16x16x32_bf16 a[80:83], v[56:59], v[128:131], a[80:83]
    v_mfma_f32_16x16x32_bf16 a[84:87], v[56:59], v[132:135], a[84:87]
    v_mfma_f32_16x16x32_bf16 a[88:91], v[56:59], v[136:139], a[88:91]
    v_mfma_f32_16x16x32_bf16 a[92:95], v[56:59], v[140:143], a[92:95]
    v_mfma_f32_16x16x32_bf16 a[96:99], v[60:63], v[112:115], a[96:99]
    v_mfma_f32_16x16x32_bf16 a[100:103], v[60:63], v[116:119], a[100:103]
    v_mfma_f32_16x16x32_bf16 a[104:107], v[60:63], v[120:123], a[104:107]
    v_mfma_f32_16x16x32_bf16 a[108:111], v[60:63], v[124:127], a[108:111]
    v_mfma_f32_16x16x32_bf16 a[112:115], v[60:63], v[128:131], a[112:115]
    v_mfma_f32_16x16x32_bf16 a[116:119], v[60:63], v[132:135], a[116:119]
    v_mfma_f32_16x16x32_bf16 a[120:123], v[60:63], v[136:139], a[120:123]
    v_mfma_f32_16x16x32_bf16 a[124:127], v[60:63], v[140:143], a[124:127]
    v_add_u32 v5, 4096, v2
    buffer_load_dwordx4 v[48:51], v5, s[12:15], s24 offen
    buffer_load_dwordx4 v[52:55], v5, s[12:15], s25 offen
    buffer_load_dwordx4 v[56:59], v5, s[12:15], s26 offen
    buffer_load_dwordx4 v[60:63], v5, s[12:15], s27 offen
    ds_read_b128 v[112:115], v3 offset:3072
    ds_read_b128 v[116:119], v3 offset:19456
    ds_read_b128 v[120:123], v3 offset:35840
    ds_read_b128 v[124:127], v3 offset:52224
    ds_read_b128 v[128:131], v4 offset:3072
    ds_read_b128 v[132:135], v4 offset:19456
    ds_read_b128 v[136:139], v4 offset:35840
    ds_read_b128 v[140:143], v4 offset:52224
    s_waitcnt vmcnt(8) lgkmcnt(8)
    v_mfma_f32_16x16x32_bf16 a[0:3], v[64:67], v[80:83], a[0:3]
    v_mfma_f32_16x16x32_bf16 a[4:7], v[64:67], v[84:87], a[4:7]
    v_mfma_f32_16x16x32_bf16 a[8:11], v[64:67], v[88:91], a[8:11]
    v_mfma_f32_16x16x32_bf16 a[12:15], v[64:67], v[92:95], a[12:15]
    v_mfma_f32_16x16x32_bf16 a[16:19], v[64:67], v[96:99], a[16:19]
    v_mfma_f32_16x16x32_bf16 a[20:23], v[64:67], v[100:103], a[20:23]
    v_mfma_f32_16x16x32_bf16 a[24:27], v[64:67], v[104:107], a[24:27]
    v_mfma_f32_16x16x32_bf16 a[28:31], v[64:67], v[108:111], a[28:31]
    v_mfma_f32_16x16x32_bf16 a[32:35], v[68:71], v[80:83], a[32:35]
    v_mfma_f32_16x16x32_bf16 a[36:39], v[68:71], v[84:87], a[36:39]
    v_mfma_f32_16x16x32_bf16 a[40:43], v[68:71], v[88:91], a[40:43]
    v_mfma_f32_16x16x32_bf16 a[44:47], v[68:71], v[92:95], a[44:47]
    v_mfma_f32_16x16x32_bf16 a[48:51], v[68:71], v[96:99], a[48:51]
    v_mfma_f32_16x16x32_bf16 a[52:55], v[68:71], v[100:103], a[52:55]
    v_mfma_f32_16x16x32_bf16 a[56:59], v[68:71], v[104:107], a[56:59]
    v_mfma_f32_16x16x32_bf16 a[60:63], v[68:71], v[108:111], a[60:63]
    v_mfma_f32_16x16x32_bf16 a[64:67], v[72:75], v[80:83], a[64:67]
    v_mfma_f32_16x16x32_bf16 a[68:71], v[72:75], v[84:87], a[68:71]
    v_mfma_f32_16x16x32_bf16 a[72:75], v[72:75], v[88:91], a[72:75]
    v_mfma_f32_16x16x32_bf16 a[76:79], v[72:75], v[92:95], a[76:79]
    v_mfma_f32_16x16x32_bf16 a[80:83], v[72:75], v[96:99], a[80:83]
    v_mfma_f32_16x16x32_bf16 a[84:87], v[72:75], v[100:103], a[84:87]
    v_mfma_f32_16x16x32_bf16 a[88:91], v[72:75], v[104:107], a[88:91]
    v_mfma_f32_16x16x32_bf16 a[92:95], v[72:75], v[108:111], a[92:95]
    v_mfma_f32_16x16x32_bf16 a[96:99], v[76:79], v[80:83], a[96:99]
    v_mfma_f32_16x16x32_bf16 a[100:103], v[76:79], v[84:87], a[100:103]
    v_mfma_f32_16x16x32_bf16 a[104:107], v[76:79], v[88:91], a[104:107]
    v_mfma_f32_16x16x32_bf16 a[108:111], v[76:79], v[92:95], a[108:111]
    v_mfma_f32_16x16x32_bf16 a[112:115], v[76:79], v[96:99], a[112:115]
    v_mfma_f32_16x16x32_bf16 a[116:119], v[76:79], v[100:103], a[116:119]
    v_mfma_f32_16x16x32_bf16 a[120:123], v[76:79], v[104:107], a[120:123]
    v_mfma_f32_16x16x32_bf16 a[124:127], v[76:79], v[108:111], a[124:127]
    v_add_u32 v5, 5120, v2
    buffer_load_dwordx4 v[64:67], v5, s[12:15], s24 offen
    buffer_load_dwordx4 v[68:71], v5, s[12:15], s25 offen
    buffer_load_dwordx4 v[72:75], v5, s[12:15], s26 offen
    buffer_load_dwordx4 v[76:79], v5, s[12:15], s27 offen
    ds_read_b128 v[80:83], v3 offset:4096
    ds_read_b128 v[84:87], v3 offset:20480
    ds_read_b128 v[88:91], v3 offset:36864
    ds_read_b128 v[92:95], v3 offset:53248
    ds_read_b128 v[96:99], v4 offset:4096
    ds_read_b128 v[100:103], v4 offset:20480
    ds_read_b128 v[104:107], v4 offset:36864
    ds_read_b128 v[108:111], v4 offset:53248
    s_waitcnt vmcnt(8) lgkmcnt(8)
    v_mfma_f32_16x16x32_bf16 a[0:3], v[32:35], v[112:115], a[0:3]
    v_mfma_f32_16x16x32_bf16 a[4:7], v[32:35], v[116:119], a[4:7]
    v_mfma_f32_16x16x32_bf16 a[8:11], v[32:35], v[120:123], a[8:11]
    v_mfma_f32_16x16x32_bf16 a[12:15], v[32:35], v[124:127], a[12:15]
    v_mfma_f32_16x16x32_bf16 a[16:19], v[32:35], v[128:131], a[16:19]
    v_mfma_f32_16x16x32_bf16 a[20:23], v[32:35], v[132:135], a[20:23]
    v_mfma_f32_16x16x32_bf16 a[24:27], v[32:35], v[136:139], a[24:27]
    v_mfma_f32_16x16x32_bf16 a[28:31], v[32:35], v[140:143], a[28:31]
    v_mfma_f32_16x16x32_bf16 a[32:35], v[36:39], v[112:115], a[32:35]
    v_mfma_f32_16x16x32_bf16 a[36:39], v[36:39], v[116:119], a[36:39]
    v_mfma_f32_16x16x32_bf16 a[40:43], v[36:39], v[120:123], a[40:43]
    v_mfma_f32_16x16x32_bf16 a[44:47], v[36:39], v[124:127], a[44:47]
    v_mfma_f32_16x16x32_bf16 a[48:51], v[36:39], v[128:131], a[48:51]
    v_mfma_f32_16x16x32_bf16 a[52:55], v[36:39], v[132:135], a[52:55]
    v_mfma_f32_16x16x32_bf16 a[56:59], v[36:39], v[136:139], a[56:59]
    v_mfma_f32_16x16x32_bf16 a[60:63], v[36:39], v[140:143], a[60:63]
    v_mfma_f32_16x16x32_bf16 a[64:67], v[40:43], v[112:115], a[64:67]
    v_mfma_f32_16x16x32_bf16 a[68:71], v[40:43], v[116:119], a[68:71]
    v_mfma_f32_16x16x32_bf16 a[72:75], v[40:43], v[120:123], a[72:75]
    v_mfma_f32_16x16x32_bf16 a[76:79], v[40:43], v[124:127], a[76:79]
    v_mfma_f32_16x16x32_bf16 a[80:83], v[40:43], v[128:131], a[80:83]
    v_mfma_f32_16x16x32_bf16 a[84:87], v[40:43], v[132:135], a[84:87]
    v_mfma_f32_16x16x32_bf16 a[88:91], v[40:43], v[136:139], a[88:91]
    v_mfma_f32_16x16x32_bf16 a[92:95], v[40:43], v[140:143], a[92:95]
    v_mfma_f32_16x16x32_bf16 a[96:99], v[44:47], v[112:115], a[96:99]
    v_mfma_f32_16x16x32_bf16 a[100:103], v[44:47], v[116:119], a[100:103]
    v_mfma_f32_16x16x32_bf16 a[104:107], v[44:47], v[120:123], a[104:107]
    v_mfma_f32_16x16x32_bf16 a[108:111], v[44:47], v[124:127], a[108:111]
    v_mfma_f32_16x16x32_bf16 a[112:115], v[44:47], v[128:131], a[112:115]
    v_mfma_f32_16x16x32_bf16 a[116:119], v[44:47], v[132:135], a[116:119]
    v_mfma_f32_16x16x32_bf16 a[120:123], v[44:47], v[136:139], a[120:123]
    v_mfma_f32_16x16x32_bf16 a[124:127], v[44:47], v[140:143], a[124:127]
    v_add_u32 v5, 6144, v2
    buffer_load_dwordx4 v[32:35], v5, s[12:15], s24 offen
    buffer_load_dwordx4 v[36:39], v5, s[12:15], s25 offen
    buffer_load_dwordx4 v[40:43], v5, s[12:15], s26 offen
    buffer_load_dwordx4 v[44:47], v5, s[12:15], s27 offen
    ds_read_b128 v[112:115], v3 offset:5120
    ds_read_b128 v[116:119], v3 offset:21504
    ds_read_b128 v[120:123], v3 offset:37888
    ds_read_b128 v[124:127], v3 offset:54272
    ds_read_b128 v[128:131], v4 offset:5120
    ds_read_b128 v[132:135], v4 offset:21504
    ds_read_b128 v[136:139], v4 offset:37888
    ds_read_b128 v[140:143], v4 offset:54272
    s_waitcnt vmcnt(8) lgkmcnt(8)
    v_mfma_f32_16x16x32_bf16 a[0:3], v[48:51], v[80:83], a[0:3]
    v_mfma_f32_16x16x32_bf16 a[4:7], v[48:51], v[84:87], a[4:7]
    v_mfma_f32_16x16x32_bf16 a[8:11], v[48:51], v[88:91], a[8:11]
    v_mfma_f32_16x16x32_bf16 a[12:15], v[48:51], v[92:95], a[12:15]
    v_mfma_f32_16x16x32_bf16 a[16:19], v[48:51], v[96:99], a[16:19]
    v_mfma_f32_16x16x32_bf16 a[20:23], v[48:51], v[100:103], a[20:23]
    v_mfma_f32_16x16x32_bf16 a[24:27], v[48:51], v[104:107], a[24:27]
    v_mfma_f32_16x16x32_bf16 a[28:31], v[48:51], v[108:111], a[28:31]
    v_mfma_f32_16x16x32_bf16 a[32:35], v[52:55], v[80:83], a[32:35]
    v_mfma_f32_16x16x32_bf16 a[36:39], v[52:55], v[84:87], a[36:39]
    v_mfma_f32_16x16x32_bf16 a[40:43], v[52:55], v[88:91], a[40:43]
    v_mfma_f32_16x16x32_bf16 a[44:47], v[52:55], v[92:95], a[44:47]
    v_mfma_f32_16x16x32_bf16 a[48:51], v[52:55], v[96:99], a[48:51]
    v_mfma_f32_16x16x32_bf16 a[52:55], v[52:55], v[100:103], a[52:55]
    v_mfma_f32_16x16x32_bf16 a[56:59], v[52:55], v[104:107], a[56:59]
    v_mfma_f32_16x16x32_bf16 a[60:63], v[52:55], v[108:111], a[60:63]
    v_mfma_f32_16x16x32_bf16 a[64:67], v[56:59], v[80:83], a[64:67]
    v_mfma_f32_16x16x32_bf16 a[68:71], v[56:59], v[84:87], a[68:71]
    v_mfma_f32_16x16x32_bf16 a[72:75], v[56:59], v[88:91], a[72:75]
    v_mfma_f32_16x16x32_bf16 a[76:79], v[56:59], v[92:95], a[76:79]
    v_mfma_f32_16x16x32_bf16 a[80:83], v[56:59], v[96:99], a[80:83]
    v_mfma_f32_16x16x32_bf16 a[84:87], v[56:59], v[100:103], a[84:87]
    v_mfma_f32_16x16x32_bf16 a[88:91], v[56:59], v[104:107], a[88:91]
    v_mfma_f32_16x16x32_bf16 a[92:95], v[56:59], v[108:111], a[92:95]
    v_mfma_f32_16x16x32_bf16 a[96:99], v[60:63], v[80:83], a[96:99]
    v_mfma_f32_16x16x32_bf16 a[100:103], v[60:63], v[84:87], a[100:103]
    v_mfma_f32_16x16x32_bf16 a[104:107], v[60:63], v[88:91], a[104:107]
    v_mfma_f32_16x16x32_bf16 a[108:111], v[60:63], v[92:95], a[108:111]
    v_mfma_f32_16x16x32_bf16 a[112:115], v[60:63], v[96:99], a[112:115]
    v_mfma_f32_16x16x32_bf16 a[116:119], v[60:63], v[100:103], a[116:119]
    v_mfma_f32_16x16x32_bf16 a[120:123], v[60:63], v[104:107], a[120:123]
    v_mfma_f32_16x16x32_bf16 a[124:127], v[60:63], v[108:111], a[124:127]
    v_add_u32 v5, 7168, v2
    buffer_load_dwordx4 v[48:51], v5, s[12:15], s24 offen
    buffer_load_dwordx4 v[52:55], v5, s[12:15], s25 offen
    buffer_load_dwordx4 v[56:59], v5, s[12:15], s26 offen
    buffer_load_dwordx4 v[60:63], v5, s[12:15], s27 offen
    ds_read_b128 v[80:83], v3 offset:6144
    ds_read_b128 v[84:87], v3 offset:22528
    ds_read_b128 v[88:91], v3 offset:38912
    ds_read_b128 v[92:95], v3 offset:55296
    ds_read_b128 v[96:99], v4 offset:6144
    ds_read_b128 v[100:103], v4 offset:22528
    ds_read_b128 v[104:107], v4 offset:38912
    ds_read_b128 v[108:111], v4 offset:55296
    s_waitcnt vmcnt(8) lgkmcnt(8)
    v_mfma_f32_16x16x32_bf16 a[0:3], v[64:67], v[112:115], a[0:3]
    v_mfma_f32_16x16x32_bf16 a[4:7], v[64:67], v[116:119], a[4:7]
    v_mfma_f32_16x16x32_bf16 a[8:11], v[64:67], v[120:123], a[8:11]
    v_mfma_f32_16x16x32_bf16 a[12:15], v[64:67], v[124:127], a[12:15]
    v_mfma_f32_16x16x32_bf16 a[16:19], v[64:67], v[128:131], a[16:19]
    v_mfma_f32_16x16x32_bf16 a[20:23], v[64:67], v[132:135], a[20:23]
    v_mfma_f32_16x16x32_bf16 a[24:27], v[64:67], v[136:139], a[24:27]
    v_mfma_f32_16x16x32_bf16 a[28:31], v[64:67], v[140:143], a[28:31]
    v_mfma_f32_16x16x32_bf16 a[32:35], v[68:71], v[112:115], a[32:35]
    v_mfma_f32_16x16x32_bf16 a[36:39], v[68:71], v[116:119], a[36:39]
    v_mfma_f32_16x16x32_bf16 a[40:43], v[68:71], v[120:123], a[40:43]
    v_mfma_f32_16x16x32_bf16 a[44:47], v[68:71], v[124:127], a[44:47]
    v_mfma_f32_16x16x32_bf16 a[48:51], v[68:71], v[128:131], a[48:51]
    v_mfma_f32_16x16x32_bf16 a[52:55], v[68:71], v[132:135], a[52:55]
    v_mfma_f32_16x16x32_bf16 a[56:59], v[68:71], v[136:139], a[56:59]
    v_mfma_f32_16x16x32_bf16 a[60:63], v[68:71], v[140:143], a[60:63]
    v_mfma_f32_16x16x32_bf16 a[64:67], v[72:75], v[112:115], a[64:67]
    v_mfma_f32_16x16x32_bf16 a[68:71], v[72:75], v[116:119], a[68:71]
    v_mfma_f32_16x16x32_bf16 a[72:75], v[72:75], v[120:123], a[72:75]
    v_mfma_f32_16x16x32_bf16 a[76:79], v[72:75], v[124:127], a[76:79]
    v_mfma_f32_16x16x32_bf16 a[80:83], v[72:75], v[128:131], a[80:83]
    v_mfma_f32_16x16x32_bf16 a[84:87], v[72:75], v[132:135], a[84:87]
    v_mfma_f32_16x16x32_bf16 a[88:91], v[72:75], v[136:139], a[88:91]
    v_mfma_f32_16x16x32_bf16 a[92:95], v[72:75], v[140:143], a[92:95]
    v_mfma_f32_16x16x32_bf16 a[96:99], v[76:79], v[112:115], a[96:99]
    v_mfma_f32_16x16x32_bf16 a[100:103], v[76:79], v[116:119], a[100:103]
    v_mfma_f32_16x16x32_bf16 a[104:107], v[76:79], v[120:123], a[104:107]
    v_mfma_f32_16x16x32_bf16 a[108:111], v[76:79], v[124:127], a[108:111]
    v_mfma_f32_16x16x32_bf16 a[112:115], v[76:79], v[128:131], a[112:115]
    v_mfma_f32_16x16x32_bf16 a[116:119], v[76:79], v[132:135], a[116:119]
    v_mfma_f32_16x16x32_bf16 a[120:123], v[76:79], v[136:139], a[120:123]
    v_mfma_f32_16x16x32_bf16 a[124:127], v[76:79], v[140:143], a[124:127]
    v_add_u32 v5, 8192, v2
    buffer_load_dwordx4 v[64:67], v5, s[12:15], s24 offen
    buffer_load_dwordx4 v[68:71], v5, s[12:15], s25 offen
    buffer_load_dwordx4 v[72:75], v5, s[12:15], s26 offen
    buffer_load_dwordx4 v[76:79], v5, s[12:15], s27 offen
    ds_read_b128 v[112:115], v3 offset:7168
    ds_read_b128 v[116:119], v3 offset:23552
    ds_read_b128 v[120:123], v3 offset:39936
    ds_read_b128 v[124:127], v3 offset:56320
    ds_read_b128 v[128:131], v4 offset:7168
    ds_read_b128 v[132:135], v4 offset:23552
    ds_read_b128 v[136:139], v4 offset:39936
    ds_read_b128 v[140:143], v4 offset:56320
    s_waitcnt vmcnt(8) lgkmcnt(8)
    v_mfma_f32_16x16x32_bf16 a[0:3], v[32:35], v[80:83], a[0:3]
    v_mfma_f32_16x16x32_bf16 a[4:7], v[32:35], v[84:87], a[4:7]
    v_mfma_f32_16x16x32_bf16 a[8:11], v[32:35], v[88:91], a[8:11]
    v_mfma_f32_16x16x32_bf16 a[12:15], v[32:35], v[92:95], a[12:15]
    v_mfma_f32_16x16x32_bf16 a[16:19], v[32:35], v[96:99], a[16:19]
    v_mfma_f32_16x16x32_bf16 a[20:23], v[32:35], v[100:103], a[20:23]
    v_mfma_f32_16x16x32_bf16 a[24:27], v[32:35], v[104:107], a[24:27]
    v_mfma_f32_16x16x32_bf16 a[28:31], v[32:35], v[108:111], a[28:31]
    v_mfma_f32_16x16x32_bf16 a[32:35], v[36:39], v[80:83], a[32:35]
    v_mfma_f32_16x16x32_bf16 a[36:39], v[36:39], v[84:87], a[36:39]
    v_mfma_f32_16x16x32_bf16 a[40:43], v[36:39], v[88:91], a[40:43]
    v_mfma_f32_16x16x32_bf16 a[44:47], v[36:39], v[92:95], a[44:47]
    v_mfma_f32_16x16x32_bf16 a[48:51], v[36:39], v[96:99], a[48:51]
    v_mfma_f32_16x16x32_bf16 a[52:55], v[36:39], v[100:103], a[52:55]
    v_mfma_f32_16x16x32_bf16 a[56:59], v[36:39], v[104:107], a[56:59]
    v_mfma_f32_16x16x32_bf16 a[60:63], v[36:39], v[108:111], a[60:63]
    v_mfma_f32_16x16x32_bf16 a[64:67], v[40:43], v[80:83], a[64:67]
    v_mfma_f32_16x16x32_bf16 a[68:71], v[40:43], v[84:87], a[68:71]
    v_mfma_f32_16x16x32_bf16 a[72:75], v[40:43], v[88:91], a[72:75]
    v_mfma_f32_16x16x32_bf16 a[76:79], v[40:43], v[92:95], a[76:79]
    v_mfma_f32_16x16x32_bf16 a[80:83], v[40:43], v[96:99], a[80:83]
    v_mfma_f32_16x16x32_bf16 a[84:87], v[40:43], v[100:103], a[84:87]
    v_mfma_f32_16x16x32_bf16 a[88:91], v[40:43], v[104:107], a[88:91]
    v_mfma_f32_16x16x32_bf16 a[92:95], v[40:43], v[108:111], a[92:95]
    v_mfma_f32_16x16x32_bf16 a[96:99], v[44:47], v[80:83], a[96:99]
    v_mfma_f32_16x16x32_bf16 a[100:103], v[44:47], v[84:87], a[100:103]
    v_mfma_f32_16x16x32_bf16 a[104:107], v[44:47], v[88:91], a[104:107]
    v_mfma_f32_16x16x32_bf16 a[108:111], v[44:47], v[92:95], a[108:111]
    v_mfma_f32_16x16x32_bf16 a[112:115], v[44:47], v[96:99], a[112:115]
    v_mfma_f32_16x16x32_bf16 a[116:119], v[44:47], v[100:103], a[116:119]
    v_mfma_f32_16x16x32_bf16 a[120:123], v[44:47], v[104:107], a[120:123]
    v_mfma_f32_16x16x32_bf16 a[124:127], v[44:47], v[108:111], a[124:127]
    v_add_u32 v5, 9216, v2
    buffer_load_dwordx4 v[32:35], v5, s[12:15], s24 offen
    buffer_load_dwordx4 v[36:39], v5, s[12:15], s25 offen
    buffer_load_dwordx4 v[40:43], v5, s[12:15], s26 offen
    buffer_load_dwordx4 v[44:47], v5, s[12:15], s27 offen
    ds_read_b128 v[80:83], v3 offset:8192
    ds_read_b128 v[84:87], v3 offset:24576
    ds_read_b128 v[88:91], v3 offset:40960
    ds_read_b128 v[92:95], v3 offset:57344
    ds_read_b128 v[96:99], v4 offset:8192
    ds_read_b128 v[100:103], v4 offset:24576
    ds_read_b128 v[104:107], v4 offset:40960
    ds_read_b128 v[108:111], v4 offset:57344
    s_waitcnt vmcnt(8) lgkmcnt(8)
    v_mfma_f32_16x16x32_bf16 a[0:3], v[48:51], v[112:115], a[0:3]
    v_mfma_f32_16x16x32_bf16 a[4:7], v[48:51], v[116:119], a[4:7]
    v_mfma_f32_16x16x32_bf16 a[8:11], v[48:51], v[120:123], a[8:11]
    v_mfma_f32_16x16x32_bf16 a[12:15], v[48:51], v[124:127], a[12:15]
    v_mfma_f32_16x16x32_bf16 a[16:19], v[48:51], v[128:131], a[16:19]
    v_mfma_f32_16x16x32_bf16 a[20:23], v[48:51], v[132:135], a[20:23]
    v_mfma_f32_16x16x32_bf16 a[24:27], v[48:51], v[136:139], a[24:27]
    v_mfma_f32_16x16x32_bf16 a[28:31], v[48:51], v[140:143], a[28:31]
    v_mfma_f32_16x16x32_bf16 a[32:35], v[52:55], v[112:115], a[32:35]
    v_mfma_f32_16x16x32_bf16 a[36:39], v[52:55], v[116:119], a[36:39]
    v_mfma_f32_16x16x32_bf16 a[40:43], v[52:55], v[120:123], a[40:43]
    v_mfma_f32_16x16x32_bf16 a[44:47], v[52:55], v[124:127], a[44:47]
    v_mfma_f32_16x16x32_bf16 a[48:51], v[52:55], v[128:131], a[48:51]
    v_mfma_f32_16x16x32_bf16 a[52:55], v[52:55], v[132:135], a[52:55]
    v_mfma_f32_16x16x32_bf16 a[56:59], v[52:55], v[136:139], a[56:59]
    v_mfma_f32_16x16x32_bf16 a[60:63], v[52:55], v[140:143], a[60:63]
    v_mfma_f32_16x16x32_bf16 a[64:67], v[56:59], v[112:115], a[64:67]
    v_mfma_f32_16x16x32_bf16 a[68:71], v[56:59], v[116:119], a[68:71]
    v_mfma_f32_16x16x32_bf16 a[72:75], v[56:59], v[120:123], a[72:75]
    v_mfma_f32_16x16x32_bf16 a[76:79], v[56:59], v[124:127], a[76:79]
    v_mfma_f32_16x16x32_bf16 a[80:83], v[56:59], v[128:131], a[80:83]
    v_mfma_f32_16x16x32_bf16 a[84:87], v[56:59], v[132:135], a[84:87]
    v_mfma_f32_16x16x32_bf16 a[88:91], v[56:59], v[136:139], a[88:91]
    v_mfma_f32_16x16x32_bf16 a[92:95], v[56:59], v[140:143], a[92:95]
    v_mfma_f32_16x16x32_bf16 a[96:99], v[60:63], v[112:115], a[96:99]
    v_mfma_f32_16x16x32_bf16 a[100:103], v[60:63], v[116:119], a[100:103]
    v_mfma_f32_16x16x32_bf16 a[104:107], v[60:63], v[120:123], a[104:107]
    v_mfma_f32_16x16x32_bf16 a[108:111], v[60:63], v[124:127], a[108:111]
    v_mfma_f32_16x16x32_bf16 a[112:115], v[60:63], v[128:131], a[112:115]
    v_mfma_f32_16x16x32_bf16 a[116:119], v[60:63], v[132:135], a[116:119]
    v_mfma_f32_16x16x32_bf16 a[120:123], v[60:63], v[136:139], a[120:123]
    v_mfma_f32_16x16x32_bf16 a[124:127], v[60:63], v[140:143], a[124:127]
    v_add_u32 v5, 10240, v2
    buffer_load_dwordx4 v[48:51], v5, s[12:15], s24 offen
    buffer_load_dwordx4 v[52:55], v5, s[12:15], s25 offen
    buffer_load_dwordx4 v[56:59], v5, s[12:15], s26 offen
    buffer_load_dwordx4 v[60:63], v5, s[12:15], s27 offen
    ds_read_b128 v[112:115], v3 offset:9216
    ds_read_b128 v[116:119], v3 offset:25600
    ds_read_b128 v[120:123], v3 offset:41984
    ds_read_b128 v[124:127], v3 offset:58368
    ds_read_b128 v[128:131], v4 offset:9216
    ds_read_b128 v[132:135], v4 offset:25600
    ds_read_b128 v[136:139], v4 offset:41984
    ds_read_b128 v[140:143], v4 offset:58368
    s_waitcnt vmcnt(8) lgkmcnt(8)
    v_mfma_f32_16x16x32_bf16 a[0:3], v[64:67], v[80:83], a[0:3]
    v_mfma_f32_16x16x32_bf16 a[4:7], v[64:67], v[84:87], a[4:7]
    v_mfma_f32_16x16x32_bf16 a[8:11], v[64:67], v[88:91], a[8:11]
    v_mfma_f32_16x16x32_bf16 a[12:15], v[64:67], v[92:95], a[12:15]
    v_mfma_f32_16x16x32_bf16 a[16:19], v[64:67], v[96:99], a[16:19]
    v_mfma_f32_16x16x32_bf16 a[20:23], v[64:67], v[100:103], a[20:23]
    v_mfma_f32_16x16x32_bf16 a[24:27], v[64:67], v[104:107], a[24:27]
    v_mfma_f32_16x16x32_bf16 a[28:31], v[64:67], v[108:111], a[28:31]
    v_mfma_f32_16x16x32_bf16 a[32:35], v[68:71], v[80:83], a[32:35]
    v_mfma_f32_16x16x32_bf16 a[36:39], v[68:71], v[84:87], a[36:39]
    v_mfma_f32_16x16x32_bf16 a[40:43], v[68:71], v[88:91], a[40:43]
    v_mfma_f32_16x16x32_bf16 a[44:47], v[68:71], v[92:95], a[44:47]
    v_mfma_f32_16x16x32_bf16 a[48:51], v[68:71], v[96:99], a[48:51]
    v_mfma_f32_16x16x32_bf16 a[52:55], v[68:71], v[100:103], a[52:55]
    v_mfma_f32_16x16x32_bf16 a[56:59], v[68:71], v[104:107], a[56:59]
    v_mfma_f32_16x16x32_bf16 a[60:63], v[68:71], v[108:111], a[60:63]
    v_mfma_f32_16x16x32_bf16 a[64:67], v[72:75], v[80:83], a[64:67]
    v_mfma_f32_16x16x32_bf16 a[68:71], v[72:75], v[84:87], a[68:71]
    v_mfma_f32_16x16x32_bf16 a[72:75], v[72:75], v[88:91], a[72:75]
    v_mfma_f32_16x16x32_bf16 a[76:79], v[72:75], v[92:95], a[76:79]
    v_mfma_f32_16x16x32_bf16 a[80:83], v[72:75], v[96:99], a[80:83]
    v_mfma_f32_16x16x32_bf16 a[84:87], v[72:75], v[100:103], a[84:87]
    v_mfma_f32_16x16x32_bf16 a[88:91], v[72:75], v[104:107], a[88:91]
    v_mfma_f32_16x16x32_bf16 a[92:95], v[72:75], v[108:111], a[92:95]
    v_mfma_f32_16x16x32_bf16 a[96:99], v[76:79], v[80:83], a[96:99]
    v_mfma_f32_16x16x32_bf16 a[100:103], v[76:79], v[84:87], a[100:103]
    v_mfma_f32_16x16x32_bf16 a[104:107], v[76:79], v[88:91], a[104:107]
    v_mfma_f32_16x16x32_bf16 a[108:111], v[76:79], v[92:95], a[108:111]
    v_mfma_f32_16x16x32_bf16 a[112:115], v[76:79], v[96:99], a[112:115]
    v_mfma_f32_16x16x32_bf16 a[116:119], v[76:79], v[100:103], a[116:119]
    v_mfma_f32_16x16x32_bf16 a[120:123], v[76:79], v[104:107], a[120:123]
    v_mfma_f32_16x16x32_bf16 a[124:127], v[76:79], v[108:111], a[124:127]
    v_add_u32 v5, 11264, v2
    buffer_load_dwordx4 v[64:67], v5, s[12:15], s24 offen
    buffer_load_dwordx4 v[68:71], v5, s[12:15], s25 offen
    buffer_load_dwordx4 v[72:75], v5, s[12:15], s26 offen
    buffer_load_dwordx4 v[76:79], v5, s[12:15], s27 offen
    ds_read_b128 v[80:83], v3 offset:10240
    ds_read_b128 v[84:87], v3 offset:26624
    ds_read_b128 v[88:91], v3 offset:43008
    ds_read_b128 v[92:95], v3 offset:59392
    ds_read_b128 v[96:99], v4 offset:10240
    ds_read_b128 v[100:103], v4 offset:26624
    ds_read_b128 v[104:107], v4 offset:43008
    ds_read_b128 v[108:111], v4 offset:59392
    s_waitcnt vmcnt(8) lgkmcnt(8)
    v_mfma_f32_16x16x32_bf16 a[0:3], v[32:35], v[112:115], a[0:3]
    v_mfma_f32_16x16x32_bf16 a[4:7], v[32:35], v[116:119], a[4:7]
    v_mfma_f32_16x16x32_bf16 a[8:11], v[32:35], v[120:123], a[8:11]
    v_mfma_f32_16x16x32_bf16 a[12:15], v[32:35], v[124:127], a[12:15]
    v_mfma_f32_16x16x32_bf16 a[16:19], v[32:35], v[128:131], a[16:19]
    v_mfma_f32_16x16x32_bf16 a[20:23], v[32:35], v[132:135], a[20:23]
    v_mfma_f32_16x16x32_bf16 a[24:27], v[32:35], v[136:139], a[24:27]
    v_mfma_f32_16x16x32_bf16 a[28:31], v[32:35], v[140:143], a[28:31]
    v_mfma_f32_16x16x32_bf16 a[32:35], v[36:39], v[112:115], a[32:35]
    v_mfma_f32_16x16x32_bf16 a[36:39], v[36:39], v[116:119], a[36:39]
    v_mfma_f32_16x16x32_bf16 a[40:43], v[36:39], v[120:123], a[40:43]
    v_mfma_f32_16x16x32_bf16 a[44:47], v[36:39], v[124:127], a[44:47]
    v_mfma_f32_16x16x32_bf16 a[48:51], v[36:39], v[128:131], a[48:51]
    v_mfma_f32_16x16x32_bf16 a[52:55], v[36:39], v[132:135], a[52:55]
    v_mfma_f32_16x16x32_bf16 a[56:59], v[36:39], v[136:139], a[56:59]
    v_mfma_f32_16x16x32_bf16 a[60:63], v[36:39], v[140:143], a[60:63]
    v_mfma_f32_16x16x32_bf16 a[64:67], v[40:43], v[112:115], a[64:67]
    v_mfma_f32_16x16x32_bf16 a[68:71], v[40:43], v[116:119], a[68:71]
    v_mfma_f32_16x16x32_bf16 a[72:75], v[40:43], v[120:123], a[72:75]
    v_mfma_f32_16x16x32_bf16 a[76:79], v[40:43], v[124:127], a[76:79]
    v_mfma_f32_16x16x32_bf16 a[80:83], v[40:43], v[128:131], a[80:83]
    v_mfma_f32_16x16x32_bf16 a[84:87], v[40:43], v[132:135], a[84:87]
    v_mfma_f32_16x16x32_bf16 a[88:91], v[40:43], v[136:139], a[88:91]
    v_mfma_f32_16x16x32_bf16 a[92:95], v[40:43], v[140:143], a[92:95]
    v_mfma_f32_16x16x32_bf16 a[96:99], v[44:47], v[112:115], a[96:99]
    v_mfma_f32_16x16x32_bf16 a[100:103], v[44:47], v[116:119], a[100:103]
    v_mfma_f32_16x16x32_bf16 a[104:107], v[44:47], v[120:123], a[104:107]
    v_mfma_f32_16x16x32_bf16 a[108:111], v[44:47], v[124:127], a[108:111]
    v_mfma_f32_16x16x32_bf16 a[112:115], v[44:47], v[128:131], a[112:115]
    v_mfma_f32_16x16x32_bf16 a[116:119], v[44:47], v[132:135], a[116:119]
    v_mfma_f32_16x16x32_bf16 a[120:123], v[44:47], v[136:139], a[120:123]
    v_mfma_f32_16x16x32_bf16 a[124:127], v[44:47], v[140:143], a[124:127]
    v_add_u32 v5, 12288, v2
    buffer_load_dwordx4 v[32:35], v5, s[12:15], s24 offen
    buffer_load_dwordx4 v[36:39], v5, s[12:15], s25 offen
    buffer_load_dwordx4 v[40:43], v5, s[12:15], s26 offen
    buffer_load_dwordx4 v[44:47], v5, s[12:15], s27 offen
    ds_read_b128 v[112:115], v3 offset:11264
    ds_read_b128 v[116:119], v3 offset:27648
    ds_read_b128 v[120:123], v3 offset:44032
    ds_read_b128 v[124:127], v3 offset:60416
    ds_read_b128 v[128:131], v4 offset:11264
    ds_read_b128 v[132:135], v4 offset:27648
    ds_read_b128 v[136:139], v4 offset:44032
    ds_read_b128 v[140:143], v4 offset:60416
    s_waitcnt vmcnt(8) lgkmcnt(8)
    v_mfma_f32_16x16x32_bf16 a[0:3], v[48:51], v[80:83], a[0:3]
    v_mfma_f32_16x16x32_bf16 a[4:7], v[48:51], v[84:87], a[4:7]
    v_mfma_f32_16x16x32_bf16 a[8:11], v[48:51], v[88:91], a[8:11]
    v_mfma_f32_16x16x32_bf16 a[12:15], v[48:51], v[92:95], a[12:15]
    v_mfma_f32_16x16x32_bf16 a[16:19], v[48:51], v[96:99], a[16:19]
    v_mfma_f32_16x16x32_bf16 a[20:23], v[48:51], v[100:103], a[20:23]
    v_mfma_f32_16x16x32_bf16 a[24:27], v[48:51], v[104:107], a[24:27]
    v_mfma_f32_16x16x32_bf16 a[28:31], v[48:51], v[108:111], a[28:31]
    v_mfma_f32_16x16x32_bf16 a[32:35], v[52:55], v[80:83], a[32:35]
    v_mfma_f32_16x16x32_bf16 a[36:39], v[52:55], v[84:87], a[36:39]
    v_mfma_f32_16x16x32_bf16 a[40:43], v[52:55], v[88:91], a[40:43]
    v_mfma_f32_16x16x32_bf16 a[44:47], v[52:55], v[92:95], a[44:47]
    v_mfma_f32_16x16x32_bf16 a[48:51], v[52:55], v[96:99], a[48:51]
    v_mfma_f32_16x16x32_bf16 a[52:55], v[52:55], v[100:103], a[52:55]
    v_mfma_f32_16x16x32_bf16 a[56:59], v[52:55], v[104:107], a[56:59]
    v_mfma_f32_16x16x32_bf16 a[60:63], v[52:55], v[108:111], a[60:63]
    v_mfma_f32_16x16x32_bf16 a[64:67], v[56:59], v[80:83], a[64:67]
    v_mfma_f32_16x16x32_bf16 a[68:71], v[56:59], v[84:87], a[68:71]
    v_mfma_f32_16x16x32_bf16 a[72:75], v[56:59], v[88:91], a[72:75]
    v_mfma_f32_16x16x32_bf16 a[76:79], v[56:59], v[92:95], a[76:79]
    v_mfma_f32_16x16x32_bf16 a[80:83], v[56:59], v[96:99], a[80:83]
    v_mfma_f32_16x16x32_bf16 a[84:87], v[56:59], v[100:103], a[84:87]
    v_mfma_f32_16x16x32_bf16 a[88:91], v[56:59], v[104:107], a[88:91]
    v_mfma_f32_16x16x32_bf16 a[92:95], v[56:59], v[108:111], a[92:95]
    v_mfma_f32_16x16x32_bf16 a[96:99], v[60:63], v[80:83], a[96:99]
    v_mfma_f32_16x16x32_bf16 a[100:103], v[60:63], v[84:87], a[100:103]
    v_mfma_f32_16x16x32_bf16 a[104:107], v[60:63], v[88:91], a[104:107]
    v_mfma_f32_16x16x32_bf16 a[108:111], v[60:63], v[92:95], a[108:111]
    v_mfma_f32_16x16x32_bf16 a[112:115], v[60:63], v[96:99], a[112:115]
    v_mfma_f32_16x16x32_bf16 a[116:119], v[60:63], v[100:103], a[116:119]
    v_mfma_f32_16x16x32_bf16 a[120:123], v[60:63], v[104:107], a[120:123]
    v_mfma_f32_16x16x32_bf16 a[124:127], v[60:63], v[108:111], a[124:127]
    v_add_u32 v5, 13312, v2
    buffer_load_dwordx4 v[48:51], v5, s[12:15], s24 offen
    buffer_load_dwordx4 v[52:55], v5, s[12:15], s25 offen
    buffer_load_dwordx4 v[56:59], v5, s[12:15], s26 offen
    buffer_load_dwordx4 v[60:63], v5, s[12:15], s27 offen
    ds_read_b128 v[80:83], v3 offset:12288
    ds_read_b128 v[84:87], v3 offset:28672
    ds_read_b128 v[88:91], v3 offset:45056
    ds_read_b128 v[92:95], v3 offset:61440
    ds_read_b128 v[96:99], v4 offset:12288
    ds_read_b128 v[100:103], v4 offset:28672
    ds_read_b128 v[104:107], v4 offset:45056
    ds_read_b128 v[108:111], v4 offset:61440
    s_waitcnt vmcnt(8) lgkmcnt(8)
    v_mfma_f32_16x16x32_bf16 a[0:3], v[64:67], v[112:115], a[0:3]
    v_mfma_f32_16x16x32_bf16 a[4:7], v[64:67], v[116:119], a[4:7]
    v_mfma_f32_16x16x32_bf16 a[8:11], v[64:67], v[120:123], a[8:11]
    v_mfma_f32_16x16x32_bf16 a[12:15], v[64:67], v[124:127], a[12:15]
    v_mfma_f32_16x16x32_bf16 a[16:19], v[64:67], v[128:131], a[16:19]
    v_mfma_f32_16x16x32_bf16 a[20:23], v[64:67], v[132:135], a[20:23]
    v_mfma_f32_16x16x32_bf16 a[24:27], v[64:67], v[136:139], a[24:27]
    v_mfma_f32_16x16x32_bf16 a[28:31], v[64:67], v[140:143], a[28:31]
    v_mfma_f32_16x16x32_bf16 a[32:35], v[68:71], v[112:115], a[32:35]
    v_mfma_f32_16x16x32_bf16 a[36:39], v[68:71], v[116:119], a[36:39]
    v_mfma_f32_16x16x32_bf16 a[40:43], v[68:71], v[120:123], a[40:43]
    v_mfma_f32_16x16x32_bf16 a[44:47], v[68:71], v[124:127], a[44:47]
    v_mfma_f32_16x16x32_bf16 a[48:51], v[68:71], v[128:131], a[48:51]
    v_mfma_f32_16x16x32_bf16 a[52:55], v[68:71], v[132:135], a[52:55]
    v_mfma_f32_16x16x32_bf16 a[56:59], v[68:71], v[136:139], a[56:59]
    v_mfma_f32_16x16x32_bf16 a[60:63], v[68:71], v[140:143], a[60:63]
    v_mfma_f32_16x16x32_bf16 a[64:67], v[72:75], v[112:115], a[64:67]
    v_mfma_f32_16x16x32_bf16 a[68:71], v[72:75], v[116:119], a[68:71]
    v_mfma_f32_16x16x32_bf16 a[72:75], v[72:75], v[120:123], a[72:75]
    v_mfma_f32_16x16x32_bf16 a[76:79], v[72:75], v[124:127], a[76:79]
    v_mfma_f32_16x16x32_bf16 a[80:83], v[72:75], v[128:131], a[80:83]
    v_mfma_f32_16x16x32_bf16 a[84:87], v[72:75], v[132:135], a[84:87]
    v_mfma_f32_16x16x32_bf16 a[88:91], v[72:75], v[136:139], a[88:91]
    v_mfma_f32_16x16x32_bf16 a[92:95], v[72:75], v[140:143], a[92:95]
    v_mfma_f32_16x16x32_bf16 a[96:99], v[76:79], v[112:115], a[96:99]
    v_mfma_f32_16x16x32_bf16 a[100:103], v[76:79], v[116:119], a[100:103]
    v_mfma_f32_16x16x32_bf16 a[104:107], v[76:79], v[120:123], a[104:107]
    v_mfma_f32_16x16x32_bf16 a[108:111], v[76:79], v[124:127], a[108:111]
    v_mfma_f32_16x16x32_bf16 a[112:115], v[76:79], v[128:131], a[112:115]
    v_mfma_f32_16x16x32_bf16 a[116:119], v[76:79], v[132:135], a[116:119]
    v_mfma_f32_16x16x32_bf16 a[120:123], v[76:79], v[136:139], a[120:123]
    v_mfma_f32_16x16x32_bf16 a[124:127], v[76:79], v[140:143], a[124:127]
    v_add_u32 v5, 14336, v2
    buffer_load_dwordx4 v[64:67], v5, s[12:15], s24 offen
    buffer_load_dwordx4 v[68:71], v5, s[12:15], s25 offen
    buffer_load_dwordx4 v[72:75], v5, s[12:15], s26 offen
    buffer_load_dwordx4 v[76:79], v5, s[12:15], s27 offen
    ds_read_b128 v[112:115], v3 offset:13312
    ds_read_b128 v[116:119], v3 offset:29696
    ds_read_b128 v[120:123], v3 offset:46080
    ds_read_b128 v[124:127], v3 offset:62464
    ds_read_b128 v[128:131], v4 offset:13312
    ds_read_b128 v[132:135], v4 offset:29696
    ds_read_b128 v[136:139], v4 offset:46080
    ds_read_b128 v[140:143], v4 offset:62464
    s_waitcnt vmcnt(8) lgkmcnt(8)
    v_mfma_f32_16x16x32_bf16 a[0:3], v[32:35], v[80:83], a[0:3]
    v_mfma_f32_16x16x32_bf16 a[4:7], v[32:35], v[84:87], a[4:7]
    v_mfma_f32_16x16x32_bf16 a[8:11], v[32:35], v[88:91], a[8:11]
    v_mfma_f32_16x16x32_bf16 a[12:15], v[32:35], v[92:95], a[12:15]
    v_mfma_f32_16x16x32_bf16 a[16:19], v[32:35], v[96:99], a[16:19]
    v_mfma_f32_16x16x32_bf16 a[20:23], v[32:35], v[100:103], a[20:23]
    v_mfma_f32_16x16x32_bf16 a[24:27], v[32:35], v[104:107], a[24:27]
    v_mfma_f32_16x16x32_bf16 a[28:31], v[32:35], v[108:111], a[28:31]
    v_mfma_f32_16x16x32_bf16 a[32:35], v[36:39], v[80:83], a[32:35]
    v_mfma_f32_16x16x32_bf16 a[36:39], v[36:39], v[84:87], a[36:39]
    v_mfma_f32_16x16x32_bf16 a[40:43], v[36:39], v[88:91], a[40:43]
    v_mfma_f32_16x16x32_bf16 a[44:47], v[36:39], v[92:95], a[44:47]
    v_mfma_f32_16x16x32_bf16 a[48:51], v[36:39], v[96:99], a[48:51]
    v_mfma_f32_16x16x32_bf16 a[52:55], v[36:39], v[100:103], a[52:55]
    v_mfma_f32_16x16x32_bf16 a[56:59], v[36:39], v[104:107], a[56:59]
    v_mfma_f32_16x16x32_bf16 a[60:63], v[36:39], v[108:111], a[60:63]
    v_mfma_f32_16x16x32_bf16 a[64:67], v[40:43], v[80:83], a[64:67]
    v_mfma_f32_16x16x32_bf16 a[68:71], v[40:43], v[84:87], a[68:71]
    v_mfma_f32_16x16x32_bf16 a[72:75], v[40:43], v[88:91], a[72:75]
    v_mfma_f32_16x16x32_bf16 a[76:79], v[40:43], v[92:95], a[76:79]
    v_mfma_f32_16x16x32_bf16 a[80:83], v[40:43], v[96:99], a[80:83]
    v_mfma_f32_16x16x32_bf16 a[84:87], v[40:43], v[100:103], a[84:87]
    v_mfma_f32_16x16x32_bf16 a[88:91], v[40:43], v[104:107], a[88:91]
    v_mfma_f32_16x16x32_bf16 a[92:95], v[40:43], v[108:111], a[92:95]
    v_mfma_f32_16x16x32_bf16 a[96:99], v[44:47], v[80:83], a[96:99]
    v_mfma_f32_16x16x32_bf16 a[100:103], v[44:47], v[84:87], a[100:103]
    v_mfma_f32_16x16x32_bf16 a[104:107], v[44:47], v[88:91], a[104:107]
    v_mfma_f32_16x16x32_bf16 a[108:111], v[44:47], v[92:95], a[108:111]
    v_mfma_f32_16x16x32_bf16 a[112:115], v[44:47], v[96:99], a[112:115]
    v_mfma_f32_16x16x32_bf16 a[116:119], v[44:47], v[100:103], a[116:119]
    v_mfma_f32_16x16x32_bf16 a[120:123], v[44:47], v[104:107], a[120:123]
    v_mfma_f32_16x16x32_bf16 a[124:127], v[44:47], v[108:111], a[124:127]
    v_add_u32 v5, 15360, v2
    buffer_load_dwordx4 v[32:35], v5, s[12:15], s24 offen
    buffer_load_dwordx4 v[36:39], v5, s[12:15], s25 offen
    buffer_load_dwordx4 v[40:43], v5, s[12:15], s26 offen
    buffer_load_dwordx4 v[44:47], v5, s[12:15], s27 offen
    ds_read_b128 v[80:83], v3 offset:14336
    ds_read_b128 v[84:87], v3 offset:30720
    ds_read_b128 v[88:91], v3 offset:47104
    ds_read_b128 v[92:95], v3 offset:63488
    ds_read_b128 v[96:99], v4 offset:14336
    ds_read_b128 v[100:103], v4 offset:30720
    ds_read_b128 v[104:107], v4 offset:47104
    ds_read_b128 v[108:111], v4 offset:63488
    s_waitcnt vmcnt(8) lgkmcnt(8)
    v_mfma_f32_16x16x32_bf16 a[0:3], v[48:51], v[112:115], a[0:3]
    v_mfma_f32_16x16x32_bf16 a[4:7], v[48:51], v[116:119], a[4:7]
    v_mfma_f32_16x16x32_bf16 a[8:11], v[48:51], v[120:123], a[8:11]
    v_mfma_f32_16x16x32_bf16 a[12:15], v[48:51], v[124:127], a[12:15]
    v_mfma_f32_16x16x32_bf16 a[16:19], v[48:51], v[128:131], a[16:19]
    v_mfma_f32_16x16x32_bf16 a[20:23], v[48:51], v[132:135], a[20:23]
    v_mfma_f32_16x16x32_bf16 a[24:27], v[48:51], v[136:139], a[24:27]
    v_mfma_f32_16x16x32_bf16 a[28:31], v[48:51], v[140:143], a[28:31]
    v_mfma_f32_16x16x32_bf16 a[32:35], v[52:55], v[112:115], a[32:35]
    v_mfma_f32_16x16x32_bf16 a[36:39], v[52:55], v[116:119], a[36:39]
    v_mfma_f32_16x16x32_bf16 a[40:43], v[52:55], v[120:123], a[40:43]
    v_mfma_f32_16x16x32_bf16 a[44:47], v[52:55], v[124:127], a[44:47]
    v_mfma_f32_16x16x32_bf16 a[48:51], v[52:55], v[128:131], a[48:51]
    v_mfma_f32_16x16x32_bf16 a[52:55], v[52:55], v[132:135], a[52:55]
    v_mfma_f32_16x16x32_bf16 a[56:59], v[52:55], v[136:139], a[56:59]
    v_mfma_f32_16x16x32_bf16 a[60:63], v[52:55], v[140:143], a[60:63]
    v_mfma_f32_16x16x32_bf16 a[64:67], v[56:59], v[112:115], a[64:67]
    v_mfma_f32_16x16x32_bf16 a[68:71], v[56:59], v[116:119], a[68:71]
    v_mfma_f32_16x16x32_bf16 a[72:75], v[56:59], v[120:123], a[72:75]
    v_mfma_f32_16x16x32_bf16 a[76:79], v[56:59], v[124:127], a[76:79]
    v_mfma_f32_16x16x32_bf16 a[80:83], v[56:59], v[128:131], a[80:83]
    v_mfma_f32_16x16x32_bf16 a[84:87], v[56:59], v[132:135], a[84:87]
    v_mfma_f32_16x16x32_bf16 a[88:91], v[56:59], v[136:139], a[88:91]
    v_mfma_f32_16x16x32_bf16 a[92:95], v[56:59], v[140:143], a[92:95]
    v_mfma_f32_16x16x32_bf16 a[96:99], v[60:63], v[112:115], a[96:99]
    v_mfma_f32_16x16x32_bf16 a[100:103], v[60:63], v[116:119], a[100:103]
    v_mfma_f32_16x16x32_bf16 a[104:107], v[60:63], v[120:123], a[104:107]
    v_mfma_f32_16x16x32_bf16 a[108:111], v[60:63], v[124:127], a[108:111]
    v_mfma_f32_16x16x32_bf16 a[112:115], v[60:63], v[128:131], a[112:115]
    v_mfma_f32_16x16x32_bf16 a[116:119], v[60:63], v[132:135], a[116:119]
    v_mfma_f32_16x16x32_bf16 a[120:123], v[60:63], v[136:139], a[120:123]
    v_mfma_f32_16x16x32_bf16 a[124:127], v[60:63], v[140:143], a[124:127]
    ds_read_b128 v[112:115], v3 offset:15360
    ds_read_b128 v[116:119], v3 offset:31744
    ds_read_b128 v[120:123], v3 offset:48128
    ds_read_b128 v[124:127], v3 offset:64512
    ds_read_b128 v[128:131], v4 offset:15360
    ds_read_b128 v[132:135], v4 offset:31744
    ds_read_b128 v[136:139], v4 offset:48128
    ds_read_b128 v[140:143], v4 offset:64512
    s_waitcnt vmcnt(4) lgkmcnt(8)
    v_mfma_f32_16x16x32_bf16 a[0:3], v[64:67], v[80:83], a[0:3]
    v_mfma_f32_16x16x32_bf16 a[4:7], v[64:67], v[84:87], a[4:7]
    v_mfma_f32_16x16x32_bf16 a[8:11], v[64:67], v[88:91], a[8:11]
    v_mfma_f32_16x16x32_bf16 a[12:15], v[64:67], v[92:95], a[12:15]
    v_mfma_f32_16x16x32_bf16 a[16:19], v[64:67], v[96:99], a[16:19]
    v_mfma_f32_16x16x32_bf16 a[20:23], v[64:67], v[100:103], a[20:23]
    v_mfma_f32_16x16x32_bf16 a[24:27], v[64:67], v[104:107], a[24:27]
    v_mfma_f32_16x16x32_bf16 a[28:31], v[64:67], v[108:111], a[28:31]
    v_mfma_f32_16x16x32_bf16 a[32:35], v[68:71], v[80:83], a[32:35]
    v_mfma_f32_16x16x32_bf16 a[36:39], v[68:71], v[84:87], a[36:39]
    v_mfma_f32_16x16x32_bf16 a[40:43], v[68:71], v[88:91], a[40:43]
    v_mfma_f32_16x16x32_bf16 a[44:47], v[68:71], v[92:95], a[44:47]
    v_mfma_f32_16x16x32_bf16 a[48:51], v[68:71], v[96:99], a[48:51]
    v_mfma_f32_16x16x32_bf16 a[52:55], v[68:71], v[100:103], a[52:55]
    v_mfma_f32_16x16x32_bf16 a[56:59], v[68:71], v[104:107], a[56:59]
    v_mfma_f32_16x16x32_bf16 a[60:63], v[68:71], v[108:111], a[60:63]
    v_mfma_f32_16x16x32_bf16 a[64:67], v[72:75], v[80:83], a[64:67]
    v_mfma_f32_16x16x32_bf16 a[68:71], v[72:75], v[84:87], a[68:71]
    v_mfma_f32_16x16x32_bf16 a[72:75], v[72:75], v[88:91], a[72:75]
    v_mfma_f32_16x16x32_bf16 a[76:79], v[72:75], v[92:95], a[76:79]
    v_mfma_f32_16x16x32_bf16 a[80:83], v[72:75], v[96:99], a[80:83]
    v_mfma_f32_16x16x32_bf16 a[84:87], v[72:75], v[100:103], a[84:87]
    v_mfma_f32_16x16x32_bf16 a[88:91], v[72:75], v[104:107], a[88:91]
    v_mfma_f32_16x16x32_bf16 a[92:95], v[72:75], v[108:111], a[92:95]
    v_mfma_f32_16x16x32_bf16 a[96:99], v[76:79], v[80:83], a[96:99]
    v_mfma_f32_16x16x32_bf16 a[100:103], v[76:79], v[84:87], a[100:103]
    v_mfma_f32_16x16x32_bf16 a[104:107], v[76:79], v[88:91], a[104:107]
    v_mfma_f32_16x16x32_bf16 a[108:111], v[76:79], v[92:95], a[108:111]
    v_mfma_f32_16x16x32_bf16 a[112:115], v[76:79], v[96:99], a[112:115]
    v_mfma_f32_16x16x32_bf16 a[116:119], v[76:79], v[100:103], a[116:119]
    v_mfma_f32_16x16x32_bf16 a[120:123], v[76:79], v[104:107], a[120:123]
    v_mfma_f32_16x16x32_bf16 a[124:127], v[76:79], v[108:111], a[124:127]
    s_waitcnt vmcnt(0) lgkmcnt(0)
    v_mfma_f32_16x16x32_bf16 a[0:3], v[32:35], v[112:115], a[0:3]
    v_mfma_f32_16x16x32_bf16 a[4:7], v[32:35], v[116:119], a[4:7]
    v_mfma_f32_16x16x32_bf16 a[8:11], v[32:35], v[120:123], a[8:11]
    v_mfma_f32_16x16x32_bf16 a[12:15], v[32:35], v[124:127], a[12:15]
    v_mfma_f32_16x16x32_bf16 a[16:19], v[32:35], v[128:131], a[16:19]
    v_mfma_f32_16x16x32_bf16 a[20:23], v[32:35], v[132:135], a[20:23]
    v_mfma_f32_16x16x32_bf16 a[24:27], v[32:35], v[136:139], a[24:27]
    v_mfma_f32_16x16x32_bf16 a[28:31], v[32:35], v[140:143], a[28:31]
    v_mfma_f32_16x16x32_bf16 a[32:35], v[36:39], v[112:115], a[32:35]
    v_mfma_f32_16x16x32_bf16 a[36:39], v[36:39], v[116:119], a[36:39]
    v_mfma_f32_16x16x32_bf16 a[40:43], v[36:39], v[120:123], a[40:43]
    v_mfma_f32_16x16x32_bf16 a[44:47], v[36:39], v[124:127], a[44:47]
    v_mfma_f32_16x16x32_bf16 a[48:51], v[36:39], v[128:131], a[48:51]
    v_mfma_f32_16x16x32_bf16 a[52:55], v[36:39], v[132:135], a[52:55]
    v_mfma_f32_16x16x32_bf16 a[56:59], v[36:39], v[136:139], a[56:59]
    v_mfma_f32_16x16x32_bf16 a[60:63], v[36:39], v[140:143], a[60:63]
    v_mfma_f32_16x16x32_bf16 a[64:67], v[40:43], v[112:115], a[64:67]
    v_mfma_f32_16x16x32_bf16 a[68:71], v[40:43], v[116:119], a[68:71]
    v_mfma_f32_16x16x32_bf16 a[72:75], v[40:43], v[120:123], a[72:75]
    v_mfma_f32_16x16x32_bf16 a[76:79], v[40:43], v[124:127], a[76:79]
    v_mfma_f32_16x16x32_bf16 a[80:83], v[40:43], v[128:131], a[80:83]
    v_mfma_f32_16x16x32_bf16 a[84:87], v[40:43], v[132:135], a[84:87]
    v_mfma_f32_16x16x32_bf16 a[88:91], v[40:43], v[136:139], a[88:91]
    v_mfma_f32_16x16x32_bf16 a[92:95], v[40:43], v[140:143], a[92:95]
    v_mfma_f32_16x16x32_bf16 a[96:99], v[44:47], v[112:115], a[96:99]
    v_mfma_f32_16x16x32_bf16 a[100:103], v[44:47], v[116:119], a[100:103]
    v_mfma_f32_16x16x32_bf16 a[104:107], v[44:47], v[120:123], a[104:107]
    v_mfma_f32_16x16x32_bf16 a[108:111], v[44:47], v[124:127], a[108:111]
    v_mfma_f32_16x16x32_bf16 a[112:115], v[44:47], v[128:131], a[112:115]
    v_mfma_f32_16x16x32_bf16 a[116:119], v[44:47], v[132:135], a[116:119]
    v_mfma_f32_16x16x32_bf16 a[120:123], v[44:47], v[136:139], a[120:123]
    v_mfma_f32_16x16x32_bf16 a[124:127], v[44:47], v[140:143], a[124:127]
    s_nop 9
    s_mul_i32 s30, s16, 448
    s_add_u32 s30, s30, s31
    s_lshl_b32 s30, s30, 10
    s_add_u32 s30, s30, 0x5000000
    s_mov_b32 s21, 0xbfb8aa3b
    v_accvgpr_read_b32 v144, a0
    v_accvgpr_read_b32 v152, a64
    v_accvgpr_read_b32 v145, a1
    v_accvgpr_read_b32 v153, a65
    v_accvgpr_read_b32 v146, a2
    v_accvgpr_read_b32 v154, a66
    v_accvgpr_read_b32 v147, a3
    v_accvgpr_read_b32 v155, a67
    v_accvgpr_read_b32 v148, a32
    v_accvgpr_read_b32 v156, a96
    v_accvgpr_read_b32 v149, a33
    v_accvgpr_read_b32 v157, a97
    v_accvgpr_read_b32 v150, a34
    v_accvgpr_read_b32 v158, a98
    v_accvgpr_read_b32 v151, a35
    v_accvgpr_read_b32 v159, a99
    v_cvt_pk_bf16_f32 v160, v144, v145
    v_cvt_pk_bf16_f32 v164, v152, v153
    v_cvt_pk_bf16_f32 v161, v146, v147
    v_cvt_pk_bf16_f32 v165, v154, v155
    v_cvt_pk_bf16_f32 v162, v148, v149
    v_cvt_pk_bf16_f32 v166, v156, v157
    v_cvt_pk_bf16_f32 v163, v150, v151
    v_cvt_pk_bf16_f32 v167, v158, v159
    v_lshlrev_b32 v144, 16, v160
    v_and_b32 v145, 0xffff0000, v160
    v_lshlrev_b32 v152, 16, v164
    v_and_b32 v153, 0xffff0000, v164
    v_lshlrev_b32 v146, 16, v161
    v_and_b32 v147, 0xffff0000, v161
    v_lshlrev_b32 v154, 16, v165
    v_and_b32 v155, 0xffff0000, v165
    v_lshlrev_b32 v148, 16, v162
    v_and_b32 v149, 0xffff0000, v162
    v_lshlrev_b32 v156, 16, v166
    v_and_b32 v157, 0xffff0000, v166
    v_lshlrev_b32 v150, 16, v163
    v_and_b32 v151, 0xffff0000, v163
    v_lshlrev_b32 v158, 16, v167
    v_and_b32 v159, 0xffff0000, v167
    v_mul_f32 v144, s21, v144
    v_mul_f32 v145, s21, v145
    v_mul_f32 v146, s21, v146
    v_mul_f32 v147, s21, v147
    v_mul_f32 v148, s21, v148
    v_mul_f32 v149, s21, v149
    v_mul_f32 v150, s21, v150
    v_mul_f32 v151, s21, v151
    v_exp_f32 v144, v144
    v_exp_f32 v145, v145
    v_exp_f32 v146, v146
    v_exp_f32 v147, v147
    v_exp_f32 v148, v148
    v_exp_f32 v149, v149
    v_exp_f32 v150, v150
    v_exp_f32 v151, v151
    v_add_f32 v144, 1.0, v144
    v_add_f32 v145, 1.0, v145
    v_add_f32 v146, 1.0, v146
    v_add_f32 v147, 1.0, v147
    v_add_f32 v148, 1.0, v148
    v_add_f32 v149, 1.0, v149
    v_add_f32 v150, 1.0, v150
    v_add_f32 v151, 1.0, v151
    v_rcp_f32 v144, v144
    v_rcp_f32 v145, v145
    v_rcp_f32 v146, v146
    v_rcp_f32 v147, v147
    v_rcp_f32 v148, v148
    v_rcp_f32 v149, v149
    v_rcp_f32 v150, v150
    v_rcp_f32 v151, v151
    s_nop 0
    v_cvt_pk_bf16_f32 v160, v144, v145
    v_cvt_pk_bf16_f32 v161, v146, v147
    v_cvt_pk_bf16_f32 v162, v148, v149
    v_cvt_pk_bf16_f32 v163, v150, v151
    v_lshlrev_b32 v144, 16, v160
    v_and_b32 v145, 0xffff0000, v160
    v_lshlrev_b32 v146, 16, v161
    v_and_b32 v147, 0xffff0000, v161
    v_lshlrev_b32 v148, 16, v162
    v_and_b32 v149, 0xffff0000, v162
    v_lshlrev_b32 v150, 16, v163
    v_and_b32 v151, 0xffff0000, v163
    v_mul_f32 v144, v144, v152
    v_mul_f32 v145, v145, v153
    v_mul_f32 v146, v146, v154
    v_mul_f32 v147, v147, v155
    v_mul_f32 v148, v148, v156
    v_mul_f32 v149, v149, v157
    v_mul_f32 v150, v150, v158
    v_mul_f32 v151, v151, v159
    v_cvt_pk_bf16_f32 v168, v144, v145
    v_cvt_pk_bf16_f32 v169, v146, v147
    v_cvt_pk_bf16_f32 v170, v148, v149
    v_cvt_pk_bf16_f32 v171, v150, v151
    s_add_u32 s19, s30, 0
    buffer_store_dwordx4 v[168:171], v2, s[12:15], s19 offen sc0 sc1
    v_accvgpr_read_b32 v144, a4
    v_accvgpr_read_b32 v152, a68
    v_accvgpr_read_b32 v145, a5
    v_accvgpr_read_b32 v153, a69
    v_accvgpr_read_b32 v146, a6
    v_accvgpr_read_b32 v154, a70
    v_accvgpr_read_b32 v147, a7
    v_accvgpr_read_b32 v155, a71
    v_accvgpr_read_b32 v148, a36
    v_accvgpr_read_b32 v156, a100
    v_accvgpr_read_b32 v149, a37
    v_accvgpr_read_b32 v157, a101
    v_accvgpr_read_b32 v150, a38
    v_accvgpr_read_b32 v158, a102
    v_accvgpr_read_b32 v151, a39
    v_accvgpr_read_b32 v159, a103
    v_cvt_pk_bf16_f32 v160, v144, v145
    v_cvt_pk_bf16_f32 v164, v152, v153
    v_cvt_pk_bf16_f32 v161, v146, v147
    v_cvt_pk_bf16_f32 v165, v154, v155
    v_cvt_pk_bf16_f32 v162, v148, v149
    v_cvt_pk_bf16_f32 v166, v156, v157
    v_cvt_pk_bf16_f32 v163, v150, v151
    v_cvt_pk_bf16_f32 v167, v158, v159
    v_lshlrev_b32 v144, 16, v160
    v_and_b32 v145, 0xffff0000, v160
    v_lshlrev_b32 v152, 16, v164
    v_and_b32 v153, 0xffff0000, v164
    v_lshlrev_b32 v146, 16, v161
    v_and_b32 v147, 0xffff0000, v161
    v_lshlrev_b32 v154, 16, v165
    v_and_b32 v155, 0xffff0000, v165
    v_lshlrev_b32 v148, 16, v162
    v_and_b32 v149, 0xffff0000, v162
    v_lshlrev_b32 v156, 16, v166
    v_and_b32 v157, 0xffff0000, v166
    v_lshlrev_b32 v150, 16, v163
    v_and_b32 v151, 0xffff0000, v163
    v_lshlrev_b32 v158, 16, v167
    v_and_b32 v159, 0xffff0000, v167
    v_mul_f32 v144, s21, v144
    v_mul_f32 v145, s21, v145
    v_mul_f32 v146, s21, v146
    v_mul_f32 v147, s21, v147
    v_mul_f32 v148, s21, v148
    v_mul_f32 v149, s21, v149
    v_mul_f32 v150, s21, v150
    v_mul_f32 v151, s21, v151
    v_exp_f32 v144, v144
    v_exp_f32 v145, v145
    v_exp_f32 v146, v146
    v_exp_f32 v147, v147
    v_exp_f32 v148, v148
    v_exp_f32 v149, v149
    v_exp_f32 v150, v150
    v_exp_f32 v151, v151
    v_add_f32 v144, 1.0, v144
    v_add_f32 v145, 1.0, v145
    v_add_f32 v146, 1.0, v146
    v_add_f32 v147, 1.0, v147
    v_add_f32 v148, 1.0, v148
    v_add_f32 v149, 1.0, v149
    v_add_f32 v150, 1.0, v150
    v_add_f32 v151, 1.0, v151
    v_rcp_f32 v144, v144
    v_rcp_f32 v145, v145
    v_rcp_f32 v146, v146
    v_rcp_f32 v147, v147
    v_rcp_f32 v148, v148
    v_rcp_f32 v149, v149
    v_rcp_f32 v150, v150
    v_rcp_f32 v151, v151
    s_nop 0
    v_cvt_pk_bf16_f32 v160, v144, v145
    v_cvt_pk_bf16_f32 v161, v146, v147
    v_cvt_pk_bf16_f32 v162, v148, v149
    v_cvt_pk_bf16_f32 v163, v150, v151
    v_lshlrev_b32 v144, 16, v160
    v_and_b32 v145, 0xffff0000, v160
    v_lshlrev_b32 v146, 16, v161
    v_and_b32 v147, 0xffff0000, v161
    v_lshlrev_b32 v148, 16, v162
    v_and_b32 v149, 0xffff0000, v162
    v_lshlrev_b32 v150, 16, v163
    v_and_b32 v151, 0xffff0000, v163
    v_mul_f32 v144, v144, v152
    v_mul_f32 v145, v145, v153
    v_mul_f32 v146, v146, v154
    v_mul_f32 v147, v147, v155
    v_mul_f32 v148, v148, v156
    v_mul_f32 v149, v149, v157
    v_mul_f32 v150, v150, v158
    v_mul_f32 v151, v151, v159
    v_cvt_pk_bf16_f32 v172, v144, v145
    v_cvt_pk_bf16_f32 v173, v146, v147
    v_cvt_pk_bf16_f32 v174, v148, v149
    v_cvt_pk_bf16_f32 v175, v150, v151
    s_add_u32 s19, s30, 57344
    buffer_store_dwordx4 v[172:175], v2, s[12:15], s19 offen sc0 sc1
    v_accvgpr_read_b32 v144, a8
    v_accvgpr_read_b32 v152, a72
    v_accvgpr_read_b32 v145, a9
    v_accvgpr_read_b32 v153, a73
    v_accvgpr_read_b32 v146, a10
    v_accvgpr_read_b32 v154, a74
    v_accvgpr_read_b32 v147, a11
    v_accvgpr_read_b32 v155, a75
    v_accvgpr_read_b32 v148, a40
    v_accvgpr_read_b32 v156, a104
    v_accvgpr_read_b32 v149, a41
    v_accvgpr_read_b32 v157, a105
    v_accvgpr_read_b32 v150, a42
    v_accvgpr_read_b32 v158, a106
    v_accvgpr_read_b32 v151, a43
    v_accvgpr_read_b32 v159, a107
    v_cvt_pk_bf16_f32 v160, v144, v145
    v_cvt_pk_bf16_f32 v164, v152, v153
    v_cvt_pk_bf16_f32 v161, v146, v147
    v_cvt_pk_bf16_f32 v165, v154, v155
    v_cvt_pk_bf16_f32 v162, v148, v149
    v_cvt_pk_bf16_f32 v166, v156, v157
    v_cvt_pk_bf16_f32 v163, v150, v151
    v_cvt_pk_bf16_f32 v167, v158, v159
    v_lshlrev_b32 v144, 16, v160
    v_and_b32 v145, 0xffff0000, v160
    v_lshlrev_b32 v152, 16, v164
    v_and_b32 v153, 0xffff0000, v164
    v_lshlrev_b32 v146, 16, v161
    v_and_b32 v147, 0xffff0000, v161
    v_lshlrev_b32 v154, 16, v165
    v_and_b32 v155, 0xffff0000, v165
    v_lshlrev_b32 v148, 16, v162
    v_and_b32 v149, 0xffff0000, v162
    v_lshlrev_b32 v156, 16, v166
    v_and_b32 v157, 0xffff0000, v166
    v_lshlrev_b32 v150, 16, v163
    v_and_b32 v151, 0xffff0000, v163
    v_lshlrev_b32 v158, 16, v167
    v_and_b32 v159, 0xffff0000, v167
    v_mul_f32 v144, s21, v144
    v_mul_f32 v145, s21, v145
    v_mul_f32 v146, s21, v146
    v_mul_f32 v147, s21, v147
    v_mul_f32 v148, s21, v148
    v_mul_f32 v149, s21, v149
    v_mul_f32 v150, s21, v150
    v_mul_f32 v151, s21, v151
    v_exp_f32 v144, v144
    v_exp_f32 v145, v145
    v_exp_f32 v146, v146
    v_exp_f32 v147, v147
    v_exp_f32 v148, v148
    v_exp_f32 v149, v149
    v_exp_f32 v150, v150
    v_exp_f32 v151, v151
    v_add_f32 v144, 1.0, v144
    v_add_f32 v145, 1.0, v145
    v_add_f32 v146, 1.0, v146
    v_add_f32 v147, 1.0, v147
    v_add_f32 v148, 1.0, v148
    v_add_f32 v149, 1.0, v149
    v_add_f32 v150, 1.0, v150
    v_add_f32 v151, 1.0, v151
    v_rcp_f32 v144, v144
    v_rcp_f32 v145, v145
    v_rcp_f32 v146, v146
    v_rcp_f32 v147, v147
    v_rcp_f32 v148, v148
    v_rcp_f32 v149, v149
    v_rcp_f32 v150, v150
    v_rcp_f32 v151, v151
    s_nop 0
    v_cvt_pk_bf16_f32 v160, v144, v145
    v_cvt_pk_bf16_f32 v161, v146, v147
    v_cvt_pk_bf16_f32 v162, v148, v149
    v_cvt_pk_bf16_f32 v163, v150, v151
    v_lshlrev_b32 v144, 16, v160
    v_and_b32 v145, 0xffff0000, v160
    v_lshlrev_b32 v146, 16, v161
    v_and_b32 v147, 0xffff0000, v161
    v_lshlrev_b32 v148, 16, v162
    v_and_b32 v149, 0xffff0000, v162
    v_lshlrev_b32 v150, 16, v163
    v_and_b32 v151, 0xffff0000, v163
    v_mul_f32 v144, v144, v152
    v_mul_f32 v145, v145, v153
    v_mul_f32 v146, v146, v154
    v_mul_f32 v147, v147, v155
    v_mul_f32 v148, v148, v156
    v_mul_f32 v149, v149, v157
    v_mul_f32 v150, v150, v158
    v_mul_f32 v151, v151, v159
    v_cvt_pk_bf16_f32 v168, v144, v145
    v_cvt_pk_bf16_f32 v169, v146, v147
    v_cvt_pk_bf16_f32 v170, v148, v149
    v_cvt_pk_bf16_f32 v171, v150, v151
    s_add_u32 s19, s30, 114688
    buffer_store_dwordx4 v[168:171], v2, s[12:15], s19 offen sc0 sc1
    v_accvgpr_read_b32 v144, a12
    v_accvgpr_read_b32 v152, a76
    v_accvgpr_read_b32 v145, a13
    v_accvgpr_read_b32 v153, a77
    v_accvgpr_read_b32 v146, a14
    v_accvgpr_read_b32 v154, a78
    v_accvgpr_read_b32 v147, a15
    v_accvgpr_read_b32 v155, a79
    v_accvgpr_read_b32 v148, a44
    v_accvgpr_read_b32 v156, a108
    v_accvgpr_read_b32 v149, a45
    v_accvgpr_read_b32 v157, a109
    v_accvgpr_read_b32 v150, a46
    v_accvgpr_read_b32 v158, a110
    v_accvgpr_read_b32 v151, a47
    v_accvgpr_read_b32 v159, a111
    v_cvt_pk_bf16_f32 v160, v144, v145
    v_cvt_pk_bf16_f32 v164, v152, v153
    v_cvt_pk_bf16_f32 v161, v146, v147
    v_cvt_pk_bf16_f32 v165, v154, v155
    v_cvt_pk_bf16_f32 v162, v148, v149
    v_cvt_pk_bf16_f32 v166, v156, v157
    v_cvt_pk_bf16_f32 v163, v150, v151
    v_cvt_pk_bf16_f32 v167, v158, v159
    v_lshlrev_b32 v144, 16, v160
    v_and_b32 v145, 0xffff0000, v160
    v_lshlrev_b32 v152, 16, v164
    v_and_b32 v153, 0xffff0000, v164
    v_lshlrev_b32 v146, 16, v161
    v_and_b32 v147, 0xffff0000, v161
    v_lshlrev_b32 v154, 16, v165
    v_and_b32 v155, 0xffff0000, v165
    v_lshlrev_b32 v148, 16, v162
    v_and_b32 v149, 0xffff0000, v162
    v_lshlrev_b32 v156, 16, v166
    v_and_b32 v157, 0xffff0000, v166
    v_lshlrev_b32 v150, 16, v163
    v_and_b32 v151, 0xffff0000, v163
    v_lshlrev_b32 v158, 16, v167
    v_and_b32 v159, 0xffff0000, v167
    v_mul_f32 v144, s21, v144
    v_mul_f32 v145, s21, v145
    v_mul_f32 v146, s21, v146
    v_mul_f32 v147, s21, v147
    v_mul_f32 v148, s21, v148
    v_mul_f32 v149, s21, v149
    v_mul_f32 v150, s21, v150
    v_mul_f32 v151, s21, v151
    v_exp_f32 v144, v144
    v_exp_f32 v145, v145
    v_exp_f32 v146, v146
    v_exp_f32 v147, v147
    v_exp_f32 v148, v148
    v_exp_f32 v149, v149
    v_exp_f32 v150, v150
    v_exp_f32 v151, v151
    v_add_f32 v144, 1.0, v144
    v_add_f32 v145, 1.0, v145
    v_add_f32 v146, 1.0, v146
    v_add_f32 v147, 1.0, v147
    v_add_f32 v148, 1.0, v148
    v_add_f32 v149, 1.0, v149
    v_add_f32 v150, 1.0, v150
    v_add_f32 v151, 1.0, v151
    v_rcp_f32 v144, v144
    v_rcp_f32 v145, v145
    v_rcp_f32 v146, v146
    v_rcp_f32 v147, v147
    v_rcp_f32 v148, v148
    v_rcp_f32 v149, v149
    v_rcp_f32 v150, v150
    v_rcp_f32 v151, v151
    s_nop 0
    v_cvt_pk_bf16_f32 v160, v144, v145
    v_cvt_pk_bf16_f32 v161, v146, v147
    v_cvt_pk_bf16_f32 v162, v148, v149
    v_cvt_pk_bf16_f32 v163, v150, v151
    v_lshlrev_b32 v144, 16, v160
    v_and_b32 v145, 0xffff0000, v160
    v_lshlrev_b32 v146, 16, v161
    v_and_b32 v147, 0xffff0000, v161
    v_lshlrev_b32 v148, 16, v162
    v_and_b32 v149, 0xffff0000, v162
    v_lshlrev_b32 v150, 16, v163
    v_and_b32 v151, 0xffff0000, v163
    v_mul_f32 v144, v144, v152
    v_mul_f32 v145, v145, v153
    v_mul_f32 v146, v146, v154
    v_mul_f32 v147, v147, v155
    v_mul_f32 v148, v148, v156
    v_mul_f32 v149, v149, v157
    v_mul_f32 v150, v150, v158
    v_mul_f32 v151, v151, v159
    v_cvt_pk_bf16_f32 v172, v144, v145
    v_cvt_pk_bf16_f32 v173, v146, v147
    v_cvt_pk_bf16_f32 v174, v148, v149
    v_cvt_pk_bf16_f32 v175, v150, v151
    s_add_u32 s19, s30, 172032
    buffer_store_dwordx4 v[172:175], v2, s[12:15], s19 offen sc0 sc1
    v_accvgpr_read_b32 v144, a16
    v_accvgpr_read_b32 v152, a80
    v_accvgpr_read_b32 v145, a17
    v_accvgpr_read_b32 v153, a81
    v_accvgpr_read_b32 v146, a18
    v_accvgpr_read_b32 v154, a82
    v_accvgpr_read_b32 v147, a19
    v_accvgpr_read_b32 v155, a83
    v_accvgpr_read_b32 v148, a48
    v_accvgpr_read_b32 v156, a112
    v_accvgpr_read_b32 v149, a49
    v_accvgpr_read_b32 v157, a113
    v_accvgpr_read_b32 v150, a50
    v_accvgpr_read_b32 v158, a114
    v_accvgpr_read_b32 v151, a51
    v_accvgpr_read_b32 v159, a115
    v_cvt_pk_bf16_f32 v160, v144, v145
    v_cvt_pk_bf16_f32 v164, v152, v153
    v_cvt_pk_bf16_f32 v161, v146, v147
    v_cvt_pk_bf16_f32 v165, v154, v155
    v_cvt_pk_bf16_f32 v162, v148, v149
    v_cvt_pk_bf16_f32 v166, v156, v157
    v_cvt_pk_bf16_f32 v163, v150, v151
    v_cvt_pk_bf16_f32 v167, v158, v159
    v_lshlrev_b32 v144, 16, v160
    v_and_b32 v145, 0xffff0000, v160
    v_lshlrev_b32 v152, 16, v164
    v_and_b32 v153, 0xffff0000, v164
    v_lshlrev_b32 v146, 16, v161
    v_and_b32 v147, 0xffff0000, v161
    v_lshlrev_b32 v154, 16, v165
    v_and_b32 v155, 0xffff0000, v165
    v_lshlrev_b32 v148, 16, v162
    v_and_b32 v149, 0xffff0000, v162
    v_lshlrev_b32 v156, 16, v166
    v_and_b32 v157, 0xffff0000, v166
    v_lshlrev_b32 v150, 16, v163
    v_and_b32 v151, 0xffff0000, v163
    v_lshlrev_b32 v158, 16, v167
    v_and_b32 v159, 0xffff0000, v167
    v_mul_f32 v144, s21, v144
    v_mul_f32 v145, s21, v145
    v_mul_f32 v146, s21, v146
    v_mul_f32 v147, s21, v147
    v_mul_f32 v148, s21, v148
    v_mul_f32 v149, s21, v149
    v_mul_f32 v150, s21, v150
    v_mul_f32 v151, s21, v151
    v_exp_f32 v144, v144
    v_exp_f32 v145, v145
    v_exp_f32 v146, v146
    v_exp_f32 v147, v147
    v_exp_f32 v148, v148
    v_exp_f32 v149, v149
    v_exp_f32 v150, v150
    v_exp_f32 v151, v151
    v_add_f32 v144, 1.0, v144
    v_add_f32 v145, 1.0, v145
    v_add_f32 v146, 1.0, v146
    v_add_f32 v147, 1.0, v147
    v_add_f32 v148, 1.0, v148
    v_add_f32 v149, 1.0, v149
    v_add_f32 v150, 1.0, v150
    v_add_f32 v151, 1.0, v151
    v_rcp_f32 v144, v144
    v_rcp_f32 v145, v145
    v_rcp_f32 v146, v146
    v_rcp_f32 v147, v147
    v_rcp_f32 v148, v148
    v_rcp_f32 v149, v149
    v_rcp_f32 v150, v150
    v_rcp_f32 v151, v151
    s_nop 0
    v_cvt_pk_bf16_f32 v160, v144, v145
    v_cvt_pk_bf16_f32 v161, v146, v147
    v_cvt_pk_bf16_f32 v162, v148, v149
    v_cvt_pk_bf16_f32 v163, v150, v151
    v_lshlrev_b32 v144, 16, v160
    v_and_b32 v145, 0xffff0000, v160
    v_lshlrev_b32 v146, 16, v161
    v_and_b32 v147, 0xffff0000, v161
    v_lshlrev_b32 v148, 16, v162
    v_and_b32 v149, 0xffff0000, v162
    v_lshlrev_b32 v150, 16, v163
    v_and_b32 v151, 0xffff0000, v163
    v_mul_f32 v144, v144, v152
    v_mul_f32 v145, v145, v153
    v_mul_f32 v146, v146, v154
    v_mul_f32 v147, v147, v155
    v_mul_f32 v148, v148, v156
    v_mul_f32 v149, v149, v157
    v_mul_f32 v150, v150, v158
    v_mul_f32 v151, v151, v159
    v_cvt_pk_bf16_f32 v168, v144, v145
    v_cvt_pk_bf16_f32 v169, v146, v147
    v_cvt_pk_bf16_f32 v170, v148, v149
    v_cvt_pk_bf16_f32 v171, v150, v151
    s_add_u32 s19, s30, 229376
    buffer_store_dwordx4 v[168:171], v2, s[12:15], s19 offen sc0 sc1
    v_accvgpr_read_b32 v144, a20
    v_accvgpr_read_b32 v152, a84
    v_accvgpr_read_b32 v145, a21
    v_accvgpr_read_b32 v153, a85
    v_accvgpr_read_b32 v146, a22
    v_accvgpr_read_b32 v154, a86
    v_accvgpr_read_b32 v147, a23
    v_accvgpr_read_b32 v155, a87
    v_accvgpr_read_b32 v148, a52
    v_accvgpr_read_b32 v156, a116
    v_accvgpr_read_b32 v149, a53
    v_accvgpr_read_b32 v157, a117
    v_accvgpr_read_b32 v150, a54
    v_accvgpr_read_b32 v158, a118
    v_accvgpr_read_b32 v151, a55
    v_accvgpr_read_b32 v159, a119
    v_cvt_pk_bf16_f32 v160, v144, v145
    v_cvt_pk_bf16_f32 v164, v152, v153
    v_cvt_pk_bf16_f32 v161, v146, v147
    v_cvt_pk_bf16_f32 v165, v154, v155
    v_cvt_pk_bf16_f32 v162, v148, v149
    v_cvt_pk_bf16_f32 v166, v156, v157
    v_cvt_pk_bf16_f32 v163, v150, v151
    v_cvt_pk_bf16_f32 v167, v158, v159
    v_lshlrev_b32 v144, 16, v160
    v_and_b32 v145, 0xffff0000, v160
    v_lshlrev_b32 v152, 16, v164
    v_and_b32 v153, 0xffff0000, v164
    v_lshlrev_b32 v146, 16, v161
    v_and_b32 v147, 0xffff0000, v161
    v_lshlrev_b32 v154, 16, v165
    v_and_b32 v155, 0xffff0000, v165
    v_lshlrev_b32 v148, 16, v162
    v_and_b32 v149, 0xffff0000, v162
    v_lshlrev_b32 v156, 16, v166
    v_and_b32 v157, 0xffff0000, v166
    v_lshlrev_b32 v150, 16, v163
    v_and_b32 v151, 0xffff0000, v163
    v_lshlrev_b32 v158, 16, v167
    v_and_b32 v159, 0xffff0000, v167
    v_mul_f32 v144, s21, v144
    v_mul_f32 v145, s21, v145
    v_mul_f32 v146, s21, v146
    v_mul_f32 v147, s21, v147
    v_mul_f32 v148, s21, v148
    v_mul_f32 v149, s21, v149
    v_mul_f32 v150, s21, v150
    v_mul_f32 v151, s21, v151
    v_exp_f32 v144, v144
    v_exp_f32 v145, v145
    v_exp_f32 v146, v146
    v_exp_f32 v147, v147
    v_exp_f32 v148, v148
    v_exp_f32 v149, v149
    v_exp_f32 v150, v150
    v_exp_f32 v151, v151
    v_add_f32 v144, 1.0, v144
    v_add_f32 v145, 1.0, v145
    v_add_f32 v146, 1.0, v146
    v_add_f32 v147, 1.0, v147
    v_add_f32 v148, 1.0, v148
    v_add_f32 v149, 1.0, v149
    v_add_f32 v150, 1.0, v150
    v_add_f32 v151, 1.0, v151
    v_rcp_f32 v144, v144
    v_rcp_f32 v145, v145
    v_rcp_f32 v146, v146
    v_rcp_f32 v147, v147
    v_rcp_f32 v148, v148
    v_rcp_f32 v149, v149
    v_rcp_f32 v150, v150
    v_rcp_f32 v151, v151
    s_nop 0
    v_cvt_pk_bf16_f32 v160, v144, v145
    v_cvt_pk_bf16_f32 v161, v146, v147
    v_cvt_pk_bf16_f32 v162, v148, v149
    v_cvt_pk_bf16_f32 v163, v150, v151
    v_lshlrev_b32 v144, 16, v160
    v_and_b32 v145, 0xffff0000, v160
    v_lshlrev_b32 v146, 16, v161
    v_and_b32 v147, 0xffff0000, v161
    v_lshlrev_b32 v148, 16, v162
    v_and_b32 v149, 0xffff0000, v162
    v_lshlrev_b32 v150, 16, v163
    v_and_b32 v151, 0xffff0000, v163
    v_mul_f32 v144, v144, v152
    v_mul_f32 v145, v145, v153
    v_mul_f32 v146, v146, v154
    v_mul_f32 v147, v147, v155
    v_mul_f32 v148, v148, v156
    v_mul_f32 v149, v149, v157
    v_mul_f32 v150, v150, v158
    v_mul_f32 v151, v151, v159
    v_cvt_pk_bf16_f32 v172, v144, v145
    v_cvt_pk_bf16_f32 v173, v146, v147
    v_cvt_pk_bf16_f32 v174, v148, v149
    v_cvt_pk_bf16_f32 v175, v150, v151
    s_add_u32 s19, s30, 286720
    buffer_store_dwordx4 v[172:175], v2, s[12:15], s19 offen sc0 sc1
    v_accvgpr_read_b32 v144, a24
    v_accvgpr_read_b32 v152, a88
    v_accvgpr_read_b32 v145, a25
    v_accvgpr_read_b32 v153, a89
    v_accvgpr_read_b32 v146, a26
    v_accvgpr_read_b32 v154, a90
    v_accvgpr_read_b32 v147, a27
    v_accvgpr_read_b32 v155, a91
    v_accvgpr_read_b32 v148, a56
    v_accvgpr_read_b32 v156, a120
    v_accvgpr_read_b32 v149, a57
    v_accvgpr_read_b32 v157, a121
    v_accvgpr_read_b32 v150, a58
    v_accvgpr_read_b32 v158, a122
    v_accvgpr_read_b32 v151, a59
    v_accvgpr_read_b32 v159, a123
    v_cvt_pk_bf16_f32 v160, v144, v145
    v_cvt_pk_bf16_f32 v164, v152, v153
    v_cvt_pk_bf16_f32 v161, v146, v147
    v_cvt_pk_bf16_f32 v165, v154, v155
    v_cvt_pk_bf16_f32 v162, v148, v149
    v_cvt_pk_bf16_f32 v166, v156, v157
    v_cvt_pk_bf16_f32 v163, v150, v151
    v_cvt_pk_bf16_f32 v167, v158, v159
    v_lshlrev_b32 v144, 16, v160
    v_and_b32 v145, 0xffff0000, v160
    v_lshlrev_b32 v152, 16, v164
    v_and_b32 v153, 0xffff0000, v164
    v_lshlrev_b32 v146, 16, v161
    v_and_b32 v147, 0xffff0000, v161
    v_lshlrev_b32 v154, 16, v165
    v_and_b32 v155, 0xffff0000, v165
    v_lshlrev_b32 v148, 16, v162
    v_and_b32 v149, 0xffff0000, v162
    v_lshlrev_b32 v156, 16, v166
    v_and_b32 v157, 0xffff0000, v166
    v_lshlrev_b32 v150, 16, v163
    v_and_b32 v151, 0xffff0000, v163
    v_lshlrev_b32 v158, 16, v167
    v_and_b32 v159, 0xffff0000, v167
    v_mul_f32 v144, s21, v144
    v_mul_f32 v145, s21, v145
    v_mul_f32 v146, s21, v146
    v_mul_f32 v147, s21, v147
    v_mul_f32 v148, s21, v148
    v_mul_f32 v149, s21, v149
    v_mul_f32 v150, s21, v150
    v_mul_f32 v151, s21, v151
    v_exp_f32 v144, v144
    v_exp_f32 v145, v145
    v_exp_f32 v146, v146
    v_exp_f32 v147, v147
    v_exp_f32 v148, v148
    v_exp_f32 v149, v149
    v_exp_f32 v150, v150
    v_exp_f32 v151, v151
    v_add_f32 v144, 1.0, v144
    v_add_f32 v145, 1.0, v145
    v_add_f32 v146, 1.0, v146
    v_add_f32 v147, 1.0, v147
    v_add_f32 v148, 1.0, v148
    v_add_f32 v149, 1.0, v149
    v_add_f32 v150, 1.0, v150
    v_add_f32 v151, 1.0, v151
    v_rcp_f32 v144, v144
    v_rcp_f32 v145, v145
    v_rcp_f32 v146, v146
    v_rcp_f32 v147, v147
    v_rcp_f32 v148, v148
    v_rcp_f32 v149, v149
    v_rcp_f32 v150, v150
    v_rcp_f32 v151, v151
    s_nop 0
    v_cvt_pk_bf16_f32 v160, v144, v145
    v_cvt_pk_bf16_f32 v161, v146, v147
    v_cvt_pk_bf16_f32 v162, v148, v149
    v_cvt_pk_bf16_f32 v163, v150, v151
    v_lshlrev_b32 v144, 16, v160
    v_and_b32 v145, 0xffff0000, v160
    v_lshlrev_b32 v146, 16, v161
    v_and_b32 v147, 0xffff0000, v161
    v_lshlrev_b32 v148, 16, v162
    v_and_b32 v149, 0xffff0000, v162
    v_lshlrev_b32 v150, 16, v163
    v_and_b32 v151, 0xffff0000, v163
    v_mul_f32 v144, v144, v152
    v_mul_f32 v145, v145, v153
    v_mul_f32 v146, v146, v154
    v_mul_f32 v147, v147, v155
    v_mul_f32 v148, v148, v156
    v_mul_f32 v149, v149, v157
    v_mul_f32 v150, v150, v158
    v_mul_f32 v151, v151, v159
    v_cvt_pk_bf16_f32 v168, v144, v145
    v_cvt_pk_bf16_f32 v169, v146, v147
    v_cvt_pk_bf16_f32 v170, v148, v149
    v_cvt_pk_bf16_f32 v171, v150, v151
    s_add_u32 s19, s30, 344064
    buffer_store_dwordx4 v[168:171], v2, s[12:15], s19 offen sc0 sc1
    v_accvgpr_read_b32 v144, a28
    v_accvgpr_read_b32 v152, a92
    v_accvgpr_read_b32 v145, a29
    v_accvgpr_read_b32 v153, a93
    v_accvgpr_read_b32 v146, a30
    v_accvgpr_read_b32 v154, a94
    v_accvgpr_read_b32 v147, a31
    v_accvgpr_read_b32 v155, a95
    v_accvgpr_read_b32 v148, a60
    v_accvgpr_read_b32 v156, a124
    v_accvgpr_read_b32 v149, a61
    v_accvgpr_read_b32 v157, a125
    v_accvgpr_read_b32 v150, a62
    v_accvgpr_read_b32 v158, a126
    v_accvgpr_read_b32 v151, a63
    v_accvgpr_read_b32 v159, a127
    v_cvt_pk_bf16_f32 v160, v144, v145
    v_cvt_pk_bf16_f32 v164, v152, v153
    v_cvt_pk_bf16_f32 v161, v146, v147
    v_cvt_pk_bf16_f32 v165, v154, v155
    v_cvt_pk_bf16_f32 v162, v148, v149
    v_cvt_pk_bf16_f32 v166, v156, v157
    v_cvt_pk_bf16_f32 v163, v150, v151
    v_cvt_pk_bf16_f32 v167, v158, v159
    v_lshlrev_b32 v144, 16, v160
    v_and_b32 v145, 0xffff0000, v160
    v_lshlrev_b32 v152, 16, v164
    v_and_b32 v153, 0xffff0000, v164
    v_lshlrev_b32 v146, 16, v161
    v_and_b32 v147, 0xffff0000, v161
    v_lshlrev_b32 v154, 16, v165
    v_and_b32 v155, 0xffff0000, v165
    v_lshlrev_b32 v148, 16, v162
    v_and_b32 v149, 0xffff0000, v162
    v_lshlrev_b32 v156, 16, v166
    v_and_b32 v157, 0xffff0000, v166
    v_lshlrev_b32 v150, 16, v163
    v_and_b32 v151, 0xffff0000, v163
    v_lshlrev_b32 v158, 16, v167
    v_and_b32 v159, 0xffff0000, v167
    v_mul_f32 v144, s21, v144
    v_mul_f32 v145, s21, v145
    v_mul_f32 v146, s21, v146
    v_mul_f32 v147, s21, v147
    v_mul_f32 v148, s21, v148
    v_mul_f32 v149, s21, v149
    v_mul_f32 v150, s21, v150
    v_mul_f32 v151, s21, v151
    v_exp_f32 v144, v144
    v_exp_f32 v145, v145
    v_exp_f32 v146, v146
    v_exp_f32 v147, v147
    v_exp_f32 v148, v148
    v_exp_f32 v149, v149
    v_exp_f32 v150, v150
    v_exp_f32 v151, v151
    v_add_f32 v144, 1.0, v144
    v_add_f32 v145, 1.0, v145
    v_add_f32 v146, 1.0, v146
    v_add_f32 v147, 1.0, v147
    v_add_f32 v148, 1.0, v148
    v_add_f32 v149, 1.0, v149
    v_add_f32 v150, 1.0, v150
    v_add_f32 v151, 1.0, v151
    v_rcp_f32 v144, v144
    v_rcp_f32 v145, v145
    v_rcp_f32 v146, v146
    v_rcp_f32 v147, v147
    v_rcp_f32 v148, v148
    v_rcp_f32 v149, v149
    v_rcp_f32 v150, v150
    v_rcp_f32 v151, v151
    s_nop 0
    v_cvt_pk_bf16_f32 v160, v144, v145
    v_cvt_pk_bf16_f32 v161, v146, v147
    v_cvt_pk_bf16_f32 v162, v148, v149
    v_cvt_pk_bf16_f32 v163, v150, v151
    v_lshlrev_b32 v144, 16, v160
    v_and_b32 v145, 0xffff0000, v160
    v_lshlrev_b32 v146, 16, v161
    v_and_b32 v147, 0xffff0000, v161
    v_lshlrev_b32 v148, 16, v162
    v_and_b32 v149, 0xffff0000, v162
    v_lshlrev_b32 v150, 16, v163
    v_and_b32 v151, 0xffff0000, v163
    v_mul_f32 v144, v144, v152
    v_mul_f32 v145, v145, v153
    v_mul_f32 v146, v146, v154
    v_mul_f32 v147, v147, v155
    v_mul_f32 v148, v148, v156
    v_mul_f32 v149, v149, v157
    v_mul_f32 v150, v150, v158
    v_mul_f32 v151, v151, v159
    v_cvt_pk_bf16_f32 v172, v144, v145
    v_cvt_pk_bf16_f32 v173, v146, v147
    v_cvt_pk_bf16_f32 v174, v148, v149
    v_cvt_pk_bf16_f32 v175, v150, v151
    s_add_u32 s19, s30, 401408
    buffer_store_dwordx4 v[172:175], v2, s[12:15], s19 offen sc0 sc1
L_g1_next:
    s_waitcnt vmcnt(0)
    v_mov_b32 v8, 1
    v_mov_b32 v9, 0
    s_mov_b32 s19, 0x7906800
    s_mov_b64 exec, 1
    buffer_atomic_add v8, v9, s[12:15], s19 offen sc1
    s_mov_b64 exec, -1
    s_add_u32 s50, s50, 224
    s_cmp_ge_u32 s50, 256
    s_cbranch_scc1 L_w2
    s_barrier
    s_branch L_g1_task
L_w2:
    s_sub_u32 s50, s50, 224
    s_cmp_ge_u32 s50, 224
    s_cselect_b32 s19, 224, 0
    s_sub_u32 s50, s50, s19
    s_mov_b32 s55, 0
    s_mov_b32 s19, 0x7906800
    v_mov_b32 v9, 0
L_w2_poll:
    buffer_load_dword v8, v9, s[12:15], s19 offen sc0 sc1
    s_add_u32 s55, s55, 1
    s_waitcnt vmcnt(0)
    v_readfirstlane_b32 s20, v8
    s_cmp_eq_u32 s20, 1023
    s_cbranch_scc1 L_w2_ok
    s_sleep 16
    s_cmp_lt_u32 s55, 4000000
    s_cbranch_scc1 L_w2_poll
    s_branch L_ch_done
L_w2_ok:
    s_cmp_lt_u32 s50, 64
    s_cbranch_scc1 L_w4_start
    s_sub_u32 s51, s50, 64
L_w3_task:
    s_barrier
    s_lshr_b32 s16, s51, 3
    s_and_b32 s17, s51, 7
    s_mul_i32 s19, s18, 14
    s_lshl_b32 s20, s19, 15
    s_lshl_b32 s21, s17, 12
    s_add_u32 s20, s20, s21
    s_add_u32 s20, s20, 0x1400000
    s_add_u32 s21, s20, 1024
    s_add_u32 s22, s20, 2048
    s_add_u32 s23, s20, 3072
    s_mul_i32 s24, s16, 229376
    s_lshl_b32 s19, s19, 10
    s_add_u32 s24, s24, s19
    s_add_u32 s24, s24, 0x5000000
    s_add_u32 s25, s24, 57344
    s_add_u32 s26, s24, 114688
    s_add_u32 s27, s24, 172032
    v_add_u32 v4, 0, v2
    v_add_u32 v5, 0, v2
    buffer_load_dwordx4 v[16:19], v4, s[12:15], s20 offen offset:0
    buffer_load_dwordx4 v[20:23], v4, s[12:15], s21 offen offset:0
    buffer_load_dwordx4 v[24:27], v4, s[12:15], s22 offen offset:0
    buffer_load_dwordx4 v[28:31], v4, s[12:15], s23 offen offset:0
    buffer_load_dwordx4 v[32:35], v5, s[12:15], s24 offen offset:0
    buffer_load_dwordx4 v[36:39], v5, s[12:15], s25 offen offset:0
    buffer_load_dwordx4 v[40:43], v5, s[12:15], s26 offen offset:0
    buffer_load_dwordx4 v[44:47], v5, s[12:15], s27 offen offset:0
    v_add_u32 v4, 32768, v2
    v_add_u32 v5, 1024, v2
    buffer_load_dwordx4 v[48:51], v4, s[12:15], s20 offen offset:0
    buffer_load_dwordx4 v[52:55], v4, s[12:15], s21 offen offset:0
    buffer_load_dwordx4 v[56:59], v4, s[12:15], s22 offen offset:0
    buffer_load_dwordx4 v[60:63], v4, s[12:15], s23 offen offset:0
    buffer_load_dwordx4 v[64:67], v5, s[12:15], s24 offen offset:0
    buffer_load_dwordx4 v[68:71], v5, s[12:15], s25 offen offset:0
    buffer_load_dwordx4 v[72:75], v5, s[12:15], s26 offen offset:0
    buffer_load_dwordx4 v[76:79], v5, s[12:15], s27 offen offset:0
    v_add_u32 v4, 65536, v2
    v_add_u32 v5, 2048, v2
    buffer_load_dwordx4 v[80:83], v4, s[12:15], s20 offen offset:0
    buffer_load_dwordx4 v[84:87], v4, s[12:15], s21 offen offset:0
    buffer_load_dwordx4 v[88:91], v4, s[12:15], s22 offen offset:0
    buffer_load_dwordx4 v[92:95], v4, s[12:15], s23 offen offset:0
    buffer_load_dwordx4 v[96:99], v5, s[12:15], s24 offen offset:0
    buffer_load_dwordx4 v[100:103], v5, s[12:15], s25 offen offset:0
    buffer_load_dwordx4 v[104:107], v5, s[12:15], s26 offen offset:0
    buffer_load_dwordx4 v[108:111], v5, s[12:15], s27 offen offset:0
    v_add_u32 v4, 98304, v2
    v_add_u32 v5, 3072, v2
    buffer_load_dwordx4 v[112:115], v4, s[12:15], s20 offen offset:0
    buffer_load_dwordx4 v[116:119], v4, s[12:15], s21 offen offset:0
    buffer_load_dwordx4 v[120:123], v4, s[12:15], s22 offen offset:0
    buffer_load_dwordx4 v[124:127], v4, s[12:15], s23 offen offset:0
    buffer_load_dwordx4 v[128:131], v5, s[12:15], s24 offen offset:0
    buffer_load_dwordx4 v[132:135], v5, s[12:15], s25 offen offset:0
    buffer_load_dwordx4 v[136:139], v5, s[12:15], s26 offen offset:0
    buffer_load_dwordx4 v[140:143], v5, s[12:15], s27 offen offset:0
    s_waitcnt vmcnt(24)
    v_mfma_f32_16x16x32_bf16 a[0:3], v[16:19], v[32:35], 0
    v_mfma_f32_16x16x32_bf16 a[4:7], v[16:19], v[36:39], 0
    v_mfma_f32_16x16x32_bf16 a[8:11], v[16:19], v[40:43], 0
    v_mfma_f32_16x16x32_bf16 a[12:15], v[16:19], v[44:47], 0
    v_mfma_f32_16x16x32_bf16 a[16:19], v[20:23], v[32:35], 0
    v_mfma_f32_16x16x32_bf16 a[20:23], v[20:23], v[36:39], 0
    v_mfma_f32_16x16x32_bf16 a[24:27], v[20:23], v[40:43], 0
    v_mfma_f32_16x16x32_bf16 a[28:31], v[20:23], v[44:47], 0
    v_mfma_f32_16x16x32_bf16 a[32:35], v[24:27], v[32:35], 0
    v_mfma_f32_16x16x32_bf16 a[36:39], v[24:27], v[36:39], 0
    v_mfma_f32_16x16x32_bf16 a[40:43], v[24:27], v[40:43], 0
    v_mfma_f32_16x16x32_bf16 a[44:47], v[24:27], v[44:47], 0
    v_mfma_f32_16x16x32_bf16 a[48:51], v[28:31], v[32:35], 0
    v_mfma_f32_16x16x32_bf16 a[52:55], v[28:31], v[36:39], 0
    v_mfma_f32_16x16x32_bf16 a[56:59], v[28:31], v[40:43], 0
    v_mfma_f32_16x16x32_bf16 a[60:63], v[28:31], v[44:47], 0
    v_add_u32 v4, 131072, v2
    v_add_u32 v5, 4096, v2
    buffer_load_dwordx4 v[16:19], v4, s[12:15], s20 offen offset:0
    buffer_load_dwordx4 v[20:23], v4, s[12:15], s21 offen offset:0
    buffer_load_dwordx4 v[24:27], v4, s[12:15], s22 offen offset:0
    buffer_load_dwordx4 v[28:31], v4, s[12:15], s23 offen offset:0
    buffer_load_dwordx4 v[32:35], v5, s[12:15], s24 offen offset:0
    buffer_load_dwordx4 v[36:39], v5, s[12:15], s25 offen offset:0
    buffer_load_dwordx4 v[40:43], v5, s[12:15], s26 offen offset:0
    buffer_load_dwordx4 v[44:47], v5, s[12:15], s27 offen offset:0
    s_waitcnt vmcnt(24)
    v_mfma_f32_16x16x32_bf16 a[0:3], v[48:51], v[64:67], a[0:3]
    v_mfma_f32_16x16x32_bf16 a[4:7], v[48:51], v[68:71], a[4:7]
    v_mfma_f32_16x16x32_bf16 a[8:11], v[48:51], v[72:75], a[8:11]
    v_mfma_f32_16x16x32_bf16 a[12:15], v[48:51], v[76:79], a[12:15]
    v_mfma_f32_16x16x32_bf16 a[16:19], v[52:55], v[64:67], a[16:19]
    v_mfma_f32_16x16x32_bf16 a[20:23], v[52:55], v[68:71], a[20:23]
    v_mfma_f32_16x16x32_bf16 a[24:27], v[52:55], v[72:75], a[24:27]
    v_mfma_f32_16x16x32_bf16 a[28:31], v[52:55], v[76:79], a[28:31]
    v_mfma_f32_16x16x32_bf16 a[32:35], v[56:59], v[64:67], a[32:35]
    v_mfma_f32_16x16x32_bf16 a[36:39], v[56:59], v[68:71], a[36:39]
    v_mfma_f32_16x16x32_bf16 a[40:43], v[56:59], v[72:75], a[40:43]
    v_mfma_f32_16x16x32_bf16 a[44:47], v[56:59], v[76:79], a[44:47]
    v_mfma_f32_16x16x32_bf16 a[48:51], v[60:63], v[64:67], a[48:51]
    v_mfma_f32_16x16x32_bf16 a[52:55], v[60:63], v[68:71], a[52:55]
    v_mfma_f32_16x16x32_bf16 a[56:59], v[60:63], v[72:75], a[56:59]
    v_mfma_f32_16x16x32_bf16 a[60:63], v[60:63], v[76:79], a[60:63]
    v_add_u32 v4, 163840, v2
    v_add_u32 v5, 5120, v2
    buffer_load_dwordx4 v[48:51], v4, s[12:15], s20 offen offset:0
    buffer_load_dwordx4 v[52:55], v4, s[12:15], s21 offen offset:0
    buffer_load_dwordx4 v[56:59], v4, s[12:15], s22 offen offset:0
    buffer_load_dwordx4 v[60:63], v4, s[12:15], s23 offen offset:0
    buffer_load_dwordx4 v[64:67], v5, s[12:15], s24 offen offset:0
    buffer_load_dwordx4 v[68:71], v5, s[12:15], s25 offen offset:0
    buffer_load_dwordx4 v[72:75], v5, s[12:15], s26 offen offset:0
    buffer_load_dwordx4 v[76:79], v5, s[12:15], s27 offen offset:0
    s_waitcnt vmcnt(24)
    v_mfma_f32_16x16x32_bf16 a[0:3], v[80:83], v[96:99], a[0:3]
    v_mfma_f32_16x16x32_bf16 a[4:7], v[80:83], v[100:103], a[4:7]
    v_mfma_f32_16x16x32_bf16 a[8:11], v[80:83], v[104:107], a[8:11]
    v_mfma_f32_16x16x32_bf16 a[12:15], v[80:83], v[108:111], a[12:15]
    v_mfma_f32_16x16x32_bf16 a[16:19], v[84:87], v[96:99], a[16:19]
    v_mfma_f32_16x16x32_bf16 a[20:23], v[84:87], v[100:103], a[20:23]
    v_mfma_f32_16x16x32_bf16 a[24:27], v[84:87], v[104:107], a[24:27]
    v_mfma_f32_16x16x32_bf16 a[28:31], v[84:87], v[108:111], a[28:31]
    v_mfma_f32_16x16x32_bf16 a[32:35], v[88:91], v[96:99], a[32:35]
    v_mfma_f32_16x16x32_bf16 a[36:39], v[88:91], v[100:103], a[36:39]
    v_mfma_f32_16x16x32_bf16 a[40:43], v[88:91], v[104:107], a[40:43]
    v_mfma_f32_16x16x32_bf16 a[44:47], v[88:91], v[108:111], a[44:47]
    v_mfma_f32_16x16x32_bf16 a[48:51], v[92:95], v[96:99], a[48:51]
    v_mfma_f32_16x16x32_bf16 a[52:55], v[92:95], v[100:103], a[52:55]
    v_mfma_f32_16x16x32_bf16 a[56:59], v[92:95], v[104:107], a[56:59]
    v_mfma_f32_16x16x32_bf16 a[60:63], v[92:95], v[108:111], a[60:63]
    v_add_u32 v4, 196608, v2
    v_add_u32 v5, 6144, v2
    buffer_load_dwordx4 v[80:83], v4, s[12:15], s20 offen offset:0
    buffer_load_dwordx4 v[84:87], v4, s[12:15], s21 offen offset:0
    buffer_load_dwordx4 v[88:91], v4, s[12:15], s22 offen offset:0
    buffer_load_dwordx4 v[92:95], v4, s[12:15], s23 offen offset:0
    buffer_load_dwordx4 v[96:99], v5, s[12:15], s24 offen offset:0
    buffer_load_dwordx4 v[100:103], v5, s[12:15], s25 offen offset:0
    buffer_load_dwordx4 v[104:107], v5, s[12:15], s26 offen offset:0
    buffer_load_dwordx4 v[108:111], v5, s[12:15], s27 offen offset:0
    s_waitcnt vmcnt(24)
    v_mfma_f32_16x16x32_bf16 a[0:3], v[112:115], v[128:131], a[0:3]
    v_mfma_f32_16x16x32_bf16 a[4:7], v[112:115], v[132:135], a[4:7]
    v_mfma_f32_16x16x32_bf16 a[8:11], v[112:115], v[136:139], a[8:11]
    v_mfma_f32_16x16x32_bf16 a[12:15], v[112:115], v[140:143], a[12:15]
    v_mfma_f32_16x16x32_bf16 a[16:19], v[116:119], v[128:131], a[16:19]
    v_mfma_f32_16x16x32_bf16 a[20:23], v[116:119], v[132:135], a[20:23]
    v_mfma_f32_16x16x32_bf16 a[24:27], v[116:119], v[136:139], a[24:27]
    v_mfma_f32_16x16x32_bf16 a[28:31], v[116:119], v[140:143], a[28:31]
    v_mfma_f32_16x16x32_bf16 a[32:35], v[120:123], v[128:131], a[32:35]
    v_mfma_f32_16x16x32_bf16 a[36:39], v[120:123], v[132:135], a[36:39]
    v_mfma_f32_16x16x32_bf16 a[40:43], v[120:123], v[136:139], a[40:43]
    v_mfma_f32_16x16x32_bf16 a[44:47], v[120:123], v[140:143], a[44:47]
    v_mfma_f32_16x16x32_bf16 a[48:51], v[124:127], v[128:131], a[48:51]
    v_mfma_f32_16x16x32_bf16 a[52:55], v[124:127], v[132:135], a[52:55]
    v_mfma_f32_16x16x32_bf16 a[56:59], v[124:127], v[136:139], a[56:59]
    v_mfma_f32_16x16x32_bf16 a[60:63], v[124:127], v[140:143], a[60:63]
    v_add_u32 v4, 229376, v2
    v_add_u32 v5, 7168, v2
    buffer_load_dwordx4 v[112:115], v4, s[12:15], s20 offen offset:0
    buffer_load_dwordx4 v[116:119], v4, s[12:15], s21 offen offset:0
    buffer_load_dwordx4 v[120:123], v4, s[12:15], s22 offen offset:0
    buffer_load_dwordx4 v[124:127], v4, s[12:15], s23 offen offset:0
    buffer_load_dwordx4 v[128:131], v5, s[12:15], s24 offen offset:0
    buffer_load_dwordx4 v[132:135], v5, s[12:15], s25 offen offset:0
    buffer_load_dwordx4 v[136:139], v5, s[12:15], s26 offen offset:0
    buffer_load_dwordx4 v[140:143], v5, s[12:15], s27 offen offset:0
    s_waitcnt vmcnt(24)
    v_mfma_f32_16x16x32_bf16 a[0:3], v[16:19], v[32:35], a[0:3]
    v_mfma_f32_16x16x32_bf16 a[4:7], v[16:19], v[36:39], a[4:7]
    v_mfma_f32_16x16x32_bf16 a[8:11], v[16:19], v[40:43], a[8:11]
    v_mfma_f32_16x16x32_bf16 a[12:15], v[16:19], v[44:47], a[12:15]
    v_mfma_f32_16x16x32_bf16 a[16:19], v[20:23], v[32:35], a[16:19]
    v_mfma_f32_16x16x32_bf16 a[20:23], v[20:23], v[36:39], a[20:23]
    v_mfma_f32_16x16x32_bf16 a[24:27], v[20:23], v[40:43], a[24:27]
    v_mfma_f32_16x16x32_bf16 a[28:31], v[20:23], v[44:47], a[28:31]
    v_mfma_f32_16x16x32_bf16 a[32:35], v[24:27], v[32:35], a[32:35]
    v_mfma_f32_16x16x32_bf16 a[36:39], v[24:27], v[36:39], a[36:39]
    v_mfma_f32_16x16x32_bf16 a[40:43], v[24:27], v[40:43], a[40:43]
    v_mfma_f32_16x16x32_bf16 a[44:47], v[24:27], v[44:47], a[44:47]
    v_mfma_f32_16x16x32_bf16 a[48:51], v[28:31], v[32:35], a[48:51]
    v_mfma_f32_16x16x32_bf16 a[52:55], v[28:31], v[36:39], a[52:55]
    v_mfma_f32_16x16x32_bf16 a[56:59], v[28:31], v[40:43], a[56:59]
    v_mfma_f32_16x16x32_bf16 a[60:63], v[28:31], v[44:47], a[60:63]
    v_add_u32 v4, 262144, v2
    v_add_u32 v5, 8192, v2
    buffer_load_dwordx4 v[16:19], v4, s[12:15], s20 offen offset:0
    buffer_load_dwordx4 v[20:23], v4, s[12:15], s21 offen offset:0
    buffer_load_dwordx4 v[24:27], v4, s[12:15], s22 offen offset:0
    buffer_load_dwordx4 v[28:31], v4, s[12:15], s23 offen offset:0
    buffer_load_dwordx4 v[32:35], v5, s[12:15], s24 offen offset:0
    buffer_load_dwordx4 v[36:39], v5, s[12:15], s25 offen offset:0
    buffer_load_dwordx4 v[40:43], v5, s[12:15], s26 offen offset:0
    buffer_load_dwordx4 v[44:47], v5, s[12:15], s27 offen offset:0
    s_waitcnt vmcnt(24)
    v_mfma_f32_16x16x32_bf16 a[0:3], v[48:51], v[64:67], a[0:3]
    v_mfma_f32_16x16x32_bf16 a[4:7], v[48:51], v[68:71], a[4:7]
    v_mfma_f32_16x16x32_bf16 a[8:11], v[48:51], v[72:75], a[8:11]
    v_mfma_f32_16x16x32_bf16 a[12:15], v[48:51], v[76:79], a[12:15]
    v_mfma_f32_16x16x32_bf16 a[16:19], v[52:55], v[64:67], a[16:19]
    v_mfma_f32_16x16x32_bf16 a[20:23], v[52:55], v[68:71], a[20:23]
    v_mfma_f32_16x16x32_bf16 a[24:27], v[52:55], v[72:75], a[24:27]
    v_mfma_f32_16x16x32_bf16 a[28:31], v[52:55], v[76:79], a[28:31]
    v_mfma_f32_16x16x32_bf16 a[32:35], v[56:59], v[64:67], a[32:35]
    v_mfma_f32_16x16x32_bf16 a[36:39], v[56:59], v[68:71], a[36:39]
    v_mfma_f32_16x16x32_bf16 a[40:43], v[56:59], v[72:75], a[40:43]
    v_mfma_f32_16x16x32_bf16 a[44:47], v[56:59], v[76:79], a[44:47]
    v_mfma_f32_16x16x32_bf16 a[48:51], v[60:63], v[64:67], a[48:51]
    v_mfma_f32_16x16x32_bf16 a[52:55], v[60:63], v[68:71], a[52:55]
    v_mfma_f32_16x16x32_bf16 a[56:59], v[60:63], v[72:75], a[56:59]
    v_mfma_f32_16x16x32_bf16 a[60:63], v[60:63], v[76:79], a[60:63]
    v_add_u32 v4, 294912, v2
    v_add_u32 v5, 9216, v2
    buffer_load_dwordx4 v[48:51], v4, s[12:15], s20 offen offset:0
    buffer_load_dwordx4 v[52:55], v4, s[12:15], s21 offen offset:0
    buffer_load_dwordx4 v[56:59], v4, s[12:15], s22 offen offset:0
    buffer_load_dwordx4 v[60:63], v4, s[12:15], s23 offen offset:0
    buffer_load_dwordx4 v[64:67], v5, s[12:15], s24 offen offset:0
    buffer_load_dwordx4 v[68:71], v5, s[12:15], s25 offen offset:0
    buffer_load_dwordx4 v[72:75], v5, s[12:15], s26 offen offset:0
    buffer_load_dwordx4 v[76:79], v5, s[12:15], s27 offen offset:0
    s_waitcnt vmcnt(24)
    v_mfma_f32_16x16x32_bf16 a[0:3], v[80:83], v[96:99], a[0:3]
    v_mfma_f32_16x16x32_bf16 a[4:7], v[80:83], v[100:103], a[4:7]
    v_mfma_f32_16x16x32_bf16 a[8:11], v[80:83], v[104:107], a[8:11]
    v_mfma_f32_16x16x32_bf16 a[12:15], v[80:83], v[108:111], a[12:15]
    v_mfma_f32_16x16x32_bf16 a[16:19], v[84:87], v[96:99], a[16:19]
    v_mfma_f32_16x16x32_bf16 a[20:23], v[84:87], v[100:103], a[20:23]
    v_mfma_f32_16x16x32_bf16 a[24:27], v[84:87], v[104:107], a[24:27]
    v_mfma_f32_16x16x32_bf16 a[28:31], v[84:87], v[108:111], a[28:31]
    v_mfma_f32_16x16x32_bf16 a[32:35], v[88:91], v[96:99], a[32:35]
    v_mfma_f32_16x16x32_bf16 a[36:39], v[88:91], v[100:103], a[36:39]
    v_mfma_f32_16x16x32_bf16 a[40:43], v[88:91], v[104:107], a[40:43]
    v_mfma_f32_16x16x32_bf16 a[44:47], v[88:91], v[108:111], a[44:47]
    v_mfma_f32_16x16x32_bf16 a[48:51], v[92:95], v[96:99], a[48:51]
    v_mfma_f32_16x16x32_bf16 a[52:55], v[92:95], v[100:103], a[52:55]
    v_mfma_f32_16x16x32_bf16 a[56:59], v[92:95], v[104:107], a[56:59]
    v_mfma_f32_16x16x32_bf16 a[60:63], v[92:95], v[108:111], a[60:63]
    v_add_u32 v4, 327680, v2
    v_add_u32 v5, 10240, v2
    buffer_load_dwordx4 v[80:83], v4, s[12:15], s20 offen offset:0
    buffer_load_dwordx4 v[84:87], v4, s[12:15], s21 offen offset:0
    buffer_load_dwordx4 v[88:91], v4, s[12:15], s22 offen offset:0
    buffer_load_dwordx4 v[92:95], v4, s[12:15], s23 offen offset:0
    buffer_load_dwordx4 v[96:99], v5, s[12:15], s24 offen offset:0
    buffer_load_dwordx4 v[100:103], v5, s[12:15], s25 offen offset:0
    buffer_load_dwordx4 v[104:107], v5, s[12:15], s26 offen offset:0
    buffer_load_dwordx4 v[108:111], v5, s[12:15], s27 offen offset:0
    s_waitcnt vmcnt(24)
    v_mfma_f32_16x16x32_bf16 a[0:3], v[112:115], v[128:131], a[0:3]
    v_mfma_f32_16x16x32_bf16 a[4:7], v[112:115], v[132:135], a[4:7]
    v_mfma_f32_16x16x32_bf16 a[8:11], v[112:115], v[136:139], a[8:11]
    v_mfma_f32_16x16x32_bf16 a[12:15], v[112:115], v[140:143], a[12:15]
    v_mfma_f32_16x16x32_bf16 a[16:19], v[116:119], v[128:131], a[16:19]
    v_mfma_f32_16x16x32_bf16 a[20:23], v[116:119], v[132:135], a[20:23]
    v_mfma_f32_16x16x32_bf16 a[24:27], v[116:119], v[136:139], a[24:27]
    v_mfma_f32_16x16x32_bf16 a[28:31], v[116:119], v[140:143], a[28:31]
    v_mfma_f32_16x16x32_bf16 a[32:35], v[120:123], v[128:131], a[32:35]
    v_mfma_f32_16x16x32_bf16 a[36:39], v[120:123], v[132:135], a[36:39]
    v_mfma_f32_16x16x32_bf16 a[40:43], v[120:123], v[136:139], a[40:43]
    v_mfma_f32_16x16x32_bf16 a[44:47], v[120:123], v[140:143], a[44:47]
    v_mfma_f32_16x16x32_bf16 a[48:51], v[124:127], v[128:131], a[48:51]
    v_mfma_f32_16x16x32_bf16 a[52:55], v[124:127], v[132:135], a[52:55]
    v_mfma_f32_16x16x32_bf16 a[56:59], v[124:127], v[136:139], a[56:59]
    v_mfma_f32_16x16x32_bf16 a[60:63], v[124:127], v[140:143], a[60:63]
    v_add_u32 v4, 360448, v2
    v_add_u32 v5, 11264, v2
    buffer_load_dwordx4 v[112:115], v4, s[12:15], s20 offen offset:0
    buffer_load_dwordx4 v[116:119], v4, s[12:15], s21 offen offset:0
    buffer_load_dwordx4 v[120:123], v4, s[12:15], s22 offen offset:0
    buffer_load_dwordx4 v[124:127], v4, s[12:15], s23 offen offset:0
    buffer_load_dwordx4 v[128:131], v5, s[12:15], s24 offen offset:0
    buffer_load_dwordx4 v[132:135], v5, s[12:15], s25 offen offset:0
    buffer_load_dwordx4 v[136:139], v5, s[12:15], s26 offen offset:0
    buffer_load_dwordx4 v[140:143], v5, s[12:15], s27 offen offset:0
    s_waitcnt vmcnt(24)
    v_mfma_f32_16x16x32_bf16 a[0:3], v[16:19], v[32:35], a[0:3]
    v_mfma_f32_16x16x32_bf16 a[4:7], v[16:19], v[36:39], a[4:7]
    v_mfma_f32_16x16x32_bf16 a[8:11], v[16:19], v[40:43], a[8:11]
    v_mfma_f32_16x16x32_bf16 a[12:15], v[16:19], v[44:47], a[12:15]
    v_mfma_f32_16x16x32_bf16 a[16:19], v[20:23], v[32:35], a[16:19]
    v_mfma_f32_16x16x32_bf16 a[20:23], v[20:23], v[36:39], a[20:23]
    v_mfma_f32_16x16x32_bf16 a[24:27], v[20:23], v[40:43], a[24:27]
    v_mfma_f32_16x16x32_bf16 a[28:31], v[20:23], v[44:47], a[28:31]
    v_mfma_f32_16x16x32_bf16 a[32:35], v[24:27], v[32:35], a[32:35]
    v_mfma_f32_16x16x32_bf16 a[36:39], v[24:27], v[36:39], a[36:39]
    v_mfma_f32_16x16x32_bf16 a[40:43], v[24:27], v[40:43], a[40:43]
    v_mfma_f32_16x16x32_bf16 a[44:47], v[24:27], v[44:47], a[44:47]
    v_mfma_f32_16x16x32_bf16 a[48:51], v[28:31], v[32:35], a[48:51]
    v_mfma_f32_16x16x32_bf16 a[52:55], v[28:31], v[36:39], a[52:55]
    v_mfma_f32_16x16x32_bf16 a[56:59], v[28:31], v[40:43], a[56:59]
    v_mfma_f32_16x16x32_bf16 a[60:63], v[28:31], v[44:47], a[60:63]
    v_add_u32 v4, 393216, v2
    v_add_u32 v5, 12288, v2
    buffer_load_dwordx4 v[16:19], v4, s[12:15], s20 offen offset:0
    buffer_load_dwordx4 v[20:23], v4, s[12:15], s21 offen offset:0
    buffer_load_dwordx4 v[24:27], v4, s[12:15], s22 offen offset:0
    buffer_load_dwordx4 v[28:31], v4, s[12:15], s23 offen offset:0
    buffer_load_dwordx4 v[32:35], v5, s[12:15], s24 offen offset:0
    buffer_load_dwordx4 v[36:39], v5, s[12:15], s25 offen offset:0
    buffer_load_dwordx4 v[40:43], v5, s[12:15], s26 offen offset:0
    buffer_load_dwordx4 v[44:47], v5, s[12:15], s27 offen offset:0
    s_waitcnt vmcnt(24)
    v_mfma_f32_16x16x32_bf16 a[0:3], v[48:51], v[64:67], a[0:3]
    v_mfma_f32_16x16x32_bf16 a[4:7], v[48:51], v[68:71], a[4:7]
    v_mfma_f32_16x16x32_bf16 a[8:11], v[48:51], v[72:75], a[8:11]
    v_mfma_f32_16x16x32_bf16 a[12:15], v[48:51], v[76:79], a[12:15]
    v_mfma_f32_16x16x32_bf16 a[16:19], v[52:55], v[64:67], a[16:19]
    v_mfma_f32_16x16x32_bf16 a[20:23], v[52:55], v[68:71], a[20:23]
    v_mfma_f32_16x16x32_bf16 a[24:27], v[52:55], v[72:75], a[24:27]
    v_mfma_f32_16x16x32_bf16 a[28:31], v[52:55], v[76:79], a[28:31]
    v_mfma_f32_16x16x32_bf16 a[32:35], v[56:59], v[64:67], a[32:35]
    v_mfma_f32_16x16x32_bf16 a[36:39], v[56:59], v[68:71], a[36:39]
    v_mfma_f32_16x16x32_bf16 a[40:43], v[56:59], v[72:75], a[40:43]
    v_mfma_f32_16x16x32_bf16 a[44:47], v[56:59], v[76:79], a[44:47]
    v_mfma_f32_16x16x32_bf16 a[48:51], v[60:63], v[64:67], a[48:51]
    v_mfma_f32_16x16x32_bf16 a[52:55], v[60:63], v[68:71], a[52:55]
    v_mfma_f32_16x16x32_bf16 a[56:59], v[60:63], v[72:75], a[56:59]
    v_mfma_f32_16x16x32_bf16 a[60:63], v[60:63], v[76:79], a[60:63]
    v_add_u32 v4, 425984, v2
    v_add_u32 v5, 13312, v2
    buffer_load_dwordx4 v[48:51], v4, s[12:15], s20 offen offset:0
    buffer_load_dwordx4 v[52:55], v4, s[12:15], s21 offen offset:0
    buffer_load_dwordx4 v[56:59], v4, s[12:15], s22 offen offset:0
    buffer_load_dwordx4 v[60:63], v4, s[12:15], s23 offen offset:0
    buffer_load_dwordx4 v[64:67], v5, s[12:15], s24 offen offset:0
    buffer_load_dwordx4 v[68:71], v5, s[12:15], s25 offen offset:0
    buffer_load_dwordx4 v[72:75], v5, s[12:15], s26 offen offset:0
    buffer_load_dwordx4 v[76:79], v5, s[12:15], s27 offen offset:0
    s_waitcnt vmcnt(24)
    v_mfma_f32_16x16x32_bf16 a[0:3], v[80:83], v[96:99], a[0:3]
    v_mfma_f32_16x16x32_bf16 a[4:7], v[80:83], v[100:103], a[4:7]
    v_mfma_f32_16x16x32_bf16 a[8:11], v[80:83], v[104:107], a[8:11]
    v_mfma_f32_16x16x32_bf16 a[12:15], v[80:83], v[108:111], a[12:15]
    v_mfma_f32_16x16x32_bf16 a[16:19], v[84:87], v[96:99], a[16:19]
    v_mfma_f32_16x16x32_bf16 a[20:23], v[84:87], v[100:103], a[20:23]
    v_mfma_f32_16x16x32_bf16 a[24:27], v[84:87], v[104:107], a[24:27]
    v_mfma_f32_16x16x32_bf16 a[28:31], v[84:87], v[108:111], a[28:31]
    v_mfma_f32_16x16x32_bf16 a[32:35], v[88:91], v[96:99], a[32:35]
    v_mfma_f32_16x16x32_bf16 a[36:39], v[88:91], v[100:103], a[36:39]
    v_mfma_f32_16x16x32_bf16 a[40:43], v[88:91], v[104:107], a[40:43]
    v_mfma_f32_16x16x32_bf16 a[44:47], v[88:91], v[108:111], a[44:47]
    v_mfma_f32_16x16x32_bf16 a[48:51], v[92:95], v[96:99], a[48:51]
    v_mfma_f32_16x16x32_bf16 a[52:55], v[92:95], v[100:103], a[52:55]
    v_mfma_f32_16x16x32_bf16 a[56:59], v[92:95], v[104:107], a[56:59]
    v_mfma_f32_16x16x32_bf16 a[60:63], v[92:95], v[108:111], a[60:63]
    s_waitcnt vmcnt(16)
    v_mfma_f32_16x16x32_bf16 a[0:3], v[112:115], v[128:131], a[0:3]
    v_mfma_f32_16x16x32_bf16 a[4:7], v[112:115], v[132:135], a[4:7]
    v_mfma_f32_16x16x32_bf16 a[8:11], v[112:115], v[136:139], a[8:11]
    v_mfma_f32_16x16x32_bf16 a[12:15], v[112:115], v[140:143], a[12:15]
    v_mfma_f32_16x16x32_bf16 a[16:19], v[116:119], v[128:131], a[16:19]
    v_mfma_f32_16x16x32_bf16 a[20:23], v[116:119], v[132:135], a[20:23]
    v_mfma_f32_16x16x32_bf16 a[24:27], v[116:119], v[136:139], a[24:27]
    v_mfma_f32_16x16x32_bf16 a[28:31], v[116:119], v[140:143], a[28:31]
    v_mfma_f32_16x16x32_bf16 a[32:35], v[120:123], v[128:131], a[32:35]
    v_mfma_f32_16x16x32_bf16 a[36:39], v[120:123], v[132:135], a[36:39]
    v_mfma_f32_16x16x32_bf16 a[40:43], v[120:123], v[136:139], a[40:43]
    v_mfma_f32_16x16x32_bf16 a[44:47], v[120:123], v[140:143], a[44:47]
    v_mfma_f32_16x16x32_bf16 a[48:51], v[124:127], v[128:131], a[48:51]
    v_mfma_f32_16x16x32_bf16 a[52:55], v[124:127], v[132:135], a[52:55]
    v_mfma_f32_16x16x32_bf16 a[56:59], v[124:127], v[136:139], a[56:59]
    v_mfma_f32_16x16x32_bf16 a[60:63], v[124:127], v[140:143], a[60:63]
    s_waitcnt vmcnt(8)
    v_mfma_f32_16x16x32_bf16 a[0:3], v[16:19], v[32:35], a[0:3]
    v_mfma_f32_16x16x32_bf16 a[4:7], v[16:19], v[36:39], a[4:7]
    v_mfma_f32_16x16x32_bf16 a[8:11], v[16:19], v[40:43], a[8:11]
    v_mfma_f32_16x16x32_bf16 a[12:15], v[16:19], v[44:47], a[12:15]
    v_mfma_f32_16x16x32_bf16 a[16:19], v[20:23], v[32:35], a[16:19]
    v_mfma_f32_16x16x32_bf16 a[20:23], v[20:23], v[36:39], a[20:23]
    v_mfma_f32_16x16x32_bf16 a[24:27], v[20:23], v[40:43], a[24:27]
    v_mfma_f32_16x16x32_bf16 a[28:31], v[20:23], v[44:47], a[28:31]
    v_mfma_f32_16x16x32_bf16 a[32:35], v[24:27], v[32:35], a[32:35]
    v_mfma_f32_16x16x32_bf16 a[36:39], v[24:27], v[36:39], a[36:39]
    v_mfma_f32_16x16x32_bf16 a[40:43], v[24:27], v[40:43], a[40:43]
    v_mfma_f32_16x16x32_bf16 a[44:47], v[24:27], v[44:47], a[44:47]
    v_mfma_f32_16x16x32_bf16 a[48:51], v[28:31], v[32:35], a[48:51]
    v_mfma_f32_16x16x32_bf16 a[52:55], v[28:31], v[36:39], a[52:55]
    v_mfma_f32_16x16x32_bf16 a[56:59], v[28:31], v[40:43], a[56:59]
    v_mfma_f32_16x16x32_bf16 a[60:63], v[28:31], v[44:47], a[60:63]
    s_waitcnt vmcnt(0)
    v_mfma_f32_16x16x32_bf16 a[0:3], v[48:51], v[64:67], a[0:3]
    v_mfma_f32_16x16x32_bf16 a[4:7], v[48:51], v[68:71], a[4:7]
    v_mfma_f32_16x16x32_bf16 a[8:11], v[48:51], v[72:75], a[8:11]
    v_mfma_f32_16x16x32_bf16 a[12:15], v[48:51], v[76:79], a[12:15]
    v_mfma_f32_16x16x32_bf16 a[16:19], v[52:55], v[64:67], a[16:19]
    v_mfma_f32_16x16x32_bf16 a[20:23], v[52:55], v[68:71], a[20:23]
    v_mfma_f32_16x16x32_bf16 a[24:27], v[52:55], v[72:75], a[24:27]
    v_mfma_f32_16x16x32_bf16 a[28:31], v[52:55], v[76:79], a[28:31]
    v_mfma_f32_16x16x32_bf16 a[32:35], v[56:59], v[64:67], a[32:35]
    v_mfma_f32_16x16x32_bf16 a[36:39], v[56:59], v[68:71], a[36:39]
    v_mfma_f32_16x16x32_bf16 a[40:43], v[56:59], v[72:75], a[40:43]
    v_mfma_f32_16x16x32_bf16 a[44:47], v[56:59], v[76:79], a[44:47]
    v_mfma_f32_16x16x32_bf16 a[48:51], v[60:63], v[64:67], a[48:51]
    v_mfma_f32_16x16x32_bf16 a[52:55], v[60:63], v[68:71], a[52:55]
    v_mfma_f32_16x16x32_bf16 a[56:59], v[60:63], v[72:75], a[56:59]
    v_mfma_f32_16x16x32_bf16 a[60:63], v[60:63], v[76:79], a[60:63]
    s_nop 9
    s_lshl_b32 s19, s18, 14
    v_add_u32 v6, s19, v2
    ds_write_b128 v6, a[0:3] offset:0
    ds_write_b128 v6, a[4:7] offset:1024
    ds_write_b128 v6, a[8:11] offset:2048
    ds_write_b128 v6, a[12:15] offset:3072
    ds_write_b128 v6, a[16:19] offset:4096
    ds_write_b128 v6, a[20:23] offset:5120
    ds_write_b128 v6, a[24:27] offset:6144
    ds_write_b128 v6, a[28:31] offset:7168
    ds_write_b128 v6, a[32:35] offset:8192
    ds_write_b128 v6, a[36:39] offset:9216
    ds_write_b128 v6, a[40:43] offset:10240
    ds_write_b128 v6, a[44:47] offset:11264
    ds_write_b128 v6, a[48:51] offset:12288
    ds_write_b128 v6, a[52:55] offset:13312
    ds_write_b128 v6, a[56:59] offset:14336
    ds_write_b128 v6, a[60:63] offset:15360
    s_waitcnt lgkmcnt(0)
    s_barrier
    s_lshl_b32 s19, s18, 10
    v_add_u32 v6, s19, v2
    ds_read_b128 v[16:19], v6 offset:0
    ds_read_b128 v[20:23], v6 offset:16384
    ds_read_b128 v[24:27], v6 offset:32768
    ds_read_b128 v[28:31], v6 offset:49152
    ds_read_b128 v[32:35], v6 offset:4096
    ds_read_b128 v[36:39], v6 offset:20480
    ds_read_b128 v[40:43], v6 offset:36864
    ds_read_b128 v[44:47], v6 offset:53248
    ds_read_b128 v[48:51], v6 offset:8192
    ds_read_b128 v[52:55], v6 offset:24576
    ds_read_b128 v[56:59], v6 offset:40960
    ds_read_b128 v[60:63], v6 offset:57344
    ds_read_b128 v[64:67], v6 offset:12288
    ds_read_b128 v[68:71], v6 offset:28672
    ds_read_b128 v[72:75], v6 offset:45056
    ds_read_b128 v[76:79], v6 offset:61440
    v_and_b32 v8, 15, v1
    v_lshlrev_b32 v8, 10, v8
    v_lshrrev_b32 v9, 4, v1
    v_lshl_add_u32 v8, v9, 3, v8
    s_lshl_b32 s19, s16, 16
    s_lshl_b32 s20, s18, 14
    s_add_u32 s19, s19, s20
    s_lshl_b32 s20, s17, 7
    s_add_u32 s19, s19, s20
    s_add_u32 s19, s19, 0x7c00000
    s_waitcnt lgkmcnt(0)
    v_add_f32 v16, v16, v20
    v_add_f32 v24, v24, v28
    v_add_f32 v17, v17, v21
    v_add_f32 v25, v25, v29
    v_add_f32 v18, v18, v22
    v_add_f32 v26, v26, v30
    v_add_f32 v19, v19, v23
    v_add_f32 v27, v27, v31
    v_add_f32 v16, v16, v24
    v_add_f32 v17, v17, v25
    v_add_f32 v18, v18, v26
    v_add_f32 v19, v19, v27
    v_add_f32 v32, v32, v36
    v_add_f32 v40, v40, v44
    v_add_f32 v33, v33, v37
    v_add_f32 v41, v41, v45
    v_add_f32 v34, v34, v38
    v_add_f32 v42, v42, v46
    v_add_f32 v35, v35, v39
    v_add_f32 v43, v43, v47
    v_add_f32 v32, v32, v40
    v_add_f32 v33, v33, v41
    v_add_f32 v34, v34, v42
    v_add_f32 v35, v35, v43
    v_add_f32 v48, v48, v52
    v_add_f32 v56, v56, v60
    v_add_f32 v49, v49, v53
    v_add_f32 v57, v57, v61
    v_add_f32 v50, v50, v54
    v_add_f32 v58, v58, v62
    v_add_f32 v51, v51, v55
    v_add_f32 v59, v59, v63
    v_add_f32 v48, v48, v56
    v_add_f32 v49, v49, v57
    v_add_f32 v50, v50, v58
    v_add_f32 v51, v51, v59
    v_add_f32 v64, v64, v68
    v_add_f32 v72, v72, v76
    v_add_f32 v65, v65, v69
    v_add_f32 v73, v73, v77
    v_add_f32 v66, v66, v70
    v_add_f32 v74, v74, v78
    v_add_f32 v67, v67, v71
    v_add_f32 v75, v75, v79
    v_add_f32 v64, v64, v72
    v_add_f32 v65, v65, v73
    v_add_f32 v66, v66, v74
    v_add_f32 v67, v67, v75
    v_cvt_pk_bf16_f32 v96, v16, v17
    v_cvt_pk_bf16_f32 v97, v18, v19
    buffer_store_dwordx2 v[96:97], v8, s[12:15], s19 offen offset:0
    v_cvt_pk_bf16_f32 v98, v32, v33
    v_cvt_pk_bf16_f32 v99, v34, v35
    buffer_store_dwordx2 v[98:99], v8, s[12:15], s19 offen offset:32
    v_cvt_pk_bf16_f32 v100, v48, v49
    v_cvt_pk_bf16_f32 v101, v50, v51
    buffer_store_dwordx2 v[100:101], v8, s[12:15], s19 offen offset:64
    v_cvt_pk_bf16_f32 v102, v64, v65
    v_cvt_pk_bf16_f32 v103, v66, v67
    buffer_store_dwordx2 v[102:103], v8, s[12:15], s19 offen offset:96
    s_add_u32 s51, s51, 160
    s_cmp_lt_u32 s51, 256
    s_cbranch_scc1 L_w3_task
    s_sub_u32 s51, s50, 64
L_w5_go:
    s_lshr_b32 s16, s51, 3
    s_and_b32 s17, s51, 7
    s_lshl_b32 s19, s16, 2
    s_add_u32 s19, s19, 0x7906c00
    v_mov_b32 v9, 0
    s_mov_b32 s55, 0
L_w5_poll:
    buffer_load_dword v8, v9, s[12:15], s19 offen sc0 sc1
    s_add_u32 s55, s55, 1
    s_waitcnt vmcnt(0)
    v_readfirstlane_b32 s20, v8
    s_cmp_eq_u32 s20, 63
    s_cbranch_scc1 L_w5_ok
    s_sleep 16
    s_cmp_lt_u32 s55, 4000000
    s_cbranch_scc1 L_w5_poll
    s_branch L_ch_done
L_w5_ok:
    s_barrier
    s_lshl_b32 s19, s18, 3
    s_lshl_b32 s20, s19, 17
    s_lshl_b32 s21, s17, 14
    s_add_u32 s20, s20, s21
    s_add_u32 s20, s20, 0xc00000
    s_add_u32 s21, s20, 4096
    s_add_u32 s22, s20, 8192
    s_add_u32 s23, s20, 12288
    s_lshl_b32 s24, s16, 19
    s_lshl_b32 s19, s18, 15
    s_add_u32 s24, s24, s19
    s_add_u32 s24, s24, 0x6800000
    s_add_u32 s25, s24, 131072
    s_add_u32 s26, s24, 262144
    s_add_u32 s27, s24, 393216
    v_add_u32 v4, 0, v2
    v_add_u32 v5, 0, v2
    buffer_load_dwordx4 v[16:19], v4, s[12:15], s20 offen offset:0
    buffer_load_dwordx4 v[20:23], v4, s[12:15], s21 offen offset:0
    buffer_load_dwordx4 v[24:27], v4, s[12:15], s22 offen offset:0
    buffer_load_dwordx4 v[28:31], v4, s[12:15], s23 offen offset:0
    buffer_load_dwordx4 v[32:35], v5, s[12:15], s24 offen offset:0
    buffer_load_dwordx4 v[36:39], v5, s[12:15], s25 offen offset:0
    buffer_load_dwordx4 v[40:43], v5, s[12:15], s26 offen offset:0
    buffer_load_dwordx4 v[44:47], v5, s[12:15], s27 offen offset:0
    buffer_load_dwordx4 v[48:51], v4, s[12:15], s20 offen offset:1024
    buffer_load_dwordx4 v[52:55], v4, s[12:15], s21 offen offset:1024
    buffer_load_dwordx4 v[56:59], v4, s[12:15], s22 offen offset:1024
    buffer_load_dwordx4 v[60:63], v4, s[12:15], s23 offen offset:1024
    buffer_load_dwordx4 v[64:67], v5, s[12:15], s24 offen offset:1024
    buffer_load_dwordx4 v[68:71], v5, s[12:15], s25 offen offset:1024
    buffer_load_dwordx4 v[72:75], v5, s[12:15], s26 offen offset:1024
    buffer_load_dwordx4 v[76:79], v5, s[12:15], s27 offen offset:1024
    buffer_load_dwordx4 v[80:83], v4, s[12:15], s20 offen offset:2048
    buffer_load_dwordx4 v[84:87], v4, s[12:15], s21 offen offset:2048
    buffer_load_dwordx4 v[88:91], v4, s[12:15], s22 offen offset:2048
    buffer_load_dwordx4 v[92:95], v4, s[12:15], s23 offen offset:2048
    buffer_load_dwordx4 v[96:99], v5, s[12:15], s24 offen offset:2048
    buffer_load_dwordx4 v[100:103], v5, s[12:15], s25 offen offset:2048
    buffer_load_dwordx4 v[104:107], v5, s[12:15], s26 offen offset:2048
    buffer_load_dwordx4 v[108:111], v5, s[12:15], s27 offen offset:2048
    buffer_load_dwordx4 v[112:115], v4, s[12:15], s20 offen offset:3072
    buffer_load_dwordx4 v[116:119], v4, s[12:15], s21 offen offset:3072
    buffer_load_dwordx4 v[120:123], v4, s[12:15], s22 offen offset:3072
    buffer_load_dwordx4 v[124:127], v4, s[12:15], s23 offen offset:3072
    buffer_load_dwordx4 v[128:131], v5, s[12:15], s24 offen offset:3072
    buffer_load_dwordx4 v[132:135], v5, s[12:15], s25 offen offset:3072
    buffer_load_dwordx4 v[136:139], v5, s[12:15], s26 offen offset:3072
    buffer_load_dwordx4 v[140:143], v5, s[12:15], s27 offen offset:3072
    s_waitcnt vmcnt(24)
    v_mfma_f32_16x16x32_bf16 a[0:3], v[16:19], v[32:35], 0
    v_mfma_f32_16x16x32_bf16 a[4:7], v[16:19], v[36:39], 0
    v_mfma_f32_16x16x32_bf16 a[8:11], v[16:19], v[40:43], 0
    v_mfma_f32_16x16x32_bf16 a[12:15], v[16:19], v[44:47], 0
    v_mfma_f32_16x16x32_bf16 a[16:19], v[20:23], v[32:35], 0
    v_mfma_f32_16x16x32_bf16 a[20:23], v[20:23], v[36:39], 0
    v_mfma_f32_16x16x32_bf16 a[24:27], v[20:23], v[40:43], 0
    v_mfma_f32_16x16x32_bf16 a[28:31], v[20:23], v[44:47], 0
    v_mfma_f32_16x16x32_bf16 a[32:35], v[24:27], v[32:35], 0
    v_mfma_f32_16x16x32_bf16 a[36:39], v[24:27], v[36:39], 0
    v_mfma_f32_16x16x32_bf16 a[40:43], v[24:27], v[40:43], 0
    v_mfma_f32_16x16x32_bf16 a[44:47], v[24:27], v[44:47], 0
    v_mfma_f32_16x16x32_bf16 a[48:51], v[28:31], v[32:35], 0
    v_mfma_f32_16x16x32_bf16 a[52:55], v[28:31], v[36:39], 0
    v_mfma_f32_16x16x32_bf16 a[56:59], v[28:31], v[40:43], 0
    v_mfma_f32_16x16x32_bf16 a[60:63], v[28:31], v[44:47], 0
    v_add_u32 v4, 131072, v2
    v_add_u32 v5, 4096, v2
    buffer_load_dwordx4 v[16:19], v4, s[12:15], s20 offen offset:0
    buffer_load_dwordx4 v[20:23], v4, s[12:15], s21 offen offset:0
    buffer_load_dwordx4 v[24:27], v4, s[12:15], s22 offen offset:0
    buffer_load_dwordx4 v[28:31], v4, s[12:15], s23 offen offset:0
    buffer_load_dwordx4 v[32:35], v5, s[12:15], s24 offen offset:0
    buffer_load_dwordx4 v[36:39], v5, s[12:15], s25 offen offset:0
    buffer_load_dwordx4 v[40:43], v5, s[12:15], s26 offen offset:0
    buffer_load_dwordx4 v[44:47], v5, s[12:15], s27 offen offset:0
    s_waitcnt vmcnt(24)
    v_mfma_f32_16x16x32_bf16 a[0:3], v[48:51], v[64:67], a[0:3]
    v_mfma_f32_16x16x32_bf16 a[4:7], v[48:51], v[68:71], a[4:7]
    v_mfma_f32_16x16x32_bf16 a[8:11], v[48:51], v[72:75], a[8:11]
    v_mfma_f32_16x16x32_bf16 a[12:15], v[48:51], v[76:79], a[12:15]
    v_mfma_f32_16x16x32_bf16 a[16:19], v[52:55], v[64:67], a[16:19]
    v_mfma_f32_16x16x32_bf16 a[20:23], v[52:55], v[68:71], a[20:23]
    v_mfma_f32_16x16x32_bf16 a[24:27], v[52:55], v[72:75], a[24:27]
    v_mfma_f32_16x16x32_bf16 a[28:31], v[52:55], v[76:79], a[28:31]
    v_mfma_f32_16x16x32_bf16 a[32:35], v[56:59], v[64:67], a[32:35]
    v_mfma_f32_16x16x32_bf16 a[36:39], v[56:59], v[68:71], a[36:39]
    v_mfma_f32_16x16x32_bf16 a[40:43], v[56:59], v[72:75], a[40:43]
    v_mfma_f32_16x16x32_bf16 a[44:47], v[56:59], v[76:79], a[44:47]
    v_mfma_f32_16x16x32_bf16 a[48:51], v[60:63], v[64:67], a[48:51]
    v_mfma_f32_16x16x32_bf16 a[52:55], v[60:63], v[68:71], a[52:55]
    v_mfma_f32_16x16x32_bf16 a[56:59], v[60:63], v[72:75], a[56:59]
    v_mfma_f32_16x16x32_bf16 a[60:63], v[60:63], v[76:79], a[60:63]
    buffer_load_dwordx4 v[48:51], v4, s[12:15], s20 offen offset:1024
    buffer_load_dwordx4 v[52:55], v4, s[12:15], s21 offen offset:1024
    buffer_load_dwordx4 v[56:59], v4, s[12:15], s22 offen offset:1024
    buffer_load_dwordx4 v[60:63], v4, s[12:15], s23 offen offset:1024
    buffer_load_dwordx4 v[64:67], v5, s[12:15], s24 offen offset:1024
    buffer_load_dwordx4 v[68:71], v5, s[12:15], s25 offen offset:1024
    buffer_load_dwordx4 v[72:75], v5, s[12:15], s26 offen offset:1024
    buffer_load_dwordx4 v[76:79], v5, s[12:15], s27 offen offset:1024
    s_waitcnt vmcnt(24)
    v_mfma_f32_16x16x32_bf16 a[0:3], v[80:83], v[96:99], a[0:3]
    v_mfma_f32_16x16x32_bf16 a[4:7], v[80:83], v[100:103], a[4:7]
    v_mfma_f32_16x16x32_bf16 a[8:11], v[80:83], v[104:107], a[8:11]
    v_mfma_f32_16x16x32_bf16 a[12:15], v[80:83], v[108:111], a[12:15]
    v_mfma_f32_16x16x32_bf16 a[16:19], v[84:87], v[96:99], a[16:19]
    v_mfma_f32_16x16x32_bf16 a[20:23], v[84:87], v[100:103], a[20:23]
    v_mfma_f32_16x16x32_bf16 a[24:27], v[84:87], v[104:107], a[24:27]
    v_mfma_f32_16x16x32_bf16 a[28:31], v[84:87], v[108:111], a[28:31]
    v_mfma_f32_16x16x32_bf16 a[32:35], v[88:91], v[96:99], a[32:35]
    v_mfma_f32_16x16x32_bf16 a[36:39], v[88:91], v[100:103], a[36:39]
    v_mfma_f32_16x16x32_bf16 a[40:43], v[88:91], v[104:107], a[40:43]
    v_mfma_f32_16x16x32_bf16 a[44:47], v[88:91], v[108:111], a[44:47]
    v_mfma_f32_16x16x32_bf16 a[48:51], v[92:95], v[96:99], a[48:51]
    v_mfma_f32_16x16x32_bf16 a[52:55], v[92:95], v[100:103], a[52:55]
    v_mfma_f32_16x16x32_bf16 a[56:59], v[92:95], v[104:107], a[56:59]
    v_mfma_f32_16x16x32_bf16 a[60:63], v[92:95], v[108:111], a[60:63]
    buffer_load_dwordx4 v[80:83], v4, s[12:15], s20 offen offset:2048
    buffer_load_dwordx4 v[84:87], v4, s[12:15], s21 offen offset:2048
    buffer_load_dwordx4 v[88:91], v4, s[12:15], s22 offen offset:2048
    buffer_load_dwordx4 v[92:95], v4, s[12:15], s23 offen offset:2048
    buffer_load_dwordx4 v[96:99], v5, s[12:15], s24 offen offset:2048
    buffer_load_dwordx4 v[100:103], v5, s[12:15], s25 offen offset:2048
    buffer_load_dwordx4 v[104:107], v5, s[12:15], s26 offen offset:2048
    buffer_load_dwordx4 v[108:111], v5, s[12:15], s27 offen offset:2048
    s_waitcnt vmcnt(24)
    v_mfma_f32_16x16x32_bf16 a[0:3], v[112:115], v[128:131], a[0:3]
    v_mfma_f32_16x16x32_bf16 a[4:7], v[112:115], v[132:135], a[4:7]
    v_mfma_f32_16x16x32_bf16 a[8:11], v[112:115], v[136:139], a[8:11]
    v_mfma_f32_16x16x32_bf16 a[12:15], v[112:115], v[140:143], a[12:15]
    v_mfma_f32_16x16x32_bf16 a[16:19], v[116:119], v[128:131], a[16:19]
    v_mfma_f32_16x16x32_bf16 a[20:23], v[116:119], v[132:135], a[20:23]
    v_mfma_f32_16x16x32_bf16 a[24:27], v[116:119], v[136:139], a[24:27]
    v_mfma_f32_16x16x32_bf16 a[28:31], v[116:119], v[140:143], a[28:31]
    v_mfma_f32_16x16x32_bf16 a[32:35], v[120:123], v[128:131], a[32:35]
    v_mfma_f32_16x16x32_bf16 a[36:39], v[120:123], v[132:135], a[36:39]
    v_mfma_f32_16x16x32_bf16 a[40:43], v[120:123], v[136:139], a[40:43]
    v_mfma_f32_16x16x32_bf16 a[44:47], v[120:123], v[140:143], a[44:47]
    v_mfma_f32_16x16x32_bf16 a[48:51], v[124:127], v[128:131], a[48:51]
    v_mfma_f32_16x16x32_bf16 a[52:55], v[124:127], v[132:135], a[52:55]
    v_mfma_f32_16x16x32_bf16 a[56:59], v[124:127], v[136:139], a[56:59]
    v_mfma_f32_16x16x32_bf16 a[60:63], v[124:127], v[140:143], a[60:63]
    buffer_load_dwordx4 v[112:115], v4, s[12:15], s20 offen offset:3072
    buffer_load_dwordx4 v[116:119], v4, s[12:15], s21 offen offset:3072
    buffer_load_dwordx4 v[120:123], v4, s[12:15], s22 offen offset:3072
    buffer_load_dwordx4 v[124:127], v4, s[12:15], s23 offen offset:3072
    buffer_load_dwordx4 v[128:131], v5, s[12:15], s24 offen offset:3072
    buffer_load_dwordx4 v[132:135], v5, s[12:15], s25 offen offset:3072
    buffer_load_dwordx4 v[136:139], v5, s[12:15], s26 offen offset:3072
    buffer_load_dwordx4 v[140:143], v5, s[12:15], s27 offen offset:3072
    s_waitcnt vmcnt(24)
    v_mfma_f32_16x16x32_bf16 a[0:3], v[16:19], v[32:35], a[0:3]
    v_mfma_f32_16x16x32_bf16 a[4:7], v[16:19], v[36:39], a[4:7]
    v_mfma_f32_16x16x32_bf16 a[8:11], v[16:19], v[40:43], a[8:11]
    v_mfma_f32_16x16x32_bf16 a[12:15], v[16:19], v[44:47], a[12:15]
    v_mfma_f32_16x16x32_bf16 a[16:19], v[20:23], v[32:35], a[16:19]
    v_mfma_f32_16x16x32_bf16 a[20:23], v[20:23], v[36:39], a[20:23]
    v_mfma_f32_16x16x32_bf16 a[24:27], v[20:23], v[40:43], a[24:27]
    v_mfma_f32_16x16x32_bf16 a[28:31], v[20:23], v[44:47], a[28:31]
    v_mfma_f32_16x16x32_bf16 a[32:35], v[24:27], v[32:35], a[32:35]
    v_mfma_f32_16x16x32_bf16 a[36:39], v[24:27], v[36:39], a[36:39]
    v_mfma_f32_16x16x32_bf16 a[40:43], v[24:27], v[40:43], a[40:43]
    v_mfma_f32_16x16x32_bf16 a[44:47], v[24:27], v[44:47], a[44:47]
    v_mfma_f32_16x16x32_bf16 a[48:51], v[28:31], v[32:35], a[48:51]
    v_mfma_f32_16x16x32_bf16 a[52:55], v[28:31], v[36:39], a[52:55]
    v_mfma_f32_16x16x32_bf16 a[56:59], v[28:31], v[40:43], a[56:59]
    v_mfma_f32_16x16x32_bf16 a[60:63], v[28:31], v[44:47], a[60:63]
    v_add_u32 v4, 262144, v2
    v_add_u32 v5, 8192, v2
    buffer_load_dwordx4 v[16:19], v4, s[12:15], s20 offen offset:0
    buffer_load_dwordx4 v[20:23], v4, s[12:15], s21 offen offset:0
    buffer_load_dwordx4 v[24:27], v4, s[12:15], s22 offen offset:0
    buffer_load_dwordx4 v[28:31], v4, s[12:15], s23 offen offset:0
    buffer_load_dwordx4 v[32:35], v5, s[12:15], s24 offen offset:0
    buffer_load_dwordx4 v[36:39], v5, s[12:15], s25 offen offset:0
    buffer_load_dwordx4 v[40:43], v5, s[12:15], s26 offen offset:0
    buffer_load_dwordx4 v[44:47], v5, s[12:15], s27 offen offset:0
    s_waitcnt vmcnt(24)
    v_mfma_f32_16x16x32_bf16 a[0:3], v[48:51], v[64:67], a[0:3]
    v_mfma_f32_16x16x32_bf16 a[4:7], v[48:51], v[68:71], a[4:7]
    v_mfma_f32_16x16x32_bf16 a[8:11], v[48:51], v[72:75], a[8:11]
    v_mfma_f32_16x16x32_bf16 a[12:15], v[48:51], v[76:79], a[12:15]
    v_mfma_f32_16x16x32_bf16 a[16:19], v[52:55], v[64:67], a[16:19]
    v_mfma_f32_16x16x32_bf16 a[20:23], v[52:55], v[68:71], a[20:23]
    v_mfma_f32_16x16x32_bf16 a[24:27], v[52:55], v[72:75], a[24:27]
    v_mfma_f32_16x16x32_bf16 a[28:31], v[52:55], v[76:79], a[28:31]
    v_mfma_f32_16x16x32_bf16 a[32:35], v[56:59], v[64:67], a[32:35]
    v_mfma_f32_16x16x32_bf16 a[36:39], v[56:59], v[68:71], a[36:39]
    v_mfma_f32_16x16x32_bf16 a[40:43], v[56:59], v[72:75], a[40:43]
    v_mfma_f32_16x16x32_bf16 a[44:47], v[56:59], v[76:79], a[44:47]
    v_mfma_f32_16x16x32_bf16 a[48:51], v[60:63], v[64:67], a[48:51]
    v_mfma_f32_16x16x32_bf16 a[52:55], v[60:63], v[68:71], a[52:55]
    v_mfma_f32_16x16x32_bf16 a[56:59], v[60:63], v[72:75], a[56:59]
    v_mfma_f32_16x16x32_bf16 a[60:63], v[60:63], v[76:79], a[60:63]
    buffer_load_dwordx4 v[48:51], v4, s[12:15], s20 offen offset:1024
    buffer_load_dwordx4 v[52:55], v4, s[12:15], s21 offen offset:1024
    buffer_load_dwordx4 v[56:59], v4, s[12:15], s22 offen offset:1024
    buffer_load_dwordx4 v[60:63], v4, s[12:15], s23 offen offset:1024
    buffer_load_dwordx4 v[64:67], v5, s[12:15], s24 offen offset:1024
    buffer_load_dwordx4 v[68:71], v5, s[12:15], s25 offen offset:1024
    buffer_load_dwordx4 v[72:75], v5, s[12:15], s26 offen offset:1024
    buffer_load_dwordx4 v[76:79], v5, s[12:15], s27 offen offset:1024
    s_waitcnt vmcnt(24)
    v_mfma_f32_16x16x32_bf16 a[0:3], v[80:83], v[96:99], a[0:3]
    v_mfma_f32_16x16x32_bf16 a[4:7], v[80:83], v[100:103], a[4:7]
    v_mfma_f32_16x16x32_bf16 a[8:11], v[80:83], v[104:107], a[8:11]
    v_mfma_f32_16x16x32_bf16 a[12:15], v[80:83], v[108:111], a[12:15]
    v_mfma_f32_16x16x32_bf16 a[16:19], v[84:87], v[96:99], a[16:19]
    v_mfma_f32_16x16x32_bf16 a[20:23], v[84:87], v[100:103], a[20:23]
    v_mfma_f32_16x16x32_bf16 a[24:27], v[84:87], v[104:107], a[24:27]
    v_mfma_f32_16x16x32_bf16 a[28:31], v[84:87], v[108:111], a[28:31]
    v_mfma_f32_16x16x32_bf16 a[32:35], v[88:91], v[96:99], a[32:35]
    v_mfma_f32_16x16x32_bf16 a[36:39], v[88:91], v[100:103], a[36:39]
    v_mfma_f32_16x16x32_bf16 a[40:43], v[88:91], v[104:107], a[40:43]
    v_mfma_f32_16x16x32_bf16 a[44:47], v[88:91], v[108:111], a[44:47]
    v_mfma_f32_16x16x32_bf16 a[48:51], v[92:95], v[96:99], a[48:51]
    v_mfma_f32_16x16x32_bf16 a[52:55], v[92:95], v[100:103], a[52:55]
    v_mfma_f32_16x16x32_bf16 a[56:59], v[92:95], v[104:107], a[56:59]
    v_mfma_f32_16x16x32_bf16 a[60:63], v[92:95], v[108:111], a[60:63]
    buffer_load_dwordx4 v[80:83], v4, s[12:15], s20 offen offset:2048
    buffer_load_dwordx4 v[84:87], v4, s[12:15], s21 offen offset:2048
    buffer_load_dwordx4 v[88:91], v4, s[12:15], s22 offen offset:2048
    buffer_load_dwordx4 v[92:95], v4, s[12:15], s23 offen offset:2048
    buffer_load_dwordx4 v[96:99], v5, s[12:15], s24 offen offset:2048
    buffer_load_dwordx4 v[100:103], v5, s[12:15], s25 offen offset:2048
    buffer_load_dwordx4 v[104:107], v5, s[12:15], s26 offen offset:2048
    buffer_load_dwordx4 v[108:111], v5, s[12:15], s27 offen offset:2048
    s_waitcnt vmcnt(24)
    v_mfma_f32_16x16x32_bf16 a[0:3], v[112:115], v[128:131], a[0:3]
    v_mfma_f32_16x16x32_bf16 a[4:7], v[112:115], v[132:135], a[4:7]
    v_mfma_f32_16x16x32_bf16 a[8:11], v[112:115], v[136:139], a[8:11]
    v_mfma_f32_16x16x32_bf16 a[12:15], v[112:115], v[140:143], a[12:15]
    v_mfma_f32_16x16x32_bf16 a[16:19], v[116:119], v[128:131], a[16:19]
    v_mfma_f32_16x16x32_bf16 a[20:23], v[116:119], v[132:135], a[20:23]
    v_mfma_f32_16x16x32_bf16 a[24:27], v[116:119], v[136:139], a[24:27]
    v_mfma_f32_16x16x32_bf16 a[28:31], v[116:119], v[140:143], a[28:31]
    v_mfma_f32_16x16x32_bf16 a[32:35], v[120:123], v[128:131], a[32:35]
    v_mfma_f32_16x16x32_bf16 a[36:39], v[120:123], v[132:135], a[36:39]
    v_mfma_f32_16x16x32_bf16 a[40:43], v[120:123], v[136:139], a[40:43]
    v_mfma_f32_16x16x32_bf16 a[44:47], v[120:123], v[140:143], a[44:47]
    v_mfma_f32_16x16x32_bf16 a[48:51], v[124:127], v[128:131], a[48:51]
    v_mfma_f32_16x16x32_bf16 a[52:55], v[124:127], v[132:135], a[52:55]
    v_mfma_f32_16x16x32_bf16 a[56:59], v[124:127], v[136:139], a[56:59]
    v_mfma_f32_16x16x32_bf16 a[60:63], v[124:127], v[140:143], a[60:63]
    buffer_load_dwordx4 v[112:115], v4, s[12:15], s20 offen offset:3072
    buffer_load_dwordx4 v[116:119], v4, s[12:15], s21 offen offset:3072
    buffer_load_dwordx4 v[120:123], v4, s[12:15], s22 offen offset:3072
    buffer_load_dwordx4 v[124:127], v4, s[12:15], s23 offen offset:3072
    buffer_load_dwordx4 v[128:131], v5, s[12:15], s24 offen offset:3072
    buffer_load_dwordx4 v[132:135], v5, s[12:15], s25 offen offset:3072
    buffer_load_dwordx4 v[136:139], v5, s[12:15], s26 offen offset:3072
    buffer_load_dwordx4 v[140:143], v5, s[12:15], s27 offen offset:3072
    s_waitcnt vmcnt(24)
    v_mfma_f32_16x16x32_bf16 a[0:3], v[16:19], v[32:35], a[0:3]
    v_mfma_f32_16x16x32_bf16 a[4:7], v[16:19], v[36:39], a[4:7]
    v_mfma_f32_16x16x32_bf16 a[8:11], v[16:19], v[40:43], a[8:11]
    v_mfma_f32_16x16x32_bf16 a[12:15], v[16:19], v[44:47], a[12:15]
    v_mfma_f32_16x16x32_bf16 a[16:19], v[20:23], v[32:35], a[16:19]
    v_mfma_f32_16x16x32_bf16 a[20:23], v[20:23], v[36:39], a[20:23]
    v_mfma_f32_16x16x32_bf16 a[24:27], v[20:23], v[40:43], a[24:27]
    v_mfma_f32_16x16x32_bf16 a[28:31], v[20:23], v[44:47], a[28:31]
    v_mfma_f32_16x16x32_bf16 a[32:35], v[24:27], v[32:35], a[32:35]
    v_mfma_f32_16x16x32_bf16 a[36:39], v[24:27], v[36:39], a[36:39]
    v_mfma_f32_16x16x32_bf16 a[40:43], v[24:27], v[40:43], a[40:43]
    v_mfma_f32_16x16x32_bf16 a[44:47], v[24:27], v[44:47], a[44:47]
    v_mfma_f32_16x16x32_bf16 a[48:51], v[28:31], v[32:35], a[48:51]
    v_mfma_f32_16x16x32_bf16 a[52:55], v[28:31], v[36:39], a[52:55]
    v_mfma_f32_16x16x32_bf16 a[56:59], v[28:31], v[40:43], a[56:59]
    v_mfma_f32_16x16x32_bf16 a[60:63], v[28:31], v[44:47], a[60:63]
    v_add_u32 v4, 393216, v2
    v_add_u32 v5, 12288, v2
    buffer_load_dwordx4 v[16:19], v4, s[12:15], s20 offen offset:0
    buffer_load_dwordx4 v[20:23], v4, s[12:15], s21 offen offset:0
    buffer_load_dwordx4 v[24:27], v4, s[12:15], s22 offen offset:0
    buffer_load_dwordx4 v[28:31], v4, s[12:15], s23 offen offset:0
    buffer_load_dwordx4 v[32:35], v5, s[12:15], s24 offen offset:0
    buffer_load_dwordx4 v[36:39], v5, s[12:15], s25 offen offset:0
    buffer_load_dwordx4 v[40:43], v5, s[12:15], s26 offen offset:0
    buffer_load_dwordx4 v[44:47], v5, s[12:15], s27 offen offset:0
    s_waitcnt vmcnt(24)
    v_mfma_f32_16x16x32_bf16 a[0:3], v[48:51], v[64:67], a[0:3]
    v_mfma_f32_16x16x32_bf16 a[4:7], v[48:51], v[68:71], a[4:7]
    v_mfma_f32_16x16x32_bf16 a[8:11], v[48:51], v[72:75], a[8:11]
    v_mfma_f32_16x16x32_bf16 a[12:15], v[48:51], v[76:79], a[12:15]
    v_mfma_f32_16x16x32_bf16 a[16:19], v[52:55], v[64:67], a[16:19]
    v_mfma_f32_16x16x32_bf16 a[20:23], v[52:55], v[68:71], a[20:23]
    v_mfma_f32_16x16x32_bf16 a[24:27], v[52:55], v[72:75], a[24:27]
    v_mfma_f32_16x16x32_bf16 a[28:31], v[52:55], v[76:79], a[28:31]
    v_mfma_f32_16x16x32_bf16 a[32:35], v[56:59], v[64:67], a[32:35]
    v_mfma_f32_16x16x32_bf16 a[36:39], v[56:59], v[68:71], a[36:39]
    v_mfma_f32_16x16x32_bf16 a[40:43], v[56:59], v[72:75], a[40:43]
    v_mfma_f32_16x16x32_bf16 a[44:47], v[56:59], v[76:79], a[44:47]
    v_mfma_f32_16x16x32_bf16 a[48:51], v[60:63], v[64:67], a[48:51]
    v_mfma_f32_16x16x32_bf16 a[52:55], v[60:63], v[68:71], a[52:55]
    v_mfma_f32_16x16x32_bf16 a[56:59], v[60:63], v[72:75], a[56:59]
    v_mfma_f32_16x16x32_bf16 a[60:63], v[60:63], v[76:79], a[60:63]
    buffer_load_dwordx4 v[48:51], v4, s[12:15], s20 offen offset:1024
    buffer_load_dwordx4 v[52:55], v4, s[12:15], s21 offen offset:1024
    buffer_load_dwordx4 v[56:59], v4, s[12:15], s22 offen offset:1024
    buffer_load_dwordx4 v[60:63], v4, s[12:15], s23 offen offset:1024
    buffer_load_dwordx4 v[64:67], v5, s[12:15], s24 offen offset:1024
    buffer_load_dwordx4 v[68:71], v5, s[12:15], s25 offen offset:1024
    buffer_load_dwordx4 v[72:75], v5, s[12:15], s26 offen offset:1024
    buffer_load_dwordx4 v[76:79], v5, s[12:15], s27 offen offset:1024
    s_waitcnt vmcnt(24)
    v_mfma_f32_16x16x32_bf16 a[0:3], v[80:83], v[96:99], a[0:3]
    v_mfma_f32_16x16x32_bf16 a[4:7], v[80:83], v[100:103], a[4:7]
    v_mfma_f32_16x16x32_bf16 a[8:11], v[80:83], v[104:107], a[8:11]
    v_mfma_f32_16x16x32_bf16 a[12:15], v[80:83], v[108:111], a[12:15]
    v_mfma_f32_16x16x32_bf16 a[16:19], v[84:87], v[96:99], a[16:19]
    v_mfma_f32_16x16x32_bf16 a[20:23], v[84:87], v[100:103], a[20:23]
    v_mfma_f32_16x16x32_bf16 a[24:27], v[84:87], v[104:107], a[24:27]
    v_mfma_f32_16x16x32_bf16 a[28:31], v[84:87], v[108:111], a[28:31]
    v_mfma_f32_16x16x32_bf16 a[32:35], v[88:91], v[96:99], a[32:35]
    v_mfma_f32_16x16x32_bf16 a[36:39], v[88:91], v[100:103], a[36:39]
    v_mfma_f32_16x16x32_bf16 a[40:43], v[88:91], v[104:107], a[40:43]
    v_mfma_f32_16x16x32_bf16 a[44:47], v[88:91], v[108:111], a[44:47]
    v_mfma_f32_16x16x32_bf16 a[48:51], v[92:95], v[96:99], a[48:51]
    v_mfma_f32_16x16x32_bf16 a[52:55], v[92:95], v[100:103], a[52:55]
    v_mfma_f32_16x16x32_bf16 a[56:59], v[92:95], v[104:107], a[56:59]
    v_mfma_f32_16x16x32_bf16 a[60:63], v[92:95], v[108:111], a[60:63]
    buffer_load_dwordx4 v[80:83], v4, s[12:15], s20 offen offset:2048
    buffer_load_dwordx4 v[84:87], v4, s[12:15], s21 offen offset:2048
    buffer_load_dwordx4 v[88:91], v4, s[12:15], s22 offen offset:2048
    buffer_load_dwordx4 v[92:95], v4, s[12:15], s23 offen offset:2048
    buffer_load_dwordx4 v[96:99], v5, s[12:15], s24 offen offset:2048
    buffer_load_dwordx4 v[100:103], v5, s[12:15], s25 offen offset:2048
    buffer_load_dwordx4 v[104:107], v5, s[12:15], s26 offen offset:2048
    buffer_load_dwordx4 v[108:111], v5, s[12:15], s27 offen offset:2048
    s_waitcnt vmcnt(24)
    v_mfma_f32_16x16x32_bf16 a[0:3], v[112:115], v[128:131], a[0:3]
    v_mfma_f32_16x16x32_bf16 a[4:7], v[112:115], v[132:135], a[4:7]
    v_mfma_f32_16x16x32_bf16 a[8:11], v[112:115], v[136:139], a[8:11]
    v_mfma_f32_16x16x32_bf16 a[12:15], v[112:115], v[140:143], a[12:15]
    v_mfma_f32_16x16x32_bf16 a[16:19], v[116:119], v[128:131], a[16:19]
    v_mfma_f32_16x16x32_bf16 a[20:23], v[116:119], v[132:135], a[20:23]
    v_mfma_f32_16x16x32_bf16 a[24:27], v[116:119], v[136:139], a[24:27]
    v_mfma_f32_16x16x32_bf16 a[28:31], v[116:119], v[140:143], a[28:31]
    v_mfma_f32_16x16x32_bf16 a[32:35], v[120:123], v[128:131], a[32:35]
    v_mfma_f32_16x16x32_bf16 a[36:39], v[120:123], v[132:135], a[36:39]
    v_mfma_f32_16x16x32_bf16 a[40:43], v[120:123], v[136:139], a[40:43]
    v_mfma_f32_16x16x32_bf16 a[44:47], v[120:123], v[140:143], a[44:47]
    v_mfma_f32_16x16x32_bf16 a[48:51], v[124:127], v[128:131], a[48:51]
    v_mfma_f32_16x16x32_bf16 a[52:55], v[124:127], v[132:135], a[52:55]
    v_mfma_f32_16x16x32_bf16 a[56:59], v[124:127], v[136:139], a[56:59]
    v_mfma_f32_16x16x32_bf16 a[60:63], v[124:127], v[140:143], a[60:63]
    buffer_load_dwordx4 v[112:115], v4, s[12:15], s20 offen offset:3072
    buffer_load_dwordx4 v[116:119], v4, s[12:15], s21 offen offset:3072
    buffer_load_dwordx4 v[120:123], v4, s[12:15], s22 offen offset:3072
    buffer_load_dwordx4 v[124:127], v4, s[12:15], s23 offen offset:3072
    buffer_load_dwordx4 v[128:131], v5, s[12:15], s24 offen offset:3072
    buffer_load_dwordx4 v[132:135], v5, s[12:15], s25 offen offset:3072
    buffer_load_dwordx4 v[136:139], v5, s[12:15], s26 offen offset:3072
    buffer_load_dwordx4 v[140:143], v5, s[12:15], s27 offen offset:3072
    s_waitcnt vmcnt(24)
    v_mfma_f32_16x16x32_bf16 a[0:3], v[16:19], v[32:35], a[0:3]
    v_mfma_f32_16x16x32_bf16 a[4:7], v[16:19], v[36:39], a[4:7]
    v_mfma_f32_16x16x32_bf16 a[8:11], v[16:19], v[40:43], a[8:11]
    v_mfma_f32_16x16x32_bf16 a[12:15], v[16:19], v[44:47], a[12:15]
    v_mfma_f32_16x16x32_bf16 a[16:19], v[20:23], v[32:35], a[16:19]
    v_mfma_f32_16x16x32_bf16 a[20:23], v[20:23], v[36:39], a[20:23]
    v_mfma_f32_16x16x32_bf16 a[24:27], v[20:23], v[40:43], a[24:27]
    v_mfma_f32_16x16x32_bf16 a[28:31], v[20:23], v[44:47], a[28:31]
    v_mfma_f32_16x16x32_bf16 a[32:35], v[24:27], v[32:35], a[32:35]
    v_mfma_f32_16x16x32_bf16 a[36:39], v[24:27], v[36:39], a[36:39]
    v_mfma_f32_16x16x32_bf16 a[40:43], v[24:27], v[40:43], a[40:43]
    v_mfma_f32_16x16x32_bf16 a[44:47], v[24:27], v[44:47], a[44:47]
    v_mfma_f32_16x16x32_bf16 a[48:51], v[28:31], v[32:35], a[48:51]
    v_mfma_f32_16x16x32_bf16 a[52:55], v[28:31], v[36:39], a[52:55]
    v_mfma_f32_16x16x32_bf16 a[56:59], v[28:31], v[40:43], a[56:59]
    v_mfma_f32_16x16x32_bf16 a[60:63], v[28:31], v[44:47], a[60:63]
    v_add_u32 v4, 524288, v2
    v_add_u32 v5, 16384, v2
    buffer_load_dwordx4 v[16:19], v4, s[12:15], s20 offen offset:0
    buffer_load_dwordx4 v[20:23], v4, s[12:15], s21 offen offset:0
    buffer_load_dwordx4 v[24:27], v4, s[12:15], s22 offen offset:0
    buffer_load_dwordx4 v[28:31], v4, s[12:15], s23 offen offset:0
    buffer_load_dwordx4 v[32:35], v5, s[12:15], s24 offen offset:0
    buffer_load_dwordx4 v[36:39], v5, s[12:15], s25 offen offset:0
    buffer_load_dwordx4 v[40:43], v5, s[12:15], s26 offen offset:0
    buffer_load_dwordx4 v[44:47], v5, s[12:15], s27 offen offset:0
    s_waitcnt vmcnt(24)
    v_mfma_f32_16x16x32_bf16 a[0:3], v[48:51], v[64:67], a[0:3]
    v_mfma_f32_16x16x32_bf16 a[4:7], v[48:51], v[68:71], a[4:7]
    v_mfma_f32_16x16x32_bf16 a[8:11], v[48:51], v[72:75], a[8:11]
    v_mfma_f32_16x16x32_bf16 a[12:15], v[48:51], v[76:79], a[12:15]
    v_mfma_f32_16x16x32_bf16 a[16:19], v[52:55], v[64:67], a[16:19]
    v_mfma_f32_16x16x32_bf16 a[20:23], v[52:55], v[68:71], a[20:23]
    v_mfma_f32_16x16x32_bf16 a[24:27], v[52:55], v[72:75], a[24:27]
    v_mfma_f32_16x16x32_bf16 a[28:31], v[52:55], v[76:79], a[28:31]
    v_mfma_f32_16x16x32_bf16 a[32:35], v[56:59], v[64:67], a[32:35]
    v_mfma_f32_16x16x32_bf16 a[36:39], v[56:59], v[68:71], a[36:39]
    v_mfma_f32_16x16x32_bf16 a[40:43], v[56:59], v[72:75], a[40:43]
    v_mfma_f32_16x16x32_bf16 a[44:47], v[56:59], v[76:79], a[44:47]
    v_mfma_f32_16x16x32_bf16 a[48:51], v[60:63], v[64:67], a[48:51]
    v_mfma_f32_16x16x32_bf16 a[52:55], v[60:63], v[68:71], a[52:55]
    v_mfma_f32_16x16x32_bf16 a[56:59], v[60:63], v[72:75], a[56:59]
    v_mfma_f32_16x16x32_bf16 a[60:63], v[60:63], v[76:79], a[60:63]
    buffer_load_dwordx4 v[48:51], v4, s[12:15], s20 offen offset:1024
    buffer_load_dwordx4 v[52:55], v4, s[12:15], s21 offen offset:1024
    buffer_load_dwordx4 v[56:59], v4, s[12:15], s22 offen offset:1024
    buffer_load_dwordx4 v[60:63], v4, s[12:15], s23 offen offset:1024
    buffer_load_dwordx4 v[64:67], v5, s[12:15], s24 offen offset:1024
    buffer_load_dwordx4 v[68:71], v5, s[12:15], s25 offen offset:1024
    buffer_load_dwordx4 v[72:75], v5, s[12:15], s26 offen offset:1024
    buffer_load_dwordx4 v[76:79], v5, s[12:15], s27 offen offset:1024
    s_waitcnt vmcnt(24)
    v_mfma_f32_16x16x32_bf16 a[0:3], v[80:83], v[96:99], a[0:3]
    v_mfma_f32_16x16x32_bf16 a[4:7], v[80:83], v[100:103], a[4:7]
    v_mfma_f32_16x16x32_bf16 a[8:11], v[80:83], v[104:107], a[8:11]
    v_mfma_f32_16x16x32_bf16 a[12:15], v[80:83], v[108:111], a[12:15]
    v_mfma_f32_16x16x32_bf16 a[16:19], v[84:87], v[96:99], a[16:19]
    v_mfma_f32_16x16x32_bf16 a[20:23], v[84:87], v[100:103], a[20:23]
    v_mfma_f32_16x16x32_bf16 a[24:27], v[84:87], v[104:107], a[24:27]
    v_mfma_f32_16x16x32_bf16 a[28:31], v[84:87], v[108:111], a[28:31]
    v_mfma_f32_16x16x32_bf16 a[32:35], v[88:91], v[96:99], a[32:35]
    v_mfma_f32_16x16x32_bf16 a[36:39], v[88:91], v[100:103], a[36:39]
    v_mfma_f32_16x16x32_bf16 a[40:43], v[88:91], v[104:107], a[40:43]
    v_mfma_f32_16x16x32_bf16 a[44:47], v[88:91], v[108:111], a[44:47]
    v_mfma_f32_16x16x32_bf16 a[48:51], v[92:95], v[96:99], a[48:51]
    v_mfma_f32_16x16x32_bf16 a[52:55], v[92:95], v[100:103], a[52:55]
    v_mfma_f32_16x16x32_bf16 a[56:59], v[92:95], v[104:107], a[56:59]
    v_mfma_f32_16x16x32_bf16 a[60:63], v[92:95], v[108:111], a[60:63]
    buffer_load_dwordx4 v[80:83], v4, s[12:15], s20 offen offset:2048
    buffer_load_dwordx4 v[84:87], v4, s[12:15], s21 offen offset:2048
    buffer_load_dwordx4 v[88:91], v4, s[12:15], s22 offen offset:2048
    buffer_load_dwordx4 v[92:95], v4, s[12:15], s23 offen offset:2048
    buffer_load_dwordx4 v[96:99], v5, s[12:15], s24 offen offset:2048
    buffer_load_dwordx4 v[100:103], v5, s[12:15], s25 offen offset:2048
    buffer_load_dwordx4 v[104:107], v5, s[12:15], s26 offen offset:2048
    buffer_load_dwordx4 v[108:111], v5, s[12:15], s27 offen offset:2048
    s_waitcnt vmcnt(24)
    v_mfma_f32_16x16x32_bf16 a[0:3], v[112:115], v[128:131], a[0:3]
    v_mfma_f32_16x16x32_bf16 a[4:7], v[112:115], v[132:135], a[4:7]
    v_mfma_f32_16x16x32_bf16 a[8:11], v[112:115], v[136:139], a[8:11]
    v_mfma_f32_16x16x32_bf16 a[12:15], v[112:115], v[140:143], a[12:15]
    v_mfma_f32_16x16x32_bf16 a[16:19], v[116:119], v[128:131], a[16:19]
    v_mfma_f32_16x16x32_bf16 a[20:23], v[116:119], v[132:135], a[20:23]
    v_mfma_f32_16x16x32_bf16 a[24:27], v[116:119], v[136:139], a[24:27]
    v_mfma_f32_16x16x32_bf16 a[28:31], v[116:119], v[140:143], a[28:31]
    v_mfma_f32_16x16x32_bf16 a[32:35], v[120:123], v[128:131], a[32:35]
    v_mfma_f32_16x16x32_bf16 a[36:39], v[120:123], v[132:135], a[36:39]
    v_mfma_f32_16x16x32_bf16 a[40:43], v[120:123], v[136:139], a[40:43]
    v_mfma_f32_16x16x32_bf16 a[44:47], v[120:123], v[140:143], a[44:47]
    v_mfma_f32_16x16x32_bf16 a[48:51], v[124:127], v[128:131], a[48:51]
    v_mfma_f32_16x16x32_bf16 a[52:55], v[124:127], v[132:135], a[52:55]
    v_mfma_f32_16x16x32_bf16 a[56:59], v[124:127], v[136:139], a[56:59]
    v_mfma_f32_16x16x32_bf16 a[60:63], v[124:127], v[140:143], a[60:63]
    buffer_load_dwordx4 v[112:115], v4, s[12:15], s20 offen offset:3072
    buffer_load_dwordx4 v[116:119], v4, s[12:15], s21 offen offset:3072
    buffer_load_dwordx4 v[120:123], v4, s[12:15], s22 offen offset:3072
    buffer_load_dwordx4 v[124:127], v4, s[12:15], s23 offen offset:3072
    buffer_load_dwordx4 v[128:131], v5, s[12:15], s24 offen offset:3072
    buffer_load_dwordx4 v[132:135], v5, s[12:15], s25 offen offset:3072
    buffer_load_dwordx4 v[136:139], v5, s[12:15], s26 offen offset:3072
    buffer_load_dwordx4 v[140:143], v5, s[12:15], s27 offen offset:3072
    s_waitcnt vmcnt(24)
    v_mfma_f32_16x16x32_bf16 a[0:3], v[16:19], v[32:35], a[0:3]
    v_mfma_f32_16x16x32_bf16 a[4:7], v[16:19], v[36:39], a[4:7]
    v_mfma_f32_16x16x32_bf16 a[8:11], v[16:19], v[40:43], a[8:11]
    v_mfma_f32_16x16x32_bf16 a[12:15], v[16:19], v[44:47], a[12:15]
    v_mfma_f32_16x16x32_bf16 a[16:19], v[20:23], v[32:35], a[16:19]
    v_mfma_f32_16x16x32_bf16 a[20:23], v[20:23], v[36:39], a[20:23]
    v_mfma_f32_16x16x32_bf16 a[24:27], v[20:23], v[40:43], a[24:27]
    v_mfma_f32_16x16x32_bf16 a[28:31], v[20:23], v[44:47], a[28:31]
    v_mfma_f32_16x16x32_bf16 a[32:35], v[24:27], v[32:35], a[32:35]
    v_mfma_f32_16x16x32_bf16 a[36:39], v[24:27], v[36:39], a[36:39]
    v_mfma_f32_16x16x32_bf16 a[40:43], v[24:27], v[40:43], a[40:43]
    v_mfma_f32_16x16x32_bf16 a[44:47], v[24:27], v[44:47], a[44:47]
    v_mfma_f32_16x16x32_bf16 a[48:51], v[28:31], v[32:35], a[48:51]
    v_mfma_f32_16x16x32_bf16 a[52:55], v[28:31], v[36:39], a[52:55]
    v_mfma_f32_16x16x32_bf16 a[56:59], v[28:31], v[40:43], a[56:59]
    v_mfma_f32_16x16x32_bf16 a[60:63], v[28:31], v[44:47], a[60:63]
    v_add_u32 v4, 655360, v2
    v_add_u32 v5, 20480, v2
    buffer_load_dwordx4 v[16:19], v4, s[12:15], s20 offen offset:0
    buffer_load_dwordx4 v[20:23], v4, s[12:15], s21 offen offset:0
    buffer_load_dwordx4 v[24:27], v4, s[12:15], s22 offen offset:0
    buffer_load_dwordx4 v[28:31], v4, s[12:15], s23 offen offset:0
    buffer_load_dwordx4 v[32:35], v5, s[12:15], s24 offen offset:0
    buffer_load_dwordx4 v[36:39], v5, s[12:15], s25 offen offset:0
    buffer_load_dwordx4 v[40:43], v5, s[12:15], s26 offen offset:0
    buffer_load_dwordx4 v[44:47], v5, s[12:15], s27 offen offset:0
    s_waitcnt vmcnt(24)
    v_mfma_f32_16x16x32_bf16 a[0:3], v[48:51], v[64:67], a[0:3]
    v_mfma_f32_16x16x32_bf16 a[4:7], v[48:51], v[68:71], a[4:7]
    v_mfma_f32_16x16x32_bf16 a[8:11], v[48:51], v[72:75], a[8:11]
    v_mfma_f32_16x16x32_bf16 a[12:15], v[48:51], v[76:79], a[12:15]
    v_mfma_f32_16x16x32_bf16 a[16:19], v[52:55], v[64:67], a[16:19]
    v_mfma_f32_16x16x32_bf16 a[20:23], v[52:55], v[68:71], a[20:23]
    v_mfma_f32_16x16x32_bf16 a[24:27], v[52:55], v[72:75], a[24:27]
    v_mfma_f32_16x16x32_bf16 a[28:31], v[52:55], v[76:79], a[28:31]
    v_mfma_f32_16x16x32_bf16 a[32:35], v[56:59], v[64:67], a[32:35]
    v_mfma_f32_16x16x32_bf16 a[36:39], v[56:59], v[68:71], a[36:39]
    v_mfma_f32_16x16x32_bf16 a[40:43], v[56:59], v[72:75], a[40:43]
    v_mfma_f32_16x16x32_bf16 a[44:47], v[56:59], v[76:79], a[44:47]
    v_mfma_f32_16x16x32_bf16 a[48:51], v[60:63], v[64:67], a[48:51]
    v_mfma_f32_16x16x32_bf16 a[52:55], v[60:63], v[68:71], a[52:55]
    v_mfma_f32_16x16x32_bf16 a[56:59], v[60:63], v[72:75], a[56:59]
    v_mfma_f32_16x16x32_bf16 a[60:63], v[60:63], v[76:79], a[60:63]
    buffer_load_dwordx4 v[48:51], v4, s[12:15], s20 offen offset:1024
    buffer_load_dwordx4 v[52:55], v4, s[12:15], s21 offen offset:1024
    buffer_load_dwordx4 v[56:59], v4, s[12:15], s22 offen offset:1024
    buffer_load_dwordx4 v[60:63], v4, s[12:15], s23 offen offset:1024
    buffer_load_dwordx4 v[64:67], v5, s[12:15], s24 offen offset:1024
    buffer_load_dwordx4 v[68:71], v5, s[12:15], s25 offen offset:1024
    buffer_load_dwordx4 v[72:75], v5, s[12:15], s26 offen offset:1024
    buffer_load_dwordx4 v[76:79], v5, s[12:15], s27 offen offset:1024
    s_waitcnt vmcnt(24)
    v_mfma_f32_16x16x32_bf16 a[0:3], v[80:83], v[96:99], a[0:3]
    v_mfma_f32_16x16x32_bf16 a[4:7], v[80:83], v[100:103], a[4:7]
    v_mfma_f32_16x16x32_bf16 a[8:11], v[80:83], v[104:107], a[8:11]
    v_mfma_f32_16x16x32_bf16 a[12:15], v[80:83], v[108:111], a[12:15]
    v_mfma_f32_16x16x32_bf16 a[16:19], v[84:87], v[96:99], a[16:19]
    v_mfma_f32_16x16x32_bf16 a[20:23], v[84:87], v[100:103], a[20:23]
    v_mfma_f32_16x16x32_bf16 a[24:27], v[84:87], v[104:107], a[24:27]
    v_mfma_f32_16x16x32_bf16 a[28:31], v[84:87], v[108:111], a[28:31]
    v_mfma_f32_16x16x32_bf16 a[32:35], v[88:91], v[96:99], a[32:35]
    v_mfma_f32_16x16x32_bf16 a[36:39], v[88:91], v[100:103], a[36:39]
    v_mfma_f32_16x16x32_bf16 a[40:43], v[88:91], v[104:107], a[40:43]
    v_mfma_f32_16x16x32_bf16 a[44:47], v[88:91], v[108:111], a[44:47]
    v_mfma_f32_16x16x32_bf16 a[48:51], v[92:95], v[96:99], a[48:51]
    v_mfma_f32_16x16x32_bf16 a[52:55], v[92:95], v[100:103], a[52:55]
    v_mfma_f32_16x16x32_bf16 a[56:59], v[92:95], v[104:107], a[56:59]
    v_mfma_f32_16x16x32_bf16 a[60:63], v[92:95], v[108:111], a[60:63]
    buffer_load_dwordx4 v[80:83], v4, s[12:15], s20 offen offset:2048
    buffer_load_dwordx4 v[84:87], v4, s[12:15], s21 offen offset:2048
    buffer_load_dwordx4 v[88:91], v4, s[12:15], s22 offen offset:2048
    buffer_load_dwordx4 v[92:95], v4, s[12:15], s23 offen offset:2048
    buffer_load_dwordx4 v[96:99], v5, s[12:15], s24 offen offset:2048
    buffer_load_dwordx4 v[100:103], v5, s[12:15], s25 offen offset:2048
    buffer_load_dwordx4 v[104:107], v5, s[12:15], s26 offen offset:2048
    buffer_load_dwordx4 v[108:111], v5, s[12:15], s27 offen offset:2048
    s_waitcnt vmcnt(24)
    v_mfma_f32_16x16x32_bf16 a[0:3], v[112:115], v[128:131], a[0:3]
    v_mfma_f32_16x16x32_bf16 a[4:7], v[112:115], v[132:135], a[4:7]
    v_mfma_f32_16x16x32_bf16 a[8:11], v[112:115], v[136:139], a[8:11]
    v_mfma_f32_16x16x32_bf16 a[12:15], v[112:115], v[140:143], a[12:15]
    v_mfma_f32_16x16x32_bf16 a[16:19], v[116:119], v[128:131], a[16:19]
    v_mfma_f32_16x16x32_bf16 a[20:23], v[116:119], v[132:135], a[20:23]
    v_mfma_f32_16x16x32_bf16 a[24:27], v[116:119], v[136:139], a[24:27]
    v_mfma_f32_16x16x32_bf16 a[28:31], v[116:119], v[140:143], a[28:31]
    v_mfma_f32_16x16x32_bf16 a[32:35], v[120:123], v[128:131], a[32:35]
    v_mfma_f32_16x16x32_bf16 a[36:39], v[120:123], v[132:135], a[36:39]
    v_mfma_f32_16x16x32_bf16 a[40:43], v[120:123], v[136:139], a[40:43]
    v_mfma_f32_16x16x32_bf16 a[44:47], v[120:123], v[140:143], a[44:47]
    v_mfma_f32_16x16x32_bf16 a[48:51], v[124:127], v[128:131], a[48:51]
    v_mfma_f32_16x16x32_bf16 a[52:55], v[124:127], v[132:135], a[52:55]
    v_mfma_f32_16x16x32_bf16 a[56:59], v[124:127], v[136:139], a[56:59]
    v_mfma_f32_16x16x32_bf16 a[60:63], v[124:127], v[140:143], a[60:63]
    buffer_load_dwordx4 v[112:115], v4, s[12:15], s20 offen offset:3072
    buffer_load_dwordx4 v[116:119], v4, s[12:15], s21 offen offset:3072
    buffer_load_dwordx4 v[120:123], v4, s[12:15], s22 offen offset:3072
    buffer_load_dwordx4 v[124:127], v4, s[12:15], s23 offen offset:3072
    buffer_load_dwordx4 v[128:131], v5, s[12:15], s24 offen offset:3072
    buffer_load_dwordx4 v[132:135], v5, s[12:15], s25 offen offset:3072
    buffer_load_dwordx4 v[136:139], v5, s[12:15], s26 offen offset:3072
    buffer_load_dwordx4 v[140:143], v5, s[12:15], s27 offen offset:3072
    s_waitcnt vmcnt(24)
    v_mfma_f32_16x16x32_bf16 a[0:3], v[16:19], v[32:35], a[0:3]
    v_mfma_f32_16x16x32_bf16 a[4:7], v[16:19], v[36:39], a[4:7]
    v_mfma_f32_16x16x32_bf16 a[8:11], v[16:19], v[40:43], a[8:11]
    v_mfma_f32_16x16x32_bf16 a[12:15], v[16:19], v[44:47], a[12:15]
    v_mfma_f32_16x16x32_bf16 a[16:19], v[20:23], v[32:35], a[16:19]
    v_mfma_f32_16x16x32_bf16 a[20:23], v[20:23], v[36:39], a[20:23]
    v_mfma_f32_16x16x32_bf16 a[24:27], v[20:23], v[40:43], a[24:27]
    v_mfma_f32_16x16x32_bf16 a[28:31], v[20:23], v[44:47], a[28:31]
    v_mfma_f32_16x16x32_bf16 a[32:35], v[24:27], v[32:35], a[32:35]
    v_mfma_f32_16x16x32_bf16 a[36:39], v[24:27], v[36:39], a[36:39]
    v_mfma_f32_16x16x32_bf16 a[40:43], v[24:27], v[40:43], a[40:43]
    v_mfma_f32_16x16x32_bf16 a[44:47], v[24:27], v[44:47], a[44:47]
    v_mfma_f32_16x16x32_bf16 a[48:51], v[28:31], v[32:35], a[48:51]
    v_mfma_f32_16x16x32_bf16 a[52:55], v[28:31], v[36:39], a[52:55]
    v_mfma_f32_16x16x32_bf16 a[56:59], v[28:31], v[40:43], a[56:59]
    v_mfma_f32_16x16x32_bf16 a[60:63], v[28:31], v[44:47], a[60:63]
    v_add_u32 v4, 786432, v2
    v_add_u32 v5, 24576, v2
    buffer_load_dwordx4 v[16:19], v4, s[12:15], s20 offen offset:0
    buffer_load_dwordx4 v[20:23], v4, s[12:15], s21 offen offset:0
    buffer_load_dwordx4 v[24:27], v4, s[12:15], s22 offen offset:0
    buffer_load_dwordx4 v[28:31], v4, s[12:15], s23 offen offset:0
    buffer_load_dwordx4 v[32:35], v5, s[12:15], s24 offen offset:0
    buffer_load_dwordx4 v[36:39], v5, s[12:15], s25 offen offset:0
    buffer_load_dwordx4 v[40:43], v5, s[12:15], s26 offen offset:0
    buffer_load_dwordx4 v[44:47], v5, s[12:15], s27 offen offset:0
    s_waitcnt vmcnt(24)
    v_mfma_f32_16x16x32_bf16 a[0:3], v[48:51], v[64:67], a[0:3]
    v_mfma_f32_16x16x32_bf16 a[4:7], v[48:51], v[68:71], a[4:7]
    v_mfma_f32_16x16x32_bf16 a[8:11], v[48:51], v[72:75], a[8:11]
    v_mfma_f32_16x16x32_bf16 a[12:15], v[48:51], v[76:79], a[12:15]
    v_mfma_f32_16x16x32_bf16 a[16:19], v[52:55], v[64:67], a[16:19]
    v_mfma_f32_16x16x32_bf16 a[20:23], v[52:55], v[68:71], a[20:23]
    v_mfma_f32_16x16x32_bf16 a[24:27], v[52:55], v[72:75], a[24:27]
    v_mfma_f32_16x16x32_bf16 a[28:31], v[52:55], v[76:79], a[28:31]
    v_mfma_f32_16x16x32_bf16 a[32:35], v[56:59], v[64:67], a[32:35]
    v_mfma_f32_16x16x32_bf16 a[36:39], v[56:59], v[68:71], a[36:39]
    v_mfma_f32_16x16x32_bf16 a[40:43], v[56:59], v[72:75], a[40:43]
    v_mfma_f32_16x16x32_bf16 a[44:47], v[56:59], v[76:79], a[44:47]
    v_mfma_f32_16x16x32_bf16 a[48:51], v[60:63], v[64:67], a[48:51]
    v_mfma_f32_16x16x32_bf16 a[52:55], v[60:63], v[68:71], a[52:55]
    v_mfma_f32_16x16x32_bf16 a[56:59], v[60:63], v[72:75], a[56:59]
    v_mfma_f32_16x16x32_bf16 a[60:63], v[60:63], v[76:79], a[60:63]
    buffer_load_dwordx4 v[48:51], v4, s[12:15], s20 offen offset:1024
    buffer_load_dwordx4 v[52:55], v4, s[12:15], s21 offen offset:1024
    buffer_load_dwordx4 v[56:59], v4, s[12:15], s22 offen offset:1024
    buffer_load_dwordx4 v[60:63], v4, s[12:15], s23 offen offset:1024
    buffer_load_dwordx4 v[64:67], v5, s[12:15], s24 offen offset:1024
    buffer_load_dwordx4 v[68:71], v5, s[12:15], s25 offen offset:1024
    buffer_load_dwordx4 v[72:75], v5, s[12:15], s26 offen offset:1024
    buffer_load_dwordx4 v[76:79], v5, s[12:15], s27 offen offset:1024
    s_waitcnt vmcnt(24)
    v_mfma_f32_16x16x32_bf16 a[0:3], v[80:83], v[96:99], a[0:3]
    v_mfma_f32_16x16x32_bf16 a[4:7], v[80:83], v[100:103], a[4:7]
    v_mfma_f32_16x16x32_bf16 a[8:11], v[80:83], v[104:107], a[8:11]
    v_mfma_f32_16x16x32_bf16 a[12:15], v[80:83], v[108:111], a[12:15]
    v_mfma_f32_16x16x32_bf16 a[16:19], v[84:87], v[96:99], a[16:19]
    v_mfma_f32_16x16x32_bf16 a[20:23], v[84:87], v[100:103], a[20:23]
    v_mfma_f32_16x16x32_bf16 a[24:27], v[84:87], v[104:107], a[24:27]
    v_mfma_f32_16x16x32_bf16 a[28:31], v[84:87], v[108:111], a[28:31]
    v_mfma_f32_16x16x32_bf16 a[32:35], v[88:91], v[96:99], a[32:35]
    v_mfma_f32_16x16x32_bf16 a[36:39], v[88:91], v[100:103], a[36:39]
    v_mfma_f32_16x16x32_bf16 a[40:43], v[88:91], v[104:107], a[40:43]
    v_mfma_f32_16x16x32_bf16 a[44:47], v[88:91], v[108:111], a[44:47]
    v_mfma_f32_16x16x32_bf16 a[48:51], v[92:95], v[96:99], a[48:51]
    v_mfma_f32_16x16x32_bf16 a[52:55], v[92:95], v[100:103], a[52:55]
    v_mfma_f32_16x16x32_bf16 a[56:59], v[92:95], v[104:107], a[56:59]
    v_mfma_f32_16x16x32_bf16 a[60:63], v[92:95], v[108:111], a[60:63]
    buffer_load_dwordx4 v[80:83], v4, s[12:15], s20 offen offset:2048
    buffer_load_dwordx4 v[84:87], v4, s[12:15], s21 offen offset:2048
    buffer_load_dwordx4 v[88:91], v4, s[12:15], s22 offen offset:2048
    buffer_load_dwordx4 v[92:95], v4, s[12:15], s23 offen offset:2048
    buffer_load_dwordx4 v[96:99], v5, s[12:15], s24 offen offset:2048
    buffer_load_dwordx4 v[100:103], v5, s[12:15], s25 offen offset:2048
    buffer_load_dwordx4 v[104:107], v5, s[12:15], s26 offen offset:2048
    buffer_load_dwordx4 v[108:111], v5, s[12:15], s27 offen offset:2048
    s_waitcnt vmcnt(24)
    v_mfma_f32_16x16x32_bf16 a[0:3], v[112:115], v[128:131], a[0:3]
    v_mfma_f32_16x16x32_bf16 a[4:7], v[112:115], v[132:135], a[4:7]
    v_mfma_f32_16x16x32_bf16 a[8:11], v[112:115], v[136:139], a[8:11]
    v_mfma_f32_16x16x32_bf16 a[12:15], v[112:115], v[140:143], a[12:15]
    v_mfma_f32_16x16x32_bf16 a[16:19], v[116:119], v[128:131], a[16:19]
    v_mfma_f32_16x16x32_bf16 a[20:23], v[116:119], v[132:135], a[20:23]
    v_mfma_f32_16x16x32_bf16 a[24:27], v[116:119], v[136:139], a[24:27]
    v_mfma_f32_16x16x32_bf16 a[28:31], v[116:119], v[140:143], a[28:31]
    v_mfma_f32_16x16x32_bf16 a[32:35], v[120:123], v[128:131], a[32:35]
    v_mfma_f32_16x16x32_bf16 a[36:39], v[120:123], v[132:135], a[36:39]
    v_mfma_f32_16x16x32_bf16 a[40:43], v[120:123], v[136:139], a[40:43]
    v_mfma_f32_16x16x32_bf16 a[44:47], v[120:123], v[140:143], a[44:47]
    v_mfma_f32_16x16x32_bf16 a[48:51], v[124:127], v[128:131], a[48:51]
    v_mfma_f32_16x16x32_bf16 a[52:55], v[124:127], v[132:135], a[52:55]
    v_mfma_f32_16x16x32_bf16 a[56:59], v[124:127], v[136:139], a[56:59]
    v_mfma_f32_16x16x32_bf16 a[60:63], v[124:127], v[140:143], a[60:63]
    buffer_load_dwordx4 v[112:115], v4, s[12:15], s20 offen offset:3072
    buffer_load_dwordx4 v[116:119], v4, s[12:15], s21 offen offset:3072
    buffer_load_dwordx4 v[120:123], v4, s[12:15], s22 offen offset:3072
    buffer_load_dwordx4 v[124:127], v4, s[12:15], s23 offen offset:3072
    buffer_load_dwordx4 v[128:131], v5, s[12:15], s24 offen offset:3072
    buffer_load_dwordx4 v[132:135], v5, s[12:15], s25 offen offset:3072
    buffer_load_dwordx4 v[136:139], v5, s[12:15], s26 offen offset:3072
    buffer_load_dwordx4 v[140:143], v5, s[12:15], s27 offen offset:3072
    s_waitcnt vmcnt(24)
    v_mfma_f32_16x16x32_bf16 a[0:3], v[16:19], v[32:35], a[0:3]
    v_mfma_f32_16x16x32_bf16 a[4:7], v[16:19], v[36:39], a[4:7]
    v_mfma_f32_16x16x32_bf16 a[8:11], v[16:19], v[40:43], a[8:11]
    v_mfma_f32_16x16x32_bf16 a[12:15], v[16:19], v[44:47], a[12:15]
    v_mfma_f32_16x16x32_bf16 a[16:19], v[20:23], v[32:35], a[16:19]
    v_mfma_f32_16x16x32_bf16 a[20:23], v[20:23], v[36:39], a[20:23]
    v_mfma_f32_16x16x32_bf16 a[24:27], v[20:23], v[40:43], a[24:27]
    v_mfma_f32_16x16x32_bf16 a[28:31], v[20:23], v[44:47], a[28:31]
    v_mfma_f32_16x16x32_bf16 a[32:35], v[24:27], v[32:35], a[32:35]
    v_mfma_f32_16x16x32_bf16 a[36:39], v[24:27], v[36:39], a[36:39]
    v_mfma_f32_16x16x32_bf16 a[40:43], v[24:27], v[40:43], a[40:43]
    v_mfma_f32_16x16x32_bf16 a[44:47], v[24:27], v[44:47], a[44:47]
    v_mfma_f32_16x16x32_bf16 a[48:51], v[28:31], v[32:35], a[48:51]
    v_mfma_f32_16x16x32_bf16 a[52:55], v[28:31], v[36:39], a[52:55]
    v_mfma_f32_16x16x32_bf16 a[56:59], v[28:31], v[40:43], a[56:59]
    v_mfma_f32_16x16x32_bf16 a[60:63], v[28:31], v[44:47], a[60:63]
    v_add_u32 v4, 917504, v2
    v_add_u32 v5, 28672, v2
    buffer_load_dwordx4 v[16:19], v4, s[12:15], s20 offen offset:0
    buffer_load_dwordx4 v[20:23], v4, s[12:15], s21 offen offset:0
    buffer_load_dwordx4 v[24:27], v4, s[12:15], s22 offen offset:0
    buffer_load_dwordx4 v[28:31], v4, s[12:15], s23 offen offset:0
    buffer_load_dwordx4 v[32:35], v5, s[12:15], s24 offen offset:0
    buffer_load_dwordx4 v[36:39], v5, s[12:15], s25 offen offset:0
    buffer_load_dwordx4 v[40:43], v5, s[12:15], s26 offen offset:0
    buffer_load_dwordx4 v[44:47], v5, s[12:15], s27 offen offset:0
    s_waitcnt vmcnt(24)
    v_mfma_f32_16x16x32_bf16 a[0:3], v[48:51], v[64:67], a[0:3]
    v_mfma_f32_16x16x32_bf16 a[4:7], v[48:51], v[68:71], a[4:7]
    v_mfma_f32_16x16x32_bf16 a[8:11], v[48:51], v[72:75], a[8:11]
    v_mfma_f32_16x16x32_bf16 a[12:15], v[48:51], v[76:79], a[12:15]
    v_mfma_f32_16x16x32_bf16 a[16:19], v[52:55], v[64:67], a[16:19]
    v_mfma_f32_16x16x32_bf16 a[20:23], v[52:55], v[68:71], a[20:23]
    v_mfma_f32_16x16x32_bf16 a[24:27], v[52:55], v[72:75], a[24:27]
    v_mfma_f32_16x16x32_bf16 a[28:31], v[52:55], v[76:79], a[28:31]
    v_mfma_f32_16x16x32_bf16 a[32:35], v[56:59], v[64:67], a[32:35]
    v_mfma_f32_16x16x32_bf16 a[36:39], v[56:59], v[68:71], a[36:39]
    v_mfma_f32_16x16x32_bf16 a[40:43], v[56:59], v[72:75], a[40:43]
    v_mfma_f32_16x16x32_bf16 a[44:47], v[56:59], v[76:79], a[44:47]
    v_mfma_f32_16x16x32_bf16 a[48:51], v[60:63], v[64:67], a[48:51]
    v_mfma_f32_16x16x32_bf16 a[52:55], v[60:63], v[68:71], a[52:55]
    v_mfma_f32_16x16x32_bf16 a[56:59], v[60:63], v[72:75], a[56:59]
    v_mfma_f32_16x16x32_bf16 a[60:63], v[60:63], v[76:79], a[60:63]
    buffer_load_dwordx4 v[48:51], v4, s[12:15], s20 offen offset:1024
    buffer_load_dwordx4 v[52:55], v4, s[12:15], s21 offen offset:1024
    buffer_load_dwordx4 v[56:59], v4, s[12:15], s22 offen offset:1024
    buffer_load_dwordx4 v[60:63], v4, s[12:15], s23 offen offset:1024
    buffer_load_dwordx4 v[64:67], v5, s[12:15], s24 offen offset:1024
    buffer_load_dwordx4 v[68:71], v5, s[12:15], s25 offen offset:1024
    buffer_load_dwordx4 v[72:75], v5, s[12:15], s26 offen offset:1024
    buffer_load_dwordx4 v[76:79], v5, s[12:15], s27 offen offset:1024
    s_waitcnt vmcnt(24)
    v_mfma_f32_16x16x32_bf16 a[0:3], v[80:83], v[96:99], a[0:3]
    v_mfma_f32_16x16x32_bf16 a[4:7], v[80:83], v[100:103], a[4:7]
    v_mfma_f32_16x16x32_bf16 a[8:11], v[80:83], v[104:107], a[8:11]
    v_mfma_f32_16x16x32_bf16 a[12:15], v[80:83], v[108:111], a[12:15]
    v_mfma_f32_16x16x32_bf16 a[16:19], v[84:87], v[96:99], a[16:19]
    v_mfma_f32_16x16x32_bf16 a[20:23], v[84:87], v[100:103], a[20:23]
    v_mfma_f32_16x16x32_bf16 a[24:27], v[84:87], v[104:107], a[24:27]
    v_mfma_f32_16x16x32_bf16 a[28:31], v[84:87], v[108:111], a[28:31]
    v_mfma_f32_16x16x32_bf16 a[32:35], v[88:91], v[96:99], a[32:35]
    v_mfma_f32_16x16x32_bf16 a[36:39], v[88:91], v[100:103], a[36:39]
    v_mfma_f32_16x16x32_bf16 a[40:43], v[88:91], v[104:107], a[40:43]
    v_mfma_f32_16x16x32_bf16 a[44:47], v[88:91], v[108:111], a[44:47]
    v_mfma_f32_16x16x32_bf16 a[48:51], v[92:95], v[96:99], a[48:51]
    v_mfma_f32_16x16x32_bf16 a[52:55], v[92:95], v[100:103], a[52:55]
    v_mfma_f32_16x16x32_bf16 a[56:59], v[92:95], v[104:107], a[56:59]
    v_mfma_f32_16x16x32_bf16 a[60:63], v[92:95], v[108:111], a[60:63]
    buffer_load_dwordx4 v[80:83], v4, s[12:15], s20 offen offset:2048
    buffer_load_dwordx4 v[84:87], v4, s[12:15], s21 offen offset:2048
    buffer_load_dwordx4 v[88:91], v4, s[12:15], s22 offen offset:2048
    buffer_load_dwordx4 v[92:95], v4, s[12:15], s23 offen offset:2048
    buffer_load_dwordx4 v[96:99], v5, s[12:15], s24 offen offset:2048
    buffer_load_dwordx4 v[100:103], v5, s[12:15], s25 offen offset:2048
    buffer_load_dwordx4 v[104:107], v5, s[12:15], s26 offen offset:2048
    buffer_load_dwordx4 v[108:111], v5, s[12:15], s27 offen offset:2048
    s_waitcnt vmcnt(24)
    v_mfma_f32_16x16x32_bf16 a[0:3], v[112:115], v[128:131], a[0:3]
    v_mfma_f32_16x16x32_bf16 a[4:7], v[112:115], v[132:135], a[4:7]
    v_mfma_f32_16x16x32_bf16 a[8:11], v[112:115], v[136:139], a[8:11]
    v_mfma_f32_16x16x32_bf16 a[12:15], v[112:115], v[140:143], a[12:15]
    v_mfma_f32_16x16x32_bf16 a[16:19], v[116:119], v[128:131], a[16:19]
    v_mfma_f32_16x16x32_bf16 a[20:23], v[116:119], v[132:135], a[20:23]
    v_mfma_f32_16x16x32_bf16 a[24:27], v[116:119], v[136:139], a[24:27]
    v_mfma_f32_16x16x32_bf16 a[28:31], v[116:119], v[140:143], a[28:31]
    v_mfma_f32_16x16x32_bf16 a[32:35], v[120:123], v[128:131], a[32:35]
    v_mfma_f32_16x16x32_bf16 a[36:39], v[120:123], v[132:135], a[36:39]
    v_mfma_f32_16x16x32_bf16 a[40:43], v[120:123], v[136:139], a[40:43]
    v_mfma_f32_16x16x32_bf16 a[44:47], v[120:123], v[140:143], a[44:47]
    v_mfma_f32_16x16x32_bf16 a[48:51], v[124:127], v[128:131], a[48:51]
    v_mfma_f32_16x16x32_bf16 a[52:55], v[124:127], v[132:135], a[52:55]
    v_mfma_f32_16x16x32_bf16 a[56:59], v[124:127], v[136:139], a[56:59]
    v_mfma_f32_16x16x32_bf16 a[60:63], v[124:127], v[140:143], a[60:63]
    buffer_load_dwordx4 v[112:115], v4, s[12:15], s20 offen offset:3072
    buffer_load_dwordx4 v[116:119], v4, s[12:15], s21 offen offset:3072
    buffer_load_dwordx4 v[120:123], v4, s[12:15], s22 offen offset:3072
    buffer_load_dwordx4 v[124:127], v4, s[12:15], s23 offen offset:3072
    buffer_load_dwordx4 v[128:131], v5, s[12:15], s24 offen offset:3072
    buffer_load_dwordx4 v[132:135], v5, s[12:15], s25 offen offset:3072
    buffer_load_dwordx4 v[136:139], v5, s[12:15], s26 offen offset:3072
    buffer_load_dwordx4 v[140:143], v5, s[12:15], s27 offen offset:3072
    s_waitcnt vmcnt(24)
    v_mfma_f32_16x16x32_bf16 a[0:3], v[16:19], v[32:35], a[0:3]
    v_mfma_f32_16x16x32_bf16 a[4:7], v[16:19], v[36:39], a[4:7]
    v_mfma_f32_16x16x32_bf16 a[8:11], v[16:19], v[40:43], a[8:11]
    v_mfma_f32_16x16x32_bf16 a[12:15], v[16:19], v[44:47], a[12:15]
    v_mfma_f32_16x16x32_bf16 a[16:19], v[20:23], v[32:35], a[16:19]
    v_mfma_f32_16x16x32_bf16 a[20:23], v[20:23], v[36:39], a[20:23]
    v_mfma_f32_16x16x32_bf16 a[24:27], v[20:23], v[40:43], a[24:27]
    v_mfma_f32_16x16x32_bf16 a[28:31], v[20:23], v[44:47], a[28:31]
    v_mfma_f32_16x16x32_bf16 a[32:35], v[24:27], v[32:35], a[32:35]
    v_mfma_f32_16x16x32_bf16 a[36:39], v[24:27], v[36:39], a[36:39]
    v_mfma_f32_16x16x32_bf16 a[40:43], v[24:27], v[40:43], a[40:43]
    v_mfma_f32_16x16x32_bf16 a[44:47], v[24:27], v[44:47], a[44:47]
    v_mfma_f32_16x16x32_bf16 a[48:51], v[28:31], v[32:35], a[48:51]
    v_mfma_f32_16x16x32_bf16 a[52:55], v[28:31], v[36:39], a[52:55]
    v_mfma_f32_16x16x32_bf16 a[56:59], v[28:31], v[40:43], a[56:59]
    v_mfma_f32_16x16x32_bf16 a[60:63], v[28:31], v[44:47], a[60:63]
    s_waitcnt vmcnt(16)
    v_mfma_f32_16x16x32_bf16 a[0:3], v[48:51], v[64:67], a[0:3]
    v_mfma_f32_16x16x32_bf16 a[4:7], v[48:51], v[68:71], a[4:7]
    v_mfma_f32_16x16x32_bf16 a[8:11], v[48:51], v[72:75], a[8:11]
    v_mfma_f32_16x16x32_bf16 a[12:15], v[48:51], v[76:79], a[12:15]
    v_mfma_f32_16x16x32_bf16 a[16:19], v[52:55], v[64:67], a[16:19]
    v_mfma_f32_16x16x32_bf16 a[20:23], v[52:55], v[68:71], a[20:23]
    v_mfma_f32_16x16x32_bf16 a[24:27], v[52:55], v[72:75], a[24:27]
    v_mfma_f32_16x16x32_bf16 a[28:31], v[52:55], v[76:79], a[28:31]
    v_mfma_f32_16x16x32_bf16 a[32:35], v[56:59], v[64:67], a[32:35]
    v_mfma_f32_16x16x32_bf16 a[36:39], v[56:59], v[68:71], a[36:39]
    v_mfma_f32_16x16x32_bf16 a[40:43], v[56:59], v[72:75], a[40:43]
    v_mfma_f32_16x16x32_bf16 a[44:47], v[56:59], v[76:79], a[44:47]
    v_mfma_f32_16x16x32_bf16 a[48:51], v[60:63], v[64:67], a[48:51]
    v_mfma_f32_16x16x32_bf16 a[52:55], v[60:63], v[68:71], a[52:55]
    v_mfma_f32_16x16x32_bf16 a[56:59], v[60:63], v[72:75], a[56:59]
    v_mfma_f32_16x16x32_bf16 a[60:63], v[60:63], v[76:79], a[60:63]
    s_waitcnt vmcnt(8)
    v_mfma_f32_16x16x32_bf16 a[0:3], v[80:83], v[96:99], a[0:3]
    v_mfma_f32_16x16x32_bf16 a[4:7], v[80:83], v[100:103], a[4:7]
    v_mfma_f32_16x16x32_bf16 a[8:11], v[80:83], v[104:107], a[8:11]
    v_mfma_f32_16x16x32_bf16 a[12:15], v[80:83], v[108:111], a[12:15]
    v_mfma_f32_16x16x32_bf16 a[16:19], v[84:87], v[96:99], a[16:19]
    v_mfma_f32_16x16x32_bf16 a[20:23], v[84:87], v[100:103], a[20:23]
    v_mfma_f32_16x16x32_bf16 a[24:27], v[84:87], v[104:107], a[24:27]
    v_mfma_f32_16x16x32_bf16 a[28:31], v[84:87], v[108:111], a[28:31]
    v_mfma_f32_16x16x32_bf16 a[32:35], v[88:91], v[96:99], a[32:35]
    v_mfma_f32_16x16x32_bf16 a[36:39], v[88:91], v[100:103], a[36:39]
    v_mfma_f32_16x16x32_bf16 a[40:43], v[88:91], v[104:107], a[40:43]
    v_mfma_f32_16x16x32_bf16 a[44:47], v[88:91], v[108:111], a[44:47]
    v_mfma_f32_16x16x32_bf16 a[48:51], v[92:95], v[96:99], a[48:51]
    v_mfma_f32_16x16x32_bf16 a[52:55], v[92:95], v[100:103], a[52:55]
    v_mfma_f32_16x16x32_bf16 a[56:59], v[92:95], v[104:107], a[56:59]
    v_mfma_f32_16x16x32_bf16 a[60:63], v[92:95], v[108:111], a[60:63]
    s_waitcnt vmcnt(0)
    v_mfma_f32_16x16x32_bf16 a[0:3], v[112:115], v[128:131], a[0:3]
    v_mfma_f32_16x16x32_bf16 a[4:7], v[112:115], v[132:135], a[4:7]
    v_mfma_f32_16x16x32_bf16 a[8:11], v[112:115], v[136:139], a[8:11]
    v_mfma_f32_16x16x32_bf16 a[12:15], v[112:115], v[140:143], a[12:15]
    v_mfma_f32_16x16x32_bf16 a[16:19], v[116:119], v[128:131], a[16:19]
    v_mfma_f32_16x16x32_bf16 a[20:23], v[116:119], v[132:135], a[20:23]
    v_mfma_f32_16x16x32_bf16 a[24:27], v[116:119], v[136:139], a[24:27]
    v_mfma_f32_16x16x32_bf16 a[28:31], v[116:119], v[140:143], a[28:31]
    v_mfma_f32_16x16x32_bf16 a[32:35], v[120:123], v[128:131], a[32:35]
    v_mfma_f32_16x16x32_bf16 a[36:39], v[120:123], v[132:135], a[36:39]
    v_mfma_f32_16x16x32_bf16 a[40:43], v[120:123], v[136:139], a[40:43]
    v_mfma_f32_16x16x32_bf16 a[44:47], v[120:123], v[140:143], a[44:47]
    v_mfma_f32_16x16x32_bf16 a[48:51], v[124:127], v[128:131], a[48:51]
    v_mfma_f32_16x16x32_bf16 a[52:55], v[124:127], v[132:135], a[52:55]
    v_mfma_f32_16x16x32_bf16 a[56:59], v[124:127], v[136:139], a[56:59]
    v_mfma_f32_16x16x32_bf16 a[60:63], v[124:127], v[140:143], a[60:63]
    s_nop 9
    s_lshl_b32 s19, s18, 14
    v_add_u32 v6, s19, v2
    ds_write_b128 v6, a[0:3] offset:0
    ds_write_b128 v6, a[4:7] offset:1024
    ds_write_b128 v6, a[8:11] offset:2048
    ds_write_b128 v6, a[12:15] offset:3072
    ds_write_b128 v6, a[16:19] offset:4096
    ds_write_b128 v6, a[20:23] offset:5120
    ds_write_b128 v6, a[24:27] offset:6144
    ds_write_b128 v6, a[28:31] offset:7168
    ds_write_b128 v6, a[32:35] offset:8192
    ds_write_b128 v6, a[36:39] offset:9216
    ds_write_b128 v6, a[40:43] offset:10240
    ds_write_b128 v6, a[44:47] offset:11264
    ds_write_b128 v6, a[48:51] offset:12288
    ds_write_b128 v6, a[52:55] offset:13312
    ds_write_b128 v6, a[56:59] offset:14336
    ds_write_b128 v6, a[60:63] offset:15360
    s_waitcnt lgkmcnt(0)
    s_barrier
    s_lshl_b32 s19, s18, 10
    v_add_u32 v6, s19, v2
    ds_read_b128 v[16:19], v6 offset:0
    ds_read_b128 v[20:23], v6 offset:16384
    ds_read_b128 v[24:27], v6 offset:32768
    ds_read_b128 v[28:31], v6 offset:49152
    ds_read_b128 v[32:35], v6 offset:4096
    ds_read_b128 v[36:39], v6 offset:20480
    ds_read_b128 v[40:43], v6 offset:36864
    ds_read_b128 v[44:47], v6 offset:53248
    ds_read_b128 v[48:51], v6 offset:8192
    ds_read_b128 v[52:55], v6 offset:24576
    ds_read_b128 v[56:59], v6 offset:40960
    ds_read_b128 v[60:63], v6 offset:57344
    ds_read_b128 v[64:67], v6 offset:12288
    ds_read_b128 v[68:71], v6 offset:28672
    ds_read_b128 v[72:75], v6 offset:45056
    ds_read_b128 v[76:79], v6 offset:61440
    v_and_b32 v8, 15, v1
    v_lshlrev_b32 v8, 10, v8
    v_lshrrev_b32 v9, 4, v1
    v_lshl_add_u32 v8, v9, 3, v8
    s_lshl_b32 s19, s16, 16
    s_lshl_b32 s20, s18, 14
    s_add_u32 s19, s19, s20
    s_lshl_b32 s20, s17, 7
    s_add_u32 s19, s19, s20
    s_add_u32 s20, s19, 0x7c00000
    buffer_load_dwordx2 v[96:97], v8, s[8:11], s19 offen offset:0
    buffer_load_dwordx2 v[104:105], v8, s[12:15], s20 offen offset:0
    buffer_load_dwordx2 v[98:99], v8, s[8:11], s19 offen offset:32
    buffer_load_dwordx2 v[106:107], v8, s[12:15], s20 offen offset:32
    buffer_load_dwordx2 v[100:101], v8, s[8:11], s19 offen offset:64
    buffer_load_dwordx2 v[108:109], v8, s[12:15], s20 offen offset:64
    buffer_load_dwordx2 v[102:103], v8, s[8:11], s19 offen offset:96
    buffer_load_dwordx2 v[110:111], v8, s[12:15], s20 offen offset:96
    s_waitcnt lgkmcnt(0)
    v_add_f32 v16, v16, v20
    v_add_f32 v24, v24, v28
    v_add_f32 v17, v17, v21
    v_add_f32 v25, v25, v29
    v_add_f32 v18, v18, v22
    v_add_f32 v26, v26, v30
    v_add_f32 v19, v19, v23
    v_add_f32 v27, v27, v31
    v_add_f32 v16, v16, v24
    v_add_f32 v17, v17, v25
    v_add_f32 v18, v18, v26
    v_add_f32 v19, v19, v27
    v_add_f32 v32, v32, v36
    v_add_f32 v40, v40, v44
    v_add_f32 v33, v33, v37
    v_add_f32 v41, v41, v45
    v_add_f32 v34, v34, v38
    v_add_f32 v42, v42, v46
    v_add_f32 v35, v35, v39
    v_add_f32 v43, v43, v47
    v_add_f32 v32, v32, v40
    v_add_f32 v33, v33, v41
    v_add_f32 v34, v34, v42
    v_add_f32 v35, v35, v43
    v_add_f32 v48, v48, v52
    v_add_f32 v56, v56, v60
    v_add_f32 v49, v49, v53
    v_add_f32 v57, v57, v61
    v_add_f32 v50, v50, v54
    v_add_f32 v58, v58, v62
    v_add_f32 v51, v51, v55
    v_add_f32 v59, v59, v63
    v_add_f32 v48, v48, v56
    v_add_f32 v49, v49, v57
    v_add_f32 v50, v50, v58
    v_add_f32 v51, v51, v59
    v_add_f32 v64, v64, v68
    v_add_f32 v72, v72, v76
    v_add_f32 v65, v65, v69
    v_add_f32 v73, v73, v77
    v_add_f32 v66, v66, v70
    v_add_f32 v74, v74, v78
    v_add_f32 v67, v67, v71
    v_add_f32 v75, v75, v79
    v_add_f32 v64, v64, v72
    v_add_f32 v65, v65, v73
    v_add_f32 v66, v66, v74
    v_add_f32 v67, v67, v75
    s_waitcnt vmcnt(0)
    v_cvt_pk_bf16_f32 v112, v16, v17
    v_cvt_pk_bf16_f32 v113, v18, v19
    v_lshlrev_b32 v16, 16, v112
    v_and_b32 v17, 0xffff0000, v112
    v_lshlrev_b32 v18, 16, v113
    v_and_b32 v19, 0xffff0000, v113
    v_lshlrev_b32 v116, 16, v96
    v_and_b32 v117, 0xffff0000, v96
    v_lshlrev_b32 v118, 16, v97
    v_and_b32 v119, 0xffff0000, v97
    v_add_f32 v16, v116, v16
    v_add_f32 v17, v117, v17
    v_add_f32 v18, v118, v18
    v_add_f32 v19, v119, v19
    v_cvt_pk_bf16_f32 v112, v16, v17
    v_cvt_pk_bf16_f32 v113, v18, v19
    v_lshlrev_b32 v16, 16, v112
    v_and_b32 v17, 0xffff0000, v112
    v_lshlrev_b32 v18, 16, v113
    v_and_b32 v19, 0xffff0000, v113
    v_lshlrev_b32 v116, 16, v104
    v_and_b32 v117, 0xffff0000, v104
    v_lshlrev_b32 v118, 16, v105
    v_and_b32 v119, 0xffff0000, v105
    v_add_f32 v16, v16, v116
    v_add_f32 v17, v17, v117
    v_add_f32 v18, v18, v118
    v_add_f32 v19, v19, v119
    v_cvt_pk_bf16_f32 v120, v16, v17
    v_cvt_pk_bf16_f32 v121, v18, v19
    buffer_store_dwordx2 v[120:121], v8, s[40:43], s19 offen offset:0
    v_cvt_pk_bf16_f32 v112, v32, v33
    v_cvt_pk_bf16_f32 v113, v34, v35
    v_lshlrev_b32 v32, 16, v112
    v_and_b32 v33, 0xffff0000, v112
    v_lshlrev_b32 v34, 16, v113
    v_and_b32 v35, 0xffff0000, v113
    v_lshlrev_b32 v116, 16, v98
    v_and_b32 v117, 0xffff0000, v98
    v_lshlrev_b32 v118, 16, v99
    v_and_b32 v119, 0xffff0000, v99
    v_add_f32 v32, v116, v32
    v_add_f32 v33, v117, v33
    v_add_f32 v34, v118, v34
    v_add_f32 v35, v119, v35
    v_cvt_pk_bf16_f32 v112, v32, v33
    v_cvt_pk_bf16_f32 v113, v34, v35
    v_lshlrev_b32 v32, 16, v112
    v_and_b32 v33, 0xffff0000, v112
    v_lshlrev_b32 v34, 16, v113
    v_and_b32 v35, 0xffff0000, v113
    v_lshlrev_b32 v116, 16, v106
    v_and_b32 v117, 0xffff0000, v106
    v_lshlrev_b32 v118, 16, v107
    v_and_b32 v119, 0xffff0000, v107
    v_add_f32 v32, v32, v116
    v_add_f32 v33, v33, v117
    v_add_f32 v34, v34, v118
    v_add_f32 v35, v35, v119
    v_cvt_pk_bf16_f32 v122, v32, v33
    v_cvt_pk_bf16_f32 v123, v34, v35
    buffer_store_dwordx2 v[122:123], v8, s[40:43], s19 offen offset:32
    v_cvt_pk_bf16_f32 v112, v48, v49
    v_cvt_pk_bf16_f32 v113, v50, v51
    v_lshlrev_b32 v48, 16, v112
    v_and_b32 v49, 0xffff0000, v112
    v_lshlrev_b32 v50, 16, v113
    v_and_b32 v51, 0xffff0000, v113
    v_lshlrev_b32 v116, 16, v100
    v_and_b32 v117, 0xffff0000, v100
    v_lshlrev_b32 v118, 16, v101
    v_and_b32 v119, 0xffff0000, v101
    v_add_f32 v48, v116, v48
    v_add_f32 v49, v117, v49
    v_add_f32 v50, v118, v50
    v_add_f32 v51, v119, v51
    v_cvt_pk_bf16_f32 v112, v48, v49
    v_cvt_pk_bf16_f32 v113, v50, v51
    v_lshlrev_b32 v48, 16, v112
    v_and_b32 v49, 0xffff0000, v112
    v_lshlrev_b32 v50, 16, v113
    v_and_b32 v51, 0xffff0000, v113
    v_lshlrev_b32 v116, 16, v108
    v_and_b32 v117, 0xffff0000, v108
    v_lshlrev_b32 v118, 16, v109
    v_and_b32 v119, 0xffff0000, v109
    v_add_f32 v48, v48, v116
    v_add_f32 v49, v49, v117
    v_add_f32 v50, v50, v118
    v_add_f32 v51, v51, v119
    v_cvt_pk_bf16_f32 v124, v48, v49
    v_cvt_pk_bf16_f32 v125, v50, v51
    buffer_store_dwordx2 v[124:125], v8, s[40:43], s19 offen offset:64
    v_cvt_pk_bf16_f32 v112, v64, v65
    v_cvt_pk_bf16_f32 v113, v66, v67
    v_lshlrev_b32 v64, 16, v112
    v_and_b32 v65, 0xffff0000, v112
    v_lshlrev_b32 v66, 16, v113
    v_and_b32 v67, 0xffff0000, v113
    v_lshlrev_b32 v116, 16, v102
    v_and_b32 v117, 0xffff0000, v102
    v_lshlrev_b32 v118, 16, v103
    v_and_b32 v119, 0xffff0000, v103
    v_add_f32 v64, v116, v64
    v_add_f32 v65, v117, v65
    v_add_f32 v66, v118, v66
    v_add_f32 v67, v119, v67
    v_cvt_pk_bf16_f32 v112, v64, v65
    v_cvt_pk_bf16_f32 v113, v66, v67
    v_lshlrev_b32 v64, 16, v112
    v_and_b32 v65, 0xffff0000, v112
    v_lshlrev_b32 v66, 16, v113
    v_and_b32 v67, 0xffff0000, v113
    v_lshlrev_b32 v116, 16, v110
    v_and_b32 v117, 0xffff0000, v110
    v_lshlrev_b32 v118, 16, v111
    v_and_b32 v119, 0xffff0000, v111
    v_add_f32 v64, v64, v116
    v_add_f32 v65, v65, v117
    v_add_f32 v66, v66, v118
    v_add_f32 v67, v67, v119
    v_cvt_pk_bf16_f32 v126, v64, v65
    v_cvt_pk_bf16_f32 v127, v66, v67
    buffer_store_dwordx2 v[126:127], v8, s[40:43], s19 offen offset:96
    s_add_u32 s51, s51, 160
    s_cmp_lt_u32 s51, 256
    s_cbranch_scc1 L_w5_go
    s_branch L_ch_done
L_w4_start:
    s_mov_b32 s51, s50
L_w4_task:
    s_lshr_b32 s52, s51, 3
    s_and_b32 s53, s51, 7
    s_lshl_b32 s19, s53, 6
    s_add_u32 s19, s19, 0x7906400
    v_and_b32 v9, 15, v1
    v_lshlrev_b32 v9, 2, v9
    s_mov_b32 s55, 0
L_w4_poll:
    buffer_load_dword v8, v9, s[12:15], s19 offen sc0 sc1
    s_add_u32 s55, s55, 1
    s_waitcnt vmcnt(0)
    v_cmp_lt_i32 vcc, s52, v8
    s_cmp_eq_u64 vcc, exec
    s_cbranch_scc1 L_w4_ok
    s_sleep 8
    s_cmp_lt_u32 s55, 4000000
    s_cbranch_scc1 L_w4_poll
    s_branch L_ch_done
L_w4_ok:
    s_lshl_b32 s16, s52, 5
    s_lshl_b32 s19, s53, 2
    s_add_u32 s16, s16, s19
    s_add_u32 s16, s16, s18
    v_lshlrev_b32 v3, 3, v1
    s_lshl_b32 s19, s16, 13
    s_add_u32 s20, s19, 0x2000000
    s_add_u32 s21, s20, 4096
    buffer_load_dwordx4 v[16:19], v2, s[12:15], s20 offen offset:0
    buffer_load_dwordx4 v[20:23], v2, s[12:15], s20 offen offset:1024
    buffer_load_dwordx4 v[24:27], v2, s[12:15], s20 offen offset:2048
    buffer_load_dwordx4 v[28:31], v2, s[12:15], s20 offen offset:3072
    buffer_load_dwordx4 v[32:35], v2, s[12:15], s21 offen offset:0
    buffer_load_dwordx4 v[36:39], v2, s[12:15], s21 offen offset:1024
    buffer_load_dwordx4 v[40:43], v2, s[12:15], s21 offen offset:2048
    buffer_load_dwordx4 v[44:47], v2, s[12:15], s21 offen offset:3072
    s_add_u32 s20, s19, 0x3000000
    s_add_u32 s21, s20, 4096
    buffer_load_dwordx4 v[48:51], v2, s[12:15], s20 offen offset:0
    buffer_load_dwordx4 v[52:55], v2, s[12:15], s20 offen offset:1024
    buffer_load_dwordx4 v[56:59], v2, s[12:15], s20 offen offset:2048
    buffer_load_dwordx4 v[60:63], v2, s[12:15], s20 offen offset:3072
    buffer_load_dwordx4 v[64:67], v2, s[12:15], s21 offen offset:0
    buffer_load_dwordx4 v[68:71], v2, s[12:15], s21 offen offset:1024
    buffer_load_dwordx4 v[72:75], v2, s[12:15], s21 offen offset:2048
    buffer_load_dwordx4 v[76:79], v2, s[12:15], s21 offen offset:3072
    s_lshl_b32 s22, s16, 12
    s_add_u32 s20, s22, 0x5800000
    buffer_load_dwordx4 v[80:83], v2, s[12:15], s20 offen offset:0
    buffer_load_dwordx4 v[84:87], v2, s[12:15], s20 offen offset:1024
    buffer_load_dwordx4 v[88:91], v2, s[12:15], s20 offen offset:2048
    buffer_load_dwordx4 v[92:95], v2, s[12:15], s20 offen offset:3072
    s_add_u32 s20, s19, 0x4000000
    s_add_u32 s21, s20, 4096
    buffer_load_dwordx4 v[96:99], v2, s[12:15], s20 offen offset:0
    buffer_load_dwordx4 v[100:103], v2, s[12:15], s20 offen offset:1024
    buffer_load_dwordx4 v[104:107], v2, s[12:15], s20 offen offset:2048
    buffer_load_dwordx4 v[108:111], v2, s[12:15], s20 offen offset:3072
    buffer_load_dwordx4 v[112:115], v2, s[12:15], s21 offen offset:0
    buffer_load_dwordx4 v[116:119], v2, s[12:15], s21 offen offset:1024
    buffer_load_dwordx4 v[120:123], v2, s[12:15], s21 offen offset:2048
    buffer_load_dwordx4 v[124:127], v2, s[12:15], s21 offen offset:3072
    s_add_u32 s20, s22, 0x6000000
    buffer_load_dwordx2 v[128:129], v3, s[12:15], s20 offen offset:0
    buffer_load_dwordx2 v[130:131], v3, s[12:15], s20 offen offset:512
    buffer_load_dwordx2 v[132:133], v3, s[12:15], s20 offen offset:1024
    buffer_load_dwordx2 v[134:135], v3, s[12:15], s20 offen offset:1536
    buffer_load_dwordx2 v[136:137], v3, s[12:15], s20 offen offset:2048
    buffer_load_dwordx2 v[138:139], v3, s[12:15], s20 offen offset:2560
    buffer_load_dwordx2 v[140:141], v3, s[12:15], s20 offen offset:3072
    buffer_load_dwordx2 v[142:143], v3, s[12:15], s20 offen offset:3584
    v_and_b32 v4, 15, v1
    v_lshrrev_b32 v5, 4, v1
    v_lshlrev_b32 v5, 2, v5
    v_add_u32 v6, 0, v5
    v_cmp_le_u32 s[30:31], v6, v4
    v_add_u32 v6, 1, v5
    v_cmp_le_u32 s[32:33], v6, v4
    v_add_u32 v6, 2, v5
    v_cmp_le_u32 s[34:35], v6, v4
    v_add_u32 v6, 3, v5
    v_cmp_le_u32 s[36:37], v6, v4
    s_mov_b32 s38, -1
    s_mov_b32 s39, 0
    s_mov_b32 s25, 0x3db504f3
    s_mov_b32 s26, 0x3fb8aa3b
    s_mov_b32 s27, 0xce6e6b28
    s_waitcnt vmcnt(16)
    v_mfma_f32_16x16x32_bf16 v[144:147], v[80:83], v[16:19], 0
    v_mfma_f32_16x16x32_bf16 v[144:147], v[84:87], v[20:23], v[144:147]
    v_mfma_f32_16x16x32_bf16 v[144:147], v[88:91], v[24:27], v[144:147]
    v_mfma_f32_16x16x32_bf16 v[144:147], v[92:95], v[28:31], v[144:147]
    v_mfma_f32_16x16x32_bf16 v[148:151], v[48:51], v[16:19], 0
    v_mfma_f32_16x16x32_bf16 v[148:151], v[52:55], v[20:23], v[148:151]
    v_mfma_f32_16x16x32_bf16 v[148:151], v[56:59], v[24:27], v[148:151]
    v_mfma_f32_16x16x32_bf16 v[148:151], v[60:63], v[28:31], v[148:151]
    v_mfma_f32_16x16x32_bf16 v[156:159], v[80:83], v[32:35], 0
    v_mfma_f32_16x16x32_bf16 v[156:159], v[84:87], v[36:39], v[156:159]
    v_mfma_f32_16x16x32_bf16 v[156:159], v[88:91], v[40:43], v[156:159]
    v_mfma_f32_16x16x32_bf16 v[156:159], v[92:95], v[44:47], v[156:159]
    v_mfma_f32_16x16x32_bf16 v[160:163], v[48:51], v[32:35], 0
    v_mfma_f32_16x16x32_bf16 v[160:163], v[52:55], v[36:39], v[160:163]
    v_mfma_f32_16x16x32_bf16 v[160:163], v[56:59], v[40:43], v[160:163]
    v_mfma_f32_16x16x32_bf16 v[160:163], v[60:63], v[44:47], v[160:163]
    v_mfma_f32_16x16x32_bf16 v[164:167], v[64:67], v[32:35], 0
    v_mfma_f32_16x16x32_bf16 v[164:167], v[68:71], v[36:39], v[164:167]
    v_mfma_f32_16x16x32_bf16 v[164:167], v[72:75], v[40:43], v[164:167]
    v_mfma_f32_16x16x32_bf16 v[164:167], v[76:79], v[44:47], v[164:167]
    s_nop 9
    v_mov_b32 v210, s27
    v_cvt_pk_bf16_f32 v180, v144, v145
    v_cvt_pk_bf16_f32 v181, v146, v147
    v_cvt_pk_bf16_f32 v182, v148, v149
    v_cvt_pk_bf16_f32 v183, v150, v151
    v_lshlrev_b32 v144, 16, v180
    v_and_b32 v145, 0xffff0000, v180
    v_lshlrev_b32 v146, 16, v181
    v_and_b32 v147, 0xffff0000, v181
    v_lshlrev_b32 v148, 16, v182
    v_and_b32 v149, 0xffff0000, v182
    v_lshlrev_b32 v150, 16, v183
    v_and_b32 v151, 0xffff0000, v183
    v_mul_f32 v144, s25, v144
    v_mul_f32 v145, s25, v145
    v_mul_f32 v146, s25, v146
    v_mul_f32 v147, s25, v147
    v_mul_f32 v148, s25, v148
    v_mul_f32 v149, s25, v149
    v_mul_f32 v150, s25, v150
    v_mul_f32 v151, s25, v151
    v_cvt_pk_bf16_f32 v180, v144, v145
    v_cvt_pk_bf16_f32 v181, v146, v147
    v_cvt_pk_bf16_f32 v182, v148, v149
    v_cvt_pk_bf16_f32 v183, v150, v151
    v_lshlrev_b32 v144, 16, v180
    v_and_b32 v145, 0xffff0000, v180
    v_lshlrev_b32 v146, 16, v181
    v_and_b32 v147, 0xffff0000, v181
    v_lshlrev_b32 v148, 16, v182
    v_and_b32 v149, 0xffff0000, v182
    v_lshlrev_b32 v150, 16, v183
    v_and_b32 v151, 0xffff0000, v183
    v_cndmask_b32 v144, v210, v144, s[38:39]
    v_cndmask_b32 v145, v210, v145, s[38:39]
    v_cndmask_b32 v146, v210, v146, s[38:39]
    v_cndmask_b32 v147, v210, v147, s[38:39]
    v_cndmask_b32 v148, v210, v148, s[30:31]
    v_cndmask_b32 v149, v210, v149, s[32:33]
    v_cndmask_b32 v150, v210, v150, s[34:35]
    v_cndmask_b32 v151, v210, v151, s[36:37]
    v_max3_f32 v200, v144, v145, v146
    v_max3_f32 v200, v200, v147, v148
    v_max3_f32 v200, v200, v149, v150
    v_max_f32 v200, v200, v151
    v_mov_b32 v201, v200
    s_nop 1
    v_permlane16_swap_b32 v200, v201
    s_nop 1
    v_max_f32 v200, v200, v201
    v_mov_b32 v201, v200
    s_nop 1
    v_permlane32_swap_b32 v200, v201
    s_nop 1
    v_max_f32 v200, v200, v201
    v_sub_f32 v144, v144, v200
    v_sub_f32 v145, v145, v200
    v_sub_f32 v146, v146, v200
    v_sub_f32 v147, v147, v200
    v_sub_f32 v148, v148, v200
    v_sub_f32 v149, v149, v200
    v_sub_f32 v150, v150, v200
    v_sub_f32 v151, v151, v200
    v_mul_f32 v144, s26, v144
    v_mul_f32 v145, s26, v145
    v_mul_f32 v146, s26, v146
    v_mul_f32 v147, s26, v147
    v_mul_f32 v148, s26, v148
    v_mul_f32 v149, s26, v149
    v_mul_f32 v150, s26, v150
    v_mul_f32 v151, s26, v151
    v_exp_f32 v144, v144
    v_exp_f32 v145, v145
    v_exp_f32 v146, v146
    v_exp_f32 v147, v147
    v_exp_f32 v148, v148
    v_exp_f32 v149, v149
    v_exp_f32 v150, v150
    v_exp_f32 v151, v151
    s_nop 0
    v_add_f32 v200, v144, v145
    v_add_f32 v200, v200, v146
    v_add_f32 v200, v200, v147
    v_add_f32 v200, v200, v148
    v_add_f32 v200, v200, v149
    v_add_f32 v200, v200, v150
    v_add_f32 v200, v200, v151
    v_mov_b32 v201, v200
    s_nop 1
    v_permlane16_swap_b32 v200, v201
    s_nop 1
    v_add_f32 v200, v200, v201
    v_mov_b32 v201, v200
    s_nop 1
    v_permlane32_swap_b32 v200, v201
    s_nop 1
    v_add_f32 v200, v200, v201
    v_rcp_f32 v200, v200
    s_nop 0
    v_mul_f32 v144, v144, v200
    v_mul_f32 v145, v145, v200
    v_mul_f32 v146, v146, v200
    v_mul_f32 v147, v147, v200
    v_mul_f32 v148, v148, v200
    v_mul_f32 v149, v149, v200
    v_mul_f32 v150, v150, v200
    v_mul_f32 v151, v151, v200
    v_cvt_pk_bf16_f32 v168, v144, v145
    v_cvt_pk_bf16_f32 v169, v146, v147
    v_cvt_pk_bf16_f32 v172, v148, v149
    v_cvt_pk_bf16_f32 v173, v150, v151
    v_mov_b32 v174, 0
    v_mov_b32 v175, 0
    v_cvt_pk_bf16_f32 v180, v156, v157
    v_cvt_pk_bf16_f32 v181, v158, v159
    v_cvt_pk_bf16_f32 v182, v160, v161
    v_cvt_pk_bf16_f32 v183, v162, v163
    v_cvt_pk_bf16_f32 v184, v164, v165
    v_cvt_pk_bf16_f32 v185, v166, v167
    v_lshlrev_b32 v156, 16, v180
    v_and_b32 v157, 0xffff0000, v180
    v_lshlrev_b32 v158, 16, v181
    v_and_b32 v159, 0xffff0000, v181
    v_lshlrev_b32 v160, 16, v182
    v_and_b32 v161, 0xffff0000, v182
    v_lshlrev_b32 v162, 16, v183
    v_and_b32 v163, 0xffff0000, v183
    v_lshlrev_b32 v164, 16, v184
    v_and_b32 v165, 0xffff0000, v184
    v_lshlrev_b32 v166, 16, v185
    v_and_b32 v167, 0xffff0000, v185
    v_mul_f32 v156, s25, v156
    v_mul_f32 v157, s25, v157
    v_mul_f32 v158, s25, v158
    v_mul_f32 v159, s25, v159
    v_mul_f32 v160, s25, v160
    v_mul_f32 v161, s25, v161
    v_mul_f32 v162, s25, v162
    v_mul_f32 v163, s25, v163
    v_mul_f32 v164, s25, v164
    v_mul_f32 v165, s25, v165
    v_mul_f32 v166, s25, v166
    v_mul_f32 v167, s25, v167
    v_cvt_pk_bf16_f32 v180, v156, v157
    v_cvt_pk_bf16_f32 v181, v158, v159
    v_cvt_pk_bf16_f32 v182, v160, v161
    v_cvt_pk_bf16_f32 v183, v162, v163
    v_cvt_pk_bf16_f32 v184, v164, v165
    v_cvt_pk_bf16_f32 v185, v166, v167
    v_lshlrev_b32 v156, 16, v180
    v_and_b32 v157, 0xffff0000, v180
    v_lshlrev_b32 v158, 16, v181
    v_and_b32 v159, 0xffff0000, v181
    v_lshlrev_b32 v160, 16, v182
    v_and_b32 v161, 0xffff0000, v182
    v_lshlrev_b32 v162, 16, v183
    v_and_b32 v163, 0xffff0000, v183
    v_lshlrev_b32 v164, 16, v184
    v_and_b32 v165, 0xffff0000, v184
    v_lshlrev_b32 v166, 16, v185
    v_and_b32 v167, 0xffff0000, v185
    v_cndmask_b32 v156, v210, v156, s[38:39]
    v_cndmask_b32 v157, v210, v157, s[38:39]
    v_cndmask_b32 v158, v210, v158, s[38:39]
    v_cndmask_b32 v159, v210, v159, s[38:39]
    v_cndmask_b32 v164, v210, v164, s[30:31]
    v_cndmask_b32 v165, v210, v165, s[32:33]
    v_cndmask_b32 v166, v210, v166, s[34:35]
    v_cndmask_b32 v167, v210, v167, s[36:37]
    v_max3_f32 v200, v156, v157, v158
    v_max3_f32 v200, v200, v159, v160
    v_max3_f32 v200, v200, v161, v162
    v_max3_f32 v200, v200, v163, v164
    v_max3_f32 v200, v200, v165, v166
    v_max_f32 v200, v200, v167
    v_mov_b32 v201, v200
    s_nop 1
    v_permlane16_swap_b32 v200, v201
    s_nop 1
    v_max_f32 v200, v200, v201
    v_mov_b32 v201, v200
    s_nop 1
    v_permlane32_swap_b32 v200, v201
    s_nop 1
    v_max_f32 v200, v200, v201
    v_sub_f32 v156, v156, v200
    v_sub_f32 v157, v157, v200
    v_sub_f32 v158, v158, v200
    v_sub_f32 v159, v159, v200
    v_sub_f32 v160, v160, v200
    v_sub_f32 v161, v161, v200
    v_sub_f32 v162, v162, v200
    v_sub_f32 v163, v163, v200
    v_sub_f32 v164, v164, v200
    v_sub_f32 v165, v165, v200
    v_sub_f32 v166, v166, v200
    v_sub_f32 v167, v167, v200
    v_mul_f32 v156, s26, v156
    v_mul_f32 v157, s26, v157
    v_mul_f32 v158, s26, v158
    v_mul_f32 v159, s26, v159
    v_mul_f32 v160, s26, v160
    v_mul_f32 v161, s26, v161
    v_mul_f32 v162, s26, v162
    v_mul_f32 v163, s26, v163
    v_mul_f32 v164, s26, v164
    v_mul_f32 v165, s26, v165
    v_mul_f32 v166, s26, v166
    v_mul_f32 v167, s26, v167
    v_exp_f32 v156, v156
    v_exp_f32 v157, v157
    v_exp_f32 v158, v158
    v_exp_f32 v159, v159
    v_exp_f32 v160, v160
    v_exp_f32 v161, v161
    v_exp_f32 v162, v162
    v_exp_f32 v163, v163
    v_exp_f32 v164, v164
    v_exp_f32 v165, v165
    v_exp_f32 v166, v166
    v_exp_f32 v167, v167
    s_nop 0
    v_add_f32 v200, v156, v157
    v_add_f32 v200, v200, v158
    v_add_f32 v200, v200, v159
    v_add_f32 v200, v200, v160
    v_add_f32 v200, v200, v161
    v_add_f32 v200, v200, v162
    v_add_f32 v200, v200, v163
    v_add_f32 v200, v200, v164
    v_add_f32 v200, v200, v165
    v_add_f32 v200, v200, v166
    v_add_f32 v200, v200, v167
    v_mov_b32 v201, v200
    s_nop 1
    v_permlane16_swap_b32 v200, v201
    s_nop 1
    v_add_f32 v200, v200, v201
    v_mov_b32 v201, v200
    s_nop 1
    v_permlane32_swap_b32 v200, v201
    s_nop 1
    v_add_f32 v200, v200, v201
    v_rcp_f32 v200, v200
    s_nop 0
    v_mul_f32 v156, v156, v200
    v_mul_f32 v157, v157, v200
    v_mul_f32 v158, v158, v200
    v_mul_f32 v159, v159, v200
    v_mul_f32 v160, v160, v200
    v_mul_f32 v161, v161, v200
    v_mul_f32 v162, v162, v200
    v_mul_f32 v163, v163, v200
    v_mul_f32 v164, v164, v200
    v_mul_f32 v165, v165, v200
    v_mul_f32 v166, v166, v200
    v_mul_f32 v167, v167, v200
    v_cvt_pk_bf16_f32 v170, v156, v157
    v_cvt_pk_bf16_f32 v171, v158, v159
    v_cvt_pk_bf16_f32 v176, v160, v161
    v_cvt_pk_bf16_f32 v177, v162, v163
    v_cvt_pk_bf16_f32 v178, v164, v165
    v_cvt_pk_bf16_f32 v179, v166, v167
    s_waitcnt vmcnt(0)
    s_nop 1
    v_mfma_f32_16x16x32_bf16 v[16:19], v[96:99], v[172:175], 0
    v_mfma_f32_16x16x32_bf16 v[20:23], v[100:103], v[172:175], 0
    v_mfma_f32_16x16x32_bf16 v[24:27], v[104:107], v[172:175], 0
    v_mfma_f32_16x16x32_bf16 v[28:31], v[108:111], v[172:175], 0
    v_mfma_f32_16x16x32_bf16 v[32:35], v[112:115], v[172:175], 0
    v_mfma_f32_16x16x32_bf16 v[36:39], v[116:119], v[172:175], 0
    v_mfma_f32_16x16x32_bf16 v[40:43], v[120:123], v[172:175], 0
    v_mfma_f32_16x16x32_bf16 v[44:47], v[124:127], v[172:175], 0
    v_mfma_f32_16x16x32_bf16 v[48:51], v[96:99], v[176:179], 0
    v_mfma_f32_16x16x32_bf16 v[52:55], v[100:103], v[176:179], 0
    v_mfma_f32_16x16x32_bf16 v[56:59], v[104:107], v[176:179], 0
    v_mfma_f32_16x16x32_bf16 v[60:63], v[108:111], v[176:179], 0
    v_mfma_f32_16x16x32_bf16 v[64:67], v[112:115], v[176:179], 0
    v_mfma_f32_16x16x32_bf16 v[68:71], v[116:119], v[176:179], 0
    v_mfma_f32_16x16x32_bf16 v[72:75], v[120:123], v[176:179], 0
    v_mfma_f32_16x16x32_bf16 v[76:79], v[124:127], v[176:179], 0
    v_mfma_f32_16x16x16_bf16 v[16:19], v[128:129], v[168:169], v[16:19]
    v_mfma_f32_16x16x16_bf16 v[20:23], v[130:131], v[168:169], v[20:23]
    v_mfma_f32_16x16x16_bf16 v[24:27], v[132:133], v[168:169], v[24:27]
    v_mfma_f32_16x16x16_bf16 v[28:31], v[134:135], v[168:169], v[28:31]
    v_mfma_f32_16x16x16_bf16 v[32:35], v[136:137], v[168:169], v[32:35]
    v_mfma_f32_16x16x16_bf16 v[36:39], v[138:139], v[168:169], v[36:39]
    v_mfma_f32_16x16x16_bf16 v[40:43], v[140:141], v[168:169], v[40:43]
    v_mfma_f32_16x16x16_bf16 v[44:47], v[142:143], v[168:169], v[44:47]
    v_mfma_f32_16x16x16_bf16 v[48:51], v[128:129], v[170:171], v[48:51]
    v_mfma_f32_16x16x16_bf16 v[52:55], v[130:131], v[170:171], v[52:55]
    v_mfma_f32_16x16x16_bf16 v[56:59], v[132:133], v[170:171], v[56:59]
    v_mfma_f32_16x16x16_bf16 v[60:63], v[134:135], v[170:171], v[60:63]
    v_mfma_f32_16x16x16_bf16 v[64:67], v[136:137], v[170:171], v[64:67]
    v_mfma_f32_16x16x16_bf16 v[68:71], v[138:139], v[170:171], v[68:71]
    v_mfma_f32_16x16x16_bf16 v[72:75], v[140:141], v[170:171], v[72:75]
    v_mfma_f32_16x16x16_bf16 v[76:79], v[142:143], v[170:171], v[76:79]
    s_nop 9
    s_lshr_b32 s19, s16, 5
    s_and_b32 s20, s16, 31
    s_lshl_b32 s19, s19, 18
    s_lshl_b32 s20, s20, 12
    s_add_u32 s19, s19, s20
    s_add_u32 s19, s19, 0x6800000
    s_add_u32 s20, s19, 0x20000
    v_cvt_pk_bf16_f32 v180, v16, v17
    v_cvt_pk_bf16_f32 v181, v18, v19
    v_cvt_pk_bf16_f32 v182, v20, v21
    v_cvt_pk_bf16_f32 v183, v22, v23
    buffer_store_dwordx4 v[180:183], v2, s[12:15], s19 offen offset:0 sc0 sc1
    v_cvt_pk_bf16_f32 v184, v24, v25
    v_cvt_pk_bf16_f32 v185, v26, v27
    v_cvt_pk_bf16_f32 v186, v28, v29
    v_cvt_pk_bf16_f32 v187, v30, v31
    buffer_store_dwordx4 v[184:187], v2, s[12:15], s19 offen offset:1024 sc0 sc1
    v_cvt_pk_bf16_f32 v180, v32, v33
    v_cvt_pk_bf16_f32 v181, v34, v35
    v_cvt_pk_bf16_f32 v182, v36, v37
    v_cvt_pk_bf16_f32 v183, v38, v39
    buffer_store_dwordx4 v[180:183], v2, s[12:15], s19 offen offset:2048 sc0 sc1
    v_cvt_pk_bf16_f32 v184, v40, v41
    v_cvt_pk_bf16_f32 v185, v42, v43
    v_cvt_pk_bf16_f32 v186, v44, v45
    v_cvt_pk_bf16_f32 v187, v46, v47
    buffer_store_dwordx4 v[184:187], v2, s[12:15], s19 offen offset:3072 sc0 sc1
    v_cvt_pk_bf16_f32 v180, v48, v49
    v_cvt_pk_bf16_f32 v181, v50, v51
    v_cvt_pk_bf16_f32 v182, v52, v53
    v_cvt_pk_bf16_f32 v183, v54, v55
    buffer_store_dwordx4 v[180:183], v2, s[12:15], s20 offen offset:0 sc0 sc1
    v_cvt_pk_bf16_f32 v184, v56, v57
    v_cvt_pk_bf16_f32 v185, v58, v59
    v_cvt_pk_bf16_f32 v186, v60, v61
    v_cvt_pk_bf16_f32 v187, v62, v63
    buffer_store_dwordx4 v[184:187], v2, s[12:15], s20 offen offset:1024 sc0 sc1
    v_cvt_pk_bf16_f32 v180, v64, v65
    v_cvt_pk_bf16_f32 v181, v66, v67
    v_cvt_pk_bf16_f32 v182, v68, v69
    v_cvt_pk_bf16_f32 v183, v70, v71
    buffer_store_dwordx4 v[180:183], v2, s[12:15], s20 offen offset:2048 sc0 sc1
    v_cvt_pk_bf16_f32 v184, v72, v73
    v_cvt_pk_bf16_f32 v185, v74, v75
    v_cvt_pk_bf16_f32 v186, v76, v77
    v_cvt_pk_bf16_f32 v187, v78, v79
    buffer_store_dwordx4 v[184:187], v2, s[12:15], s20 offen offset:3072 sc0 sc1
    s_waitcnt vmcnt(0)
    s_lshr_b32 s19, s52, 1
    s_lshl_b32 s19, s19, 2
    s_add_u32 s19, s19, 0x7906c00
    v_mov_b32 v8, 1
    v_mov_b32 v9, 0
    s_mov_b64 exec, 1
    buffer_atomic_add v8, v9, s[12:15], s19 offen sc1
    s_mov_b64 exec, -1
    s_add_u32 s51, s51, 64
    s_cmp_lt_u32 s51, 512
    s_cbranch_scc1 L_w4_task
    s_branch L_ch_done
.section .rodata,"a"
.p2align 6
.amdhsa_kernel prep_kernel
  .amdhsa_next_free_vgpr 112
  .amdhsa_next_free_sgpr 40
  .amdhsa_accum_offset 112
  .amdhsa_group_segment_fixed_size 0
  .amdhsa_kernarg_size 112
  .amdhsa_user_sgpr_count 2
  .amdhsa_user_sgpr_kernarg_segment_ptr 1
  .amdhsa_system_sgpr_workgroup_id_x 1
.end_amdhsa_kernel
.p2align 6
.amdhsa_kernel chain_kernel
  .amdhsa_next_free_vgpr 512
  .amdhsa_next_free_sgpr 60
  .amdhsa_accum_offset 256
  .amdhsa_group_segment_fixed_size 0
  .amdhsa_kernarg_size 112
  .amdhsa_user_sgpr_count 2
  .amdhsa_user_sgpr_kernarg_segment_ptr 1
  .amdhsa_system_sgpr_workgroup_id_x 1
.end_amdhsa_kernel
```
